```python
import torch

def _softmax(x, axis=-1):
    return torch.softmax(x, dim=axis)

def _gelu(x):
    return torch.nn.functional.gelu(x, approximate='tanh')

def _silu(x):
    return torch.nn.functional.silu(x)

def _sigmoid(x):
    return torch.sigmoid(x)

def _layernorm(x, axis=-1, eps=1e-05):
    m = x.mean(dim=axis, keepdim=True)
    v = x.var(dim=axis, keepdim=True, unbiased=False)
    return (x - m) / torch.sqrt(v + eps)

def _scatter_add(tgt, idx, src, axis=0):
    return tgt.clone().index_add_(axis, idx, src)

def _segment_sum(src, seg, n):
    out = torch.zeros((n,) + src.shape[1:], dtype=src.dtype)
    return out.index_add_(0, seg, src)

def _pad(x, pw):
    flat = tuple((v for pair in reversed(pw) for v in pair))
    return torch.nn.functional.pad(x, flat)
kernel_name = 'adaLN_cond__sliding_block_cached__mixer_s_mlp__prompt'

def setup_inputs():

    _w = lambda a: (lambda t: t.to(torch.bfloat16) if t.is_floating_point() else t)(torch.as_tensor(a))

    def _A_setup():
        B, Sq, D = (1, 2048, 640)
        Hq, Hkv, Sk, Dh = (32, 32, 2048, 128)
        assert Hq % Hkv == 0, (Hq, Hkv)
        return {'x': _w((lambda *s: torch.randn(*s, dtype=torch.bfloat16) * 0.1)(B, Sq, D)), 'k_cache': _w((lambda *s: torch.randn(*s, dtype=torch.bfloat16) * 0.8)(B, Hkv, Sk, Dh)), 'v_cache': _w((lambda *s: torch.randn(*s, dtype=torch.bfloat16) * 0.8)(B, Hkv, Sk, Dh)), 'wq': _w((lambda *s: torch.randn(*s, dtype=torch.bfloat16) * 0.8)(D, Hq * Dh) * D ** (-0.5)), 'wo': _w((lambda *s: torch.randn(*s, dtype=torch.bfloat16) * 0.8)(Hq * Dh, D) * (Hq * Dh) ** (-0.5))}
    _A_in = _A_setup()

    def _B_setup():
        B, S, D, F = (1, 2048, 640, 1728)
        return {'x': _w((lambda *s: torch.randn(*s, dtype=torch.bfloat16) * 0.1)(B, S, D)), 'w1': _w((lambda *s: torch.randn(*s, dtype=torch.bfloat16) * 3.2)(D, D) * D ** (-0.5)), 'w2': _w((lambda *s: torch.randn(*s, dtype=torch.bfloat16) * 3.2)(D, D) * D ** (-0.5)), 'w3': _w((lambda *s: torch.randn(*s, dtype=torch.bfloat16) * 3.2)(D, F) * D ** (-0.5)), 'w4': _w((lambda *s: torch.randn(*s, dtype=torch.bfloat16) * 3.2)(F, D) * F ** (-0.5))}
    _B_in = _B_setup()
    return {'A_x': _A_in['x'], 'A_k_cache': _A_in['k_cache'], 'A_v_cache': _A_in['v_cache'], 'A_wq': _A_in['wq'], 'A_wo': _A_in['wo'], 'B_x': _B_in['x'], 'B_w1': _B_in['w1'], 'B_w2': _B_in['w2'], 'B_w3': _B_in['w3'], 'B_w4': _B_in['w4'], 'c': _w((lambda *s: torch.randn(*s, dtype=torch.bfloat16) * 0.2)(1, 640) * 8.0), 'w_mod': _w((lambda *s: torch.randn(*s, dtype=torch.bfloat16) * 0.2)(640, 6 * 640) * 640 ** (-0.5) * 8.0)}

def reference(A_x, A_k_cache, A_v_cache, A_wq, A_wo, B_x, B_w1, B_w2, B_w3, B_w4, c, w_mod):

    def _A_ref(x, k_cache, v_cache, wq, wo):
        B, Sq, D = x.shape
        Hq, Dh = (32, 128)
        Hkv, Sk = (k_cache.shape[1], k_cache.shape[2])
        W = min(4096, max(256, Sk // 4))
        rep = Hq // Hkv
        q = (lambda x, *d: x.permute(*d))((x @ wq).reshape(B, Sq, Hq, Dh), 0, 2, 1, 3)
        k = (lambda x, n, axis: torch.repeat_interleave(x, n, dim=axis))(k_cache[:, :, Sk - W:, :], rep, axis=1)
        v = (lambda x, n, axis: torch.repeat_interleave(x, n, dim=axis))(v_cache[:, :, Sk - W:, :], rep, axis=1)
        scores = torch.einsum('bhqd,bhkd->bhqk', q, k) * Dh ** (-0.5)
        p = _softmax(scores, axis=-1)
        o = torch.einsum('bhqk,bhkd->bhqd', p, v)
        return (lambda x, *d: x.permute(*d))(o, 0, 2, 1, 3).reshape(B, Sq, Hq * Dh) @ wo

    def _B_ref(x, w1, w2, w3, w4):
        B, S, D = x.shape
        h = _gelu(_layernorm(x, axis=-1) @ w1)
        c = D // 4
        g0 = _pad(h[:, :, 0 * c:1 * c], ((0, 0), (1, 0), (0, 0)))[:, :S, :]
        g1 = _pad(h[:, :, 1 * c:2 * c], ((0, 0), (0, 1), (0, 0)))[:, 1:, :]
        g2 = _pad(h[:, :, 2 * c:3 * c], ((0, 0), (2, 0), (0, 0)))[:, :S, :]
        g3 = _pad(h[:, :, 3 * c:], ((0, 0), (0, 2), (0, 0)))[:, 2:, :]
        hs = torch.concatenate([g0, g1, g2, g3], axis=-1) @ w2
        x1 = x + hs
        h2 = _gelu(_layernorm(x1, axis=-1) @ w3) @ w4
        return x1 + h2
    x = A_x
    mod = (_silu(c) @ w_mod).reshape(c.shape[0], 6, 1, -1)
    sa, ca, ga, sb, cb, gb = (mod[:, 0].clone(), mod[:, 1].clone(), mod[:, 2].clone(), mod[:, 3].clone(), mod[:, 4].clone(), mod[:, 5].clone())
    h = _layernorm(x, axis=-1) * (1 + ca) + sa
    x = x + ga * _A_ref(h, A_k_cache, A_v_cache, A_wq, A_wo)
    h = _layernorm(x, axis=-1) * (1 + cb) + sb
    x = x + gb * _B_ref(h, B_w1, B_w2, B_w3, B_w4)
    return x
```

```asm
; @launch kernel=k0_kernel grid=(263,1,1) block=(256,1,1) lds=20480
; @launch kernel=ka_kernel grid=(256,1,1) block=(256,1,1) lds=163840
; @launch kernel=kb_kernel grid=(256,1,1) block=(256,1,1) lds=163840
.amdgcn_target "amdgcn-amd-amdhsa--gfx950"
.text
.globl k0_kernel
.p2align 8
.type k0_kernel,@function
k0_kernel:
    s_cmp_ge_u32 s2, 255
    s_cbranch_scc1 k0_pref
    s_load_dwordx2 s[4:5], s[0:1], 112
    v_lshrrev_b32 v2, 6, v0
    s_nop 0
    v_readfirstlane_b32 s17, v2
    s_nop 0
    s_cmp_ge_u32 s2, 127
    s_cbranch_scc1 k0_ln
    s_cmp_ge_u32 s2, 100
    s_cbranch_scc1 k0_cs3
    s_cmp_ge_u32 s2, 60
    s_cbranch_scc1 k0_tile
    s_load_dwordx2 s[6:7], s[0:1], 88
    s_load_dwordx2 s[8:9], s[0:1], 80
    v_and_b32 v2, 63, v0
    v_lshrrev_b32 v3, 3, v2
    v_and_b32 v4, 7, v2
    s_mul_i32 s21, s17, 160
    v_add_u32 v5, s21, v3
    s_mov_b32 s22, 7680
    v_mul_lo_u32 v1, v5, s22
    v_lshlrev_b32 v4, 4, v4
    v_add_u32 v1, v1, v4
    s_lshl_b32 s20, s2, 7
    v_lshlrev_b32 v6, 1, v0
    s_waitcnt lgkmcnt(0)
    s_mov_b32 s44, s8
    s_mov_b32 s45, s9
    s_mov_b32 s46, 1280
    s_mov_b32 s47, 0x20000
    s_mov_b32 s40, s6
    s_mov_b32 s41, s7
    s_mov_b32 s42, 4915200
    s_mov_b32 s43, 0x20000
    buffer_load_ushort v120, v6, s[44:47], 0 offen offset:0
    buffer_load_ushort v121, v6, s[44:47], 0 offen offset:512
    buffer_load_ushort v122, v6, s[44:47], 0 offen offset:1024
    buffer_load_dwordx4 v[16:19], v1, s[40:43], s20 offen nt
    s_add_u32 s20, s20, 61440
    buffer_load_dwordx4 v[20:23], v1, s[40:43], s20 offen nt
    s_add_u32 s20, s20, 61440
    buffer_load_dwordx4 v[24:27], v1, s[40:43], s20 offen nt
    s_add_u32 s20, s20, 61440
    buffer_load_dwordx4 v[28:31], v1, s[40:43], s20 offen nt
    s_add_u32 s20, s20, 61440
    buffer_load_dwordx4 v[32:35], v1, s[40:43], s20 offen nt
    s_add_u32 s20, s20, 61440
    buffer_load_dwordx4 v[36:39], v1, s[40:43], s20 offen nt
    s_add_u32 s20, s20, 61440
    buffer_load_dwordx4 v[40:43], v1, s[40:43], s20 offen nt
    s_add_u32 s20, s20, 61440
    buffer_load_dwordx4 v[44:47], v1, s[40:43], s20 offen nt
    s_add_u32 s20, s20, 61440
    buffer_load_dwordx4 v[48:51], v1, s[40:43], s20 offen nt
    s_add_u32 s20, s20, 61440
    buffer_load_dwordx4 v[52:55], v1, s[40:43], s20 offen nt
    s_add_u32 s20, s20, 61440
    buffer_load_dwordx4 v[56:59], v1, s[40:43], s20 offen nt
    s_add_u32 s20, s20, 61440
    buffer_load_dwordx4 v[60:63], v1, s[40:43], s20 offen nt
    s_add_u32 s20, s20, 61440
    buffer_load_dwordx4 v[64:67], v1, s[40:43], s20 offen nt
    s_add_u32 s20, s20, 61440
    buffer_load_dwordx4 v[68:71], v1, s[40:43], s20 offen nt
    s_add_u32 s20, s20, 61440
    buffer_load_dwordx4 v[72:75], v1, s[40:43], s20 offen nt
    s_add_u32 s20, s20, 61440
    buffer_load_dwordx4 v[76:79], v1, s[40:43], s20 offen nt
    s_add_u32 s20, s20, 61440
    buffer_load_dwordx4 v[80:83], v1, s[40:43], s20 offen nt
    s_add_u32 s20, s20, 61440
    buffer_load_dwordx4 v[84:87], v1, s[40:43], s20 offen nt
    s_add_u32 s20, s20, 61440
    buffer_load_dwordx4 v[88:91], v1, s[40:43], s20 offen nt
    s_add_u32 s20, s20, 61440
    buffer_load_dwordx4 v[92:95], v1, s[40:43], s20 offen nt
    s_mov_b32 s12, s4
    s_mov_b32 s13, s5
    s_mov_b32 s14, 49545216
    s_mov_b32 s15, 0x20000
    s_waitcnt vmcnt(20)
    v_lshlrev_b32 v120, 16, v120
    v_lshlrev_b32 v121, 16, v121
    v_lshlrev_b32 v122, 16, v122
    v_mul_f32 v124, 0xbfb8aa3b, v120
    v_mul_f32 v125, 0xbfb8aa3b, v121
    v_mul_f32 v126, 0xbfb8aa3b, v122
    v_exp_f32 v124, v124
    v_exp_f32 v125, v125
    v_exp_f32 v126, v126
    v_add_f32 v124, 1.0, v124
    v_add_f32 v125, 1.0, v125
    v_add_f32 v126, 1.0, v126
    v_rcp_f32 v124, v124
    v_rcp_f32 v125, v125
    v_rcp_f32 v126, v126
    v_mul_f32 v120, v120, v124
    v_mul_f32 v121, v121, v125
    v_mul_f32 v122, v122, v126
    v_cvt_pk_bf16_f32 v120, v120, v120
    v_cvt_pk_bf16_f32 v121, v121, v121
    v_cvt_pk_bf16_f32 v122, v122, v122
    v_and_b32 v120, 0xffff0000, v120
    v_and_b32 v121, 0xffff0000, v121
    v_and_b32 v122, 0xffff0000, v122
    v_lshlrev_b32 v6, 2, v0
    ds_write_b32 v6, v120 offset:0
    ds_write_b32 v6, v121 offset:1024
    ds_write_b32 v6, v122 offset:2048
    s_waitcnt lgkmcnt(0)
    s_barrier
    v_lshlrev_b32 v6, 2, v5
    ds_read_b32 v120, v6 offset:0
    ds_read_b32 v122, v6 offset:32
    ds_read_b32 v124, v6 offset:64
    ds_read_b32 v126, v6 offset:96
    ds_read_b32 v128, v6 offset:128
    ds_read_b32 v130, v6 offset:160
    ds_read_b32 v132, v6 offset:192
    ds_read_b32 v134, v6 offset:224
    ds_read_b32 v136, v6 offset:256
    ds_read_b32 v138, v6 offset:288
    ds_read_b32 v140, v6 offset:320
    ds_read_b32 v142, v6 offset:352
    ds_read_b32 v144, v6 offset:384
    ds_read_b32 v146, v6 offset:416
    ds_read_b32 v148, v6 offset:448
    ds_read_b32 v150, v6 offset:480
    ds_read_b32 v152, v6 offset:512
    ds_read_b32 v154, v6 offset:544
    ds_read_b32 v156, v6 offset:576
    ds_read_b32 v158, v6 offset:608
    s_waitcnt lgkmcnt(0)
    s_waitcnt vmcnt(19)
    v_lshlrev_b32 v110, 16, v16
    v_and_b32 v111, 0xffff0000, v16
    v_pk_mul_f32 v[100:101], v[110:111], v[120:121] op_sel_hi:[1,0]
    v_lshlrev_b32 v112, 16, v17
    v_and_b32 v113, 0xffff0000, v17
    v_pk_mul_f32 v[102:103], v[112:113], v[120:121] op_sel_hi:[1,0]
    v_lshlrev_b32 v110, 16, v18
    v_and_b32 v111, 0xffff0000, v18
    v_pk_mul_f32 v[104:105], v[110:111], v[120:121] op_sel_hi:[1,0]
    v_lshlrev_b32 v112, 16, v19
    v_and_b32 v113, 0xffff0000, v19
    v_pk_mul_f32 v[106:107], v[112:113], v[120:121] op_sel_hi:[1,0]
    s_waitcnt vmcnt(18)
    v_lshlrev_b32 v110, 16, v20
    v_and_b32 v111, 0xffff0000, v20
    v_pk_fma_f32 v[100:101], v[110:111], v[122:123], v[100:101] op_sel_hi:[1,0,1]
    v_lshlrev_b32 v112, 16, v21
    v_and_b32 v113, 0xffff0000, v21
    v_pk_fma_f32 v[102:103], v[112:113], v[122:123], v[102:103] op_sel_hi:[1,0,1]
    v_lshlrev_b32 v110, 16, v22
    v_and_b32 v111, 0xffff0000, v22
    v_pk_fma_f32 v[104:105], v[110:111], v[122:123], v[104:105] op_sel_hi:[1,0,1]
    v_lshlrev_b32 v112, 16, v23
    v_and_b32 v113, 0xffff0000, v23
    v_pk_fma_f32 v[106:107], v[112:113], v[122:123], v[106:107] op_sel_hi:[1,0,1]
    s_waitcnt vmcnt(17)
    v_lshlrev_b32 v110, 16, v24
    v_and_b32 v111, 0xffff0000, v24
    v_pk_fma_f32 v[100:101], v[110:111], v[124:125], v[100:101] op_sel_hi:[1,0,1]
    v_lshlrev_b32 v112, 16, v25
    v_and_b32 v113, 0xffff0000, v25
    v_pk_fma_f32 v[102:103], v[112:113], v[124:125], v[102:103] op_sel_hi:[1,0,1]
    v_lshlrev_b32 v110, 16, v26
    v_and_b32 v111, 0xffff0000, v26
    v_pk_fma_f32 v[104:105], v[110:111], v[124:125], v[104:105] op_sel_hi:[1,0,1]
    v_lshlrev_b32 v112, 16, v27
    v_and_b32 v113, 0xffff0000, v27
    v_pk_fma_f32 v[106:107], v[112:113], v[124:125], v[106:107] op_sel_hi:[1,0,1]
    s_waitcnt vmcnt(16)
    v_lshlrev_b32 v110, 16, v28
    v_and_b32 v111, 0xffff0000, v28
    v_pk_fma_f32 v[100:101], v[110:111], v[126:127], v[100:101] op_sel_hi:[1,0,1]
    v_lshlrev_b32 v112, 16, v29
    v_and_b32 v113, 0xffff0000, v29
    v_pk_fma_f32 v[102:103], v[112:113], v[126:127], v[102:103] op_sel_hi:[1,0,1]
    v_lshlrev_b32 v110, 16, v30
    v_and_b32 v111, 0xffff0000, v30
    v_pk_fma_f32 v[104:105], v[110:111], v[126:127], v[104:105] op_sel_hi:[1,0,1]
    v_lshlrev_b32 v112, 16, v31
    v_and_b32 v113, 0xffff0000, v31
    v_pk_fma_f32 v[106:107], v[112:113], v[126:127], v[106:107] op_sel_hi:[1,0,1]
    s_waitcnt vmcnt(15)
    v_lshlrev_b32 v110, 16, v32
    v_and_b32 v111, 0xffff0000, v32
    v_pk_fma_f32 v[100:101], v[110:111], v[128:129], v[100:101] op_sel_hi:[1,0,1]
    v_lshlrev_b32 v112, 16, v33
    v_and_b32 v113, 0xffff0000, v33
    v_pk_fma_f32 v[102:103], v[112:113], v[128:129], v[102:103] op_sel_hi:[1,0,1]
    v_lshlrev_b32 v110, 16, v34
    v_and_b32 v111, 0xffff0000, v34
    v_pk_fma_f32 v[104:105], v[110:111], v[128:129], v[104:105] op_sel_hi:[1,0,1]
    v_lshlrev_b32 v112, 16, v35
    v_and_b32 v113, 0xffff0000, v35
    v_pk_fma_f32 v[106:107], v[112:113], v[128:129], v[106:107] op_sel_hi:[1,0,1]
    s_waitcnt vmcnt(14)
    v_lshlrev_b32 v110, 16, v36
    v_and_b32 v111, 0xffff0000, v36
    v_pk_fma_f32 v[100:101], v[110:111], v[130:131], v[100:101] op_sel_hi:[1,0,1]
    v_lshlrev_b32 v112, 16, v37
    v_and_b32 v113, 0xffff0000, v37
    v_pk_fma_f32 v[102:103], v[112:113], v[130:131], v[102:103] op_sel_hi:[1,0,1]
    v_lshlrev_b32 v110, 16, v38
    v_and_b32 v111, 0xffff0000, v38
    v_pk_fma_f32 v[104:105], v[110:111], v[130:131], v[104:105] op_sel_hi:[1,0,1]
    v_lshlrev_b32 v112, 16, v39
    v_and_b32 v113, 0xffff0000, v39
    v_pk_fma_f32 v[106:107], v[112:113], v[130:131], v[106:107] op_sel_hi:[1,0,1]
    s_waitcnt vmcnt(13)
    v_lshlrev_b32 v110, 16, v40
    v_and_b32 v111, 0xffff0000, v40
    v_pk_fma_f32 v[100:101], v[110:111], v[132:133], v[100:101] op_sel_hi:[1,0,1]
    v_lshlrev_b32 v112, 16, v41
    v_and_b32 v113, 0xffff0000, v41
    v_pk_fma_f32 v[102:103], v[112:113], v[132:133], v[102:103] op_sel_hi:[1,0,1]
    v_lshlrev_b32 v110, 16, v42
    v_and_b32 v111, 0xffff0000, v42
    v_pk_fma_f32 v[104:105], v[110:111], v[132:133], v[104:105] op_sel_hi:[1,0,1]
    v_lshlrev_b32 v112, 16, v43
    v_and_b32 v113, 0xffff0000, v43
    v_pk_fma_f32 v[106:107], v[112:113], v[132:133], v[106:107] op_sel_hi:[1,0,1]
    s_waitcnt vmcnt(12)
    v_lshlrev_b32 v110, 16, v44
    v_and_b32 v111, 0xffff0000, v44
    v_pk_fma_f32 v[100:101], v[110:111], v[134:135], v[100:101] op_sel_hi:[1,0,1]
    v_lshlrev_b32 v112, 16, v45
    v_and_b32 v113, 0xffff0000, v45
    v_pk_fma_f32 v[102:103], v[112:113], v[134:135], v[102:103] op_sel_hi:[1,0,1]
    v_lshlrev_b32 v110, 16, v46
    v_and_b32 v111, 0xffff0000, v46
    v_pk_fma_f32 v[104:105], v[110:111], v[134:135], v[104:105] op_sel_hi:[1,0,1]
    v_lshlrev_b32 v112, 16, v47
    v_and_b32 v113, 0xffff0000, v47
    v_pk_fma_f32 v[106:107], v[112:113], v[134:135], v[106:107] op_sel_hi:[1,0,1]
    s_waitcnt vmcnt(11)
    v_lshlrev_b32 v110, 16, v48
    v_and_b32 v111, 0xffff0000, v48
    v_pk_fma_f32 v[100:101], v[110:111], v[136:137], v[100:101] op_sel_hi:[1,0,1]
    v_lshlrev_b32 v112, 16, v49
    v_and_b32 v113, 0xffff0000, v49
    v_pk_fma_f32 v[102:103], v[112:113], v[136:137], v[102:103] op_sel_hi:[1,0,1]
    v_lshlrev_b32 v110, 16, v50
    v_and_b32 v111, 0xffff0000, v50
    v_pk_fma_f32 v[104:105], v[110:111], v[136:137], v[104:105] op_sel_hi:[1,0,1]
    v_lshlrev_b32 v112, 16, v51
    v_and_b32 v113, 0xffff0000, v51
    v_pk_fma_f32 v[106:107], v[112:113], v[136:137], v[106:107] op_sel_hi:[1,0,1]
    s_waitcnt vmcnt(10)
    v_lshlrev_b32 v110, 16, v52
    v_and_b32 v111, 0xffff0000, v52
    v_pk_fma_f32 v[100:101], v[110:111], v[138:139], v[100:101] op_sel_hi:[1,0,1]
    v_lshlrev_b32 v112, 16, v53
    v_and_b32 v113, 0xffff0000, v53
    v_pk_fma_f32 v[102:103], v[112:113], v[138:139], v[102:103] op_sel_hi:[1,0,1]
    v_lshlrev_b32 v110, 16, v54
    v_and_b32 v111, 0xffff0000, v54
    v_pk_fma_f32 v[104:105], v[110:111], v[138:139], v[104:105] op_sel_hi:[1,0,1]
    v_lshlrev_b32 v112, 16, v55
    v_and_b32 v113, 0xffff0000, v55
    v_pk_fma_f32 v[106:107], v[112:113], v[138:139], v[106:107] op_sel_hi:[1,0,1]
    s_waitcnt vmcnt(9)
    v_lshlrev_b32 v110, 16, v56
    v_and_b32 v111, 0xffff0000, v56
    v_pk_fma_f32 v[100:101], v[110:111], v[140:141], v[100:101] op_sel_hi:[1,0,1]
    v_lshlrev_b32 v112, 16, v57
    v_and_b32 v113, 0xffff0000, v57
    v_pk_fma_f32 v[102:103], v[112:113], v[140:141], v[102:103] op_sel_hi:[1,0,1]
    v_lshlrev_b32 v110, 16, v58
    v_and_b32 v111, 0xffff0000, v58
    v_pk_fma_f32 v[104:105], v[110:111], v[140:141], v[104:105] op_sel_hi:[1,0,1]
    v_lshlrev_b32 v112, 16, v59
    v_and_b32 v113, 0xffff0000, v59
    v_pk_fma_f32 v[106:107], v[112:113], v[140:141], v[106:107] op_sel_hi:[1,0,1]
    s_waitcnt vmcnt(8)
    v_lshlrev_b32 v110, 16, v60
    v_and_b32 v111, 0xffff0000, v60
    v_pk_fma_f32 v[100:101], v[110:111], v[142:143], v[100:101] op_sel_hi:[1,0,1]
    v_lshlrev_b32 v112, 16, v61
    v_and_b32 v113, 0xffff0000, v61
    v_pk_fma_f32 v[102:103], v[112:113], v[142:143], v[102:103] op_sel_hi:[1,0,1]
    v_lshlrev_b32 v110, 16, v62
    v_and_b32 v111, 0xffff0000, v62
    v_pk_fma_f32 v[104:105], v[110:111], v[142:143], v[104:105] op_sel_hi:[1,0,1]
    v_lshlrev_b32 v112, 16, v63
    v_and_b32 v113, 0xffff0000, v63
    v_pk_fma_f32 v[106:107], v[112:113], v[142:143], v[106:107] op_sel_hi:[1,0,1]
    s_waitcnt vmcnt(7)
    v_lshlrev_b32 v110, 16, v64
    v_and_b32 v111, 0xffff0000, v64
    v_pk_fma_f32 v[100:101], v[110:111], v[144:145], v[100:101] op_sel_hi:[1,0,1]
    v_lshlrev_b32 v112, 16, v65
    v_and_b32 v113, 0xffff0000, v65
    v_pk_fma_f32 v[102:103], v[112:113], v[144:145], v[102:103] op_sel_hi:[1,0,1]
    v_lshlrev_b32 v110, 16, v66
    v_and_b32 v111, 0xffff0000, v66
    v_pk_fma_f32 v[104:105], v[110:111], v[144:145], v[104:105] op_sel_hi:[1,0,1]
    v_lshlrev_b32 v112, 16, v67
    v_and_b32 v113, 0xffff0000, v67
    v_pk_fma_f32 v[106:107], v[112:113], v[144:145], v[106:107] op_sel_hi:[1,0,1]
    s_waitcnt vmcnt(6)
    v_lshlrev_b32 v110, 16, v68
    v_and_b32 v111, 0xffff0000, v68
    v_pk_fma_f32 v[100:101], v[110:111], v[146:147], v[100:101] op_sel_hi:[1,0,1]
    v_lshlrev_b32 v112, 16, v69
    v_and_b32 v113, 0xffff0000, v69
    v_pk_fma_f32 v[102:103], v[112:113], v[146:147], v[102:103] op_sel_hi:[1,0,1]
    v_lshlrev_b32 v110, 16, v70
    v_and_b32 v111, 0xffff0000, v70
    v_pk_fma_f32 v[104:105], v[110:111], v[146:147], v[104:105] op_sel_hi:[1,0,1]
    v_lshlrev_b32 v112, 16, v71
    v_and_b32 v113, 0xffff0000, v71
    v_pk_fma_f32 v[106:107], v[112:113], v[146:147], v[106:107] op_sel_hi:[1,0,1]
    s_waitcnt vmcnt(5)
    v_lshlrev_b32 v110, 16, v72
    v_and_b32 v111, 0xffff0000, v72
    v_pk_fma_f32 v[100:101], v[110:111], v[148:149], v[100:101] op_sel_hi:[1,0,1]
    v_lshlrev_b32 v112, 16, v73
    v_and_b32 v113, 0xffff0000, v73
    v_pk_fma_f32 v[102:103], v[112:113], v[148:149], v[102:103] op_sel_hi:[1,0,1]
    v_lshlrev_b32 v110, 16, v74
    v_and_b32 v111, 0xffff0000, v74
    v_pk_fma_f32 v[104:105], v[110:111], v[148:149], v[104:105] op_sel_hi:[1,0,1]
    v_lshlrev_b32 v112, 16, v75
    v_and_b32 v113, 0xffff0000, v75
    v_pk_fma_f32 v[106:107], v[112:113], v[148:149], v[106:107] op_sel_hi:[1,0,1]
    s_waitcnt vmcnt(4)
    v_lshlrev_b32 v110, 16, v76
    v_and_b32 v111, 0xffff0000, v76
    v_pk_fma_f32 v[100:101], v[110:111], v[150:151], v[100:101] op_sel_hi:[1,0,1]
    v_lshlrev_b32 v112, 16, v77
    v_and_b32 v113, 0xffff0000, v77
    v_pk_fma_f32 v[102:103], v[112:113], v[150:151], v[102:103] op_sel_hi:[1,0,1]
    v_lshlrev_b32 v110, 16, v78
    v_and_b32 v111, 0xffff0000, v78
    v_pk_fma_f32 v[104:105], v[110:111], v[150:151], v[104:105] op_sel_hi:[1,0,1]
    v_lshlrev_b32 v112, 16, v79
    v_and_b32 v113, 0xffff0000, v79
    v_pk_fma_f32 v[106:107], v[112:113], v[150:151], v[106:107] op_sel_hi:[1,0,1]
    s_waitcnt vmcnt(3)
    v_lshlrev_b32 v110, 16, v80
    v_and_b32 v111, 0xffff0000, v80
    v_pk_fma_f32 v[100:101], v[110:111], v[152:153], v[100:101] op_sel_hi:[1,0,1]
    v_lshlrev_b32 v112, 16, v81
    v_and_b32 v113, 0xffff0000, v81
    v_pk_fma_f32 v[102:103], v[112:113], v[152:153], v[102:103] op_sel_hi:[1,0,1]
    v_lshlrev_b32 v110, 16, v82
    v_and_b32 v111, 0xffff0000, v82
    v_pk_fma_f32 v[104:105], v[110:111], v[152:153], v[104:105] op_sel_hi:[1,0,1]
    v_lshlrev_b32 v112, 16, v83
    v_and_b32 v113, 0xffff0000, v83
    v_pk_fma_f32 v[106:107], v[112:113], v[152:153], v[106:107] op_sel_hi:[1,0,1]
    s_waitcnt vmcnt(2)
    v_lshlrev_b32 v110, 16, v84
    v_and_b32 v111, 0xffff0000, v84
    v_pk_fma_f32 v[100:101], v[110:111], v[154:155], v[100:101] op_sel_hi:[1,0,1]
    v_lshlrev_b32 v112, 16, v85
    v_and_b32 v113, 0xffff0000, v85
    v_pk_fma_f32 v[102:103], v[112:113], v[154:155], v[102:103] op_sel_hi:[1,0,1]
    v_lshlrev_b32 v110, 16, v86
    v_and_b32 v111, 0xffff0000, v86
    v_pk_fma_f32 v[104:105], v[110:111], v[154:155], v[104:105] op_sel_hi:[1,0,1]
    v_lshlrev_b32 v112, 16, v87
    v_and_b32 v113, 0xffff0000, v87
    v_pk_fma_f32 v[106:107], v[112:113], v[154:155], v[106:107] op_sel_hi:[1,0,1]
    s_waitcnt vmcnt(1)
    v_lshlrev_b32 v110, 16, v88
    v_and_b32 v111, 0xffff0000, v88
    v_pk_fma_f32 v[100:101], v[110:111], v[156:157], v[100:101] op_sel_hi:[1,0,1]
    v_lshlrev_b32 v112, 16, v89
    v_and_b32 v113, 0xffff0000, v89
    v_pk_fma_f32 v[102:103], v[112:113], v[156:157], v[102:103] op_sel_hi:[1,0,1]
    v_lshlrev_b32 v110, 16, v90
    v_and_b32 v111, 0xffff0000, v90
    v_pk_fma_f32 v[104:105], v[110:111], v[156:157], v[104:105] op_sel_hi:[1,0,1]
    v_lshlrev_b32 v112, 16, v91
    v_and_b32 v113, 0xffff0000, v91
    v_pk_fma_f32 v[106:107], v[112:113], v[156:157], v[106:107] op_sel_hi:[1,0,1]
    s_waitcnt vmcnt(0)
    v_lshlrev_b32 v110, 16, v92
    v_and_b32 v111, 0xffff0000, v92
    v_pk_fma_f32 v[100:101], v[110:111], v[158:159], v[100:101] op_sel_hi:[1,0,1]
    v_lshlrev_b32 v112, 16, v93
    v_and_b32 v113, 0xffff0000, v93
    v_pk_fma_f32 v[102:103], v[112:113], v[158:159], v[102:103] op_sel_hi:[1,0,1]
    v_lshlrev_b32 v110, 16, v94
    v_and_b32 v111, 0xffff0000, v94
    v_pk_fma_f32 v[104:105], v[110:111], v[158:159], v[104:105] op_sel_hi:[1,0,1]
    v_lshlrev_b32 v112, 16, v95
    v_and_b32 v113, 0xffff0000, v95
    v_pk_fma_f32 v[106:107], v[112:113], v[158:159], v[106:107] op_sel_hi:[1,0,1]
    s_nop 1
    v_add_f32_dpp v100, v100, v100 row_ror:8 row_mask:0xf bank_mask:0xf
    v_add_f32_dpp v101, v101, v101 row_ror:8 row_mask:0xf bank_mask:0xf
    v_add_f32_dpp v102, v102, v102 row_ror:8 row_mask:0xf bank_mask:0xf
    v_add_f32_dpp v103, v103, v103 row_ror:8 row_mask:0xf bank_mask:0xf
    v_add_f32_dpp v104, v104, v104 row_ror:8 row_mask:0xf bank_mask:0xf
    v_add_f32_dpp v105, v105, v105 row_ror:8 row_mask:0xf bank_mask:0xf
    v_add_f32_dpp v106, v106, v106 row_ror:8 row_mask:0xf bank_mask:0xf
    v_add_f32_dpp v107, v107, v107 row_ror:8 row_mask:0xf bank_mask:0xf
    v_mov_b32 v110, v100
    v_mov_b32 v111, v101
    v_mov_b32 v112, v102
    v_mov_b32 v113, v103
    v_mov_b32 v114, v104
    v_mov_b32 v115, v105
    v_mov_b32 v116, v106
    v_mov_b32 v117, v107
    s_nop 0
    v_permlane16_swap_b32 v100, v110
    v_permlane16_swap_b32 v101, v111
    v_permlane16_swap_b32 v102, v112
    v_permlane16_swap_b32 v103, v113
    v_permlane16_swap_b32 v104, v114
    v_permlane16_swap_b32 v105, v115
    v_permlane16_swap_b32 v106, v116
    v_permlane16_swap_b32 v107, v117
    s_nop 0
    v_add_f32 v100, v100, v110
    v_add_f32 v101, v101, v111
    v_add_f32 v102, v102, v112
    v_add_f32 v103, v103, v113
    v_add_f32 v104, v104, v114
    v_add_f32 v105, v105, v115
    v_add_f32 v106, v106, v116
    v_add_f32 v107, v107, v117
    v_mov_b32 v110, v100
    v_mov_b32 v111, v101
    v_mov_b32 v112, v102
    v_mov_b32 v113, v103
    v_mov_b32 v114, v104
    v_mov_b32 v115, v105
    v_mov_b32 v116, v106
    v_mov_b32 v117, v107
    s_nop 0
    v_permlane32_swap_b32 v100, v110
    v_permlane32_swap_b32 v101, v111
    v_permlane32_swap_b32 v102, v112
    v_permlane32_swap_b32 v103, v113
    v_permlane32_swap_b32 v104, v114
    v_permlane32_swap_b32 v105, v115
    v_permlane32_swap_b32 v106, v116
    v_permlane32_swap_b32 v107, v117
    s_nop 0
    v_add_f32 v100, v100, v110
    v_add_f32 v101, v101, v111
    v_add_f32 v102, v102, v112
    v_add_f32 v103, v103, v113
    v_add_f32 v104, v104, v114
    v_add_f32 v105, v105, v115
    v_add_f32 v106, v106, v116
    v_add_f32 v107, v107, v117
    v_and_b32 v2, 63, v0
    v_lshlrev_b32 v6, 5, v2
    s_lshl_b32 s21, s17, 8
    v_add_u32 v6, s21, v6
    v_cmp_gt_u32 vcc, 8, v2
    s_and_saveexec_b64 s[24:25], vcc
    ds_write_b128 v6, v[100:103] offset:4096
    ds_write_b128 v6, v[104:107] offset:4112
    s_mov_b64 exec, s[24:25]
    s_waitcnt lgkmcnt(0)
    s_barrier
    s_cmp_ge_u32 s17, 1
    s_cbranch_scc1 k0_end
    v_lshlrev_b32 v6, 2, v0
    ds_read_b32 v8, v6 offset:4096
    ds_read_b32 v9, v6 offset:4352
    ds_read_b32 v10, v6 offset:4608
    ds_read_b32 v11, v6 offset:4864
    s_waitcnt lgkmcnt(0)
    v_add_f32 v8, v8, v9
    v_add_f32 v10, v10, v11
    v_add_f32 v8, v8, v10
    v_cvt_pk_bf16_f32 v8, v8, v8
    v_and_b32 v8, 0xffff0000, v8
    s_mul_hi_u32 s26, s2, 429496730
    v_add_f32 v9, 1.0, v8
    v_cvt_pk_bf16_f32 v9, v9, v9
    v_and_b32 v9, 0xffff0000, v9
    v_mul_f32 v10, 0x3e0293ee, v8
    s_cmp_eq_u32 s26, 0
    s_cselect_b64 vcc, -1, 0
    v_cndmask_b32 v8, v8, v10, vcc
    s_cmp_eq_u32 s26, 1
    s_cselect_b64 vcc, -1, 0
    v_cndmask_b32 v8, v8, v9, vcc
    s_cmp_eq_u32 s26, 4
    s_cselect_b64 vcc, -1, 0
    v_cndmask_b32 v8, v8, v9, vcc
    s_lshl_b32 s27, s2, 8
    buffer_store_dword v8, v6, s[12:15], s27 offen
    s_sub_u32 s27, s26, 3
    s_cmp_le_u32 s27, 1
    s_cbranch_scc0 k0_gdone
    s_xor_b32 s27, s27, 1
    s_mul_i32 s28, s26, 10
    s_sub_u32 s28, s2, s28
    s_lshl_b32 s28, s28, 6
    v_add_u32 v11, s28, v0
    v_lshrrev_b32 v12, 5, v11
    v_mul_u32_u24 v12, 6144, v12
    v_bfe_u32 v13, v11, 2, 2
    v_lshlrev_b32 v13, 8, v13
    v_add_u32 v12, v12, v13
    v_bfe_u32 v13, v11, 4, 1
    v_lshlrev_b32 v13, 3, v13
    v_add_u32 v12, v12, v13
    v_and_b32 v13, 3, v11
    v_lshlrev_b32 v13, 1, v13
    v_add_u32 v12, v12, v13
    s_lshl_b32 s27, s27, 4
    s_add_u32 s27, s27, 23532544
    buffer_store_short_d16_hi v8, v12, s[12:15], s27 offen
    s_add_u32 s27, s27, 122880
    buffer_store_short_d16_hi v8, v12, s[12:15], s27 offen
    s_add_u32 s27, s27, 122880
    buffer_store_short_d16_hi v8, v12, s[12:15], s27 offen
    s_add_u32 s27, s27, 122880
    buffer_store_short_d16_hi v8, v12, s[12:15], s27 offen
    s_add_u32 s27, s27, 122880
    buffer_store_short_d16_hi v8, v12, s[12:15], s27 offen
    s_add_u32 s27, s27, 122880
    buffer_store_short_d16_hi v8, v12, s[12:15], s27 offen
    s_add_u32 s27, s27, 122880
    buffer_store_short_d16_hi v8, v12, s[12:15], s27 offen
    s_add_u32 s27, s27, 122880
    buffer_store_short_d16_hi v8, v12, s[12:15], s27 offen
k0_gdone:
    s_endpgm
k0_ln:
    s_load_dwordx2 s[6:7], s[0:1], 0
    s_load_dwordx2 s[10:11], s[0:1], 24
    v_and_b32 v2, 63, v0
    v_lshrrev_b32 v3, 4, v2
    s_sub_u32 s20, s2, 127
    s_lshr_b32 s20, s20, 3
    s_lshl_b32 s20, s20, 2
    s_and_b32 s21, s2, 7
    s_lshr_b32 s22, s21, 1
    s_add_u32 s20, s20, s22
    s_and_b32 s21, s21, 1
    s_lshl_b32 s21, s21, 6
    s_add_u32 s20, s20, s21
    s_lshl_b32 s20, s20, 4
    s_lshl_b32 s21, s17, 2
    s_add_u32 s20, s20, s21
    v_add_u32 v3, s20, v3
    v_and_b32 v4, 15, v2
    v_mul_u32_u24 v5, 1280, v3
    v_lshlrev_b32 v6, 4, v4
    v_add_u32 v5, v5, v6
    s_waitcnt lgkmcnt(0)
    s_mov_b32 s12, s4
    s_mov_b32 s13, s5
    s_mov_b32 s14, 49545216
    s_mov_b32 s15, 0x20000
    s_mov_b32 s40, s6
    s_mov_b32 s41, s7
    s_mov_b32 s42, 2621440
    s_mov_b32 s43, 0x20000
    buffer_load_dwordx4 v[16:19], v5, s[40:43], 0 offen offset:0
    buffer_load_dwordx4 v[20:23], v5, s[40:43], 0 offen offset:256
    buffer_load_dwordx4 v[24:27], v5, s[40:43], 0 offen offset:512
    buffer_load_dwordx4 v[28:31], v5, s[40:43], 0 offen offset:768
    buffer_load_dwordx4 v[32:35], v5, s[40:43], 0 offen offset:1024
    s_getpc_b64 s[20:21]
k0_kernel_pc_1:
    s_add_u32 s20, s20, ka_kernel-k0_kernel_pc_1
    s_addc_u32 s21, s21, 0
    s_sub_u32 s22, s2, 127
    s_lshr_b32 s22, s22, 3
    s_mul_i32 s23, s22, 8192
    s_min_u32 s23, s23, code_end-ka_kernel-8192
    s_add_u32 s20, s20, s23
    s_addc_u32 s21, s21, 0
    v_lshlrev_b32 v8, 4, v0
    global_load_dwordx4 v[100:103], v8, s[20:21]
    v_add_u32 v8, 0x1000, v8
    global_load_dwordx4 v[100:103], v8, s[20:21]
    v_lshrrev_b32 v9, 7, v0
    v_lshlrev_b32 v9, 13, v9
    v_and_b32 v10, 127, v0
    v_lshlrev_b32 v10, 4, v10
    v_add_u32 v9, v9, v10
    s_and_b32 s23, s2, 7
    s_lshr_b32 s23, s23, 1
    s_lshl_b32 s23, s23, 11
    s_mul_i32 s22, s22, 131072
    s_add_u32 s23, s23, s22
    s_mov_b32 s44, s10
    s_mov_b32 s45, s11
    s_mov_b32 s46, 5242880
    s_mov_b32 s47, 0x20000
    buffer_load_dwordx4 v[104:107], v9, s[44:47], s23 offen
    s_add_u32 s23, s23, 16384
    buffer_load_dwordx4 v[104:107], v9, s[44:47], s23 offen
    s_add_u32 s23, s23, 16384
    buffer_load_dwordx4 v[104:107], v9, s[44:47], s23 offen
    s_add_u32 s23, s23, 16384
    buffer_load_dwordx4 v[104:107], v9, s[44:47], s23 offen
    s_add_u32 s23, s23, 16384
    buffer_load_dwordx4 v[104:107], v9, s[44:47], s23 offen
    s_add_u32 s23, s23, 16384
    buffer_load_dwordx4 v[104:107], v9, s[44:47], s23 offen
    s_add_u32 s23, s23, 16384
    buffer_load_dwordx4 v[104:107], v9, s[44:47], s23 offen
    s_add_u32 s23, s23, 16384
    buffer_load_dwordx4 v[104:107], v9, s[44:47], s23 offen
    s_add_u32 s23, s23, 16384
    v_lshrrev_b32 v5, 5, v3
    v_mul_u32_u24 v5, 40960, v5
    v_lshrrev_b32 v6, 1, v4
    v_lshlrev_b32 v6, 10, v6
    v_add_u32 v5, v5, v6
    v_and_b32 v6, 1, v4
    v_lshlrev_b32 v6, 9, v6
    v_add_u32 v5, v5, v6
    v_and_b32 v6, 31, v3
    v_lshlrev_b32 v6, 4, v6
    v_add_u32 v5, v5, v6
    s_waitcnt vmcnt(10)
    v_lshlrev_b32 v40, 16, v16
    v_and_b32 v41, 0xffff0000, v16
    v_lshlrev_b32 v42, 16, v17
    v_and_b32 v43, 0xffff0000, v17
    v_lshlrev_b32 v44, 16, v18
    v_and_b32 v45, 0xffff0000, v18
    v_lshlrev_b32 v46, 16, v19
    v_and_b32 v47, 0xffff0000, v19
    v_lshlrev_b32 v48, 16, v20
    v_and_b32 v49, 0xffff0000, v20
    v_lshlrev_b32 v50, 16, v21
    v_and_b32 v51, 0xffff0000, v21
    v_lshlrev_b32 v52, 16, v22
    v_and_b32 v53, 0xffff0000, v22
    v_lshlrev_b32 v54, 16, v23
    v_and_b32 v55, 0xffff0000, v23
    v_lshlrev_b32 v56, 16, v24
    v_and_b32 v57, 0xffff0000, v24
    v_lshlrev_b32 v58, 16, v25
    v_and_b32 v59, 0xffff0000, v25
    v_lshlrev_b32 v60, 16, v26
    v_and_b32 v61, 0xffff0000, v26
    v_lshlrev_b32 v62, 16, v27
    v_and_b32 v63, 0xffff0000, v27
    v_lshlrev_b32 v64, 16, v28
    v_and_b32 v65, 0xffff0000, v28
    v_lshlrev_b32 v66, 16, v29
    v_and_b32 v67, 0xffff0000, v29
    v_lshlrev_b32 v68, 16, v30
    v_and_b32 v69, 0xffff0000, v30
    v_lshlrev_b32 v70, 16, v31
    v_and_b32 v71, 0xffff0000, v31
    v_lshlrev_b32 v72, 16, v32
    v_and_b32 v73, 0xffff0000, v32
    v_lshlrev_b32 v74, 16, v33
    v_and_b32 v75, 0xffff0000, v33
    v_lshlrev_b32 v76, 16, v34
    v_and_b32 v77, 0xffff0000, v34
    v_lshlrev_b32 v78, 16, v35
    v_and_b32 v79, 0xffff0000, v35
    v_pk_add_f32 v[10:11], v[40:41], v[42:43]
    v_pk_mul_f32 v[12:13], v[40:41], v[40:41]
    v_pk_fma_f32 v[12:13], v[42:43], v[42:43], v[12:13]
    v_pk_add_f32 v[10:11], v[10:11], v[44:45]
    v_pk_fma_f32 v[12:13], v[44:45], v[44:45], v[12:13]
    v_pk_add_f32 v[10:11], v[10:11], v[46:47]
    v_pk_fma_f32 v[12:13], v[46:47], v[46:47], v[12:13]
    v_pk_add_f32 v[10:11], v[10:11], v[48:49]
    v_pk_fma_f32 v[12:13], v[48:49], v[48:49], v[12:13]
    v_pk_add_f32 v[10:11], v[10:11], v[50:51]
    v_pk_fma_f32 v[12:13], v[50:51], v[50:51], v[12:13]
    v_pk_add_f32 v[10:11], v[10:11], v[52:53]
    v_pk_fma_f32 v[12:13], v[52:53], v[52:53], v[12:13]
    v_pk_add_f32 v[10:11], v[10:11], v[54:55]
    v_pk_fma_f32 v[12:13], v[54:55], v[54:55], v[12:13]
    v_pk_add_f32 v[10:11], v[10:11], v[56:57]
    v_pk_fma_f32 v[12:13], v[56:57], v[56:57], v[12:13]
    v_pk_add_f32 v[10:11], v[10:11], v[58:59]
    v_pk_fma_f32 v[12:13], v[58:59], v[58:59], v[12:13]
    v_pk_add_f32 v[10:11], v[10:11], v[60:61]
    v_pk_fma_f32 v[12:13], v[60:61], v[60:61], v[12:13]
    v_pk_add_f32 v[10:11], v[10:11], v[62:63]
    v_pk_fma_f32 v[12:13], v[62:63], v[62:63], v[12:13]
    v_pk_add_f32 v[10:11], v[10:11], v[64:65]
    v_pk_fma_f32 v[12:13], v[64:65], v[64:65], v[12:13]
    v_pk_add_f32 v[10:11], v[10:11], v[66:67]
    v_pk_fma_f32 v[12:13], v[66:67], v[66:67], v[12:13]
    v_pk_add_f32 v[10:11], v[10:11], v[68:69]
    v_pk_fma_f32 v[12:13], v[68:69], v[68:69], v[12:13]
    v_pk_add_f32 v[10:11], v[10:11], v[70:71]
    v_pk_fma_f32 v[12:13], v[70:71], v[70:71], v[12:13]
    v_pk_add_f32 v[10:11], v[10:11], v[72:73]
    v_pk_fma_f32 v[12:13], v[72:73], v[72:73], v[12:13]
    v_pk_add_f32 v[10:11], v[10:11], v[74:75]
    v_pk_fma_f32 v[12:13], v[74:75], v[74:75], v[12:13]
    v_pk_add_f32 v[10:11], v[10:11], v[76:77]
    v_pk_fma_f32 v[12:13], v[76:77], v[76:77], v[12:13]
    v_pk_add_f32 v[10:11], v[10:11], v[78:79]
    v_pk_fma_f32 v[12:13], v[78:79], v[78:79], v[12:13]
    v_add_f32 v10, v10, v11
    v_add_f32 v11, v12, v13
    s_nop 1
    v_add_f32_dpp v10, v10, v10 row_ror:8 row_mask:0xf bank_mask:0xf
    v_add_f32_dpp v11, v11, v11 row_ror:8 row_mask:0xf bank_mask:0xf
    s_nop 1
    v_add_f32_dpp v10, v10, v10 row_ror:4 row_mask:0xf bank_mask:0xf
    v_add_f32_dpp v11, v11, v11 row_ror:4 row_mask:0xf bank_mask:0xf
    s_nop 1
    v_add_f32_dpp v10, v10, v10 row_ror:2 row_mask:0xf bank_mask:0xf
    v_add_f32_dpp v11, v11, v11 row_ror:2 row_mask:0xf bank_mask:0xf
    s_nop 1
    v_add_f32_dpp v10, v10, v10 row_ror:1 row_mask:0xf bank_mask:0xf
    v_add_f32_dpp v11, v11, v11 row_ror:1 row_mask:0xf bank_mask:0xf
    v_mul_f32 v10, 0x3acccccd, v10
    v_mul_f32 v11, 0x3acccccd, v11
    v_fma_f32 v11, -v10, v10, v11
    v_max_f32 v11, 0, v11
    v_add_f32 v11, 0x3727c5ac, v11
    v_rsq_f32 v11, v11
    s_nop 0
    v_mul_f32 v12, 0x3e0293ee, v11
    v_mul_f32 v14, v10, v12
    v_sub_f32 v14, 0, v14
    v_pk_fma_f32 v[40:41], v[40:41], v[12:13], v[14:15] op_sel_hi:[1,0,0]
    v_pk_fma_f32 v[42:43], v[42:43], v[12:13], v[14:15] op_sel_hi:[1,0,0]
    v_pk_fma_f32 v[44:45], v[44:45], v[12:13], v[14:15] op_sel_hi:[1,0,0]
    v_pk_fma_f32 v[46:47], v[46:47], v[12:13], v[14:15] op_sel_hi:[1,0,0]
    v_pk_fma_f32 v[48:49], v[48:49], v[12:13], v[14:15] op_sel_hi:[1,0,0]
    v_pk_fma_f32 v[50:51], v[50:51], v[12:13], v[14:15] op_sel_hi:[1,0,0]
    v_pk_fma_f32 v[52:53], v[52:53], v[12:13], v[14:15] op_sel_hi:[1,0,0]
    v_pk_fma_f32 v[54:55], v[54:55], v[12:13], v[14:15] op_sel_hi:[1,0,0]
    v_pk_fma_f32 v[56:57], v[56:57], v[12:13], v[14:15] op_sel_hi:[1,0,0]
    v_pk_fma_f32 v[58:59], v[58:59], v[12:13], v[14:15] op_sel_hi:[1,0,0]
    v_pk_fma_f32 v[60:61], v[60:61], v[12:13], v[14:15] op_sel_hi:[1,0,0]
    v_pk_fma_f32 v[62:63], v[62:63], v[12:13], v[14:15] op_sel_hi:[1,0,0]
    v_pk_fma_f32 v[64:65], v[64:65], v[12:13], v[14:15] op_sel_hi:[1,0,0]
    v_pk_fma_f32 v[66:67], v[66:67], v[12:13], v[14:15] op_sel_hi:[1,0,0]
    v_pk_fma_f32 v[68:69], v[68:69], v[12:13], v[14:15] op_sel_hi:[1,0,0]
    v_pk_fma_f32 v[70:71], v[70:71], v[12:13], v[14:15] op_sel_hi:[1,0,0]
    v_pk_fma_f32 v[72:73], v[72:73], v[12:13], v[14:15] op_sel_hi:[1,0,0]
    v_pk_fma_f32 v[74:75], v[74:75], v[12:13], v[14:15] op_sel_hi:[1,0,0]
    v_pk_fma_f32 v[76:77], v[76:77], v[12:13], v[14:15] op_sel_hi:[1,0,0]
    v_pk_fma_f32 v[78:79], v[78:79], v[12:13], v[14:15] op_sel_hi:[1,0,0]
    v_cvt_pk_f16_f32 v16, v40, v41
    v_cvt_pk_f16_f32 v17, v42, v43
    v_cvt_pk_f16_f32 v18, v44, v45
    v_cvt_pk_f16_f32 v19, v46, v47
    v_cvt_pk_f16_f32 v20, v48, v49
    v_cvt_pk_f16_f32 v21, v50, v51
    v_cvt_pk_f16_f32 v22, v52, v53
    v_cvt_pk_f16_f32 v23, v54, v55
    v_cvt_pk_f16_f32 v24, v56, v57
    v_cvt_pk_f16_f32 v25, v58, v59
    v_cvt_pk_f16_f32 v26, v60, v61
    v_cvt_pk_f16_f32 v27, v62, v63
    v_cvt_pk_f16_f32 v28, v64, v65
    v_cvt_pk_f16_f32 v29, v66, v67
    v_cvt_pk_f16_f32 v30, v68, v69
    v_cvt_pk_f16_f32 v31, v70, v71
    v_cvt_pk_f16_f32 v32, v72, v73
    v_cvt_pk_f16_f32 v33, v74, v75
    v_cvt_pk_f16_f32 v34, v76, v77
    v_cvt_pk_f16_f32 v35, v78, v79
    s_mov_b32 s20, 65536
    buffer_store_dwordx4 v[16:19], v5, s[12:15], s20 offen
    s_mov_b32 s20, 73728
    buffer_store_dwordx4 v[20:23], v5, s[12:15], s20 offen
    s_mov_b32 s20, 81920
    buffer_store_dwordx4 v[24:27], v5, s[12:15], s20 offen
    s_mov_b32 s20, 90112
    buffer_store_dwordx4 v[28:31], v5, s[12:15], s20 offen
    s_mov_b32 s20, 98304
    buffer_store_dwordx4 v[32:35], v5, s[12:15], s20 offen
    s_endpgm
k0_cs3:
    s_load_dwordx2 s[6:7], s[0:1], 64
    s_sub_u32 s3, s2, 100
    v_and_b32 v2, 63, v0
    v_lshrrev_b32 v3, 3, v2
    v_and_b32 v4, 7, v2
    s_mul_i32 s21, s17, 160
    v_add_u32 v5, s21, v3
    s_mov_b32 s22, 3456
    v_mul_lo_u32 v1, v5, s22
    v_lshlrev_b32 v4, 4, v4
    v_add_u32 v1, v1, v4
    s_lshl_b32 s20, s3, 7
    s_waitcnt lgkmcnt(0)
    s_mov_b32 s12, s4
    s_mov_b32 s13, s5
    s_mov_b32 s14, 49545216
    s_mov_b32 s15, 0x20000
    s_mov_b32 s40, s6
    s_mov_b32 s41, s7
    s_mov_b32 s42, 2211840
    s_mov_b32 s43, 0x20000
    buffer_load_dwordx4 v[16:19], v1, s[40:43], s20 offen
    s_add_u32 s20, s20, 27648
    buffer_load_dwordx4 v[20:23], v1, s[40:43], s20 offen
    s_add_u32 s20, s20, 27648
    buffer_load_dwordx4 v[24:27], v1, s[40:43], s20 offen
    s_add_u32 s20, s20, 27648
    buffer_load_dwordx4 v[28:31], v1, s[40:43], s20 offen
    s_add_u32 s20, s20, 27648
    buffer_load_dwordx4 v[32:35], v1, s[40:43], s20 offen
    s_add_u32 s20, s20, 27648
    buffer_load_dwordx4 v[36:39], v1, s[40:43], s20 offen
    s_add_u32 s20, s20, 27648
    buffer_load_dwordx4 v[40:43], v1, s[40:43], s20 offen
    s_add_u32 s20, s20, 27648
    buffer_load_dwordx4 v[44:47], v1, s[40:43], s20 offen
    s_add_u32 s20, s20, 27648
    buffer_load_dwordx4 v[48:51], v1, s[40:43], s20 offen
    s_add_u32 s20, s20, 27648
    buffer_load_dwordx4 v[52:55], v1, s[40:43], s20 offen
    s_add_u32 s20, s20, 27648
    buffer_load_dwordx4 v[56:59], v1, s[40:43], s20 offen
    s_add_u32 s20, s20, 27648
    buffer_load_dwordx4 v[60:63], v1, s[40:43], s20 offen
    s_add_u32 s20, s20, 27648
    buffer_load_dwordx4 v[64:67], v1, s[40:43], s20 offen
    s_add_u32 s20, s20, 27648
    buffer_load_dwordx4 v[68:71], v1, s[40:43], s20 offen
    s_add_u32 s20, s20, 27648
    buffer_load_dwordx4 v[72:75], v1, s[40:43], s20 offen
    s_add_u32 s20, s20, 27648
    buffer_load_dwordx4 v[76:79], v1, s[40:43], s20 offen
    s_add_u32 s20, s20, 27648
    buffer_load_dwordx4 v[80:83], v1, s[40:43], s20 offen
    s_add_u32 s20, s20, 27648
    buffer_load_dwordx4 v[84:87], v1, s[40:43], s20 offen
    s_add_u32 s20, s20, 27648
    buffer_load_dwordx4 v[88:91], v1, s[40:43], s20 offen
    s_add_u32 s20, s20, 27648
    buffer_load_dwordx4 v[92:95], v1, s[40:43], s20 offen
    v_mov_b32 v100, 0
    v_mov_b32 v101, 0
    v_mov_b32 v102, 0
    v_mov_b32 v103, 0
    v_mov_b32 v104, 0
    v_mov_b32 v105, 0
    v_mov_b32 v106, 0
    v_mov_b32 v107, 0
    s_waitcnt vmcnt(19)
    v_lshlrev_b32 v110, 16, v16
    v_and_b32 v111, 0xffff0000, v16
    v_pk_add_f32 v[100:101], v[100:101], v[110:111]
    v_lshlrev_b32 v112, 16, v17
    v_and_b32 v113, 0xffff0000, v17
    v_pk_add_f32 v[102:103], v[102:103], v[112:113]
    v_lshlrev_b32 v110, 16, v18
    v_and_b32 v111, 0xffff0000, v18
    v_pk_add_f32 v[104:105], v[104:105], v[110:111]
    v_lshlrev_b32 v112, 16, v19
    v_and_b32 v113, 0xffff0000, v19
    v_pk_add_f32 v[106:107], v[106:107], v[112:113]
    s_waitcnt vmcnt(18)
    v_lshlrev_b32 v110, 16, v20
    v_and_b32 v111, 0xffff0000, v20
    v_pk_add_f32 v[100:101], v[100:101], v[110:111]
    v_lshlrev_b32 v112, 16, v21
    v_and_b32 v113, 0xffff0000, v21
    v_pk_add_f32 v[102:103], v[102:103], v[112:113]
    v_lshlrev_b32 v110, 16, v22
    v_and_b32 v111, 0xffff0000, v22
    v_pk_add_f32 v[104:105], v[104:105], v[110:111]
    v_lshlrev_b32 v112, 16, v23
    v_and_b32 v113, 0xffff0000, v23
    v_pk_add_f32 v[106:107], v[106:107], v[112:113]
    s_waitcnt vmcnt(17)
    v_lshlrev_b32 v110, 16, v24
    v_and_b32 v111, 0xffff0000, v24
    v_pk_add_f32 v[100:101], v[100:101], v[110:111]
    v_lshlrev_b32 v112, 16, v25
    v_and_b32 v113, 0xffff0000, v25
    v_pk_add_f32 v[102:103], v[102:103], v[112:113]
    v_lshlrev_b32 v110, 16, v26
    v_and_b32 v111, 0xffff0000, v26
    v_pk_add_f32 v[104:105], v[104:105], v[110:111]
    v_lshlrev_b32 v112, 16, v27
    v_and_b32 v113, 0xffff0000, v27
    v_pk_add_f32 v[106:107], v[106:107], v[112:113]
    s_waitcnt vmcnt(16)
    v_lshlrev_b32 v110, 16, v28
    v_and_b32 v111, 0xffff0000, v28
    v_pk_add_f32 v[100:101], v[100:101], v[110:111]
    v_lshlrev_b32 v112, 16, v29
    v_and_b32 v113, 0xffff0000, v29
    v_pk_add_f32 v[102:103], v[102:103], v[112:113]
    v_lshlrev_b32 v110, 16, v30
    v_and_b32 v111, 0xffff0000, v30
    v_pk_add_f32 v[104:105], v[104:105], v[110:111]
    v_lshlrev_b32 v112, 16, v31
    v_and_b32 v113, 0xffff0000, v31
    v_pk_add_f32 v[106:107], v[106:107], v[112:113]
    s_waitcnt vmcnt(15)
    v_lshlrev_b32 v110, 16, v32
    v_and_b32 v111, 0xffff0000, v32
    v_pk_add_f32 v[100:101], v[100:101], v[110:111]
    v_lshlrev_b32 v112, 16, v33
    v_and_b32 v113, 0xffff0000, v33
    v_pk_add_f32 v[102:103], v[102:103], v[112:113]
    v_lshlrev_b32 v110, 16, v34
    v_and_b32 v111, 0xffff0000, v34
    v_pk_add_f32 v[104:105], v[104:105], v[110:111]
    v_lshlrev_b32 v112, 16, v35
    v_and_b32 v113, 0xffff0000, v35
    v_pk_add_f32 v[106:107], v[106:107], v[112:113]
    s_waitcnt vmcnt(14)
    v_lshlrev_b32 v110, 16, v36
    v_and_b32 v111, 0xffff0000, v36
    v_pk_add_f32 v[100:101], v[100:101], v[110:111]
    v_lshlrev_b32 v112, 16, v37
    v_and_b32 v113, 0xffff0000, v37
    v_pk_add_f32 v[102:103], v[102:103], v[112:113]
    v_lshlrev_b32 v110, 16, v38
    v_and_b32 v111, 0xffff0000, v38
    v_pk_add_f32 v[104:105], v[104:105], v[110:111]
    v_lshlrev_b32 v112, 16, v39
    v_and_b32 v113, 0xffff0000, v39
    v_pk_add_f32 v[106:107], v[106:107], v[112:113]
    s_waitcnt vmcnt(13)
    v_lshlrev_b32 v110, 16, v40
    v_and_b32 v111, 0xffff0000, v40
    v_pk_add_f32 v[100:101], v[100:101], v[110:111]
    v_lshlrev_b32 v112, 16, v41
    v_and_b32 v113, 0xffff0000, v41
    v_pk_add_f32 v[102:103], v[102:103], v[112:113]
    v_lshlrev_b32 v110, 16, v42
    v_and_b32 v111, 0xffff0000, v42
    v_pk_add_f32 v[104:105], v[104:105], v[110:111]
    v_lshlrev_b32 v112, 16, v43
    v_and_b32 v113, 0xffff0000, v43
    v_pk_add_f32 v[106:107], v[106:107], v[112:113]
    s_waitcnt vmcnt(12)
    v_lshlrev_b32 v110, 16, v44
    v_and_b32 v111, 0xffff0000, v44
    v_pk_add_f32 v[100:101], v[100:101], v[110:111]
    v_lshlrev_b32 v112, 16, v45
    v_and_b32 v113, 0xffff0000, v45
    v_pk_add_f32 v[102:103], v[102:103], v[112:113]
    v_lshlrev_b32 v110, 16, v46
    v_and_b32 v111, 0xffff0000, v46
    v_pk_add_f32 v[104:105], v[104:105], v[110:111]
    v_lshlrev_b32 v112, 16, v47
    v_and_b32 v113, 0xffff0000, v47
    v_pk_add_f32 v[106:107], v[106:107], v[112:113]
    s_waitcnt vmcnt(11)
    v_lshlrev_b32 v110, 16, v48
    v_and_b32 v111, 0xffff0000, v48
    v_pk_add_f32 v[100:101], v[100:101], v[110:111]
    v_lshlrev_b32 v112, 16, v49
    v_and_b32 v113, 0xffff0000, v49
    v_pk_add_f32 v[102:103], v[102:103], v[112:113]
    v_lshlrev_b32 v110, 16, v50
    v_and_b32 v111, 0xffff0000, v50
    v_pk_add_f32 v[104:105], v[104:105], v[110:111]
    v_lshlrev_b32 v112, 16, v51
    v_and_b32 v113, 0xffff0000, v51
    v_pk_add_f32 v[106:107], v[106:107], v[112:113]
    s_waitcnt vmcnt(10)
    v_lshlrev_b32 v110, 16, v52
    v_and_b32 v111, 0xffff0000, v52
    v_pk_add_f32 v[100:101], v[100:101], v[110:111]
    v_lshlrev_b32 v112, 16, v53
    v_and_b32 v113, 0xffff0000, v53
    v_pk_add_f32 v[102:103], v[102:103], v[112:113]
    v_lshlrev_b32 v110, 16, v54
    v_and_b32 v111, 0xffff0000, v54
    v_pk_add_f32 v[104:105], v[104:105], v[110:111]
    v_lshlrev_b32 v112, 16, v55
    v_and_b32 v113, 0xffff0000, v55
    v_pk_add_f32 v[106:107], v[106:107], v[112:113]
    s_waitcnt vmcnt(9)
    v_lshlrev_b32 v110, 16, v56
    v_and_b32 v111, 0xffff0000, v56
    v_pk_add_f32 v[100:101], v[100:101], v[110:111]
    v_lshlrev_b32 v112, 16, v57
    v_and_b32 v113, 0xffff0000, v57
    v_pk_add_f32 v[102:103], v[102:103], v[112:113]
    v_lshlrev_b32 v110, 16, v58
    v_and_b32 v111, 0xffff0000, v58
    v_pk_add_f32 v[104:105], v[104:105], v[110:111]
    v_lshlrev_b32 v112, 16, v59
    v_and_b32 v113, 0xffff0000, v59
    v_pk_add_f32 v[106:107], v[106:107], v[112:113]
    s_waitcnt vmcnt(8)
    v_lshlrev_b32 v110, 16, v60
    v_and_b32 v111, 0xffff0000, v60
    v_pk_add_f32 v[100:101], v[100:101], v[110:111]
    v_lshlrev_b32 v112, 16, v61
    v_and_b32 v113, 0xffff0000, v61
    v_pk_add_f32 v[102:103], v[102:103], v[112:113]
    v_lshlrev_b32 v110, 16, v62
    v_and_b32 v111, 0xffff0000, v62
    v_pk_add_f32 v[104:105], v[104:105], v[110:111]
    v_lshlrev_b32 v112, 16, v63
    v_and_b32 v113, 0xffff0000, v63
    v_pk_add_f32 v[106:107], v[106:107], v[112:113]
    s_waitcnt vmcnt(7)
    v_lshlrev_b32 v110, 16, v64
    v_and_b32 v111, 0xffff0000, v64
    v_pk_add_f32 v[100:101], v[100:101], v[110:111]
    v_lshlrev_b32 v112, 16, v65
    v_and_b32 v113, 0xffff0000, v65
    v_pk_add_f32 v[102:103], v[102:103], v[112:113]
    v_lshlrev_b32 v110, 16, v66
    v_and_b32 v111, 0xffff0000, v66
    v_pk_add_f32 v[104:105], v[104:105], v[110:111]
    v_lshlrev_b32 v112, 16, v67
    v_and_b32 v113, 0xffff0000, v67
    v_pk_add_f32 v[106:107], v[106:107], v[112:113]
    s_waitcnt vmcnt(6)
    v_lshlrev_b32 v110, 16, v68
    v_and_b32 v111, 0xffff0000, v68
    v_pk_add_f32 v[100:101], v[100:101], v[110:111]
    v_lshlrev_b32 v112, 16, v69
    v_and_b32 v113, 0xffff0000, v69
    v_pk_add_f32 v[102:103], v[102:103], v[112:113]
    v_lshlrev_b32 v110, 16, v70
    v_and_b32 v111, 0xffff0000, v70
    v_pk_add_f32 v[104:105], v[104:105], v[110:111]
    v_lshlrev_b32 v112, 16, v71
    v_and_b32 v113, 0xffff0000, v71
    v_pk_add_f32 v[106:107], v[106:107], v[112:113]
    s_waitcnt vmcnt(5)
    v_lshlrev_b32 v110, 16, v72
    v_and_b32 v111, 0xffff0000, v72
    v_pk_add_f32 v[100:101], v[100:101], v[110:111]
    v_lshlrev_b32 v112, 16, v73
    v_and_b32 v113, 0xffff0000, v73
    v_pk_add_f32 v[102:103], v[102:103], v[112:113]
    v_lshlrev_b32 v110, 16, v74
    v_and_b32 v111, 0xffff0000, v74
    v_pk_add_f32 v[104:105], v[104:105], v[110:111]
    v_lshlrev_b32 v112, 16, v75
    v_and_b32 v113, 0xffff0000, v75
    v_pk_add_f32 v[106:107], v[106:107], v[112:113]
    s_waitcnt vmcnt(4)
    v_lshlrev_b32 v110, 16, v76
    v_and_b32 v111, 0xffff0000, v76
    v_pk_add_f32 v[100:101], v[100:101], v[110:111]
    v_lshlrev_b32 v112, 16, v77
    v_and_b32 v113, 0xffff0000, v77
    v_pk_add_f32 v[102:103], v[102:103], v[112:113]
    v_lshlrev_b32 v110, 16, v78
    v_and_b32 v111, 0xffff0000, v78
    v_pk_add_f32 v[104:105], v[104:105], v[110:111]
    v_lshlrev_b32 v112, 16, v79
    v_and_b32 v113, 0xffff0000, v79
    v_pk_add_f32 v[106:107], v[106:107], v[112:113]
    s_waitcnt vmcnt(3)
    v_lshlrev_b32 v110, 16, v80
    v_and_b32 v111, 0xffff0000, v80
    v_pk_add_f32 v[100:101], v[100:101], v[110:111]
    v_lshlrev_b32 v112, 16, v81
    v_and_b32 v113, 0xffff0000, v81
    v_pk_add_f32 v[102:103], v[102:103], v[112:113]
    v_lshlrev_b32 v110, 16, v82
    v_and_b32 v111, 0xffff0000, v82
    v_pk_add_f32 v[104:105], v[104:105], v[110:111]
    v_lshlrev_b32 v112, 16, v83
    v_and_b32 v113, 0xffff0000, v83
    v_pk_add_f32 v[106:107], v[106:107], v[112:113]
    s_waitcnt vmcnt(2)
    v_lshlrev_b32 v110, 16, v84
    v_and_b32 v111, 0xffff0000, v84
    v_pk_add_f32 v[100:101], v[100:101], v[110:111]
    v_lshlrev_b32 v112, 16, v85
    v_and_b32 v113, 0xffff0000, v85
    v_pk_add_f32 v[102:103], v[102:103], v[112:113]
    v_lshlrev_b32 v110, 16, v86
    v_and_b32 v111, 0xffff0000, v86
    v_pk_add_f32 v[104:105], v[104:105], v[110:111]
    v_lshlrev_b32 v112, 16, v87
    v_and_b32 v113, 0xffff0000, v87
    v_pk_add_f32 v[106:107], v[106:107], v[112:113]
    s_waitcnt vmcnt(1)
    v_lshlrev_b32 v110, 16, v88
    v_and_b32 v111, 0xffff0000, v88
    v_pk_add_f32 v[100:101], v[100:101], v[110:111]
    v_lshlrev_b32 v112, 16, v89
    v_and_b32 v113, 0xffff0000, v89
    v_pk_add_f32 v[102:103], v[102:103], v[112:113]
    v_lshlrev_b32 v110, 16, v90
    v_and_b32 v111, 0xffff0000, v90
    v_pk_add_f32 v[104:105], v[104:105], v[110:111]
    v_lshlrev_b32 v112, 16, v91
    v_and_b32 v113, 0xffff0000, v91
    v_pk_add_f32 v[106:107], v[106:107], v[112:113]
    s_waitcnt vmcnt(0)
    v_lshlrev_b32 v110, 16, v92
    v_and_b32 v111, 0xffff0000, v92
    v_pk_add_f32 v[100:101], v[100:101], v[110:111]
    v_lshlrev_b32 v112, 16, v93
    v_and_b32 v113, 0xffff0000, v93
    v_pk_add_f32 v[102:103], v[102:103], v[112:113]
    v_lshlrev_b32 v110, 16, v94
    v_and_b32 v111, 0xffff0000, v94
    v_pk_add_f32 v[104:105], v[104:105], v[110:111]
    v_lshlrev_b32 v112, 16, v95
    v_and_b32 v113, 0xffff0000, v95
    v_pk_add_f32 v[106:107], v[106:107], v[112:113]
    s_nop 1
    v_add_f32_dpp v100, v100, v100 row_ror:8 row_mask:0xf bank_mask:0xf
    v_add_f32_dpp v101, v101, v101 row_ror:8 row_mask:0xf bank_mask:0xf
    v_add_f32_dpp v102, v102, v102 row_ror:8 row_mask:0xf bank_mask:0xf
    v_add_f32_dpp v103, v103, v103 row_ror:8 row_mask:0xf bank_mask:0xf
    v_add_f32_dpp v104, v104, v104 row_ror:8 row_mask:0xf bank_mask:0xf
    v_add_f32_dpp v105, v105, v105 row_ror:8 row_mask:0xf bank_mask:0xf
    v_add_f32_dpp v106, v106, v106 row_ror:8 row_mask:0xf bank_mask:0xf
    v_add_f32_dpp v107, v107, v107 row_ror:8 row_mask:0xf bank_mask:0xf
    v_mov_b32 v110, v100
    v_mov_b32 v111, v101
    v_mov_b32 v112, v102
    v_mov_b32 v113, v103
    v_mov_b32 v114, v104
    v_mov_b32 v115, v105
    v_mov_b32 v116, v106
    v_mov_b32 v117, v107
    s_nop 0
    v_permlane16_swap_b32 v100, v110
    v_permlane16_swap_b32 v101, v111
    v_permlane16_swap_b32 v102, v112
    v_permlane16_swap_b32 v103, v113
    v_permlane16_swap_b32 v104, v114
    v_permlane16_swap_b32 v105, v115
    v_permlane16_swap_b32 v106, v116
    v_permlane16_swap_b32 v107, v117
    s_nop 0
    v_add_f32 v100, v100, v110
    v_add_f32 v101, v101, v111
    v_add_f32 v102, v102, v112
    v_add_f32 v103, v103, v113
    v_add_f32 v104, v104, v114
    v_add_f32 v105, v105, v115
    v_add_f32 v106, v106, v116
    v_add_f32 v107, v107, v117
    v_mov_b32 v110, v100
    v_mov_b32 v111, v101
    v_mov_b32 v112, v102
    v_mov_b32 v113, v103
    v_mov_b32 v114, v104
    v_mov_b32 v115, v105
    v_mov_b32 v116, v106
    v_mov_b32 v117, v107
    s_nop 0
    v_permlane32_swap_b32 v100, v110
    v_permlane32_swap_b32 v101, v111
    v_permlane32_swap_b32 v102, v112
    v_permlane32_swap_b32 v103, v113
    v_permlane32_swap_b32 v104, v114
    v_permlane32_swap_b32 v105, v115
    v_permlane32_swap_b32 v106, v116
    v_permlane32_swap_b32 v107, v117
    s_nop 0
    v_add_f32 v100, v100, v110
    v_add_f32 v101, v101, v111
    v_add_f32 v102, v102, v112
    v_add_f32 v103, v103, v113
    v_add_f32 v104, v104, v114
    v_add_f32 v105, v105, v115
    v_add_f32 v106, v106, v116
    v_add_f32 v107, v107, v117
    v_and_b32 v2, 63, v0
    v_lshlrev_b32 v6, 5, v2
    s_lshl_b32 s21, s17, 8
    v_add_u32 v6, s21, v6
    v_cmp_gt_u32 vcc, 8, v2
    s_and_saveexec_b64 s[24:25], vcc
    ds_write_b128 v6, v[100:103] offset:4096
    ds_write_b128 v6, v[104:107] offset:4112
    s_mov_b64 exec, s[24:25]
    s_waitcnt lgkmcnt(0)
    s_barrier
    s_cmp_ge_u32 s17, 1
    s_cbranch_scc1 k0_end
    v_lshlrev_b32 v6, 2, v0
    ds_read_b32 v8, v6 offset:4096
    ds_read_b32 v9, v6 offset:4352
    ds_read_b32 v10, v6 offset:4608
    ds_read_b32 v11, v6 offset:4864
    s_waitcnt lgkmcnt(0)
    v_add_f32 v8, v8, v9
    v_add_f32 v10, v10, v11
    v_add_f32 v8, v8, v10
    s_lshl_b32 s26, s3, 8
    s_add_u32 s26, s26, 24576
    buffer_store_dword v8, v6, s[12:15], s26 offen
    s_endpgm
k0_tile:
    s_load_dwordx2 s[8:9], s[0:1], 48
    s_sub_u32 s3, s2, 60
    s_lshl_b32 s3, s3, 2
    s_add_u32 s3, s3, s17
    s_mul_hi_u32 s24, s3, 214748365
    s_mul_i32 s25, s24, 20
    s_sub_u32 s25, s3, s25
    s_mul_i32 s26, s25, 40960
    s_mul_i32 s27, s24, 160
    s_add_u32 s26, s26, s27
    s_mul_i32 s28, s17, 5120
    v_and_b32 v2, 63, v0
    v_add_u32 v3, 0, v2
    v_mul_u32_u24 v4, 6554, v3
    v_lshrrev_b32 v4, 16, v4
    v_mul_u32_u24 v5, 10, v4
    v_sub_u32 v5, v3, v5
    v_mul_u32_u24 v4, 1280, v4
    v_lshl_add_u32 v8, v5, 4, v4
    v_add_u32 v3, 64, v2
    v_mul_u32_u24 v4, 6554, v3
    v_lshrrev_b32 v4, 16, v4
    v_mul_u32_u24 v5, 10, v4
    v_sub_u32 v5, v3, v5
    v_mul_u32_u24 v4, 1280, v4
    v_lshl_add_u32 v9, v5, 4, v4
    v_add_u32 v3, 128, v2
    v_mul_u32_u24 v4, 6554, v3
    v_lshrrev_b32 v4, 16, v4
    v_mul_u32_u24 v5, 10, v4
    v_sub_u32 v5, v3, v5
    v_mul_u32_u24 v4, 1280, v4
    v_lshl_add_u32 v10, v5, 4, v4
    v_add_u32 v3, 192, v2
    v_mul_u32_u24 v4, 6554, v3
    v_lshrrev_b32 v4, 16, v4
    v_mul_u32_u24 v5, 10, v4
    v_sub_u32 v5, v3, v5
    v_mul_u32_u24 v4, 1280, v4
    v_lshl_add_u32 v11, v5, 4, v4
    v_add_u32 v3, 256, v2
    v_mul_u32_u24 v4, 6554, v3
    v_lshrrev_b32 v4, 16, v4
    v_mul_u32_u24 v5, 10, v4
    v_sub_u32 v5, v3, v5
    v_mul_u32_u24 v4, 1280, v4
    v_lshl_add_u32 v12, v5, 4, v4
    s_waitcnt lgkmcnt(0)
    s_mov_b32 s40, s8
    s_mov_b32 s41, s9
    s_mov_b32 s42, 819200
    s_mov_b32 s43, 0x20000
    s_add_u32 m0, s28, 0
    s_nop 0
    buffer_load_dwordx4 v8, s[40:43], s26 offen nt lds
    s_add_u32 m0, s28, 1024
    s_nop 0
    buffer_load_dwordx4 v9, s[40:43], s26 offen nt lds
    s_add_u32 m0, s28, 2048
    s_nop 0
    buffer_load_dwordx4 v10, s[40:43], s26 offen nt lds
    s_add_u32 m0, s28, 3072
    s_nop 0
    buffer_load_dwordx4 v11, s[40:43], s26 offen nt lds
    s_add_u32 m0, s28, 4096
    s_nop 0
    buffer_load_dwordx4 v12, s[40:43], s26 offen nt lds
    s_mov_b32 s12, s4
    s_mov_b32 s13, s5
    s_mov_b32 s14, 49545216
    s_mov_b32 s15, 0x20000
    v_lshrrev_b32 v3, 4, v2
    v_bfe_u32 v4, v2, 2, 2
    v_and_b32 v5, 3, v2
    v_lshlrev_b32 v5, 3, v5
    v_lshlrev_b32 v3, 2, v3
    v_add_u32 v3, v3, v4
    v_mul_u32_u24 v3, 160, v3
    v_add3_u32 v3, v3, v5, s28
    v_lshlrev_b32 v6, 4, v2
    s_mul_i32 s27, s3, 6144
    s_add_u32 s27, s27, 23527424
    s_add_u32 s29, s27, 4096
    v_and_b32 v14, 15, v2
    v_cmp_eq_u32 vcc, 2, v14
    v_mov_b32 v15, 0x3f803f80
    s_nop 0
    v_cndmask_b32 v36, 0, v15, vcc
    v_mov_b32 v37, v36
    v_mov_b32 v38, v36
    v_mov_b32 v39, v36
    v_cmp_lt_u32 vcc, 1, v14
    s_and_saveexec_b64 s[30:31], vcc
    buffer_store_dwordx4 v[36:39], v6, s[12:15], s29 offen offset:1024
    s_mov_b64 exec, s[30:31]
    s_waitcnt vmcnt(1)
    ds_read_b64_tr_b16 v[16:17], v3 offset:0
    ds_read_b64_tr_b16 v[18:19], v3 offset:2560
    ds_read_b64_tr_b16 v[20:21], v3 offset:32
    ds_read_b64_tr_b16 v[22:23], v3 offset:2592
    ds_read_b64_tr_b16 v[24:25], v3 offset:64
    ds_read_b64_tr_b16 v[26:27], v3 offset:2624
    ds_read_b64_tr_b16 v[28:29], v3 offset:96
    ds_read_b64_tr_b16 v[30:31], v3 offset:2656
    ds_read_b64_tr_b16 v[32:33], v3 offset:128
    ds_read_b64_tr_b16 v[34:35], v3 offset:2688
    s_waitcnt lgkmcnt(0)
    buffer_store_dwordx4 v[16:19], v6, s[12:15], s27 offen offset:0
    buffer_store_dwordx4 v[20:23], v6, s[12:15], s27 offen offset:1024
    buffer_store_dwordx4 v[24:27], v6, s[12:15], s27 offen offset:2048
    buffer_store_dwordx4 v[28:31], v6, s[12:15], s27 offen offset:3072
    buffer_store_dwordx4 v[32:35], v6, s[12:15], s29 offen
    s_endpgm
k0_pref:
    s_cmp_ge_u32 s2, 263
    s_cbranch_scc1 k0_end
    s_load_dwordx2 s[8:9], s[0:1], 112
    s_sub_u32 s3, s2, 255
    s_lshl_b32 s3, s3, 12
    s_add_u32 s3, s3, 32768
    v_lshlrev_b32 v2, 4, v0
    v_mov_b32 v8, 0
    v_mov_b32 v9, 0
    v_mov_b32 v10, 0
    v_mov_b32 v11, 0
    s_waitcnt lgkmcnt(0)
    s_mov_b32 s12, s8
    s_mov_b32 s13, s9
    s_mov_b32 s14, 49545216
    s_mov_b32 s15, 0x20000
    buffer_store_dwordx4 v[8:11], v2, s[12:15], s3 offen
k0_end:
    s_endpgm
.globl ka_kernel
.p2align 8
.type ka_kernel,@function
ka_kernel:
    s_cmp_ge_u32 s2, 256
    s_cbranch_scc1 ka_end
    s_load_dwordx2 s[4:5], s[0:1], 24
    s_load_dwordx2 s[6:7], s[0:1], 8
    s_load_dwordx2 s[8:9], s[0:1], 16
    s_load_dwordx2 s[10:11], s[0:1], 112
    s_load_dwordx2 s[56:57], s[0:1], 32
    s_load_dwordx2 s[58:59], s[0:1], 56
    s_load_dwordx2 s[60:61], s[0:1], 64
    s_load_dwordx2 s[62:63], s[0:1], 72
    v_lshrrev_b32 v30, 6, v0
    s_nop 0
    v_readfirstlane_b32 s32, v30
    s_nop 0
    s_and_b32 s41, s2, 7
    s_lshr_b32 s42, s2, 3
    s_and_b32 s43, s41, 1
    s_lshl_b32 s43, s43, 2
    s_and_b32 s44, s42, 3
    s_add_u32 s34, s43, s44
    s_lshr_b32 s43, s41, 1
    s_lshl_b32 s43, s43, 3
    s_lshr_b32 s44, s42, 2
    s_add_u32 s33, s43, s44
    v_and_b32 v32, 63, v0
    v_lshlrev_b32 v1, 4, v32
    v_add_u32 v2, 40960, v1
    v_lshrrev_b32 v33, 4, v32
    v_and_b32 v34, 15, v32
    v_lshlrev_b32 v35, 2, v33
    v_xor_b32 v35, v34, v35
    v_lshlrev_b32 v35, 4, v35
    v_lshlrev_b32 v36, 13, v33
    v_add_u32 v3, v36, v35
    v_add_u32 v4, 31744, v3
    v_add_u32 v5, 63488, v3
    v_add_u32 v6, 95232, v3
    s_lshl_b32 s41, s34, 3
    s_lshl_b32 s42, s32, 1
    s_add_u32 s41, s41, s42
    s_mul_i32 s35, s41, 40960
    s_lshl_b32 s38, s32, 12
    s_lshl_b32 s36, s32, 17
    s_lshl_b32 s45, s33, 8
    s_waitcnt lgkmcnt(0)
    s_add_u32 s12, s4, s45
    s_addc_u32 s13, s5, 0
    s_sub_u32 s14, 5242880, s45
    s_mov_b32 s15, 0x20000
    s_add_u32 s24, s10, 65536
    s_addc_u32 s25, s11, 0
    s_mov_b32 s26, 2621440
    s_mov_b32 s27, 0x20000
    s_mov_b32 s48, s10
    s_mov_b32 s49, s11
    s_mov_b32 s50, 49545216
    s_mov_b32 s51, 0x20000
    s_add_u32 m0, s38, 98304
    s_add_u32 s39, s36, 0
    buffer_load_dwordx4 v3, s[12:15], s39 offen offset:0 nt lds
    buffer_load_dwordx4 v4, s[12:15], s39 offen offset:1024 nt lds
    buffer_load_dwordx4 v5, s[12:15], s39 offen offset:2048 nt lds
    buffer_load_dwordx4 v6, s[12:15], s39 offen offset:3072 nt lds
    s_add_u32 s46, s35, 0
    s_add_u32 s47, s35, 4096
    buffer_load_dwordx4 v[48:51], v1, s[24:27], s46 offen offset:0
    buffer_load_dwordx4 v[52:55], v2, s[24:27], s46 offen offset:0
    s_lshl_b32 s41, s32, 10
    s_add_u32 m0, s41, 32768
    s_add_u32 s42, s41, 0
    buffer_load_dwordx4 v1, s[48:51], s42 offen lds
    s_mov_b32 m0, 36864
    s_mov_b32 s42, 4096
    buffer_load_dwordx4 v1, s[48:51], s42 offen lds
    buffer_load_dwordx4 v[56:59], v1, s[24:27], s46 offen offset:1024
    buffer_load_dwordx4 v[60:63], v2, s[24:27], s46 offen offset:1024
    buffer_load_dwordx4 v[64:67], v1, s[24:27], s46 offen offset:2048
    buffer_load_dwordx4 v[68:71], v2, s[24:27], s46 offen offset:2048
    s_add_u32 m0, s38, 114688
    s_add_u32 s39, s36, 524288
    buffer_load_dwordx4 v3, s[12:15], s39 offen offset:0 nt lds
    buffer_load_dwordx4 v4, s[12:15], s39 offen offset:1024 nt lds
    buffer_load_dwordx4 v5, s[12:15], s39 offen offset:2048 nt lds
    buffer_load_dwordx4 v6, s[12:15], s39 offen offset:3072 nt lds
    buffer_load_dwordx4 v[72:75], v1, s[24:27], s46 offen offset:3072
    buffer_load_dwordx4 v[76:79], v2, s[24:27], s46 offen offset:3072
    buffer_load_dwordx4 v[80:83], v1, s[24:27], s47 offen offset:0
    buffer_load_dwordx4 v[84:87], v2, s[24:27], s47 offen offset:0
    buffer_load_dwordx4 v[88:91], v1, s[24:27], s47 offen offset:1024
    buffer_load_dwordx4 v[92:95], v2, s[24:27], s47 offen offset:1024
    buffer_load_dwordx4 v[96:99], v1, s[24:27], s47 offen offset:2048
    buffer_load_dwordx4 v[100:103], v2, s[24:27], s47 offen offset:2048
    buffer_load_dwordx4 v[104:107], v1, s[24:27], s47 offen offset:3072
    buffer_load_dwordx4 v[108:111], v2, s[24:27], s47 offen offset:3072
    s_add_u32 m0, s38, 131072
    s_add_u32 s39, s36, 1048576
    buffer_load_dwordx4 v3, s[12:15], s39 offen offset:0 nt lds
    buffer_load_dwordx4 v4, s[12:15], s39 offen offset:1024 nt lds
    buffer_load_dwordx4 v5, s[12:15], s39 offen offset:2048 nt lds
    buffer_load_dwordx4 v6, s[12:15], s39 offen offset:3072 nt lds
    s_add_u32 m0, s38, 147456
    s_add_u32 s39, s36, 1572864
    buffer_load_dwordx4 v3, s[12:15], s39 offen offset:0 nt lds
    buffer_load_dwordx4 v4, s[12:15], s39 offen offset:1024 nt lds
    buffer_load_dwordx4 v5, s[12:15], s39 offen offset:2048 nt lds
    buffer_load_dwordx4 v6, s[12:15], s39 offen offset:3072 nt lds
    s_lshl_b32 s53, s32, 13
    s_add_u32 s53, s53, 131072
    s_lshl_b32 s54, s2, 2
    s_add_u32 s54, s54, s32
    s_mov_b32 s64, s56
    s_mov_b32 s65, s57
    s_mov_b32 s66, 5242880
    s_mov_b32 s67, 0x20000
    s_lshr_b32 s41, s54, 7
    s_and_b32 s42, s54, 127
    s_mul_i32 s68, s42, 40960
    s_mul_i32 s43, s41, 160
    s_add_u32 s68, s68, s43
    s_mul_i32 s69, s54, 5120
    s_add_u32 s69, s69, 18284544
    s_add_u32 s52, s69, 4096
    s_mov_b32 s75, 0x20000
    s_cmp_lt_u32 s54, 160
    s_cbranch_scc0 ka_pt_4
    s_mov_b32 s72, s58
    s_mov_b32 s73, s59
    s_mov_b32 s74, 819200
    s_mov_b32 s80, 1280
    s_mov_b32 s81, 10
    s_mov_b32 s82, 6554
    s_mov_b32 s83, 160
    s_mul_hi_u32 s41, s54, 214748365
    s_mul_i32 s42, s41, 20
    s_sub_u32 s42, s54, s42
    s_mul_i32 s77, s54, 5120
    s_add_u32 s77, s77, 24510464
    s_mul_i32 s43, s41, 160
    s_mov_b32 s44, 0
    s_branch ka_pt_go
ka_pt_4:
    s_cmp_lt_u32 s54, 592
    s_cbranch_scc0 ka_pt_3
    s_mov_b32 s72, s62
    s_mov_b32 s73, s63
    s_mov_b32 s74, 2211840
    s_mov_b32 s80, 1280
    s_mov_b32 s81, 10
    s_mov_b32 s82, 6554
    s_mov_b32 s83, 160
    s_sub_u32 s45, s54, 160
    s_mul_hi_u32 s41, s45, 79536432
    s_mul_i32 s42, s41, 54
    s_sub_u32 s42, s45, s42
    s_mul_i32 s77, s45, 5120
    s_add_u32 s77, s77, 27656192
    s_mul_i32 s43, s41, 160
    s_mov_b32 s44, 0
    s_branch ka_pt_go
ka_pt_3:
    s_mov_b32 s72, s60
    s_mov_b32 s73, s61
    s_mov_b32 s74, 2211840
    s_mov_b32 s80, 3456
    s_mov_b32 s81, 14
    s_mov_b32 s82, 4682
    s_mov_b32 s83, 224
    s_sub_u32 s45, s54, 592
    s_mul_hi_u32 s41, s45, 214748365
    s_mul_i32 s42, s41, 20
    s_sub_u32 s42, s45, s42
    s_mul_i32 s77, s45, 7168
    s_add_u32 s77, s77, 25362432
    s_mul_i32 s43, s41, 7
    s_min_u32 s43, s43, 101
    s_lshl_b32 s43, s43, 5
    s_mov_b32 s44, 1
    s_cmp_lt_u32 s54, 912
    s_cselect_b32 s77, s77, 0x40000000
    s_cselect_b32 s74, s74, 0
ka_pt_go:
    s_mul_i32 s76, s42, s80
    s_lshl_b32 s76, s76, 5
    s_add_u32 s76, s76, s43
    s_add_u32 s78, s77, 4096
    s_cmp_eq_u32 s44, 1
    s_cselect_b32 s79, s78, 0x40000000
    s_lshl_b32 s41, s33, 19
    s_add_u32 s41, s41, 393216
    s_add_u32 s16, s6, s41
    s_addc_u32 s17, s7, 0
    s_mov_b32 s18, 131072
    s_mov_b32 s19, 0x20000
    s_add_u32 s20, s8, s41
    s_addc_u32 s21, s9, 0
    s_mov_b32 s22, 131072
    s_mov_b32 s23, 0x20000
    s_add_u32 s28, s10, 32505856
    s_addc_u32 s29, s11, 0
    s_mov_b32 s30, 16777216
    s_mov_b32 s31, 0x20000
    v_lshlrev_b32 v36, 8, v33
    v_add_u32 v11, v36, v35
    v_add_u32 v37, 0, v33
    v_xor_b32 v37, v34, v37
    v_lshlrev_b32 v37, 4, v37
    v_add_u32 v7, v36, v37
    v_add_u32 v37, 4, v33
    v_xor_b32 v37, v34, v37
    v_lshlrev_b32 v37, 4, v37
    v_add_u32 v8, v36, v37
    v_add_u32 v37, 8, v33
    v_xor_b32 v37, v34, v37
    v_lshlrev_b32 v37, 4, v37
    v_add_u32 v9, v36, v37
    v_add_u32 v37, 12, v33
    v_xor_b32 v37, v34, v37
    v_lshlrev_b32 v37, 4, v37
    v_add_u32 v10, v36, v37
    v_lshrrev_b32 v29, 5, v32
    v_and_b32 v36, 31, v32
    v_and_b32 v37, 15, v32
    v_xor_b32 v37, v37, v29
    v_lshlrev_b32 v38, 8, v36
    v_xor_b32 v39, 0, v37
    v_lshlrev_b32 v39, 4, v39
    v_add_u32 v12, v38, v39
    v_xor_b32 v39, 2, v37
    v_lshlrev_b32 v39, 4, v39
    v_add_u32 v13, v38, v39
    v_xor_b32 v39, 4, v37
    v_lshlrev_b32 v39, 4, v39
    v_add_u32 v14, v38, v39
    v_xor_b32 v39, 6, v37
    v_lshlrev_b32 v39, 4, v39
    v_add_u32 v15, v38, v39
    v_xor_b32 v39, 8, v37
    v_lshlrev_b32 v39, 4, v39
    v_add_u32 v16, v38, v39
    v_xor_b32 v39, 10, v37
    v_lshlrev_b32 v39, 4, v39
    v_add_u32 v17, v38, v39
    v_xor_b32 v39, 12, v37
    v_lshlrev_b32 v39, 4, v39
    v_add_u32 v18, v38, v39
    v_xor_b32 v39, 14, v37
    v_lshlrev_b32 v39, 4, v39
    v_add_u32 v19, v38, v39
    v_bfe_u32 v36, v32, 2, 2
    v_and_b32 v37, 1, v32
    v_lshlrev_b32 v37, 1, v37
    v_bfe_u32 v38, v32, 1, 1
    v_or_b32 v37, v37, v38
    v_lshlrev_b32 v37, 3, v37
    v_bfe_u32 v38, v32, 4, 1
    v_lshlrev_b32 v38, 5, v38
    v_add_u32 v37, v37, v38
    v_lshlrev_b32 v38, 3, v29
    v_add_u32 v38, v38, v36
    v_lshlrev_b32 v38, 8, v38
    v_add_u32 v37, v37, v38
    v_add_u32 v37, 98304, v37
    v_xor_b32 v38, 0, v36
    v_lshlrev_b32 v38, 6, v38
    v_add_u32 v20, v37, v38
    v_xor_b32 v38, 1, v36
    v_lshlrev_b32 v38, 6, v38
    v_add_u32 v21, v37, v38
    v_xor_b32 v38, 2, v36
    v_lshlrev_b32 v38, 6, v38
    v_add_u32 v22, v37, v38
    v_xor_b32 v38, 3, v36
    v_lshlrev_b32 v38, 6, v38
    v_add_u32 v23, v37, v38
    v_bfe_u32 v36, v32, 4, 1
    v_lshlrev_b32 v36, 17, v36
    v_and_b32 v37, 15, v32
    v_lshlrev_b32 v38, 4, v29
    v_add_u32 v37, v37, v38
    v_lshlrev_b32 v37, 4, v37
    v_add_u32 v28, v36, v37
    v_lshlrev_b32 v30, 5, v29
    v_add_u32 v30, 32768, v30
    s_waitcnt vmcnt(26)
    s_barrier
    ds_read_b128 v[240:243], v30 offset:0
    ds_read_b128 v[244:247], v30 offset:16
    ds_read_b128 v[248:251], v30 offset:2560
    ds_read_b128 v[252:255], v30 offset:2576
    ds_read_b64_tr_b16 a[128:129], v20 offset:0
    ds_read_b64_tr_b16 a[130:131], v20 offset:1024
    ds_read_b64_tr_b16 a[132:133], v21 offset:0
    ds_read_b64_tr_b16 a[134:135], v21 offset:1024
    ds_read_b64_tr_b16 a[136:137], v22 offset:0
    ds_read_b64_tr_b16 a[138:139], v22 offset:1024
    ds_read_b64_tr_b16 a[140:141], v23 offset:0
    ds_read_b64_tr_b16 a[142:143], v23 offset:1024
    ds_read_b128 v[32:35], v30 offset:64
    ds_read_b128 v[36:39], v30 offset:80
    ds_read_b128 v[40:43], v30 offset:2624
    ds_read_b128 v[44:47], v30 offset:2640
    s_waitcnt lgkmcnt(12)
    v_fma_mix_f32 v24, v48, v248, v240 op_sel:[0,0,0] op_sel_hi:[1,0,0]
    v_fma_mix_f32 v25, v48, v249, v241 op_sel:[1,0,0] op_sel_hi:[1,0,0]
    v_cvt_pk_bf16_f32 v48, v24, v25
    v_fma_mix_f32 v26, v49, v250, v242 op_sel:[0,0,0] op_sel_hi:[1,0,0]
    v_fma_mix_f32 v27, v49, v251, v243 op_sel:[1,0,0] op_sel_hi:[1,0,0]
    v_cvt_pk_bf16_f32 v49, v26, v27
    v_fma_mix_f32 v24, v50, v252, v244 op_sel:[0,0,0] op_sel_hi:[1,0,0]
    v_fma_mix_f32 v25, v50, v253, v245 op_sel:[1,0,0] op_sel_hi:[1,0,0]
    v_cvt_pk_bf16_f32 v50, v24, v25
    v_fma_mix_f32 v26, v51, v254, v246 op_sel:[0,0,0] op_sel_hi:[1,0,0]
    v_fma_mix_f32 v27, v51, v255, v247 op_sel:[1,0,0] op_sel_hi:[1,0,0]
    v_cvt_pk_bf16_f32 v51, v26, v27
    v_fma_mix_f32 v24, v52, v248, v240 op_sel:[0,0,0] op_sel_hi:[1,0,0]
    v_fma_mix_f32 v25, v52, v249, v241 op_sel:[1,0,0] op_sel_hi:[1,0,0]
    v_cvt_pk_bf16_f32 v52, v24, v25
    v_fma_mix_f32 v26, v53, v250, v242 op_sel:[0,0,0] op_sel_hi:[1,0,0]
    v_fma_mix_f32 v27, v53, v251, v243 op_sel:[1,0,0] op_sel_hi:[1,0,0]
    v_cvt_pk_bf16_f32 v53, v26, v27
    v_fma_mix_f32 v24, v54, v252, v244 op_sel:[0,0,0] op_sel_hi:[1,0,0]
    v_fma_mix_f32 v25, v54, v253, v245 op_sel:[1,0,0] op_sel_hi:[1,0,0]
    v_cvt_pk_bf16_f32 v54, v24, v25
    v_fma_mix_f32 v26, v55, v254, v246 op_sel:[0,0,0] op_sel_hi:[1,0,0]
    v_fma_mix_f32 v27, v55, v255, v247 op_sel:[1,0,0] op_sel_hi:[1,0,0]
    v_cvt_pk_bf16_f32 v55, v26, v27
    s_waitcnt vmcnt(24)
    s_waitcnt lgkmcnt(0)
    v_mfma_f32_32x32x16_bf16 v[112:127], a[128:131], v[48:51], 0
    ds_read_b64_tr_b16 a[144:145], v20 offset:4096
    ds_read_b128 v[240:243], v30 offset:128
    v_fma_mix_f32 v24, v56, v40, v32 op_sel:[0,0,0] op_sel_hi:[1,0,0]
    v_fma_mix_f32 v25, v56, v41, v33 op_sel:[1,0,0] op_sel_hi:[1,0,0]
    v_cvt_pk_bf16_f32 v56, v24, v25
    v_mfma_f32_32x32x16_bf16 v[128:143], a[128:131], v[52:55], 0
    ds_read_b64_tr_b16 a[146:147], v20 offset:5120
    ds_read_b128 v[244:247], v30 offset:144
    v_fma_mix_f32 v26, v57, v42, v34 op_sel:[0,0,0] op_sel_hi:[1,0,0]
    v_fma_mix_f32 v27, v57, v43, v35 op_sel:[1,0,0] op_sel_hi:[1,0,0]
    v_mfma_f32_32x32x16_bf16 v[144:159], a[132:135], v[48:51], 0
    ds_read_b64_tr_b16 a[148:149], v21 offset:4096
    ds_read_b128 v[248:251], v30 offset:2688
    v_cvt_pk_bf16_f32 v57, v26, v27
    v_fma_mix_f32 v24, v58, v44, v36 op_sel:[0,0,0] op_sel_hi:[1,0,0]
    v_fma_mix_f32 v25, v58, v45, v37 op_sel:[1,0,0] op_sel_hi:[1,0,0]
    v_mfma_f32_32x32x16_bf16 v[160:175], a[132:135], v[52:55], 0
    ds_read_b64_tr_b16 a[150:151], v21 offset:5120
    ds_read_b128 v[252:255], v30 offset:2704
    v_cvt_pk_bf16_f32 v58, v24, v25
    v_fma_mix_f32 v26, v59, v46, v38 op_sel:[0,0,0] op_sel_hi:[1,0,0]
    v_fma_mix_f32 v27, v59, v47, v39 op_sel:[1,0,0] op_sel_hi:[1,0,0]
    v_mfma_f32_32x32x16_bf16 v[176:191], a[136:139], v[48:51], 0
    ds_read_b64_tr_b16 a[152:153], v22 offset:4096
    v_cvt_pk_bf16_f32 v59, v26, v27
    v_fma_mix_f32 v24, v60, v40, v32 op_sel:[0,0,0] op_sel_hi:[1,0,0]
    v_fma_mix_f32 v25, v60, v41, v33 op_sel:[1,0,0] op_sel_hi:[1,0,0]
    v_mfma_f32_32x32x16_bf16 v[192:207], a[136:139], v[52:55], 0
    ds_read_b64_tr_b16 a[154:155], v22 offset:5120
    v_cvt_pk_bf16_f32 v60, v24, v25
    v_fma_mix_f32 v26, v61, v42, v34 op_sel:[0,0,0] op_sel_hi:[1,0,0]
    v_fma_mix_f32 v27, v61, v43, v35 op_sel:[1,0,0] op_sel_hi:[1,0,0]
    v_mfma_f32_32x32x16_bf16 v[208:223], a[140:143], v[48:51], 0
    ds_read_b64_tr_b16 a[156:157], v23 offset:4096
    v_cvt_pk_bf16_f32 v61, v26, v27
    v_fma_mix_f32 v24, v62, v44, v36 op_sel:[0,0,0] op_sel_hi:[1,0,0]
    v_fma_mix_f32 v25, v62, v45, v37 op_sel:[1,0,0] op_sel_hi:[1,0,0]
    v_cvt_pk_bf16_f32 v62, v24, v25
    v_mfma_f32_32x32x16_bf16 v[224:239], a[140:143], v[52:55], 0
    ds_read_b64_tr_b16 a[158:159], v23 offset:5120
    v_fma_mix_f32 v26, v63, v46, v38 op_sel:[0,0,0] op_sel_hi:[1,0,0]
    v_fma_mix_f32 v27, v63, v47, v39 op_sel:[1,0,0] op_sel_hi:[1,0,0]
    v_cvt_pk_bf16_f32 v63, v26, v27
    s_waitcnt vmcnt(22)
    s_waitcnt lgkmcnt(4)
    v_mfma_f32_32x32x16_bf16 v[112:127], a[144:147], v[56:59], v[112:127]
    ds_read_b64_tr_b16 a[160:161], v20 offset:8192
    ds_read_b128 v[32:35], v30 offset:192
    v_fma_mix_f32 v24, v64, v248, v240 op_sel:[0,0,0] op_sel_hi:[1,0,0]
    v_fma_mix_f32 v25, v64, v249, v241 op_sel:[1,0,0] op_sel_hi:[1,0,0]
    v_cvt_pk_bf16_f32 v64, v24, v25
    v_mfma_f32_32x32x16_bf16 v[128:143], a[144:147], v[60:63], v[128:143]
    ds_read_b64_tr_b16 a[162:163], v20 offset:9216
    ds_read_b128 v[36:39], v30 offset:208
    v_fma_mix_f32 v26, v65, v250, v242 op_sel:[0,0,0] op_sel_hi:[1,0,0]
    v_fma_mix_f32 v27, v65, v251, v243 op_sel:[1,0,0] op_sel_hi:[1,0,0]
    v_cvt_pk_bf16_f32 v65, v26, v27
    v_fma_mix_f32 v24, v66, v252, v244 op_sel:[0,0,0] op_sel_hi:[1,0,0]
    v_mfma_f32_32x32x16_bf16 v[144:159], a[148:151], v[56:59], v[144:159]
    ds_read_b64_tr_b16 a[164:165], v21 offset:8192
    ds_read_b128 v[40:43], v30 offset:2752
    v_fma_mix_f32 v25, v66, v253, v245 op_sel:[1,0,0] op_sel_hi:[1,0,0]
    v_cvt_pk_bf16_f32 v66, v24, v25
    v_fma_mix_f32 v26, v67, v254, v246 op_sel:[0,0,0] op_sel_hi:[1,0,0]
    v_mfma_f32_32x32x16_bf16 v[160:175], a[148:151], v[60:63], v[160:175]
    ds_read_b64_tr_b16 a[166:167], v21 offset:9216
    ds_read_b128 v[44:47], v30 offset:2768
    v_fma_mix_f32 v27, v67, v255, v247 op_sel:[1,0,0] op_sel_hi:[1,0,0]
    v_cvt_pk_bf16_f32 v67, v26, v27
    v_fma_mix_f32 v24, v68, v248, v240 op_sel:[0,0,0] op_sel_hi:[1,0,0]
    v_fma_mix_f32 v25, v68, v249, v241 op_sel:[1,0,0] op_sel_hi:[1,0,0]
    s_waitcnt lgkmcnt(8)
    v_mfma_f32_32x32x16_bf16 v[176:191], a[152:155], v[56:59], v[176:191]
    ds_read_b64_tr_b16 a[168:169], v22 offset:8192
    s_add_u32 s46, s35, 8192
    buffer_load_dwordx4 v[48:51], v1, s[24:27], s46 offen offset:0
    v_mfma_f32_32x32x16_bf16 v[192:207], a[152:155], v[60:63], v[192:207]
    ds_read_b64_tr_b16 a[170:171], v22 offset:9216
    v_cvt_pk_bf16_f32 v68, v24, v25
    v_fma_mix_f32 v26, v69, v250, v242 op_sel:[0,0,0] op_sel_hi:[1,0,0]
    v_fma_mix_f32 v27, v69, v251, v243 op_sel:[1,0,0] op_sel_hi:[1,0,0]
    v_cvt_pk_bf16_f32 v69, v26, v27
    v_fma_mix_f32 v24, v70, v252, v244 op_sel:[0,0,0] op_sel_hi:[1,0,0]
    v_mfma_f32_32x32x16_bf16 v[208:223], a[156:159], v[56:59], v[208:223]
    ds_read_b64_tr_b16 a[172:173], v23 offset:8192
    buffer_load_dwordx4 v[52:55], v2, s[24:27], s46 offen offset:0
    v_fma_mix_f32 v25, v70, v253, v245 op_sel:[1,0,0] op_sel_hi:[1,0,0]
    v_mfma_f32_32x32x16_bf16 v[224:239], a[156:159], v[60:63], v[224:239]
    ds_read_b64_tr_b16 a[174:175], v23 offset:9216
    v_cvt_pk_bf16_f32 v70, v24, v25
    v_fma_mix_f32 v26, v71, v254, v246 op_sel:[0,0,0] op_sel_hi:[1,0,0]
    v_fma_mix_f32 v27, v71, v255, v247 op_sel:[1,0,0] op_sel_hi:[1,0,0]
    v_cvt_pk_bf16_f32 v71, v26, v27
    s_waitcnt vmcnt(18)
    s_waitcnt lgkmcnt(4)
    v_mfma_f32_32x32x16_bf16 v[112:127], a[160:163], v[64:67], v[112:127]
    ds_read_b64_tr_b16 a[176:177], v20 offset:12288
    ds_read_b128 v[240:243], v30 offset:256
    v_fma_mix_f32 v24, v72, v40, v32 op_sel:[0,0,0] op_sel_hi:[1,0,0]
    v_fma_mix_f32 v25, v72, v41, v33 op_sel:[1,0,0] op_sel_hi:[1,0,0]
    v_cvt_pk_bf16_f32 v72, v24, v25
    v_mfma_f32_32x32x16_bf16 v[128:143], a[160:163], v[68:71], v[128:143]
    ds_read_b64_tr_b16 a[178:179], v20 offset:13312
    ds_read_b128 v[244:247], v30 offset:272
    v_fma_mix_f32 v26, v73, v42, v34 op_sel:[0,0,0] op_sel_hi:[1,0,0]
    v_fma_mix_f32 v27, v73, v43, v35 op_sel:[1,0,0] op_sel_hi:[1,0,0]
    v_cvt_pk_bf16_f32 v73, v26, v27
    v_fma_mix_f32 v24, v74, v44, v36 op_sel:[0,0,0] op_sel_hi:[1,0,0]
    v_mfma_f32_32x32x16_bf16 v[144:159], a[164:167], v[64:67], v[144:159]
    ds_read_b64_tr_b16 a[180:181], v21 offset:12288
    ds_read_b128 v[248:251], v30 offset:2816
    v_fma_mix_f32 v25, v74, v45, v37 op_sel:[1,0,0] op_sel_hi:[1,0,0]
    v_cvt_pk_bf16_f32 v74, v24, v25
    v_fma_mix_f32 v26, v75, v46, v38 op_sel:[0,0,0] op_sel_hi:[1,0,0]
    v_mfma_f32_32x32x16_bf16 v[160:175], a[164:167], v[68:71], v[160:175]
    ds_read_b64_tr_b16 a[182:183], v21 offset:13312
    ds_read_b128 v[252:255], v30 offset:2832
    v_fma_mix_f32 v27, v75, v47, v39 op_sel:[1,0,0] op_sel_hi:[1,0,0]
    v_cvt_pk_bf16_f32 v75, v26, v27
    v_fma_mix_f32 v24, v76, v40, v32 op_sel:[0,0,0] op_sel_hi:[1,0,0]
    s_waitcnt lgkmcnt(8)
    v_mfma_f32_32x32x16_bf16 v[176:191], a[168:171], v[64:67], v[176:191]
    ds_read_b64_tr_b16 a[184:185], v22 offset:12288
    buffer_load_dwordx4 v[56:59], v1, s[24:27], s46 offen offset:1024
    v_fma_mix_f32 v25, v76, v41, v33 op_sel:[1,0,0] op_sel_hi:[1,0,0]
    v_cvt_pk_bf16_f32 v76, v24, v25
    v_mfma_f32_32x32x16_bf16 v[192:207], a[168:171], v[68:71], v[192:207]
    ds_read_b64_tr_b16 a[186:187], v22 offset:13312
    v_fma_mix_f32 v26, v77, v42, v34 op_sel:[0,0,0] op_sel_hi:[1,0,0]
    v_fma_mix_f32 v27, v77, v43, v35 op_sel:[1,0,0] op_sel_hi:[1,0,0]
    v_cvt_pk_bf16_f32 v77, v26, v27
    v_fma_mix_f32 v24, v78, v44, v36 op_sel:[0,0,0] op_sel_hi:[1,0,0]
    v_mfma_f32_32x32x16_bf16 v[208:223], a[172:175], v[64:67], v[208:223]
    ds_read_b64_tr_b16 a[188:189], v23 offset:12288
    buffer_load_dwordx4 v[60:63], v2, s[24:27], s46 offen offset:1024
    v_fma_mix_f32 v25, v78, v45, v37 op_sel:[1,0,0] op_sel_hi:[1,0,0]
    v_mfma_f32_32x32x16_bf16 v[224:239], a[172:175], v[68:71], v[224:239]
    ds_read_b64_tr_b16 a[190:191], v23 offset:13312
    v_cvt_pk_bf16_f32 v78, v24, v25
    v_fma_mix_f32 v26, v79, v46, v38 op_sel:[0,0,0] op_sel_hi:[1,0,0]
    v_fma_mix_f32 v27, v79, v47, v39 op_sel:[1,0,0] op_sel_hi:[1,0,0]
    v_cvt_pk_bf16_f32 v79, v26, v27
    s_barrier
    s_waitcnt vmcnt(18)
    s_waitcnt lgkmcnt(4)
    v_mfma_f32_32x32x16_bf16 v[112:127], a[176:179], v[72:75], v[112:127]
    ds_read_b64_tr_b16 a[128:129], v20 offset:16384
    ds_read_b128 v[32:35], v30 offset:320
    v_fma_mix_f32 v24, v80, v248, v240 op_sel:[0,0,0] op_sel_hi:[1,0,0]
    v_fma_mix_f32 v25, v80, v249, v241 op_sel:[1,0,0] op_sel_hi:[1,0,0]
    v_cvt_pk_bf16_f32 v80, v24, v25
    v_mfma_f32_32x32x16_bf16 v[128:143], a[176:179], v[76:79], v[128:143]
    ds_read_b64_tr_b16 a[130:131], v20 offset:17408
    ds_read_b128 v[36:39], v30 offset:336
    v_fma_mix_f32 v26, v81, v250, v242 op_sel:[0,0,0] op_sel_hi:[1,0,0]
    v_fma_mix_f32 v27, v81, v251, v243 op_sel:[1,0,0] op_sel_hi:[1,0,0]
    v_cvt_pk_bf16_f32 v81, v26, v27
    v_fma_mix_f32 v24, v82, v252, v244 op_sel:[0,0,0] op_sel_hi:[1,0,0]
    v_mfma_f32_32x32x16_bf16 v[144:159], a[180:183], v[72:75], v[144:159]
    ds_read_b64_tr_b16 a[132:133], v21 offset:16384
    ds_read_b128 v[40:43], v30 offset:2880
    v_fma_mix_f32 v25, v82, v253, v245 op_sel:[1,0,0] op_sel_hi:[1,0,0]
    v_cvt_pk_bf16_f32 v82, v24, v25
    v_fma_mix_f32 v26, v83, v254, v246 op_sel:[0,0,0] op_sel_hi:[1,0,0]
    v_mfma_f32_32x32x16_bf16 v[160:175], a[180:183], v[76:79], v[160:175]
    ds_read_b64_tr_b16 a[134:135], v21 offset:17408
    ds_read_b128 v[44:47], v30 offset:2896
    v_fma_mix_f32 v27, v83, v255, v247 op_sel:[1,0,0] op_sel_hi:[1,0,0]
    v_cvt_pk_bf16_f32 v83, v26, v27
    v_fma_mix_f32 v24, v84, v248, v240 op_sel:[0,0,0] op_sel_hi:[1,0,0]
    s_waitcnt lgkmcnt(8)
    v_mfma_f32_32x32x16_bf16 v[176:191], a[184:187], v[72:75], v[176:191]
    ds_read_b64_tr_b16 a[136:137], v22 offset:16384
    buffer_load_dwordx4 v[64:67], v1, s[24:27], s46 offen offset:2048
    v_fma_mix_f32 v25, v84, v249, v241 op_sel:[1,0,0] op_sel_hi:[1,0,0]
    v_cvt_pk_bf16_f32 v84, v24, v25
    v_mfma_f32_32x32x16_bf16 v[192:207], a[184:187], v[76:79], v[192:207]
    ds_read_b64_tr_b16 a[138:139], v22 offset:17408
    v_fma_mix_f32 v26, v85, v250, v242 op_sel:[0,0,0] op_sel_hi:[1,0,0]
    v_fma_mix_f32 v27, v85, v251, v243 op_sel:[1,0,0] op_sel_hi:[1,0,0]
    v_cvt_pk_bf16_f32 v85, v26, v27
    v_fma_mix_f32 v24, v86, v252, v244 op_sel:[0,0,0] op_sel_hi:[1,0,0]
    v_mfma_f32_32x32x16_bf16 v[208:223], a[188:191], v[72:75], v[208:223]
    ds_read_b64_tr_b16 a[140:141], v23 offset:16384
    buffer_load_dwordx4 v[68:71], v2, s[24:27], s46 offen offset:2048
    v_fma_mix_f32 v25, v86, v253, v245 op_sel:[1,0,0] op_sel_hi:[1,0,0]
    v_mfma_f32_32x32x16_bf16 v[224:239], a[188:191], v[76:79], v[224:239]
    ds_read_b64_tr_b16 a[142:143], v23 offset:17408
    v_cvt_pk_bf16_f32 v86, v24, v25
    v_fma_mix_f32 v26, v87, v254, v246 op_sel:[0,0,0] op_sel_hi:[1,0,0]
    v_fma_mix_f32 v27, v87, v255, v247 op_sel:[1,0,0] op_sel_hi:[1,0,0]
    v_cvt_pk_bf16_f32 v87, v26, v27
    s_waitcnt vmcnt(18)
    s_waitcnt lgkmcnt(4)
    v_mfma_f32_32x32x16_bf16 v[112:127], a[128:131], v[80:83], v[112:127]
    ds_read_b64_tr_b16 a[144:145], v20 offset:20480
    ds_read_b128 v[240:243], v30 offset:384
    v_fma_mix_f32 v24, v88, v40, v32 op_sel:[0,0,0] op_sel_hi:[1,0,0]
    v_fma_mix_f32 v25, v88, v41, v33 op_sel:[1,0,0] op_sel_hi:[1,0,0]
    v_cvt_pk_bf16_f32 v88, v24, v25
    v_mfma_f32_32x32x16_bf16 v[128:143], a[128:131], v[84:87], v[128:143]
    ds_read_b64_tr_b16 a[146:147], v20 offset:21504
    ds_read_b128 v[244:247], v30 offset:400
    v_fma_mix_f32 v26, v89, v42, v34 op_sel:[0,0,0] op_sel_hi:[1,0,0]
    v_fma_mix_f32 v27, v89, v43, v35 op_sel:[1,0,0] op_sel_hi:[1,0,0]
    v_cvt_pk_bf16_f32 v89, v26, v27
    v_fma_mix_f32 v24, v90, v44, v36 op_sel:[0,0,0] op_sel_hi:[1,0,0]
    v_mfma_f32_32x32x16_bf16 v[144:159], a[132:135], v[80:83], v[144:159]
    ds_read_b64_tr_b16 a[148:149], v21 offset:20480
    ds_read_b128 v[248:251], v30 offset:2944
    v_fma_mix_f32 v25, v90, v45, v37 op_sel:[1,0,0] op_sel_hi:[1,0,0]
    v_cvt_pk_bf16_f32 v90, v24, v25
    v_fma_mix_f32 v26, v91, v46, v38 op_sel:[0,0,0] op_sel_hi:[1,0,0]
    v_mfma_f32_32x32x16_bf16 v[160:175], a[132:135], v[84:87], v[160:175]
    ds_read_b64_tr_b16 a[150:151], v21 offset:21504
    ds_read_b128 v[252:255], v30 offset:2960
    v_fma_mix_f32 v27, v91, v47, v39 op_sel:[1,0,0] op_sel_hi:[1,0,0]
    v_cvt_pk_bf16_f32 v91, v26, v27
    v_fma_mix_f32 v24, v92, v40, v32 op_sel:[0,0,0] op_sel_hi:[1,0,0]
    s_waitcnt lgkmcnt(8)
    v_mfma_f32_32x32x16_bf16 v[176:191], a[136:139], v[80:83], v[176:191]
    ds_read_b64_tr_b16 a[152:153], v22 offset:20480
    buffer_load_dwordx4 v[72:75], v1, s[24:27], s46 offen offset:3072
    v_fma_mix_f32 v25, v92, v41, v33 op_sel:[1,0,0] op_sel_hi:[1,0,0]
    v_cvt_pk_bf16_f32 v92, v24, v25
    v_mfma_f32_32x32x16_bf16 v[192:207], a[136:139], v[84:87], v[192:207]
    ds_read_b64_tr_b16 a[154:155], v22 offset:21504
    v_fma_mix_f32 v26, v93, v42, v34 op_sel:[0,0,0] op_sel_hi:[1,0,0]
    v_fma_mix_f32 v27, v93, v43, v35 op_sel:[1,0,0] op_sel_hi:[1,0,0]
    v_cvt_pk_bf16_f32 v93, v26, v27
    v_fma_mix_f32 v24, v94, v44, v36 op_sel:[0,0,0] op_sel_hi:[1,0,0]
    v_mfma_f32_32x32x16_bf16 v[208:223], a[140:143], v[80:83], v[208:223]
    ds_read_b64_tr_b16 a[156:157], v23 offset:20480
    buffer_load_dwordx4 v[76:79], v2, s[24:27], s46 offen offset:3072
    v_fma_mix_f32 v25, v94, v45, v37 op_sel:[1,0,0] op_sel_hi:[1,0,0]
    v_mfma_f32_32x32x16_bf16 v[224:239], a[140:143], v[84:87], v[224:239]
    ds_read_b64_tr_b16 a[158:159], v23 offset:21504
    v_cvt_pk_bf16_f32 v94, v24, v25
    v_fma_mix_f32 v26, v95, v46, v38 op_sel:[0,0,0] op_sel_hi:[1,0,0]
    v_fma_mix_f32 v27, v95, v47, v39 op_sel:[1,0,0] op_sel_hi:[1,0,0]
    v_cvt_pk_bf16_f32 v95, v26, v27
    s_waitcnt vmcnt(18)
    s_waitcnt lgkmcnt(4)
    v_mfma_f32_32x32x16_bf16 v[112:127], a[144:147], v[88:91], v[112:127]
    ds_read_b64_tr_b16 a[160:161], v20 offset:24576
    ds_read_b128 v[32:35], v30 offset:448
    v_fma_mix_f32 v24, v96, v248, v240 op_sel:[0,0,0] op_sel_hi:[1,0,0]
    v_fma_mix_f32 v25, v96, v249, v241 op_sel:[1,0,0] op_sel_hi:[1,0,0]
    v_cvt_pk_bf16_f32 v96, v24, v25
    v_mfma_f32_32x32x16_bf16 v[128:143], a[144:147], v[92:95], v[128:143]
    ds_read_b64_tr_b16 a[162:163], v20 offset:25600
    ds_read_b128 v[36:39], v30 offset:464
    v_fma_mix_f32 v26, v97, v250, v242 op_sel:[0,0,0] op_sel_hi:[1,0,0]
    v_fma_mix_f32 v27, v97, v251, v243 op_sel:[1,0,0] op_sel_hi:[1,0,0]
    v_cvt_pk_bf16_f32 v97, v26, v27
    v_fma_mix_f32 v24, v98, v252, v244 op_sel:[0,0,0] op_sel_hi:[1,0,0]
    v_mfma_f32_32x32x16_bf16 v[144:159], a[148:151], v[88:91], v[144:159]
    ds_read_b64_tr_b16 a[164:165], v21 offset:24576
    ds_read_b128 v[40:43], v30 offset:3008
    v_fma_mix_f32 v25, v98, v253, v245 op_sel:[1,0,0] op_sel_hi:[1,0,0]
    v_cvt_pk_bf16_f32 v98, v24, v25
    v_fma_mix_f32 v26, v99, v254, v246 op_sel:[0,0,0] op_sel_hi:[1,0,0]
    v_mfma_f32_32x32x16_bf16 v[160:175], a[148:151], v[92:95], v[160:175]
    ds_read_b64_tr_b16 a[166:167], v21 offset:25600
    ds_read_b128 v[44:47], v30 offset:3024
    v_fma_mix_f32 v27, v99, v255, v247 op_sel:[1,0,0] op_sel_hi:[1,0,0]
    v_cvt_pk_bf16_f32 v99, v26, v27
    v_fma_mix_f32 v24, v100, v248, v240 op_sel:[0,0,0] op_sel_hi:[1,0,0]
    v_fma_mix_f32 v25, v100, v249, v241 op_sel:[1,0,0] op_sel_hi:[1,0,0]
    s_waitcnt lgkmcnt(8)
    v_mfma_f32_32x32x16_bf16 v[176:191], a[152:155], v[88:91], v[176:191]
    ds_read_b64_tr_b16 a[168:169], v22 offset:24576
    s_add_u32 s47, s35, 12288
    buffer_load_dwordx4 v[80:83], v1, s[24:27], s47 offen offset:0
    v_mfma_f32_32x32x16_bf16 v[192:207], a[152:155], v[92:95], v[192:207]
    ds_read_b64_tr_b16 a[170:171], v22 offset:25600
    v_cvt_pk_bf16_f32 v100, v24, v25
    v_fma_mix_f32 v26, v101, v250, v242 op_sel:[0,0,0] op_sel_hi:[1,0,0]
    v_fma_mix_f32 v27, v101, v251, v243 op_sel:[1,0,0] op_sel_hi:[1,0,0]
    v_cvt_pk_bf16_f32 v101, v26, v27
    v_fma_mix_f32 v24, v102, v252, v244 op_sel:[0,0,0] op_sel_hi:[1,0,0]
    v_mfma_f32_32x32x16_bf16 v[208:223], a[156:159], v[88:91], v[208:223]
    ds_read_b64_tr_b16 a[172:173], v23 offset:24576
    buffer_load_dwordx4 v[84:87], v2, s[24:27], s47 offen offset:0
    v_fma_mix_f32 v25, v102, v253, v245 op_sel:[1,0,0] op_sel_hi:[1,0,0]
    v_mfma_f32_32x32x16_bf16 v[224:239], a[156:159], v[92:95], v[224:239]
    ds_read_b64_tr_b16 a[174:175], v23 offset:25600
    v_cvt_pk_bf16_f32 v102, v24, v25
    v_fma_mix_f32 v26, v103, v254, v246 op_sel:[0,0,0] op_sel_hi:[1,0,0]
    v_fma_mix_f32 v27, v103, v255, v247 op_sel:[1,0,0] op_sel_hi:[1,0,0]
    v_cvt_pk_bf16_f32 v103, v26, v27
    s_waitcnt vmcnt(18)
    s_waitcnt lgkmcnt(4)
    v_mfma_f32_32x32x16_bf16 v[112:127], a[160:163], v[96:99], v[112:127]
    ds_read_b64_tr_b16 a[176:177], v20 offset:28672
    ds_read_b128 v[240:243], v30 offset:512
    v_fma_mix_f32 v24, v104, v40, v32 op_sel:[0,0,0] op_sel_hi:[1,0,0]
    v_fma_mix_f32 v25, v104, v41, v33 op_sel:[1,0,0] op_sel_hi:[1,0,0]
    v_cvt_pk_bf16_f32 v104, v24, v25
    v_mfma_f32_32x32x16_bf16 v[128:143], a[160:163], v[100:103], v[128:143]
    ds_read_b64_tr_b16 a[178:179], v20 offset:29696
    ds_read_b128 v[244:247], v30 offset:528
    v_fma_mix_f32 v26, v105, v42, v34 op_sel:[0,0,0] op_sel_hi:[1,0,0]
    v_fma_mix_f32 v27, v105, v43, v35 op_sel:[1,0,0] op_sel_hi:[1,0,0]
    v_cvt_pk_bf16_f32 v105, v26, v27
    v_fma_mix_f32 v24, v106, v44, v36 op_sel:[0,0,0] op_sel_hi:[1,0,0]
    v_mfma_f32_32x32x16_bf16 v[144:159], a[164:167], v[96:99], v[144:159]
    ds_read_b64_tr_b16 a[180:181], v21 offset:28672
    ds_read_b128 v[248:251], v30 offset:3072
    v_fma_mix_f32 v25, v106, v45, v37 op_sel:[1,0,0] op_sel_hi:[1,0,0]
    v_cvt_pk_bf16_f32 v106, v24, v25
    v_fma_mix_f32 v26, v107, v46, v38 op_sel:[0,0,0] op_sel_hi:[1,0,0]
    v_mfma_f32_32x32x16_bf16 v[160:175], a[164:167], v[100:103], v[160:175]
    ds_read_b64_tr_b16 a[182:183], v21 offset:29696
    ds_read_b128 v[252:255], v30 offset:3088
    v_fma_mix_f32 v27, v107, v47, v39 op_sel:[1,0,0] op_sel_hi:[1,0,0]
    v_cvt_pk_bf16_f32 v107, v26, v27
    v_fma_mix_f32 v24, v108, v40, v32 op_sel:[0,0,0] op_sel_hi:[1,0,0]
    s_waitcnt lgkmcnt(8)
    v_mfma_f32_32x32x16_bf16 v[176:191], a[168:171], v[96:99], v[176:191]
    ds_read_b64_tr_b16 a[184:185], v22 offset:28672
    buffer_load_dwordx4 v[88:91], v1, s[24:27], s47 offen offset:1024
    v_fma_mix_f32 v25, v108, v41, v33 op_sel:[1,0,0] op_sel_hi:[1,0,0]
    v_cvt_pk_bf16_f32 v108, v24, v25
    v_mfma_f32_32x32x16_bf16 v[192:207], a[168:171], v[100:103], v[192:207]
    ds_read_b64_tr_b16 a[186:187], v22 offset:29696
    v_fma_mix_f32 v26, v109, v42, v34 op_sel:[0,0,0] op_sel_hi:[1,0,0]
    v_fma_mix_f32 v27, v109, v43, v35 op_sel:[1,0,0] op_sel_hi:[1,0,0]
    v_cvt_pk_bf16_f32 v109, v26, v27
    v_fma_mix_f32 v24, v110, v44, v36 op_sel:[0,0,0] op_sel_hi:[1,0,0]
    v_mfma_f32_32x32x16_bf16 v[208:223], a[172:175], v[96:99], v[208:223]
    ds_read_b64_tr_b16 a[188:189], v23 offset:28672
    buffer_load_dwordx4 v[92:95], v2, s[24:27], s47 offen offset:1024
    v_fma_mix_f32 v25, v110, v45, v37 op_sel:[1,0,0] op_sel_hi:[1,0,0]
    v_mfma_f32_32x32x16_bf16 v[224:239], a[172:175], v[100:103], v[224:239]
    ds_read_b64_tr_b16 a[190:191], v23 offset:29696
    v_cvt_pk_bf16_f32 v110, v24, v25
    v_fma_mix_f32 v26, v111, v46, v38 op_sel:[0,0,0] op_sel_hi:[1,0,0]
    v_fma_mix_f32 v27, v111, v47, v39 op_sel:[1,0,0] op_sel_hi:[1,0,0]
    v_cvt_pk_bf16_f32 v111, v26, v27
    s_waitcnt vmcnt(16)
    s_barrier
    s_waitcnt vmcnt(10)
    s_waitcnt lgkmcnt(4)
    v_mfma_f32_32x32x16_bf16 v[112:127], a[176:179], v[104:107], v[112:127]
    ds_read_b64_tr_b16 a[128:129], v20 offset:32768
    ds_read_b128 v[32:35], v30 offset:576
    v_fma_mix_f32 v24, v48, v248, v240 op_sel:[0,0,0] op_sel_hi:[1,0,0]
    v_fma_mix_f32 v25, v48, v249, v241 op_sel:[1,0,0] op_sel_hi:[1,0,0]
    v_cvt_pk_bf16_f32 v48, v24, v25
    v_fma_mix_f32 v26, v49, v250, v242 op_sel:[0,0,0] op_sel_hi:[1,0,0]
    v_fma_mix_f32 v27, v49, v251, v243 op_sel:[1,0,0] op_sel_hi:[1,0,0]
    v_cvt_pk_bf16_f32 v49, v26, v27
    v_mfma_f32_32x32x16_bf16 v[128:143], a[176:179], v[108:111], v[128:143]
    ds_read_b64_tr_b16 a[130:131], v20 offset:33792
    ds_read_b128 v[36:39], v30 offset:592
    v_fma_mix_f32 v24, v50, v252, v244 op_sel:[0,0,0] op_sel_hi:[1,0,0]
    v_fma_mix_f32 v25, v50, v253, v245 op_sel:[1,0,0] op_sel_hi:[1,0,0]
    v_cvt_pk_bf16_f32 v50, v24, v25
    v_fma_mix_f32 v26, v51, v254, v246 op_sel:[0,0,0] op_sel_hi:[1,0,0]
    v_fma_mix_f32 v27, v51, v255, v247 op_sel:[1,0,0] op_sel_hi:[1,0,0]
    v_cvt_pk_bf16_f32 v51, v26, v27
    v_fma_mix_f32 v24, v52, v248, v240 op_sel:[0,0,0] op_sel_hi:[1,0,0]
    v_mfma_f32_32x32x16_bf16 v[144:159], a[180:183], v[104:107], v[144:159]
    ds_read_b64_tr_b16 a[132:133], v21 offset:32768
    ds_read_b128 v[40:43], v30 offset:3136
    s_add_u32 m0, s38, 98304
    s_add_u32 s39, s36, 2097152
    buffer_load_dwordx4 v3, s[12:15], s39 offen offset:0 nt lds
    v_mfma_f32_32x32x16_bf16 v[160:175], a[180:183], v[108:111], v[160:175]
    ds_read_b64_tr_b16 a[134:135], v21 offset:33792
    ds_read_b128 v[44:47], v30 offset:3152
    buffer_load_dwordx4 v4, s[12:15], s39 offen offset:1024 nt lds
    v_fma_mix_f32 v25, v52, v249, v241 op_sel:[1,0,0] op_sel_hi:[1,0,0]
    s_waitcnt lgkmcnt(8)
    v_mfma_f32_32x32x16_bf16 v[176:191], a[184:187], v[104:107], v[176:191]
    ds_read_b64_tr_b16 a[136:137], v22 offset:32768
    buffer_load_dwordx4 v5, s[12:15], s39 offen offset:2048 nt lds
    v_cvt_pk_bf16_f32 v52, v24, v25
    v_fma_mix_f32 v26, v53, v250, v242 op_sel:[0,0,0] op_sel_hi:[1,0,0]
    v_mfma_f32_32x32x16_bf16 v[192:207], a[184:187], v[108:111], v[192:207]
    ds_read_b64_tr_b16 a[138:139], v22 offset:33792
    buffer_load_dwordx4 v6, s[12:15], s39 offen offset:3072 nt lds
    v_fma_mix_f32 v27, v53, v251, v243 op_sel:[1,0,0] op_sel_hi:[1,0,0]
    v_cvt_pk_bf16_f32 v53, v26, v27
    v_fma_mix_f32 v24, v54, v252, v244 op_sel:[0,0,0] op_sel_hi:[1,0,0]
    v_mfma_f32_32x32x16_bf16 v[208:223], a[188:191], v[104:107], v[208:223]
    ds_read_b64_tr_b16 a[140:141], v23 offset:32768
    buffer_load_dwordx4 v[96:99], v1, s[24:27], s47 offen offset:2048
    v_fma_mix_f32 v25, v54, v253, v245 op_sel:[1,0,0] op_sel_hi:[1,0,0]
    v_cvt_pk_bf16_f32 v54, v24, v25
    v_mfma_f32_32x32x16_bf16 v[224:239], a[188:191], v[108:111], v[224:239]
    ds_read_b64_tr_b16 a[142:143], v23 offset:33792
    buffer_load_dwordx4 v[100:103], v2, s[24:27], s47 offen offset:2048
    v_fma_mix_f32 v26, v55, v254, v246 op_sel:[0,0,0] op_sel_hi:[1,0,0]
    v_fma_mix_f32 v27, v55, v255, v247 op_sel:[1,0,0] op_sel_hi:[1,0,0]
    v_cvt_pk_bf16_f32 v55, v26, v27
    s_waitcnt vmcnt(14)
    s_waitcnt lgkmcnt(4)
    v_mfma_f32_32x32x16_bf16 v[112:127], a[128:131], v[48:51], v[112:127]
    ds_read_b64_tr_b16 a[144:145], v20 offset:36864
    ds_read_b128 v[240:243], v30 offset:640
    v_fma_mix_f32 v24, v56, v40, v32 op_sel:[0,0,0] op_sel_hi:[1,0,0]
    v_fma_mix_f32 v25, v56, v41, v33 op_sel:[1,0,0] op_sel_hi:[1,0,0]
    v_cvt_pk_bf16_f32 v56, v24, v25
    v_mfma_f32_32x32x16_bf16 v[128:143], a[128:131], v[52:55], v[128:143]
    ds_read_b64_tr_b16 a[146:147], v20 offset:37888
    ds_read_b128 v[244:247], v30 offset:656
    v_fma_mix_f32 v26, v57, v42, v34 op_sel:[0,0,0] op_sel_hi:[1,0,0]
    v_fma_mix_f32 v27, v57, v43, v35 op_sel:[1,0,0] op_sel_hi:[1,0,0]
    v_cvt_pk_bf16_f32 v57, v26, v27
    v_fma_mix_f32 v24, v58, v44, v36 op_sel:[0,0,0] op_sel_hi:[1,0,0]
    v_mfma_f32_32x32x16_bf16 v[144:159], a[132:135], v[48:51], v[144:159]
    ds_read_b64_tr_b16 a[148:149], v21 offset:36864
    ds_read_b128 v[248:251], v30 offset:3200
    v_fma_mix_f32 v25, v58, v45, v37 op_sel:[1,0,0] op_sel_hi:[1,0,0]
    v_cvt_pk_bf16_f32 v58, v24, v25
    v_fma_mix_f32 v26, v59, v46, v38 op_sel:[0,0,0] op_sel_hi:[1,0,0]
    v_mfma_f32_32x32x16_bf16 v[160:175], a[132:135], v[52:55], v[160:175]
    ds_read_b64_tr_b16 a[150:151], v21 offset:37888
    ds_read_b128 v[252:255], v30 offset:3216
    v_fma_mix_f32 v27, v59, v47, v39 op_sel:[1,0,0] op_sel_hi:[1,0,0]
    v_cvt_pk_bf16_f32 v59, v26, v27
    v_fma_mix_f32 v24, v60, v40, v32 op_sel:[0,0,0] op_sel_hi:[1,0,0]
    s_waitcnt lgkmcnt(8)
    v_mfma_f32_32x32x16_bf16 v[176:191], a[136:139], v[48:51], v[176:191]
    ds_read_b64_tr_b16 a[152:153], v22 offset:36864
    buffer_load_dwordx4 v[104:107], v1, s[24:27], s47 offen offset:3072
    v_fma_mix_f32 v25, v60, v41, v33 op_sel:[1,0,0] op_sel_hi:[1,0,0]
    v_cvt_pk_bf16_f32 v60, v24, v25
    v_mfma_f32_32x32x16_bf16 v[192:207], a[136:139], v[52:55], v[192:207]
    ds_read_b64_tr_b16 a[154:155], v22 offset:37888
    v_fma_mix_f32 v26, v61, v42, v34 op_sel:[0,0,0] op_sel_hi:[1,0,0]
    v_fma_mix_f32 v27, v61, v43, v35 op_sel:[1,0,0] op_sel_hi:[1,0,0]
    v_cvt_pk_bf16_f32 v61, v26, v27
    v_fma_mix_f32 v24, v62, v44, v36 op_sel:[0,0,0] op_sel_hi:[1,0,0]
    v_mfma_f32_32x32x16_bf16 v[208:223], a[140:143], v[48:51], v[208:223]
    ds_read_b64_tr_b16 a[156:157], v23 offset:36864
    buffer_load_dwordx4 v[108:111], v2, s[24:27], s47 offen offset:3072
    v_fma_mix_f32 v25, v62, v45, v37 op_sel:[1,0,0] op_sel_hi:[1,0,0]
    v_mfma_f32_32x32x16_bf16 v[224:239], a[140:143], v[52:55], v[224:239]
    ds_read_b64_tr_b16 a[158:159], v23 offset:37888
    v_cvt_pk_bf16_f32 v62, v24, v25
    v_fma_mix_f32 v26, v63, v46, v38 op_sel:[0,0,0] op_sel_hi:[1,0,0]
    v_fma_mix_f32 v27, v63, v47, v39 op_sel:[1,0,0] op_sel_hi:[1,0,0]
    v_cvt_pk_bf16_f32 v63, v26, v27
    s_waitcnt vmcnt(14)
    s_waitcnt lgkmcnt(4)
    v_mfma_f32_32x32x16_bf16 v[112:127], a[144:147], v[56:59], v[112:127]
    ds_read_b64_tr_b16 a[160:161], v20 offset:40960
    ds_read_b128 v[32:35], v30 offset:704
    v_fma_mix_f32 v24, v64, v248, v240 op_sel:[0,0,0] op_sel_hi:[1,0,0]
    v_fma_mix_f32 v25, v64, v249, v241 op_sel:[1,0,0] op_sel_hi:[1,0,0]
    v_cvt_pk_bf16_f32 v64, v24, v25
    v_mfma_f32_32x32x16_bf16 v[128:143], a[144:147], v[60:63], v[128:143]
    ds_read_b64_tr_b16 a[162:163], v20 offset:41984
    ds_read_b128 v[36:39], v30 offset:720
    v_fma_mix_f32 v26, v65, v250, v242 op_sel:[0,0,0] op_sel_hi:[1,0,0]
    v_fma_mix_f32 v27, v65, v251, v243 op_sel:[1,0,0] op_sel_hi:[1,0,0]
    v_cvt_pk_bf16_f32 v65, v26, v27
    v_fma_mix_f32 v24, v66, v252, v244 op_sel:[0,0,0] op_sel_hi:[1,0,0]
    v_mfma_f32_32x32x16_bf16 v[144:159], a[148:151], v[56:59], v[144:159]
    ds_read_b64_tr_b16 a[164:165], v21 offset:40960
    ds_read_b128 v[40:43], v30 offset:3264
    v_fma_mix_f32 v25, v66, v253, v245 op_sel:[1,0,0] op_sel_hi:[1,0,0]
    v_cvt_pk_bf16_f32 v66, v24, v25
    v_fma_mix_f32 v26, v67, v254, v246 op_sel:[0,0,0] op_sel_hi:[1,0,0]
    v_mfma_f32_32x32x16_bf16 v[160:175], a[148:151], v[60:63], v[160:175]
    ds_read_b64_tr_b16 a[166:167], v21 offset:41984
    ds_read_b128 v[44:47], v30 offset:3280
    v_fma_mix_f32 v27, v67, v255, v247 op_sel:[1,0,0] op_sel_hi:[1,0,0]
    v_cvt_pk_bf16_f32 v67, v26, v27
    v_fma_mix_f32 v24, v68, v248, v240 op_sel:[0,0,0] op_sel_hi:[1,0,0]
    v_fma_mix_f32 v25, v68, v249, v241 op_sel:[1,0,0] op_sel_hi:[1,0,0]
    s_waitcnt lgkmcnt(8)
    v_mfma_f32_32x32x16_bf16 v[176:191], a[152:155], v[56:59], v[176:191]
    ds_read_b64_tr_b16 a[168:169], v22 offset:40960
    s_add_u32 s46, s35, 16384
    buffer_load_dwordx4 v[48:51], v1, s[24:27], s46 offen offset:0
    v_mfma_f32_32x32x16_bf16 v[192:207], a[152:155], v[60:63], v[192:207]
    ds_read_b64_tr_b16 a[170:171], v22 offset:41984
    v_cvt_pk_bf16_f32 v68, v24, v25
    v_fma_mix_f32 v26, v69, v250, v242 op_sel:[0,0,0] op_sel_hi:[1,0,0]
    v_fma_mix_f32 v27, v69, v251, v243 op_sel:[1,0,0] op_sel_hi:[1,0,0]
    v_cvt_pk_bf16_f32 v69, v26, v27
    v_fma_mix_f32 v24, v70, v252, v244 op_sel:[0,0,0] op_sel_hi:[1,0,0]
    v_mfma_f32_32x32x16_bf16 v[208:223], a[156:159], v[56:59], v[208:223]
    ds_read_b64_tr_b16 a[172:173], v23 offset:40960
    buffer_load_dwordx4 v[52:55], v2, s[24:27], s46 offen offset:0
    v_fma_mix_f32 v25, v70, v253, v245 op_sel:[1,0,0] op_sel_hi:[1,0,0]
    v_mfma_f32_32x32x16_bf16 v[224:239], a[156:159], v[60:63], v[224:239]
    ds_read_b64_tr_b16 a[174:175], v23 offset:41984
    v_cvt_pk_bf16_f32 v70, v24, v25
    v_fma_mix_f32 v26, v71, v254, v246 op_sel:[0,0,0] op_sel_hi:[1,0,0]
    v_fma_mix_f32 v27, v71, v255, v247 op_sel:[1,0,0] op_sel_hi:[1,0,0]
    v_cvt_pk_bf16_f32 v71, v26, v27
    s_waitcnt vmcnt(14)
    s_waitcnt lgkmcnt(4)
    v_mfma_f32_32x32x16_bf16 v[112:127], a[160:163], v[64:67], v[112:127]
    ds_read_b64_tr_b16 a[176:177], v20 offset:45056
    ds_read_b128 v[240:243], v30 offset:768
    v_fma_mix_f32 v24, v72, v40, v32 op_sel:[0,0,0] op_sel_hi:[1,0,0]
    v_fma_mix_f32 v25, v72, v41, v33 op_sel:[1,0,0] op_sel_hi:[1,0,0]
    v_cvt_pk_bf16_f32 v72, v24, v25
    v_mfma_f32_32x32x16_bf16 v[128:143], a[160:163], v[68:71], v[128:143]
    ds_read_b64_tr_b16 a[178:179], v20 offset:46080
    ds_read_b128 v[244:247], v30 offset:784
    v_fma_mix_f32 v26, v73, v42, v34 op_sel:[0,0,0] op_sel_hi:[1,0,0]
    v_fma_mix_f32 v27, v73, v43, v35 op_sel:[1,0,0] op_sel_hi:[1,0,0]
    v_cvt_pk_bf16_f32 v73, v26, v27
    v_fma_mix_f32 v24, v74, v44, v36 op_sel:[0,0,0] op_sel_hi:[1,0,0]
    v_mfma_f32_32x32x16_bf16 v[144:159], a[164:167], v[64:67], v[144:159]
    ds_read_b64_tr_b16 a[180:181], v21 offset:45056
    ds_read_b128 v[248:251], v30 offset:3328
    v_fma_mix_f32 v25, v74, v45, v37 op_sel:[1,0,0] op_sel_hi:[1,0,0]
    v_cvt_pk_bf16_f32 v74, v24, v25
    v_fma_mix_f32 v26, v75, v46, v38 op_sel:[0,0,0] op_sel_hi:[1,0,0]
    v_mfma_f32_32x32x16_bf16 v[160:175], a[164:167], v[68:71], v[160:175]
    ds_read_b64_tr_b16 a[182:183], v21 offset:46080
    ds_read_b128 v[252:255], v30 offset:3344
    v_fma_mix_f32 v27, v75, v47, v39 op_sel:[1,0,0] op_sel_hi:[1,0,0]
    v_cvt_pk_bf16_f32 v75, v26, v27
    v_fma_mix_f32 v24, v76, v40, v32 op_sel:[0,0,0] op_sel_hi:[1,0,0]
    s_waitcnt lgkmcnt(8)
    v_mfma_f32_32x32x16_bf16 v[176:191], a[168:171], v[64:67], v[176:191]
    ds_read_b64_tr_b16 a[184:185], v22 offset:45056
    buffer_load_dwordx4 v[56:59], v1, s[24:27], s46 offen offset:1024
    v_fma_mix_f32 v25, v76, v41, v33 op_sel:[1,0,0] op_sel_hi:[1,0,0]
    v_cvt_pk_bf16_f32 v76, v24, v25
    v_mfma_f32_32x32x16_bf16 v[192:207], a[168:171], v[68:71], v[192:207]
    ds_read_b64_tr_b16 a[186:187], v22 offset:46080
    v_fma_mix_f32 v26, v77, v42, v34 op_sel:[0,0,0] op_sel_hi:[1,0,0]
    v_fma_mix_f32 v27, v77, v43, v35 op_sel:[1,0,0] op_sel_hi:[1,0,0]
    v_cvt_pk_bf16_f32 v77, v26, v27
    v_fma_mix_f32 v24, v78, v44, v36 op_sel:[0,0,0] op_sel_hi:[1,0,0]
    v_mfma_f32_32x32x16_bf16 v[208:223], a[172:175], v[64:67], v[208:223]
    ds_read_b64_tr_b16 a[188:189], v23 offset:45056
    buffer_load_dwordx4 v[60:63], v2, s[24:27], s46 offen offset:1024
    v_fma_mix_f32 v25, v78, v45, v37 op_sel:[1,0,0] op_sel_hi:[1,0,0]
    v_mfma_f32_32x32x16_bf16 v[224:239], a[172:175], v[68:71], v[224:239]
    ds_read_b64_tr_b16 a[190:191], v23 offset:46080
    v_cvt_pk_bf16_f32 v78, v24, v25
    v_fma_mix_f32 v26, v79, v46, v38 op_sel:[0,0,0] op_sel_hi:[1,0,0]
    v_fma_mix_f32 v27, v79, v47, v39 op_sel:[1,0,0] op_sel_hi:[1,0,0]
    v_cvt_pk_bf16_f32 v79, v26, v27
    s_barrier
    s_waitcnt vmcnt(14)
    s_waitcnt lgkmcnt(4)
    v_mfma_f32_32x32x16_bf16 v[112:127], a[176:179], v[72:75], v[112:127]
    ds_read_b64_tr_b16 a[128:129], v20 offset:49152
    ds_read_b128 v[32:35], v30 offset:832
    v_fma_mix_f32 v24, v80, v248, v240 op_sel:[0,0,0] op_sel_hi:[1,0,0]
    v_fma_mix_f32 v25, v80, v249, v241 op_sel:[1,0,0] op_sel_hi:[1,0,0]
    v_cvt_pk_bf16_f32 v80, v24, v25
    v_fma_mix_f32 v26, v81, v250, v242 op_sel:[0,0,0] op_sel_hi:[1,0,0]
    v_fma_mix_f32 v27, v81, v251, v243 op_sel:[1,0,0] op_sel_hi:[1,0,0]
    v_cvt_pk_bf16_f32 v81, v26, v27
    v_mfma_f32_32x32x16_bf16 v[128:143], a[176:179], v[76:79], v[128:143]
    ds_read_b64_tr_b16 a[130:131], v20 offset:50176
    ds_read_b128 v[36:39], v30 offset:848
    v_fma_mix_f32 v24, v82, v252, v244 op_sel:[0,0,0] op_sel_hi:[1,0,0]
    v_fma_mix_f32 v25, v82, v253, v245 op_sel:[1,0,0] op_sel_hi:[1,0,0]
    v_cvt_pk_bf16_f32 v82, v24, v25
    v_fma_mix_f32 v26, v83, v254, v246 op_sel:[0,0,0] op_sel_hi:[1,0,0]
    v_fma_mix_f32 v27, v83, v255, v247 op_sel:[1,0,0] op_sel_hi:[1,0,0]
    v_cvt_pk_bf16_f32 v83, v26, v27
    v_fma_mix_f32 v24, v84, v248, v240 op_sel:[0,0,0] op_sel_hi:[1,0,0]
    v_mfma_f32_32x32x16_bf16 v[144:159], a[180:183], v[72:75], v[144:159]
    ds_read_b64_tr_b16 a[132:133], v21 offset:49152
    ds_read_b128 v[40:43], v30 offset:3392
    s_add_u32 m0, s38, 114688
    s_add_u32 s39, s36, 2621440
    buffer_load_dwordx4 v3, s[12:15], s39 offen offset:0 nt lds
    v_mfma_f32_32x32x16_bf16 v[160:175], a[180:183], v[76:79], v[160:175]
    ds_read_b64_tr_b16 a[134:135], v21 offset:50176
    ds_read_b128 v[44:47], v30 offset:3408
    buffer_load_dwordx4 v4, s[12:15], s39 offen offset:1024 nt lds
    v_fma_mix_f32 v25, v84, v249, v241 op_sel:[1,0,0] op_sel_hi:[1,0,0]
    s_waitcnt lgkmcnt(8)
    v_mfma_f32_32x32x16_bf16 v[176:191], a[184:187], v[72:75], v[176:191]
    ds_read_b64_tr_b16 a[136:137], v22 offset:49152
    buffer_load_dwordx4 v5, s[12:15], s39 offen offset:2048 nt lds
    v_cvt_pk_bf16_f32 v84, v24, v25
    v_fma_mix_f32 v26, v85, v250, v242 op_sel:[0,0,0] op_sel_hi:[1,0,0]
    v_mfma_f32_32x32x16_bf16 v[192:207], a[184:187], v[76:79], v[192:207]
    ds_read_b64_tr_b16 a[138:139], v22 offset:50176
    buffer_load_dwordx4 v6, s[12:15], s39 offen offset:3072 nt lds
    v_fma_mix_f32 v27, v85, v251, v243 op_sel:[1,0,0] op_sel_hi:[1,0,0]
    v_cvt_pk_bf16_f32 v85, v26, v27
    v_fma_mix_f32 v24, v86, v252, v244 op_sel:[0,0,0] op_sel_hi:[1,0,0]
    v_mfma_f32_32x32x16_bf16 v[208:223], a[188:191], v[72:75], v[208:223]
    ds_read_b64_tr_b16 a[140:141], v23 offset:49152
    buffer_load_dwordx4 v[64:67], v1, s[24:27], s46 offen offset:2048
    v_fma_mix_f32 v25, v86, v253, v245 op_sel:[1,0,0] op_sel_hi:[1,0,0]
    v_cvt_pk_bf16_f32 v86, v24, v25
    v_mfma_f32_32x32x16_bf16 v[224:239], a[188:191], v[76:79], v[224:239]
    ds_read_b64_tr_b16 a[142:143], v23 offset:50176
    buffer_load_dwordx4 v[68:71], v2, s[24:27], s46 offen offset:2048
    v_fma_mix_f32 v26, v87, v254, v246 op_sel:[0,0,0] op_sel_hi:[1,0,0]
    v_fma_mix_f32 v27, v87, v255, v247 op_sel:[1,0,0] op_sel_hi:[1,0,0]
    v_cvt_pk_bf16_f32 v87, v26, v27
    s_waitcnt vmcnt(18)
    s_waitcnt lgkmcnt(4)
    v_mfma_f32_32x32x16_bf16 v[112:127], a[128:131], v[80:83], v[112:127]
    ds_read_b64_tr_b16 a[144:145], v20 offset:53248
    ds_read_b128 v[240:243], v30 offset:896
    v_fma_mix_f32 v24, v88, v40, v32 op_sel:[0,0,0] op_sel_hi:[1,0,0]
    v_fma_mix_f32 v25, v88, v41, v33 op_sel:[1,0,0] op_sel_hi:[1,0,0]
    v_cvt_pk_bf16_f32 v88, v24, v25
    v_mfma_f32_32x32x16_bf16 v[128:143], a[128:131], v[84:87], v[128:143]
    ds_read_b64_tr_b16 a[146:147], v20 offset:54272
    ds_read_b128 v[244:247], v30 offset:912
    v_fma_mix_f32 v26, v89, v42, v34 op_sel:[0,0,0] op_sel_hi:[1,0,0]
    v_fma_mix_f32 v27, v89, v43, v35 op_sel:[1,0,0] op_sel_hi:[1,0,0]
    v_cvt_pk_bf16_f32 v89, v26, v27
    v_fma_mix_f32 v24, v90, v44, v36 op_sel:[0,0,0] op_sel_hi:[1,0,0]
    v_mfma_f32_32x32x16_bf16 v[144:159], a[132:135], v[80:83], v[144:159]
    ds_read_b64_tr_b16 a[148:149], v21 offset:53248
    ds_read_b128 v[248:251], v30 offset:3456
    v_fma_mix_f32 v25, v90, v45, v37 op_sel:[1,0,0] op_sel_hi:[1,0,0]
    v_cvt_pk_bf16_f32 v90, v24, v25
    v_fma_mix_f32 v26, v91, v46, v38 op_sel:[0,0,0] op_sel_hi:[1,0,0]
    v_mfma_f32_32x32x16_bf16 v[160:175], a[132:135], v[84:87], v[160:175]
    ds_read_b64_tr_b16 a[150:151], v21 offset:54272
    ds_read_b128 v[252:255], v30 offset:3472
    v_fma_mix_f32 v27, v91, v47, v39 op_sel:[1,0,0] op_sel_hi:[1,0,0]
    v_cvt_pk_bf16_f32 v91, v26, v27
    v_fma_mix_f32 v24, v92, v40, v32 op_sel:[0,0,0] op_sel_hi:[1,0,0]
    s_waitcnt lgkmcnt(8)
    v_mfma_f32_32x32x16_bf16 v[176:191], a[136:139], v[80:83], v[176:191]
    ds_read_b64_tr_b16 a[152:153], v22 offset:53248
    buffer_load_dwordx4 v[72:75], v1, s[24:27], s46 offen offset:3072
    v_fma_mix_f32 v25, v92, v41, v33 op_sel:[1,0,0] op_sel_hi:[1,0,0]
    v_cvt_pk_bf16_f32 v92, v24, v25
    v_mfma_f32_32x32x16_bf16 v[192:207], a[136:139], v[84:87], v[192:207]
    ds_read_b64_tr_b16 a[154:155], v22 offset:54272
    v_fma_mix_f32 v26, v93, v42, v34 op_sel:[0,0,0] op_sel_hi:[1,0,0]
    v_fma_mix_f32 v27, v93, v43, v35 op_sel:[1,0,0] op_sel_hi:[1,0,0]
    v_cvt_pk_bf16_f32 v93, v26, v27
    v_fma_mix_f32 v24, v94, v44, v36 op_sel:[0,0,0] op_sel_hi:[1,0,0]
    v_mfma_f32_32x32x16_bf16 v[208:223], a[140:143], v[80:83], v[208:223]
    ds_read_b64_tr_b16 a[156:157], v23 offset:53248
    buffer_load_dwordx4 v[76:79], v2, s[24:27], s46 offen offset:3072
    v_fma_mix_f32 v25, v94, v45, v37 op_sel:[1,0,0] op_sel_hi:[1,0,0]
    v_mfma_f32_32x32x16_bf16 v[224:239], a[140:143], v[84:87], v[224:239]
    ds_read_b64_tr_b16 a[158:159], v23 offset:54272
    v_cvt_pk_bf16_f32 v94, v24, v25
    v_fma_mix_f32 v26, v95, v46, v38 op_sel:[0,0,0] op_sel_hi:[1,0,0]
    v_fma_mix_f32 v27, v95, v47, v39 op_sel:[1,0,0] op_sel_hi:[1,0,0]
    v_cvt_pk_bf16_f32 v95, v26, v27
    s_waitcnt vmcnt(14)
    s_waitcnt lgkmcnt(4)
    v_mfma_f32_32x32x16_bf16 v[112:127], a[144:147], v[88:91], v[112:127]
    ds_read_b64_tr_b16 a[160:161], v20 offset:57344
    ds_read_b128 v[32:35], v30 offset:960
    v_fma_mix_f32 v24, v96, v248, v240 op_sel:[0,0,0] op_sel_hi:[1,0,0]
    v_fma_mix_f32 v25, v96, v249, v241 op_sel:[1,0,0] op_sel_hi:[1,0,0]
    v_cvt_pk_bf16_f32 v96, v24, v25
    v_mfma_f32_32x32x16_bf16 v[128:143], a[144:147], v[92:95], v[128:143]
    ds_read_b64_tr_b16 a[162:163], v20 offset:58368
    ds_read_b128 v[36:39], v30 offset:976
    v_fma_mix_f32 v26, v97, v250, v242 op_sel:[0,0,0] op_sel_hi:[1,0,0]
    v_fma_mix_f32 v27, v97, v251, v243 op_sel:[1,0,0] op_sel_hi:[1,0,0]
    v_cvt_pk_bf16_f32 v97, v26, v27
    v_fma_mix_f32 v24, v98, v252, v244 op_sel:[0,0,0] op_sel_hi:[1,0,0]
    v_mfma_f32_32x32x16_bf16 v[144:159], a[148:151], v[88:91], v[144:159]
    ds_read_b64_tr_b16 a[164:165], v21 offset:57344
    ds_read_b128 v[40:43], v30 offset:3520
    v_fma_mix_f32 v25, v98, v253, v245 op_sel:[1,0,0] op_sel_hi:[1,0,0]
    v_cvt_pk_bf16_f32 v98, v24, v25
    v_fma_mix_f32 v26, v99, v254, v246 op_sel:[0,0,0] op_sel_hi:[1,0,0]
    v_mfma_f32_32x32x16_bf16 v[160:175], a[148:151], v[92:95], v[160:175]
    ds_read_b64_tr_b16 a[166:167], v21 offset:58368
    ds_read_b128 v[44:47], v30 offset:3536
    v_fma_mix_f32 v27, v99, v255, v247 op_sel:[1,0,0] op_sel_hi:[1,0,0]
    v_cvt_pk_bf16_f32 v99, v26, v27
    v_fma_mix_f32 v24, v100, v248, v240 op_sel:[0,0,0] op_sel_hi:[1,0,0]
    v_fma_mix_f32 v25, v100, v249, v241 op_sel:[1,0,0] op_sel_hi:[1,0,0]
    s_waitcnt lgkmcnt(8)
    v_mfma_f32_32x32x16_bf16 v[176:191], a[152:155], v[88:91], v[176:191]
    ds_read_b64_tr_b16 a[168:169], v22 offset:57344
    s_add_u32 s47, s35, 20480
    buffer_load_dwordx4 v[80:83], v1, s[24:27], s47 offen offset:0
    v_mfma_f32_32x32x16_bf16 v[192:207], a[152:155], v[92:95], v[192:207]
    ds_read_b64_tr_b16 a[170:171], v22 offset:58368
    v_cvt_pk_bf16_f32 v100, v24, v25
    v_fma_mix_f32 v26, v101, v250, v242 op_sel:[0,0,0] op_sel_hi:[1,0,0]
    v_fma_mix_f32 v27, v101, v251, v243 op_sel:[1,0,0] op_sel_hi:[1,0,0]
    v_cvt_pk_bf16_f32 v101, v26, v27
    v_fma_mix_f32 v24, v102, v252, v244 op_sel:[0,0,0] op_sel_hi:[1,0,0]
    v_mfma_f32_32x32x16_bf16 v[208:223], a[156:159], v[88:91], v[208:223]
    ds_read_b64_tr_b16 a[172:173], v23 offset:57344
    buffer_load_dwordx4 v[84:87], v2, s[24:27], s47 offen offset:0
    v_fma_mix_f32 v25, v102, v253, v245 op_sel:[1,0,0] op_sel_hi:[1,0,0]
    v_mfma_f32_32x32x16_bf16 v[224:239], a[156:159], v[92:95], v[224:239]
    ds_read_b64_tr_b16 a[174:175], v23 offset:58368
    v_cvt_pk_bf16_f32 v102, v24, v25
    v_fma_mix_f32 v26, v103, v254, v246 op_sel:[0,0,0] op_sel_hi:[1,0,0]
    v_fma_mix_f32 v27, v103, v255, v247 op_sel:[1,0,0] op_sel_hi:[1,0,0]
    v_cvt_pk_bf16_f32 v103, v26, v27
    s_waitcnt vmcnt(14)
    s_waitcnt lgkmcnt(4)
    v_mfma_f32_32x32x16_bf16 v[112:127], a[160:163], v[96:99], v[112:127]
    ds_read_b64_tr_b16 a[176:177], v20 offset:61440
    ds_read_b128 v[240:243], v30 offset:1024
    v_fma_mix_f32 v24, v104, v40, v32 op_sel:[0,0,0] op_sel_hi:[1,0,0]
    v_fma_mix_f32 v25, v104, v41, v33 op_sel:[1,0,0] op_sel_hi:[1,0,0]
    v_cvt_pk_bf16_f32 v104, v24, v25
    v_mfma_f32_32x32x16_bf16 v[128:143], a[160:163], v[100:103], v[128:143]
    ds_read_b64_tr_b16 a[178:179], v20 offset:62464
    ds_read_b128 v[244:247], v30 offset:1040
    v_fma_mix_f32 v26, v105, v42, v34 op_sel:[0,0,0] op_sel_hi:[1,0,0]
    v_fma_mix_f32 v27, v105, v43, v35 op_sel:[1,0,0] op_sel_hi:[1,0,0]
    v_cvt_pk_bf16_f32 v105, v26, v27
    v_fma_mix_f32 v24, v106, v44, v36 op_sel:[0,0,0] op_sel_hi:[1,0,0]
    v_mfma_f32_32x32x16_bf16 v[144:159], a[164:167], v[96:99], v[144:159]
    ds_read_b64_tr_b16 a[180:181], v21 offset:61440
    ds_read_b128 v[248:251], v30 offset:3584
    v_fma_mix_f32 v25, v106, v45, v37 op_sel:[1,0,0] op_sel_hi:[1,0,0]
    v_cvt_pk_bf16_f32 v106, v24, v25
    v_fma_mix_f32 v26, v107, v46, v38 op_sel:[0,0,0] op_sel_hi:[1,0,0]
    v_mfma_f32_32x32x16_bf16 v[160:175], a[164:167], v[100:103], v[160:175]
    ds_read_b64_tr_b16 a[182:183], v21 offset:62464
    ds_read_b128 v[252:255], v30 offset:3600
    v_fma_mix_f32 v27, v107, v47, v39 op_sel:[1,0,0] op_sel_hi:[1,0,0]
    v_cvt_pk_bf16_f32 v107, v26, v27
    v_fma_mix_f32 v24, v108, v40, v32 op_sel:[0,0,0] op_sel_hi:[1,0,0]
    s_waitcnt lgkmcnt(8)
    v_mfma_f32_32x32x16_bf16 v[176:191], a[168:171], v[96:99], v[176:191]
    ds_read_b64_tr_b16 a[184:185], v22 offset:61440
    buffer_load_dwordx4 v[88:91], v1, s[24:27], s47 offen offset:1024
    v_fma_mix_f32 v25, v108, v41, v33 op_sel:[1,0,0] op_sel_hi:[1,0,0]
    v_cvt_pk_bf16_f32 v108, v24, v25
    v_mfma_f32_32x32x16_bf16 v[192:207], a[168:171], v[100:103], v[192:207]
    ds_read_b64_tr_b16 a[186:187], v22 offset:62464
    v_fma_mix_f32 v26, v109, v42, v34 op_sel:[0,0,0] op_sel_hi:[1,0,0]
    v_fma_mix_f32 v27, v109, v43, v35 op_sel:[1,0,0] op_sel_hi:[1,0,0]
    v_cvt_pk_bf16_f32 v109, v26, v27
    v_fma_mix_f32 v24, v110, v44, v36 op_sel:[0,0,0] op_sel_hi:[1,0,0]
    v_mfma_f32_32x32x16_bf16 v[208:223], a[172:175], v[96:99], v[208:223]
    ds_read_b64_tr_b16 a[188:189], v23 offset:61440
    buffer_load_dwordx4 v[92:95], v2, s[24:27], s47 offen offset:1024
    v_fma_mix_f32 v25, v110, v45, v37 op_sel:[1,0,0] op_sel_hi:[1,0,0]
    v_mfma_f32_32x32x16_bf16 v[224:239], a[172:175], v[100:103], v[224:239]
    ds_read_b64_tr_b16 a[190:191], v23 offset:62464
    v_cvt_pk_bf16_f32 v110, v24, v25
    v_fma_mix_f32 v26, v111, v46, v38 op_sel:[0,0,0] op_sel_hi:[1,0,0]
    v_fma_mix_f32 v27, v111, v47, v39 op_sel:[1,0,0] op_sel_hi:[1,0,0]
    v_cvt_pk_bf16_f32 v111, v26, v27
    s_barrier
    s_waitcnt vmcnt(14)
    s_waitcnt lgkmcnt(4)
    v_mfma_f32_32x32x16_bf16 v[112:127], a[176:179], v[104:107], v[112:127]
    ds_read_b64_tr_b16 a[128:129], v20 offset:0
    ds_read_b128 v[32:35], v30 offset:1088
    v_fma_mix_f32 v24, v48, v248, v240 op_sel:[0,0,0] op_sel_hi:[1,0,0]
    v_fma_mix_f32 v25, v48, v249, v241 op_sel:[1,0,0] op_sel_hi:[1,0,0]
    v_cvt_pk_bf16_f32 v48, v24, v25
    v_fma_mix_f32 v26, v49, v250, v242 op_sel:[0,0,0] op_sel_hi:[1,0,0]
    v_fma_mix_f32 v27, v49, v251, v243 op_sel:[1,0,0] op_sel_hi:[1,0,0]
    v_cvt_pk_bf16_f32 v49, v26, v27
    v_mfma_f32_32x32x16_bf16 v[128:143], a[176:179], v[108:111], v[128:143]
    ds_read_b64_tr_b16 a[130:131], v20 offset:1024
    ds_read_b128 v[36:39], v30 offset:1104
    v_fma_mix_f32 v24, v50, v252, v244 op_sel:[0,0,0] op_sel_hi:[1,0,0]
    v_fma_mix_f32 v25, v50, v253, v245 op_sel:[1,0,0] op_sel_hi:[1,0,0]
    v_cvt_pk_bf16_f32 v50, v24, v25
    v_fma_mix_f32 v26, v51, v254, v246 op_sel:[0,0,0] op_sel_hi:[1,0,0]
    v_fma_mix_f32 v27, v51, v255, v247 op_sel:[1,0,0] op_sel_hi:[1,0,0]
    v_cvt_pk_bf16_f32 v51, v26, v27
    v_fma_mix_f32 v24, v52, v248, v240 op_sel:[0,0,0] op_sel_hi:[1,0,0]
    v_mfma_f32_32x32x16_bf16 v[144:159], a[180:183], v[104:107], v[144:159]
    ds_read_b64_tr_b16 a[132:133], v21 offset:0
    ds_read_b128 v[40:43], v30 offset:3648
    s_add_u32 m0, s38, 131072
    s_add_u32 s39, s36, 3145728
    buffer_load_dwordx4 v3, s[12:15], s39 offen offset:0 nt lds
    v_mfma_f32_32x32x16_bf16 v[160:175], a[180:183], v[108:111], v[160:175]
    ds_read_b64_tr_b16 a[134:135], v21 offset:1024
    ds_read_b128 v[44:47], v30 offset:3664
    buffer_load_dwordx4 v4, s[12:15], s39 offen offset:1024 nt lds
    v_fma_mix_f32 v25, v52, v249, v241 op_sel:[1,0,0] op_sel_hi:[1,0,0]
    s_waitcnt lgkmcnt(8)
    v_mfma_f32_32x32x16_bf16 v[176:191], a[184:187], v[104:107], v[176:191]
    ds_read_b64_tr_b16 a[136:137], v22 offset:0
    buffer_load_dwordx4 v5, s[12:15], s39 offen offset:2048 nt lds
    v_cvt_pk_bf16_f32 v52, v24, v25
    v_fma_mix_f32 v26, v53, v250, v242 op_sel:[0,0,0] op_sel_hi:[1,0,0]
    v_mfma_f32_32x32x16_bf16 v[192:207], a[184:187], v[108:111], v[192:207]
    ds_read_b64_tr_b16 a[138:139], v22 offset:1024
    buffer_load_dwordx4 v6, s[12:15], s39 offen offset:3072 nt lds
    v_fma_mix_f32 v27, v53, v251, v243 op_sel:[1,0,0] op_sel_hi:[1,0,0]
    v_cvt_pk_bf16_f32 v53, v26, v27
    v_fma_mix_f32 v24, v54, v252, v244 op_sel:[0,0,0] op_sel_hi:[1,0,0]
    v_mfma_f32_32x32x16_bf16 v[208:223], a[188:191], v[104:107], v[208:223]
    ds_read_b64_tr_b16 a[140:141], v23 offset:0
    buffer_load_dwordx4 v[96:99], v1, s[24:27], s47 offen offset:2048
    v_fma_mix_f32 v25, v54, v253, v245 op_sel:[1,0,0] op_sel_hi:[1,0,0]
    v_cvt_pk_bf16_f32 v54, v24, v25
    v_mfma_f32_32x32x16_bf16 v[224:239], a[188:191], v[108:111], v[224:239]
    ds_read_b64_tr_b16 a[142:143], v23 offset:1024
    buffer_load_dwordx4 v[100:103], v2, s[24:27], s47 offen offset:2048
    v_fma_mix_f32 v26, v55, v254, v246 op_sel:[0,0,0] op_sel_hi:[1,0,0]
    v_fma_mix_f32 v27, v55, v255, v247 op_sel:[1,0,0] op_sel_hi:[1,0,0]
    v_cvt_pk_bf16_f32 v55, v26, v27
    s_waitcnt vmcnt(18)
    s_waitcnt lgkmcnt(4)
    v_mfma_f32_32x32x16_bf16 v[112:127], a[128:131], v[48:51], v[112:127]
    ds_read_b64_tr_b16 a[144:145], v20 offset:4096
    ds_read_b128 v[240:243], v30 offset:1152
    v_fma_mix_f32 v24, v56, v40, v32 op_sel:[0,0,0] op_sel_hi:[1,0,0]
    v_fma_mix_f32 v25, v56, v41, v33 op_sel:[1,0,0] op_sel_hi:[1,0,0]
    v_cvt_pk_bf16_f32 v56, v24, v25
    v_mfma_f32_32x32x16_bf16 v[128:143], a[128:131], v[52:55], v[128:143]
    ds_read_b64_tr_b16 a[146:147], v20 offset:5120
    ds_read_b128 v[244:247], v30 offset:1168
    v_fma_mix_f32 v26, v57, v42, v34 op_sel:[0,0,0] op_sel_hi:[1,0,0]
    v_fma_mix_f32 v27, v57, v43, v35 op_sel:[1,0,0] op_sel_hi:[1,0,0]
    v_cvt_pk_bf16_f32 v57, v26, v27
    v_fma_mix_f32 v24, v58, v44, v36 op_sel:[0,0,0] op_sel_hi:[1,0,0]
    v_mfma_f32_32x32x16_bf16 v[144:159], a[132:135], v[48:51], v[144:159]
    ds_read_b64_tr_b16 a[148:149], v21 offset:4096
    ds_read_b128 v[248:251], v30 offset:3712
    v_fma_mix_f32 v25, v58, v45, v37 op_sel:[1,0,0] op_sel_hi:[1,0,0]
    v_cvt_pk_bf16_f32 v58, v24, v25
    v_fma_mix_f32 v26, v59, v46, v38 op_sel:[0,0,0] op_sel_hi:[1,0,0]
    v_mfma_f32_32x32x16_bf16 v[160:175], a[132:135], v[52:55], v[160:175]
    ds_read_b64_tr_b16 a[150:151], v21 offset:5120
    ds_read_b128 v[252:255], v30 offset:3728
    v_fma_mix_f32 v27, v59, v47, v39 op_sel:[1,0,0] op_sel_hi:[1,0,0]
    v_cvt_pk_bf16_f32 v59, v26, v27
    v_fma_mix_f32 v24, v60, v40, v32 op_sel:[0,0,0] op_sel_hi:[1,0,0]
    s_waitcnt lgkmcnt(8)
    v_mfma_f32_32x32x16_bf16 v[176:191], a[136:139], v[48:51], v[176:191]
    ds_read_b64_tr_b16 a[152:153], v22 offset:4096
    buffer_load_dwordx4 v[104:107], v1, s[24:27], s47 offen offset:3072
    v_fma_mix_f32 v25, v60, v41, v33 op_sel:[1,0,0] op_sel_hi:[1,0,0]
    v_cvt_pk_bf16_f32 v60, v24, v25
    v_mfma_f32_32x32x16_bf16 v[192:207], a[136:139], v[52:55], v[192:207]
    ds_read_b64_tr_b16 a[154:155], v22 offset:5120
    v_fma_mix_f32 v26, v61, v42, v34 op_sel:[0,0,0] op_sel_hi:[1,0,0]
    v_fma_mix_f32 v27, v61, v43, v35 op_sel:[1,0,0] op_sel_hi:[1,0,0]
    v_cvt_pk_bf16_f32 v61, v26, v27
    v_fma_mix_f32 v24, v62, v44, v36 op_sel:[0,0,0] op_sel_hi:[1,0,0]
    v_mfma_f32_32x32x16_bf16 v[208:223], a[140:143], v[48:51], v[208:223]
    ds_read_b64_tr_b16 a[156:157], v23 offset:4096
    buffer_load_dwordx4 v[108:111], v2, s[24:27], s47 offen offset:3072
    v_fma_mix_f32 v25, v62, v45, v37 op_sel:[1,0,0] op_sel_hi:[1,0,0]
    v_mfma_f32_32x32x16_bf16 v[224:239], a[140:143], v[52:55], v[224:239]
    ds_read_b64_tr_b16 a[158:159], v23 offset:5120
    v_cvt_pk_bf16_f32 v62, v24, v25
    v_fma_mix_f32 v26, v63, v46, v38 op_sel:[0,0,0] op_sel_hi:[1,0,0]
    v_fma_mix_f32 v27, v63, v47, v39 op_sel:[1,0,0] op_sel_hi:[1,0,0]
    v_cvt_pk_bf16_f32 v63, v26, v27
    s_waitcnt vmcnt(14)
    s_waitcnt lgkmcnt(4)
    v_mfma_f32_32x32x16_bf16 v[112:127], a[144:147], v[56:59], v[112:127]
    ds_read_b64_tr_b16 a[160:161], v20 offset:8192
    ds_read_b128 v[32:35], v30 offset:1216
    v_fma_mix_f32 v24, v64, v248, v240 op_sel:[0,0,0] op_sel_hi:[1,0,0]
    v_fma_mix_f32 v25, v64, v249, v241 op_sel:[1,0,0] op_sel_hi:[1,0,0]
    v_cvt_pk_bf16_f32 v64, v24, v25
    v_mfma_f32_32x32x16_bf16 v[128:143], a[144:147], v[60:63], v[128:143]
    ds_read_b64_tr_b16 a[162:163], v20 offset:9216
    ds_read_b128 v[36:39], v30 offset:1232
    v_fma_mix_f32 v26, v65, v250, v242 op_sel:[0,0,0] op_sel_hi:[1,0,0]
    v_fma_mix_f32 v27, v65, v251, v243 op_sel:[1,0,0] op_sel_hi:[1,0,0]
    v_cvt_pk_bf16_f32 v65, v26, v27
    v_fma_mix_f32 v24, v66, v252, v244 op_sel:[0,0,0] op_sel_hi:[1,0,0]
    v_mfma_f32_32x32x16_bf16 v[144:159], a[148:151], v[56:59], v[144:159]
    ds_read_b64_tr_b16 a[164:165], v21 offset:8192
    ds_read_b128 v[40:43], v30 offset:3776
    v_fma_mix_f32 v25, v66, v253, v245 op_sel:[1,0,0] op_sel_hi:[1,0,0]
    v_cvt_pk_bf16_f32 v66, v24, v25
    v_fma_mix_f32 v26, v67, v254, v246 op_sel:[0,0,0] op_sel_hi:[1,0,0]
    v_mfma_f32_32x32x16_bf16 v[160:175], a[148:151], v[60:63], v[160:175]
    ds_read_b64_tr_b16 a[166:167], v21 offset:9216
    ds_read_b128 v[44:47], v30 offset:3792
    v_fma_mix_f32 v27, v67, v255, v247 op_sel:[1,0,0] op_sel_hi:[1,0,0]
    v_cvt_pk_bf16_f32 v67, v26, v27
    v_fma_mix_f32 v24, v68, v248, v240 op_sel:[0,0,0] op_sel_hi:[1,0,0]
    v_fma_mix_f32 v25, v68, v249, v241 op_sel:[1,0,0] op_sel_hi:[1,0,0]
    s_waitcnt lgkmcnt(8)
    v_mfma_f32_32x32x16_bf16 v[176:191], a[152:155], v[56:59], v[176:191]
    ds_read_b64_tr_b16 a[168:169], v22 offset:8192
    s_add_u32 s46, s35, 24576
    buffer_load_dwordx4 v[48:51], v1, s[24:27], s46 offen offset:0
    v_mfma_f32_32x32x16_bf16 v[192:207], a[152:155], v[60:63], v[192:207]
    ds_read_b64_tr_b16 a[170:171], v22 offset:9216
    v_cvt_pk_bf16_f32 v68, v24, v25
    v_fma_mix_f32 v26, v69, v250, v242 op_sel:[0,0,0] op_sel_hi:[1,0,0]
    v_fma_mix_f32 v27, v69, v251, v243 op_sel:[1,0,0] op_sel_hi:[1,0,0]
    v_cvt_pk_bf16_f32 v69, v26, v27
    v_fma_mix_f32 v24, v70, v252, v244 op_sel:[0,0,0] op_sel_hi:[1,0,0]
    v_mfma_f32_32x32x16_bf16 v[208:223], a[156:159], v[56:59], v[208:223]
    ds_read_b64_tr_b16 a[172:173], v23 offset:8192
    buffer_load_dwordx4 v[52:55], v2, s[24:27], s46 offen offset:0
    v_fma_mix_f32 v25, v70, v253, v245 op_sel:[1,0,0] op_sel_hi:[1,0,0]
    v_mfma_f32_32x32x16_bf16 v[224:239], a[156:159], v[60:63], v[224:239]
    ds_read_b64_tr_b16 a[174:175], v23 offset:9216
    v_cvt_pk_bf16_f32 v70, v24, v25
    v_fma_mix_f32 v26, v71, v254, v246 op_sel:[0,0,0] op_sel_hi:[1,0,0]
    v_fma_mix_f32 v27, v71, v255, v247 op_sel:[1,0,0] op_sel_hi:[1,0,0]
    v_cvt_pk_bf16_f32 v71, v26, v27
    s_waitcnt vmcnt(14)
    s_waitcnt lgkmcnt(4)
    v_mfma_f32_32x32x16_bf16 v[112:127], a[160:163], v[64:67], v[112:127]
    ds_read_b64_tr_b16 a[176:177], v20 offset:12288
    ds_read_b128 v[240:243], v30 offset:1280
    v_fma_mix_f32 v24, v72, v40, v32 op_sel:[0,0,0] op_sel_hi:[1,0,0]
    v_fma_mix_f32 v25, v72, v41, v33 op_sel:[1,0,0] op_sel_hi:[1,0,0]
    v_cvt_pk_bf16_f32 v72, v24, v25
    v_mfma_f32_32x32x16_bf16 v[128:143], a[160:163], v[68:71], v[128:143]
    ds_read_b64_tr_b16 a[178:179], v20 offset:13312
    ds_read_b128 v[244:247], v30 offset:1296
    v_fma_mix_f32 v26, v73, v42, v34 op_sel:[0,0,0] op_sel_hi:[1,0,0]
    v_fma_mix_f32 v27, v73, v43, v35 op_sel:[1,0,0] op_sel_hi:[1,0,0]
    v_cvt_pk_bf16_f32 v73, v26, v27
    v_fma_mix_f32 v24, v74, v44, v36 op_sel:[0,0,0] op_sel_hi:[1,0,0]
    v_mfma_f32_32x32x16_bf16 v[144:159], a[164:167], v[64:67], v[144:159]
    ds_read_b64_tr_b16 a[180:181], v21 offset:12288
    ds_read_b128 v[248:251], v30 offset:3840
    v_fma_mix_f32 v25, v74, v45, v37 op_sel:[1,0,0] op_sel_hi:[1,0,0]
    v_cvt_pk_bf16_f32 v74, v24, v25
    v_fma_mix_f32 v26, v75, v46, v38 op_sel:[0,0,0] op_sel_hi:[1,0,0]
    v_mfma_f32_32x32x16_bf16 v[160:175], a[164:167], v[68:71], v[160:175]
    ds_read_b64_tr_b16 a[182:183], v21 offset:13312
    ds_read_b128 v[252:255], v30 offset:3856
    v_fma_mix_f32 v27, v75, v47, v39 op_sel:[1,0,0] op_sel_hi:[1,0,0]
    v_cvt_pk_bf16_f32 v75, v26, v27
    v_fma_mix_f32 v24, v76, v40, v32 op_sel:[0,0,0] op_sel_hi:[1,0,0]
    s_waitcnt lgkmcnt(8)
    v_mfma_f32_32x32x16_bf16 v[176:191], a[168:171], v[64:67], v[176:191]
    ds_read_b64_tr_b16 a[184:185], v22 offset:12288
    buffer_load_dwordx4 v[56:59], v1, s[24:27], s46 offen offset:1024
    v_fma_mix_f32 v25, v76, v41, v33 op_sel:[1,0,0] op_sel_hi:[1,0,0]
    v_cvt_pk_bf16_f32 v76, v24, v25
    v_mfma_f32_32x32x16_bf16 v[192:207], a[168:171], v[68:71], v[192:207]
    ds_read_b64_tr_b16 a[186:187], v22 offset:13312
    v_fma_mix_f32 v26, v77, v42, v34 op_sel:[0,0,0] op_sel_hi:[1,0,0]
    v_fma_mix_f32 v27, v77, v43, v35 op_sel:[1,0,0] op_sel_hi:[1,0,0]
    v_cvt_pk_bf16_f32 v77, v26, v27
    v_fma_mix_f32 v24, v78, v44, v36 op_sel:[0,0,0] op_sel_hi:[1,0,0]
    v_mfma_f32_32x32x16_bf16 v[208:223], a[172:175], v[64:67], v[208:223]
    ds_read_b64_tr_b16 a[188:189], v23 offset:12288
    buffer_load_dwordx4 v[60:63], v2, s[24:27], s46 offen offset:1024
    v_fma_mix_f32 v25, v78, v45, v37 op_sel:[1,0,0] op_sel_hi:[1,0,0]
    v_mfma_f32_32x32x16_bf16 v[224:239], a[172:175], v[68:71], v[224:239]
    ds_read_b64_tr_b16 a[190:191], v23 offset:13312
    v_cvt_pk_bf16_f32 v78, v24, v25
    v_fma_mix_f32 v26, v79, v46, v38 op_sel:[0,0,0] op_sel_hi:[1,0,0]
    v_fma_mix_f32 v27, v79, v47, v39 op_sel:[1,0,0] op_sel_hi:[1,0,0]
    v_cvt_pk_bf16_f32 v79, v26, v27
    s_barrier
    s_waitcnt vmcnt(14)
    s_waitcnt lgkmcnt(4)
    v_mfma_f32_32x32x16_bf16 v[112:127], a[176:179], v[72:75], v[112:127]
    ds_read_b64_tr_b16 a[128:129], v20 offset:16384
    ds_read_b128 v[32:35], v30 offset:1344
    v_fma_mix_f32 v24, v80, v248, v240 op_sel:[0,0,0] op_sel_hi:[1,0,0]
    v_fma_mix_f32 v25, v80, v249, v241 op_sel:[1,0,0] op_sel_hi:[1,0,0]
    v_cvt_pk_bf16_f32 v80, v24, v25
    v_fma_mix_f32 v26, v81, v250, v242 op_sel:[0,0,0] op_sel_hi:[1,0,0]
    v_fma_mix_f32 v27, v81, v251, v243 op_sel:[1,0,0] op_sel_hi:[1,0,0]
    v_cvt_pk_bf16_f32 v81, v26, v27
    v_mfma_f32_32x32x16_bf16 v[128:143], a[176:179], v[76:79], v[128:143]
    ds_read_b64_tr_b16 a[130:131], v20 offset:17408
    ds_read_b128 v[36:39], v30 offset:1360
    v_fma_mix_f32 v24, v82, v252, v244 op_sel:[0,0,0] op_sel_hi:[1,0,0]
    v_fma_mix_f32 v25, v82, v253, v245 op_sel:[1,0,0] op_sel_hi:[1,0,0]
    v_cvt_pk_bf16_f32 v82, v24, v25
    v_fma_mix_f32 v26, v83, v254, v246 op_sel:[0,0,0] op_sel_hi:[1,0,0]
    v_fma_mix_f32 v27, v83, v255, v247 op_sel:[1,0,0] op_sel_hi:[1,0,0]
    v_cvt_pk_bf16_f32 v83, v26, v27
    v_fma_mix_f32 v24, v84, v248, v240 op_sel:[0,0,0] op_sel_hi:[1,0,0]
    v_mfma_f32_32x32x16_bf16 v[144:159], a[180:183], v[72:75], v[144:159]
    ds_read_b64_tr_b16 a[132:133], v21 offset:16384
    ds_read_b128 v[40:43], v30 offset:3904
    s_add_u32 m0, s38, 147456
    s_add_u32 s39, s36, 3670016
    buffer_load_dwordx4 v3, s[12:15], s39 offen offset:0 nt lds
    v_mfma_f32_32x32x16_bf16 v[160:175], a[180:183], v[76:79], v[160:175]
    ds_read_b64_tr_b16 a[134:135], v21 offset:17408
    ds_read_b128 v[44:47], v30 offset:3920
    buffer_load_dwordx4 v4, s[12:15], s39 offen offset:1024 nt lds
    v_fma_mix_f32 v25, v84, v249, v241 op_sel:[1,0,0] op_sel_hi:[1,0,0]
    s_waitcnt lgkmcnt(8)
    v_mfma_f32_32x32x16_bf16 v[176:191], a[184:187], v[72:75], v[176:191]
    ds_read_b64_tr_b16 a[136:137], v22 offset:16384
    buffer_load_dwordx4 v5, s[12:15], s39 offen offset:2048 nt lds
    v_cvt_pk_bf16_f32 v84, v24, v25
    v_fma_mix_f32 v26, v85, v250, v242 op_sel:[0,0,0] op_sel_hi:[1,0,0]
    v_mfma_f32_32x32x16_bf16 v[192:207], a[184:187], v[76:79], v[192:207]
    ds_read_b64_tr_b16 a[138:139], v22 offset:17408
    buffer_load_dwordx4 v6, s[12:15], s39 offen offset:3072 nt lds
    v_fma_mix_f32 v27, v85, v251, v243 op_sel:[1,0,0] op_sel_hi:[1,0,0]
    v_cvt_pk_bf16_f32 v85, v26, v27
    v_fma_mix_f32 v24, v86, v252, v244 op_sel:[0,0,0] op_sel_hi:[1,0,0]
    v_mfma_f32_32x32x16_bf16 v[208:223], a[188:191], v[72:75], v[208:223]
    ds_read_b64_tr_b16 a[140:141], v23 offset:16384
    buffer_load_dwordx4 v[64:67], v1, s[24:27], s46 offen offset:2048
    v_fma_mix_f32 v25, v86, v253, v245 op_sel:[1,0,0] op_sel_hi:[1,0,0]
    v_cvt_pk_bf16_f32 v86, v24, v25
    v_mfma_f32_32x32x16_bf16 v[224:239], a[188:191], v[76:79], v[224:239]
    ds_read_b64_tr_b16 a[142:143], v23 offset:17408
    buffer_load_dwordx4 v[68:71], v2, s[24:27], s46 offen offset:2048
    v_fma_mix_f32 v26, v87, v254, v246 op_sel:[0,0,0] op_sel_hi:[1,0,0]
    v_fma_mix_f32 v27, v87, v255, v247 op_sel:[1,0,0] op_sel_hi:[1,0,0]
    v_cvt_pk_bf16_f32 v87, v26, v27
    s_waitcnt vmcnt(18)
    s_waitcnt lgkmcnt(4)
    v_mfma_f32_32x32x16_bf16 v[112:127], a[128:131], v[80:83], v[112:127]
    ds_read_b64_tr_b16 a[144:145], v20 offset:20480
    ds_read_b128 v[240:243], v30 offset:1408
    v_fma_mix_f32 v24, v88, v40, v32 op_sel:[0,0,0] op_sel_hi:[1,0,0]
    v_fma_mix_f32 v25, v88, v41, v33 op_sel:[1,0,0] op_sel_hi:[1,0,0]
    v_cvt_pk_bf16_f32 v88, v24, v25
    v_mfma_f32_32x32x16_bf16 v[128:143], a[128:131], v[84:87], v[128:143]
    ds_read_b64_tr_b16 a[146:147], v20 offset:21504
    ds_read_b128 v[244:247], v30 offset:1424
    v_fma_mix_f32 v26, v89, v42, v34 op_sel:[0,0,0] op_sel_hi:[1,0,0]
    v_fma_mix_f32 v27, v89, v43, v35 op_sel:[1,0,0] op_sel_hi:[1,0,0]
    v_cvt_pk_bf16_f32 v89, v26, v27
    v_fma_mix_f32 v24, v90, v44, v36 op_sel:[0,0,0] op_sel_hi:[1,0,0]
    v_mfma_f32_32x32x16_bf16 v[144:159], a[132:135], v[80:83], v[144:159]
    ds_read_b64_tr_b16 a[148:149], v21 offset:20480
    ds_read_b128 v[248:251], v30 offset:3968
    v_fma_mix_f32 v25, v90, v45, v37 op_sel:[1,0,0] op_sel_hi:[1,0,0]
    v_cvt_pk_bf16_f32 v90, v24, v25
    v_fma_mix_f32 v26, v91, v46, v38 op_sel:[0,0,0] op_sel_hi:[1,0,0]
    v_mfma_f32_32x32x16_bf16 v[160:175], a[132:135], v[84:87], v[160:175]
    ds_read_b64_tr_b16 a[150:151], v21 offset:21504
    ds_read_b128 v[252:255], v30 offset:3984
    v_fma_mix_f32 v27, v91, v47, v39 op_sel:[1,0,0] op_sel_hi:[1,0,0]
    v_cvt_pk_bf16_f32 v91, v26, v27
    v_fma_mix_f32 v24, v92, v40, v32 op_sel:[0,0,0] op_sel_hi:[1,0,0]
    s_waitcnt lgkmcnt(8)
    v_mfma_f32_32x32x16_bf16 v[176:191], a[136:139], v[80:83], v[176:191]
    ds_read_b64_tr_b16 a[152:153], v22 offset:20480
    buffer_load_dwordx4 v[72:75], v1, s[24:27], s46 offen offset:3072
    v_fma_mix_f32 v25, v92, v41, v33 op_sel:[1,0,0] op_sel_hi:[1,0,0]
    v_cvt_pk_bf16_f32 v92, v24, v25
    v_mfma_f32_32x32x16_bf16 v[192:207], a[136:139], v[84:87], v[192:207]
    ds_read_b64_tr_b16 a[154:155], v22 offset:21504
    v_fma_mix_f32 v26, v93, v42, v34 op_sel:[0,0,0] op_sel_hi:[1,0,0]
    v_fma_mix_f32 v27, v93, v43, v35 op_sel:[1,0,0] op_sel_hi:[1,0,0]
    v_cvt_pk_bf16_f32 v93, v26, v27
    v_fma_mix_f32 v24, v94, v44, v36 op_sel:[0,0,0] op_sel_hi:[1,0,0]
    v_mfma_f32_32x32x16_bf16 v[208:223], a[140:143], v[80:83], v[208:223]
    ds_read_b64_tr_b16 a[156:157], v23 offset:20480
    buffer_load_dwordx4 v[76:79], v2, s[24:27], s46 offen offset:3072
    v_fma_mix_f32 v25, v94, v45, v37 op_sel:[1,0,0] op_sel_hi:[1,0,0]
    v_mfma_f32_32x32x16_bf16 v[224:239], a[140:143], v[84:87], v[224:239]
    ds_read_b64_tr_b16 a[158:159], v23 offset:21504
    v_cvt_pk_bf16_f32 v94, v24, v25
    v_fma_mix_f32 v26, v95, v46, v38 op_sel:[0,0,0] op_sel_hi:[1,0,0]
    v_fma_mix_f32 v27, v95, v47, v39 op_sel:[1,0,0] op_sel_hi:[1,0,0]
    v_cvt_pk_bf16_f32 v95, v26, v27
    s_waitcnt vmcnt(14)
    s_waitcnt lgkmcnt(4)
    v_mfma_f32_32x32x16_bf16 v[112:127], a[144:147], v[88:91], v[112:127]
    ds_read_b64_tr_b16 a[160:161], v20 offset:24576
    ds_read_b128 v[32:35], v30 offset:1472
    v_fma_mix_f32 v24, v96, v248, v240 op_sel:[0,0,0] op_sel_hi:[1,0,0]
    v_fma_mix_f32 v25, v96, v249, v241 op_sel:[1,0,0] op_sel_hi:[1,0,0]
    v_cvt_pk_bf16_f32 v96, v24, v25
    v_mfma_f32_32x32x16_bf16 v[128:143], a[144:147], v[92:95], v[128:143]
    ds_read_b64_tr_b16 a[162:163], v20 offset:25600
    ds_read_b128 v[36:39], v30 offset:1488
    v_fma_mix_f32 v26, v97, v250, v242 op_sel:[0,0,0] op_sel_hi:[1,0,0]
    v_fma_mix_f32 v27, v97, v251, v243 op_sel:[1,0,0] op_sel_hi:[1,0,0]
    v_cvt_pk_bf16_f32 v97, v26, v27
    v_fma_mix_f32 v24, v98, v252, v244 op_sel:[0,0,0] op_sel_hi:[1,0,0]
    v_mfma_f32_32x32x16_bf16 v[144:159], a[148:151], v[88:91], v[144:159]
    ds_read_b64_tr_b16 a[164:165], v21 offset:24576
    ds_read_b128 v[40:43], v30 offset:4032
    v_fma_mix_f32 v25, v98, v253, v245 op_sel:[1,0,0] op_sel_hi:[1,0,0]
    v_cvt_pk_bf16_f32 v98, v24, v25
    v_fma_mix_f32 v26, v99, v254, v246 op_sel:[0,0,0] op_sel_hi:[1,0,0]
    v_mfma_f32_32x32x16_bf16 v[160:175], a[148:151], v[92:95], v[160:175]
    ds_read_b64_tr_b16 a[166:167], v21 offset:25600
    ds_read_b128 v[44:47], v30 offset:4048
    v_fma_mix_f32 v27, v99, v255, v247 op_sel:[1,0,0] op_sel_hi:[1,0,0]
    v_cvt_pk_bf16_f32 v99, v26, v27
    v_fma_mix_f32 v24, v100, v248, v240 op_sel:[0,0,0] op_sel_hi:[1,0,0]
    v_fma_mix_f32 v25, v100, v249, v241 op_sel:[1,0,0] op_sel_hi:[1,0,0]
    s_waitcnt lgkmcnt(8)
    v_mfma_f32_32x32x16_bf16 v[176:191], a[152:155], v[88:91], v[176:191]
    ds_read_b64_tr_b16 a[168:169], v22 offset:24576
    s_add_u32 s47, s35, 28672
    buffer_load_dwordx4 v[80:83], v1, s[24:27], s47 offen offset:0
    v_mfma_f32_32x32x16_bf16 v[192:207], a[152:155], v[92:95], v[192:207]
    ds_read_b64_tr_b16 a[170:171], v22 offset:25600
    v_cvt_pk_bf16_f32 v100, v24, v25
    v_fma_mix_f32 v26, v101, v250, v242 op_sel:[0,0,0] op_sel_hi:[1,0,0]
    v_fma_mix_f32 v27, v101, v251, v243 op_sel:[1,0,0] op_sel_hi:[1,0,0]
    v_cvt_pk_bf16_f32 v101, v26, v27
    v_fma_mix_f32 v24, v102, v252, v244 op_sel:[0,0,0] op_sel_hi:[1,0,0]
    v_mfma_f32_32x32x16_bf16 v[208:223], a[156:159], v[88:91], v[208:223]
    ds_read_b64_tr_b16 a[172:173], v23 offset:24576
    buffer_load_dwordx4 v[84:87], v2, s[24:27], s47 offen offset:0
    v_fma_mix_f32 v25, v102, v253, v245 op_sel:[1,0,0] op_sel_hi:[1,0,0]
    v_mfma_f32_32x32x16_bf16 v[224:239], a[156:159], v[92:95], v[224:239]
    ds_read_b64_tr_b16 a[174:175], v23 offset:25600
    v_cvt_pk_bf16_f32 v102, v24, v25
    v_fma_mix_f32 v26, v103, v254, v246 op_sel:[0,0,0] op_sel_hi:[1,0,0]
    v_fma_mix_f32 v27, v103, v255, v247 op_sel:[1,0,0] op_sel_hi:[1,0,0]
    v_cvt_pk_bf16_f32 v103, v26, v27
    s_waitcnt vmcnt(14)
    s_waitcnt lgkmcnt(4)
    v_mfma_f32_32x32x16_bf16 v[112:127], a[160:163], v[96:99], v[112:127]
    ds_read_b64_tr_b16 a[176:177], v20 offset:28672
    ds_read_b128 v[240:243], v30 offset:1536
    v_fma_mix_f32 v24, v104, v40, v32 op_sel:[0,0,0] op_sel_hi:[1,0,0]
    v_fma_mix_f32 v25, v104, v41, v33 op_sel:[1,0,0] op_sel_hi:[1,0,0]
    v_cvt_pk_bf16_f32 v104, v24, v25
    v_mfma_f32_32x32x16_bf16 v[128:143], a[160:163], v[100:103], v[128:143]
    ds_read_b64_tr_b16 a[178:179], v20 offset:29696
    ds_read_b128 v[244:247], v30 offset:1552
    v_fma_mix_f32 v26, v105, v42, v34 op_sel:[0,0,0] op_sel_hi:[1,0,0]
    v_fma_mix_f32 v27, v105, v43, v35 op_sel:[1,0,0] op_sel_hi:[1,0,0]
    v_cvt_pk_bf16_f32 v105, v26, v27
    v_fma_mix_f32 v24, v106, v44, v36 op_sel:[0,0,0] op_sel_hi:[1,0,0]
    v_mfma_f32_32x32x16_bf16 v[144:159], a[164:167], v[96:99], v[144:159]
    ds_read_b64_tr_b16 a[180:181], v21 offset:28672
    ds_read_b128 v[248:251], v30 offset:4096
    v_fma_mix_f32 v25, v106, v45, v37 op_sel:[1,0,0] op_sel_hi:[1,0,0]
    v_cvt_pk_bf16_f32 v106, v24, v25
    v_fma_mix_f32 v26, v107, v46, v38 op_sel:[0,0,0] op_sel_hi:[1,0,0]
    v_mfma_f32_32x32x16_bf16 v[160:175], a[164:167], v[100:103], v[160:175]
    ds_read_b64_tr_b16 a[182:183], v21 offset:29696
    ds_read_b128 v[252:255], v30 offset:4112
    v_fma_mix_f32 v27, v107, v47, v39 op_sel:[1,0,0] op_sel_hi:[1,0,0]
    v_cvt_pk_bf16_f32 v107, v26, v27
    v_fma_mix_f32 v24, v108, v40, v32 op_sel:[0,0,0] op_sel_hi:[1,0,0]
    s_waitcnt lgkmcnt(8)
    v_mfma_f32_32x32x16_bf16 v[176:191], a[168:171], v[96:99], v[176:191]
    ds_read_b64_tr_b16 a[184:185], v22 offset:28672
    buffer_load_dwordx4 v[88:91], v1, s[24:27], s47 offen offset:1024
    v_fma_mix_f32 v25, v108, v41, v33 op_sel:[1,0,0] op_sel_hi:[1,0,0]
    v_cvt_pk_bf16_f32 v108, v24, v25
    v_mfma_f32_32x32x16_bf16 v[192:207], a[168:171], v[100:103], v[192:207]
    ds_read_b64_tr_b16 a[186:187], v22 offset:29696
    v_fma_mix_f32 v26, v109, v42, v34 op_sel:[0,0,0] op_sel_hi:[1,0,0]
    v_fma_mix_f32 v27, v109, v43, v35 op_sel:[1,0,0] op_sel_hi:[1,0,0]
    v_cvt_pk_bf16_f32 v109, v26, v27
    v_fma_mix_f32 v24, v110, v44, v36 op_sel:[0,0,0] op_sel_hi:[1,0,0]
    v_mfma_f32_32x32x16_bf16 v[208:223], a[172:175], v[96:99], v[208:223]
    ds_read_b64_tr_b16 a[188:189], v23 offset:28672
    buffer_load_dwordx4 v[92:95], v2, s[24:27], s47 offen offset:1024
    v_fma_mix_f32 v25, v110, v45, v37 op_sel:[1,0,0] op_sel_hi:[1,0,0]
    v_mfma_f32_32x32x16_bf16 v[224:239], a[172:175], v[100:103], v[224:239]
    ds_read_b64_tr_b16 a[190:191], v23 offset:29696
    v_cvt_pk_bf16_f32 v110, v24, v25
    v_fma_mix_f32 v26, v111, v46, v38 op_sel:[0,0,0] op_sel_hi:[1,0,0]
    v_fma_mix_f32 v27, v111, v47, v39 op_sel:[1,0,0] op_sel_hi:[1,0,0]
    v_cvt_pk_bf16_f32 v111, v26, v27
    s_barrier
    s_waitcnt vmcnt(14)
    s_waitcnt lgkmcnt(4)
    v_mfma_f32_32x32x16_bf16 v[112:127], a[176:179], v[104:107], v[112:127]
    ds_read_b64_tr_b16 a[128:129], v20 offset:32768
    ds_read_b128 v[32:35], v30 offset:1600
    v_fma_mix_f32 v24, v48, v248, v240 op_sel:[0,0,0] op_sel_hi:[1,0,0]
    v_fma_mix_f32 v25, v48, v249, v241 op_sel:[1,0,0] op_sel_hi:[1,0,0]
    v_cvt_pk_bf16_f32 v48, v24, v25
    v_fma_mix_f32 v26, v49, v250, v242 op_sel:[0,0,0] op_sel_hi:[1,0,0]
    v_fma_mix_f32 v27, v49, v251, v243 op_sel:[1,0,0] op_sel_hi:[1,0,0]
    v_cvt_pk_bf16_f32 v49, v26, v27
    v_mfma_f32_32x32x16_bf16 v[128:143], a[176:179], v[108:111], v[128:143]
    ds_read_b64_tr_b16 a[130:131], v20 offset:33792
    ds_read_b128 v[36:39], v30 offset:1616
    v_fma_mix_f32 v24, v50, v252, v244 op_sel:[0,0,0] op_sel_hi:[1,0,0]
    v_fma_mix_f32 v25, v50, v253, v245 op_sel:[1,0,0] op_sel_hi:[1,0,0]
    v_cvt_pk_bf16_f32 v50, v24, v25
    v_fma_mix_f32 v26, v51, v254, v246 op_sel:[0,0,0] op_sel_hi:[1,0,0]
    v_fma_mix_f32 v27, v51, v255, v247 op_sel:[1,0,0] op_sel_hi:[1,0,0]
    v_cvt_pk_bf16_f32 v51, v26, v27
    v_fma_mix_f32 v24, v52, v248, v240 op_sel:[0,0,0] op_sel_hi:[1,0,0]
    v_mfma_f32_32x32x16_bf16 v[144:159], a[180:183], v[104:107], v[144:159]
    ds_read_b64_tr_b16 a[132:133], v21 offset:32768
    ds_read_b128 v[40:43], v30 offset:4160
    s_add_u32 m0, s38, 98304
    s_add_u32 s39, s36, 4194304
    buffer_load_dwordx4 v3, s[12:15], s39 offen offset:0 nt lds
    v_mfma_f32_32x32x16_bf16 v[160:175], a[180:183], v[108:111], v[160:175]
    ds_read_b64_tr_b16 a[134:135], v21 offset:33792
    ds_read_b128 v[44:47], v30 offset:4176
    buffer_load_dwordx4 v4, s[12:15], s39 offen offset:1024 nt lds
    v_fma_mix_f32 v25, v52, v249, v241 op_sel:[1,0,0] op_sel_hi:[1,0,0]
    s_waitcnt lgkmcnt(8)
    v_mfma_f32_32x32x16_bf16 v[176:191], a[184:187], v[104:107], v[176:191]
    ds_read_b64_tr_b16 a[136:137], v22 offset:32768
    buffer_load_dwordx4 v5, s[12:15], s39 offen offset:2048 nt lds
    v_cvt_pk_bf16_f32 v52, v24, v25
    v_fma_mix_f32 v26, v53, v250, v242 op_sel:[0,0,0] op_sel_hi:[1,0,0]
    v_mfma_f32_32x32x16_bf16 v[192:207], a[184:187], v[108:111], v[192:207]
    ds_read_b64_tr_b16 a[138:139], v22 offset:33792
    buffer_load_dwordx4 v6, s[12:15], s39 offen offset:3072 nt lds
    v_fma_mix_f32 v27, v53, v251, v243 op_sel:[1,0,0] op_sel_hi:[1,0,0]
    v_cvt_pk_bf16_f32 v53, v26, v27
    v_fma_mix_f32 v24, v54, v252, v244 op_sel:[0,0,0] op_sel_hi:[1,0,0]
    v_mfma_f32_32x32x16_bf16 v[208:223], a[188:191], v[104:107], v[208:223]
    ds_read_b64_tr_b16 a[140:141], v23 offset:32768
    buffer_load_dwordx4 v[96:99], v1, s[24:27], s47 offen offset:2048
    v_fma_mix_f32 v25, v54, v253, v245 op_sel:[1,0,0] op_sel_hi:[1,0,0]
    v_cvt_pk_bf16_f32 v54, v24, v25
    v_mfma_f32_32x32x16_bf16 v[224:239], a[188:191], v[108:111], v[224:239]
    ds_read_b64_tr_b16 a[142:143], v23 offset:33792
    buffer_load_dwordx4 v[100:103], v2, s[24:27], s47 offen offset:2048
    v_fma_mix_f32 v26, v55, v254, v246 op_sel:[0,0,0] op_sel_hi:[1,0,0]
    v_fma_mix_f32 v27, v55, v255, v247 op_sel:[1,0,0] op_sel_hi:[1,0,0]
    v_cvt_pk_bf16_f32 v55, v26, v27
    s_waitcnt vmcnt(18)
    s_waitcnt lgkmcnt(4)
    v_mfma_f32_32x32x16_bf16 v[112:127], a[128:131], v[48:51], v[112:127]
    ds_read_b64_tr_b16 a[144:145], v20 offset:36864
    ds_read_b128 v[240:243], v30 offset:1664
    v_fma_mix_f32 v24, v56, v40, v32 op_sel:[0,0,0] op_sel_hi:[1,0,0]
    v_fma_mix_f32 v25, v56, v41, v33 op_sel:[1,0,0] op_sel_hi:[1,0,0]
    v_cvt_pk_bf16_f32 v56, v24, v25
    v_mfma_f32_32x32x16_bf16 v[128:143], a[128:131], v[52:55], v[128:143]
    ds_read_b64_tr_b16 a[146:147], v20 offset:37888
    ds_read_b128 v[244:247], v30 offset:1680
    v_fma_mix_f32 v26, v57, v42, v34 op_sel:[0,0,0] op_sel_hi:[1,0,0]
    v_fma_mix_f32 v27, v57, v43, v35 op_sel:[1,0,0] op_sel_hi:[1,0,0]
    v_cvt_pk_bf16_f32 v57, v26, v27
    v_fma_mix_f32 v24, v58, v44, v36 op_sel:[0,0,0] op_sel_hi:[1,0,0]
    v_mfma_f32_32x32x16_bf16 v[144:159], a[132:135], v[48:51], v[144:159]
    ds_read_b64_tr_b16 a[148:149], v21 offset:36864
    ds_read_b128 v[248:251], v30 offset:4224
    v_fma_mix_f32 v25, v58, v45, v37 op_sel:[1,0,0] op_sel_hi:[1,0,0]
    v_cvt_pk_bf16_f32 v58, v24, v25
    v_fma_mix_f32 v26, v59, v46, v38 op_sel:[0,0,0] op_sel_hi:[1,0,0]
    v_mfma_f32_32x32x16_bf16 v[160:175], a[132:135], v[52:55], v[160:175]
    ds_read_b64_tr_b16 a[150:151], v21 offset:37888
    ds_read_b128 v[252:255], v30 offset:4240
    v_fma_mix_f32 v27, v59, v47, v39 op_sel:[1,0,0] op_sel_hi:[1,0,0]
    v_cvt_pk_bf16_f32 v59, v26, v27
    v_fma_mix_f32 v24, v60, v40, v32 op_sel:[0,0,0] op_sel_hi:[1,0,0]
    s_waitcnt lgkmcnt(8)
    v_mfma_f32_32x32x16_bf16 v[176:191], a[136:139], v[48:51], v[176:191]
    ds_read_b64_tr_b16 a[152:153], v22 offset:36864
    buffer_load_dwordx4 v[104:107], v1, s[24:27], s47 offen offset:3072
    v_fma_mix_f32 v25, v60, v41, v33 op_sel:[1,0,0] op_sel_hi:[1,0,0]
    v_cvt_pk_bf16_f32 v60, v24, v25
    v_mfma_f32_32x32x16_bf16 v[192:207], a[136:139], v[52:55], v[192:207]
    ds_read_b64_tr_b16 a[154:155], v22 offset:37888
    v_fma_mix_f32 v26, v61, v42, v34 op_sel:[0,0,0] op_sel_hi:[1,0,0]
    v_fma_mix_f32 v27, v61, v43, v35 op_sel:[1,0,0] op_sel_hi:[1,0,0]
    v_cvt_pk_bf16_f32 v61, v26, v27
    v_fma_mix_f32 v24, v62, v44, v36 op_sel:[0,0,0] op_sel_hi:[1,0,0]
    v_mfma_f32_32x32x16_bf16 v[208:223], a[140:143], v[48:51], v[208:223]
    ds_read_b64_tr_b16 a[156:157], v23 offset:36864
    buffer_load_dwordx4 v[108:111], v2, s[24:27], s47 offen offset:3072
    v_fma_mix_f32 v25, v62, v45, v37 op_sel:[1,0,0] op_sel_hi:[1,0,0]
    v_mfma_f32_32x32x16_bf16 v[224:239], a[140:143], v[52:55], v[224:239]
    ds_read_b64_tr_b16 a[158:159], v23 offset:37888
    v_cvt_pk_bf16_f32 v62, v24, v25
    v_fma_mix_f32 v26, v63, v46, v38 op_sel:[0,0,0] op_sel_hi:[1,0,0]
    v_fma_mix_f32 v27, v63, v47, v39 op_sel:[1,0,0] op_sel_hi:[1,0,0]
    v_cvt_pk_bf16_f32 v63, v26, v27
    s_waitcnt vmcnt(14)
    s_waitcnt lgkmcnt(4)
    v_mfma_f32_32x32x16_bf16 v[112:127], a[144:147], v[56:59], v[112:127]
    ds_read_b64_tr_b16 a[160:161], v20 offset:40960
    ds_read_b128 v[32:35], v30 offset:1728
    v_fma_mix_f32 v24, v64, v248, v240 op_sel:[0,0,0] op_sel_hi:[1,0,0]
    v_fma_mix_f32 v25, v64, v249, v241 op_sel:[1,0,0] op_sel_hi:[1,0,0]
    v_cvt_pk_bf16_f32 v64, v24, v25
    v_mfma_f32_32x32x16_bf16 v[128:143], a[144:147], v[60:63], v[128:143]
    ds_read_b64_tr_b16 a[162:163], v20 offset:41984
    ds_read_b128 v[36:39], v30 offset:1744
    v_fma_mix_f32 v26, v65, v250, v242 op_sel:[0,0,0] op_sel_hi:[1,0,0]
    v_fma_mix_f32 v27, v65, v251, v243 op_sel:[1,0,0] op_sel_hi:[1,0,0]
    v_cvt_pk_bf16_f32 v65, v26, v27
    v_fma_mix_f32 v24, v66, v252, v244 op_sel:[0,0,0] op_sel_hi:[1,0,0]
    v_mfma_f32_32x32x16_bf16 v[144:159], a[148:151], v[56:59], v[144:159]
    ds_read_b64_tr_b16 a[164:165], v21 offset:40960
    ds_read_b128 v[40:43], v30 offset:4288
    v_fma_mix_f32 v25, v66, v253, v245 op_sel:[1,0,0] op_sel_hi:[1,0,0]
    v_cvt_pk_bf16_f32 v66, v24, v25
    v_fma_mix_f32 v26, v67, v254, v246 op_sel:[0,0,0] op_sel_hi:[1,0,0]
    v_mfma_f32_32x32x16_bf16 v[160:175], a[148:151], v[60:63], v[160:175]
    ds_read_b64_tr_b16 a[166:167], v21 offset:41984
    ds_read_b128 v[44:47], v30 offset:4304
    v_fma_mix_f32 v27, v67, v255, v247 op_sel:[1,0,0] op_sel_hi:[1,0,0]
    v_cvt_pk_bf16_f32 v67, v26, v27
    v_fma_mix_f32 v24, v68, v248, v240 op_sel:[0,0,0] op_sel_hi:[1,0,0]
    v_fma_mix_f32 v25, v68, v249, v241 op_sel:[1,0,0] op_sel_hi:[1,0,0]
    s_waitcnt lgkmcnt(8)
    v_mfma_f32_32x32x16_bf16 v[176:191], a[152:155], v[56:59], v[176:191]
    ds_read_b64_tr_b16 a[168:169], v22 offset:40960
    s_add_u32 s46, s35, 32768
    buffer_load_dwordx4 v[48:51], v1, s[24:27], s46 offen offset:0
    v_mfma_f32_32x32x16_bf16 v[192:207], a[152:155], v[60:63], v[192:207]
    ds_read_b64_tr_b16 a[170:171], v22 offset:41984
    v_cvt_pk_bf16_f32 v68, v24, v25
    v_fma_mix_f32 v26, v69, v250, v242 op_sel:[0,0,0] op_sel_hi:[1,0,0]
    v_fma_mix_f32 v27, v69, v251, v243 op_sel:[1,0,0] op_sel_hi:[1,0,0]
    v_cvt_pk_bf16_f32 v69, v26, v27
    v_fma_mix_f32 v24, v70, v252, v244 op_sel:[0,0,0] op_sel_hi:[1,0,0]
    v_mfma_f32_32x32x16_bf16 v[208:223], a[156:159], v[56:59], v[208:223]
    ds_read_b64_tr_b16 a[172:173], v23 offset:40960
    buffer_load_dwordx4 v[52:55], v2, s[24:27], s46 offen offset:0
    v_fma_mix_f32 v25, v70, v253, v245 op_sel:[1,0,0] op_sel_hi:[1,0,0]
    v_mfma_f32_32x32x16_bf16 v[224:239], a[156:159], v[60:63], v[224:239]
    ds_read_b64_tr_b16 a[174:175], v23 offset:41984
    v_cvt_pk_bf16_f32 v70, v24, v25
    v_fma_mix_f32 v26, v71, v254, v246 op_sel:[0,0,0] op_sel_hi:[1,0,0]
    v_fma_mix_f32 v27, v71, v255, v247 op_sel:[1,0,0] op_sel_hi:[1,0,0]
    v_cvt_pk_bf16_f32 v71, v26, v27
    s_waitcnt vmcnt(14)
    s_waitcnt lgkmcnt(4)
    v_mfma_f32_32x32x16_bf16 v[112:127], a[160:163], v[64:67], v[112:127]
    ds_read_b64_tr_b16 a[176:177], v20 offset:45056
    ds_read_b128 v[240:243], v30 offset:1792
    v_fma_mix_f32 v24, v72, v40, v32 op_sel:[0,0,0] op_sel_hi:[1,0,0]
    v_fma_mix_f32 v25, v72, v41, v33 op_sel:[1,0,0] op_sel_hi:[1,0,0]
    v_cvt_pk_bf16_f32 v72, v24, v25
    v_mfma_f32_32x32x16_bf16 v[128:143], a[160:163], v[68:71], v[128:143]
    ds_read_b64_tr_b16 a[178:179], v20 offset:46080
    ds_read_b128 v[244:247], v30 offset:1808
    v_fma_mix_f32 v26, v73, v42, v34 op_sel:[0,0,0] op_sel_hi:[1,0,0]
    v_fma_mix_f32 v27, v73, v43, v35 op_sel:[1,0,0] op_sel_hi:[1,0,0]
    v_cvt_pk_bf16_f32 v73, v26, v27
    v_fma_mix_f32 v24, v74, v44, v36 op_sel:[0,0,0] op_sel_hi:[1,0,0]
    v_mfma_f32_32x32x16_bf16 v[144:159], a[164:167], v[64:67], v[144:159]
    ds_read_b64_tr_b16 a[180:181], v21 offset:45056
    ds_read_b128 v[248:251], v30 offset:4352
    v_fma_mix_f32 v25, v74, v45, v37 op_sel:[1,0,0] op_sel_hi:[1,0,0]
    v_cvt_pk_bf16_f32 v74, v24, v25
    v_fma_mix_f32 v26, v75, v46, v38 op_sel:[0,0,0] op_sel_hi:[1,0,0]
    v_mfma_f32_32x32x16_bf16 v[160:175], a[164:167], v[68:71], v[160:175]
    ds_read_b64_tr_b16 a[182:183], v21 offset:46080
    ds_read_b128 v[252:255], v30 offset:4368
    v_fma_mix_f32 v27, v75, v47, v39 op_sel:[1,0,0] op_sel_hi:[1,0,0]
    v_cvt_pk_bf16_f32 v75, v26, v27
    v_fma_mix_f32 v24, v76, v40, v32 op_sel:[0,0,0] op_sel_hi:[1,0,0]
    s_waitcnt lgkmcnt(8)
    v_mfma_f32_32x32x16_bf16 v[176:191], a[168:171], v[64:67], v[176:191]
    ds_read_b64_tr_b16 a[184:185], v22 offset:45056
    buffer_load_dwordx4 v[56:59], v1, s[24:27], s46 offen offset:1024
    v_fma_mix_f32 v25, v76, v41, v33 op_sel:[1,0,0] op_sel_hi:[1,0,0]
    v_cvt_pk_bf16_f32 v76, v24, v25
    v_mfma_f32_32x32x16_bf16 v[192:207], a[168:171], v[68:71], v[192:207]
    ds_read_b64_tr_b16 a[186:187], v22 offset:46080
    v_fma_mix_f32 v26, v77, v42, v34 op_sel:[0,0,0] op_sel_hi:[1,0,0]
    v_fma_mix_f32 v27, v77, v43, v35 op_sel:[1,0,0] op_sel_hi:[1,0,0]
    v_cvt_pk_bf16_f32 v77, v26, v27
    v_fma_mix_f32 v24, v78, v44, v36 op_sel:[0,0,0] op_sel_hi:[1,0,0]
    v_mfma_f32_32x32x16_bf16 v[208:223], a[172:175], v[64:67], v[208:223]
    ds_read_b64_tr_b16 a[188:189], v23 offset:45056
    buffer_load_dwordx4 v[60:63], v2, s[24:27], s46 offen offset:1024
    v_fma_mix_f32 v25, v78, v45, v37 op_sel:[1,0,0] op_sel_hi:[1,0,0]
    v_mfma_f32_32x32x16_bf16 v[224:239], a[172:175], v[68:71], v[224:239]
    ds_read_b64_tr_b16 a[190:191], v23 offset:46080
    v_cvt_pk_bf16_f32 v78, v24, v25
    v_fma_mix_f32 v26, v79, v46, v38 op_sel:[0,0,0] op_sel_hi:[1,0,0]
    v_fma_mix_f32 v27, v79, v47, v39 op_sel:[1,0,0] op_sel_hi:[1,0,0]
    v_cvt_pk_bf16_f32 v79, v26, v27
    s_barrier
    s_waitcnt vmcnt(14)
    s_waitcnt lgkmcnt(4)
    v_mfma_f32_32x32x16_bf16 v[112:127], a[176:179], v[72:75], v[112:127]
    ds_read_b64_tr_b16 a[128:129], v20 offset:49152
    ds_read_b128 v[32:35], v30 offset:1856
    v_fma_mix_f32 v24, v80, v248, v240 op_sel:[0,0,0] op_sel_hi:[1,0,0]
    v_fma_mix_f32 v25, v80, v249, v241 op_sel:[1,0,0] op_sel_hi:[1,0,0]
    v_cvt_pk_bf16_f32 v80, v24, v25
    v_fma_mix_f32 v26, v81, v250, v242 op_sel:[0,0,0] op_sel_hi:[1,0,0]
    v_fma_mix_f32 v27, v81, v251, v243 op_sel:[1,0,0] op_sel_hi:[1,0,0]
    v_cvt_pk_bf16_f32 v81, v26, v27
    v_mfma_f32_32x32x16_bf16 v[128:143], a[176:179], v[76:79], v[128:143]
    ds_read_b64_tr_b16 a[130:131], v20 offset:50176
    ds_read_b128 v[36:39], v30 offset:1872
    v_fma_mix_f32 v24, v82, v252, v244 op_sel:[0,0,0] op_sel_hi:[1,0,0]
    v_fma_mix_f32 v25, v82, v253, v245 op_sel:[1,0,0] op_sel_hi:[1,0,0]
    v_cvt_pk_bf16_f32 v82, v24, v25
    v_fma_mix_f32 v26, v83, v254, v246 op_sel:[0,0,0] op_sel_hi:[1,0,0]
    v_fma_mix_f32 v27, v83, v255, v247 op_sel:[1,0,0] op_sel_hi:[1,0,0]
    v_cvt_pk_bf16_f32 v83, v26, v27
    v_fma_mix_f32 v24, v84, v248, v240 op_sel:[0,0,0] op_sel_hi:[1,0,0]
    v_mfma_f32_32x32x16_bf16 v[144:159], a[180:183], v[72:75], v[144:159]
    ds_read_b64_tr_b16 a[132:133], v21 offset:49152
    ds_read_b128 v[40:43], v30 offset:4416
    s_add_u32 m0, s38, 114688
    s_add_u32 s39, s36, 4718592
    buffer_load_dwordx4 v3, s[12:15], s39 offen offset:0 nt lds
    v_mfma_f32_32x32x16_bf16 v[160:175], a[180:183], v[76:79], v[160:175]
    ds_read_b64_tr_b16 a[134:135], v21 offset:50176
    ds_read_b128 v[44:47], v30 offset:4432
    buffer_load_dwordx4 v4, s[12:15], s39 offen offset:1024 nt lds
    v_fma_mix_f32 v25, v84, v249, v241 op_sel:[1,0,0] op_sel_hi:[1,0,0]
    s_waitcnt lgkmcnt(8)
    v_mfma_f32_32x32x16_bf16 v[176:191], a[184:187], v[72:75], v[176:191]
    ds_read_b64_tr_b16 a[136:137], v22 offset:49152
    buffer_load_dwordx4 v5, s[12:15], s39 offen offset:2048 nt lds
    v_cvt_pk_bf16_f32 v84, v24, v25
    v_fma_mix_f32 v26, v85, v250, v242 op_sel:[0,0,0] op_sel_hi:[1,0,0]
    v_mfma_f32_32x32x16_bf16 v[192:207], a[184:187], v[76:79], v[192:207]
    ds_read_b64_tr_b16 a[138:139], v22 offset:50176
    buffer_load_dwordx4 v6, s[12:15], s39 offen offset:3072 nt lds
    v_fma_mix_f32 v27, v85, v251, v243 op_sel:[1,0,0] op_sel_hi:[1,0,0]
    v_cvt_pk_bf16_f32 v85, v26, v27
    v_fma_mix_f32 v24, v86, v252, v244 op_sel:[0,0,0] op_sel_hi:[1,0,0]
    v_mfma_f32_32x32x16_bf16 v[208:223], a[188:191], v[72:75], v[208:223]
    ds_read_b64_tr_b16 a[140:141], v23 offset:49152
    buffer_load_dwordx4 v[64:67], v1, s[24:27], s46 offen offset:2048
    v_fma_mix_f32 v25, v86, v253, v245 op_sel:[1,0,0] op_sel_hi:[1,0,0]
    v_cvt_pk_bf16_f32 v86, v24, v25
    v_mfma_f32_32x32x16_bf16 v[224:239], a[188:191], v[76:79], v[224:239]
    ds_read_b64_tr_b16 a[142:143], v23 offset:50176
    buffer_load_dwordx4 v[68:71], v2, s[24:27], s46 offen offset:2048
    v_fma_mix_f32 v26, v87, v254, v246 op_sel:[0,0,0] op_sel_hi:[1,0,0]
    v_fma_mix_f32 v27, v87, v255, v247 op_sel:[1,0,0] op_sel_hi:[1,0,0]
    v_cvt_pk_bf16_f32 v87, v26, v27
    s_waitcnt vmcnt(18)
    s_waitcnt lgkmcnt(4)
    v_mfma_f32_32x32x16_bf16 v[112:127], a[128:131], v[80:83], v[112:127]
    ds_read_b64_tr_b16 a[144:145], v20 offset:53248
    ds_read_b128 v[240:243], v30 offset:1920
    v_fma_mix_f32 v24, v88, v40, v32 op_sel:[0,0,0] op_sel_hi:[1,0,0]
    v_fma_mix_f32 v25, v88, v41, v33 op_sel:[1,0,0] op_sel_hi:[1,0,0]
    v_cvt_pk_bf16_f32 v88, v24, v25
    v_fma_mix_f32 v26, v89, v42, v34 op_sel:[0,0,0] op_sel_hi:[1,0,0]
    v_fma_mix_f32 v27, v89, v43, v35 op_sel:[1,0,0] op_sel_hi:[1,0,0]
    v_cvt_pk_bf16_f32 v89, v26, v27
    v_mfma_f32_32x32x16_bf16 v[128:143], a[128:131], v[84:87], v[128:143]
    ds_read_b64_tr_b16 a[146:147], v20 offset:54272
    ds_read_b128 v[244:247], v30 offset:1936
    v_fma_mix_f32 v24, v90, v44, v36 op_sel:[0,0,0] op_sel_hi:[1,0,0]
    v_fma_mix_f32 v25, v90, v45, v37 op_sel:[1,0,0] op_sel_hi:[1,0,0]
    v_cvt_pk_bf16_f32 v90, v24, v25
    v_fma_mix_f32 v26, v91, v46, v38 op_sel:[0,0,0] op_sel_hi:[1,0,0]
    v_fma_mix_f32 v27, v91, v47, v39 op_sel:[1,0,0] op_sel_hi:[1,0,0]
    v_cvt_pk_bf16_f32 v91, v26, v27
    v_fma_mix_f32 v24, v92, v40, v32 op_sel:[0,0,0] op_sel_hi:[1,0,0]
    v_mfma_f32_32x32x16_bf16 v[144:159], a[132:135], v[80:83], v[144:159]
    ds_read_b64_tr_b16 a[148:149], v21 offset:53248
    ds_read_b128 v[248:251], v30 offset:4480
    s_add_u32 m0, s38, 0
    s_add_u32 s37, s38, 0
    buffer_load_dwordx4 v7, s[16:19], s37 offen offset:0 nt lds
    v_mfma_f32_32x32x16_bf16 v[160:175], a[132:135], v[84:87], v[160:175]
    ds_read_b64_tr_b16 a[150:151], v21 offset:54272
    ds_read_b128 v[252:255], v30 offset:4496
    buffer_load_dwordx4 v8, s[16:19], s37 offen offset:1024 nt lds
    v_fma_mix_f32 v25, v92, v41, v33 op_sel:[1,0,0] op_sel_hi:[1,0,0]
    s_waitcnt lgkmcnt(8)
    v_mfma_f32_32x32x16_bf16 v[176:191], a[136:139], v[80:83], v[176:191]
    ds_read_b64_tr_b16 a[152:153], v22 offset:53248
    buffer_load_dwordx4 v9, s[16:19], s37 offen offset:2048 nt lds
    v_cvt_pk_bf16_f32 v92, v24, v25
    v_fma_mix_f32 v26, v93, v42, v34 op_sel:[0,0,0] op_sel_hi:[1,0,0]
    v_mfma_f32_32x32x16_bf16 v[192:207], a[136:139], v[84:87], v[192:207]
    ds_read_b64_tr_b16 a[154:155], v22 offset:54272
    buffer_load_dwordx4 v10, s[16:19], s37 offen offset:3072 nt lds
    v_fma_mix_f32 v27, v93, v43, v35 op_sel:[1,0,0] op_sel_hi:[1,0,0]
    v_cvt_pk_bf16_f32 v93, v26, v27
    v_fma_mix_f32 v24, v94, v44, v36 op_sel:[0,0,0] op_sel_hi:[1,0,0]
    v_mfma_f32_32x32x16_bf16 v[208:223], a[140:143], v[80:83], v[208:223]
    ds_read_b64_tr_b16 a[156:157], v23 offset:53248
    buffer_load_dwordx4 v[72:75], v1, s[24:27], s46 offen offset:3072
    v_fma_mix_f32 v25, v94, v45, v37 op_sel:[1,0,0] op_sel_hi:[1,0,0]
    v_cvt_pk_bf16_f32 v94, v24, v25
    v_mfma_f32_32x32x16_bf16 v[224:239], a[140:143], v[84:87], v[224:239]
    ds_read_b64_tr_b16 a[158:159], v23 offset:54272
    buffer_load_dwordx4 v[76:79], v2, s[24:27], s46 offen offset:3072
    v_fma_mix_f32 v26, v95, v46, v38 op_sel:[0,0,0] op_sel_hi:[1,0,0]
    v_fma_mix_f32 v27, v95, v47, v39 op_sel:[1,0,0] op_sel_hi:[1,0,0]
    v_cvt_pk_bf16_f32 v95, v26, v27
    s_waitcnt vmcnt(18)
    s_waitcnt lgkmcnt(4)
    v_mfma_f32_32x32x16_bf16 v[112:127], a[144:147], v[88:91], v[112:127]
    ds_read_b64_tr_b16 a[160:161], v20 offset:57344
    ds_read_b128 v[32:35], v30 offset:1984
    v_fma_mix_f32 v24, v96, v248, v240 op_sel:[0,0,0] op_sel_hi:[1,0,0]
    v_fma_mix_f32 v25, v96, v249, v241 op_sel:[1,0,0] op_sel_hi:[1,0,0]
    v_cvt_pk_bf16_f32 v96, v24, v25
    v_mfma_f32_32x32x16_bf16 v[128:143], a[144:147], v[92:95], v[128:143]
    ds_read_b64_tr_b16 a[162:163], v20 offset:58368
    ds_read_b128 v[36:39], v30 offset:2000
    v_fma_mix_f32 v26, v97, v250, v242 op_sel:[0,0,0] op_sel_hi:[1,0,0]
    v_fma_mix_f32 v27, v97, v251, v243 op_sel:[1,0,0] op_sel_hi:[1,0,0]
    v_cvt_pk_bf16_f32 v97, v26, v27
    v_fma_mix_f32 v24, v98, v252, v244 op_sel:[0,0,0] op_sel_hi:[1,0,0]
    v_mfma_f32_32x32x16_bf16 v[144:159], a[148:151], v[88:91], v[144:159]
    ds_read_b64_tr_b16 a[164:165], v21 offset:57344
    ds_read_b128 v[40:43], v30 offset:4544
    v_fma_mix_f32 v25, v98, v253, v245 op_sel:[1,0,0] op_sel_hi:[1,0,0]
    v_cvt_pk_bf16_f32 v98, v24, v25
    v_fma_mix_f32 v26, v99, v254, v246 op_sel:[0,0,0] op_sel_hi:[1,0,0]
    v_mfma_f32_32x32x16_bf16 v[160:175], a[148:151], v[92:95], v[160:175]
    ds_read_b64_tr_b16 a[166:167], v21 offset:58368
    ds_read_b128 v[44:47], v30 offset:4560
    v_fma_mix_f32 v27, v99, v255, v247 op_sel:[1,0,0] op_sel_hi:[1,0,0]
    v_cvt_pk_bf16_f32 v99, v26, v27
    v_fma_mix_f32 v24, v100, v248, v240 op_sel:[0,0,0] op_sel_hi:[1,0,0]
    v_fma_mix_f32 v25, v100, v249, v241 op_sel:[1,0,0] op_sel_hi:[1,0,0]
    s_waitcnt lgkmcnt(8)
    v_mfma_f32_32x32x16_bf16 v[176:191], a[152:155], v[88:91], v[176:191]
    ds_read_b64_tr_b16 a[168:169], v22 offset:57344
    s_add_u32 s47, s35, 36864
    buffer_load_dwordx4 v[80:83], v1, s[24:27], s47 offen offset:0
    v_mfma_f32_32x32x16_bf16 v[192:207], a[152:155], v[92:95], v[192:207]
    ds_read_b64_tr_b16 a[170:171], v22 offset:58368
    v_cvt_pk_bf16_f32 v100, v24, v25
    v_fma_mix_f32 v26, v101, v250, v242 op_sel:[0,0,0] op_sel_hi:[1,0,0]
    v_fma_mix_f32 v27, v101, v251, v243 op_sel:[1,0,0] op_sel_hi:[1,0,0]
    v_cvt_pk_bf16_f32 v101, v26, v27
    v_fma_mix_f32 v24, v102, v252, v244 op_sel:[0,0,0] op_sel_hi:[1,0,0]
    v_mfma_f32_32x32x16_bf16 v[208:223], a[156:159], v[88:91], v[208:223]
    ds_read_b64_tr_b16 a[172:173], v23 offset:57344
    buffer_load_dwordx4 v[84:87], v2, s[24:27], s47 offen offset:0
    v_fma_mix_f32 v25, v102, v253, v245 op_sel:[1,0,0] op_sel_hi:[1,0,0]
    v_mfma_f32_32x32x16_bf16 v[224:239], a[156:159], v[92:95], v[224:239]
    ds_read_b64_tr_b16 a[174:175], v23 offset:58368
    v_cvt_pk_bf16_f32 v102, v24, v25
    v_fma_mix_f32 v26, v103, v254, v246 op_sel:[0,0,0] op_sel_hi:[1,0,0]
    v_fma_mix_f32 v27, v103, v255, v247 op_sel:[1,0,0] op_sel_hi:[1,0,0]
    v_cvt_pk_bf16_f32 v103, v26, v27
    s_waitcnt vmcnt(18)
    s_waitcnt lgkmcnt(4)
    v_mfma_f32_32x32x16_bf16 v[112:127], a[160:163], v[96:99], v[112:127]
    ds_read_b64_tr_b16 a[176:177], v20 offset:61440
    ds_read_b128 v[240:243], v30 offset:2048
    v_fma_mix_f32 v24, v104, v40, v32 op_sel:[0,0,0] op_sel_hi:[1,0,0]
    v_fma_mix_f32 v25, v104, v41, v33 op_sel:[1,0,0] op_sel_hi:[1,0,0]
    v_cvt_pk_bf16_f32 v104, v24, v25
    v_mfma_f32_32x32x16_bf16 v[128:143], a[160:163], v[100:103], v[128:143]
    ds_read_b64_tr_b16 a[178:179], v20 offset:62464
    ds_read_b128 v[244:247], v30 offset:2064
    v_fma_mix_f32 v26, v105, v42, v34 op_sel:[0,0,0] op_sel_hi:[1,0,0]
    v_fma_mix_f32 v27, v105, v43, v35 op_sel:[1,0,0] op_sel_hi:[1,0,0]
    v_cvt_pk_bf16_f32 v105, v26, v27
    v_fma_mix_f32 v24, v106, v44, v36 op_sel:[0,0,0] op_sel_hi:[1,0,0]
    v_mfma_f32_32x32x16_bf16 v[144:159], a[164:167], v[96:99], v[144:159]
    ds_read_b64_tr_b16 a[180:181], v21 offset:61440
    ds_read_b128 v[248:251], v30 offset:4608
    v_fma_mix_f32 v25, v106, v45, v37 op_sel:[1,0,0] op_sel_hi:[1,0,0]
    v_cvt_pk_bf16_f32 v106, v24, v25
    v_fma_mix_f32 v26, v107, v46, v38 op_sel:[0,0,0] op_sel_hi:[1,0,0]
    v_mfma_f32_32x32x16_bf16 v[160:175], a[164:167], v[100:103], v[160:175]
    ds_read_b64_tr_b16 a[182:183], v21 offset:62464
    ds_read_b128 v[252:255], v30 offset:4624
    v_fma_mix_f32 v27, v107, v47, v39 op_sel:[1,0,0] op_sel_hi:[1,0,0]
    v_cvt_pk_bf16_f32 v107, v26, v27
    v_fma_mix_f32 v24, v108, v40, v32 op_sel:[0,0,0] op_sel_hi:[1,0,0]
    s_waitcnt lgkmcnt(8)
    v_mfma_f32_32x32x16_bf16 v[176:191], a[168:171], v[96:99], v[176:191]
    ds_read_b64_tr_b16 a[184:185], v22 offset:61440
    buffer_load_dwordx4 v[88:91], v1, s[24:27], s47 offen offset:1024
    v_fma_mix_f32 v25, v108, v41, v33 op_sel:[1,0,0] op_sel_hi:[1,0,0]
    v_cvt_pk_bf16_f32 v108, v24, v25
    v_mfma_f32_32x32x16_bf16 v[192:207], a[168:171], v[100:103], v[192:207]
    ds_read_b64_tr_b16 a[186:187], v22 offset:62464
    v_fma_mix_f32 v26, v109, v42, v34 op_sel:[0,0,0] op_sel_hi:[1,0,0]
    v_fma_mix_f32 v27, v109, v43, v35 op_sel:[1,0,0] op_sel_hi:[1,0,0]
    v_cvt_pk_bf16_f32 v109, v26, v27
    v_fma_mix_f32 v24, v110, v44, v36 op_sel:[0,0,0] op_sel_hi:[1,0,0]
    v_mfma_f32_32x32x16_bf16 v[208:223], a[172:175], v[96:99], v[208:223]
    ds_read_b64_tr_b16 a[188:189], v23 offset:61440
    buffer_load_dwordx4 v[92:95], v2, s[24:27], s47 offen offset:1024
    v_fma_mix_f32 v25, v110, v45, v37 op_sel:[1,0,0] op_sel_hi:[1,0,0]
    v_mfma_f32_32x32x16_bf16 v[224:239], a[172:175], v[100:103], v[224:239]
    ds_read_b64_tr_b16 a[190:191], v23 offset:62464
    v_cvt_pk_bf16_f32 v110, v24, v25
    v_fma_mix_f32 v26, v111, v46, v38 op_sel:[0,0,0] op_sel_hi:[1,0,0]
    v_fma_mix_f32 v27, v111, v47, v39 op_sel:[1,0,0] op_sel_hi:[1,0,0]
    v_cvt_pk_bf16_f32 v111, v26, v27
    s_barrier
    s_waitcnt vmcnt(18)
    s_waitcnt lgkmcnt(4)
    v_mfma_f32_32x32x16_bf16 v[112:127], a[176:179], v[104:107], v[112:127]
    ds_read_b64_tr_b16 a[128:129], v20 offset:0
    ds_read_b128 v[32:35], v30 offset:2112
    v_fma_mix_f32 v24, v48, v248, v240 op_sel:[0,0,0] op_sel_hi:[1,0,0]
    v_fma_mix_f32 v25, v48, v249, v241 op_sel:[1,0,0] op_sel_hi:[1,0,0]
    v_cvt_pk_bf16_f32 v48, v24, v25
    v_mfma_f32_32x32x16_bf16 v[128:143], a[176:179], v[108:111], v[128:143]
    ds_read_b64_tr_b16 a[130:131], v20 offset:1024
    ds_read_b128 v[36:39], v30 offset:2128
    v_fma_mix_f32 v26, v49, v250, v242 op_sel:[0,0,0] op_sel_hi:[1,0,0]
    v_fma_mix_f32 v27, v49, v251, v243 op_sel:[1,0,0] op_sel_hi:[1,0,0]
    v_cvt_pk_bf16_f32 v49, v26, v27
    v_fma_mix_f32 v24, v50, v252, v244 op_sel:[0,0,0] op_sel_hi:[1,0,0]
    v_mfma_f32_32x32x16_bf16 v[144:159], a[180:183], v[104:107], v[144:159]
    ds_read_b64_tr_b16 a[132:133], v21 offset:0
    ds_read_b128 v[40:43], v30 offset:4672
    v_fma_mix_f32 v25, v50, v253, v245 op_sel:[1,0,0] op_sel_hi:[1,0,0]
    v_cvt_pk_bf16_f32 v50, v24, v25
    v_fma_mix_f32 v26, v51, v254, v246 op_sel:[0,0,0] op_sel_hi:[1,0,0]
    v_mfma_f32_32x32x16_bf16 v[160:175], a[180:183], v[108:111], v[160:175]
    ds_read_b64_tr_b16 a[134:135], v21 offset:1024
    ds_read_b128 v[44:47], v30 offset:4688
    v_fma_mix_f32 v27, v51, v255, v247 op_sel:[1,0,0] op_sel_hi:[1,0,0]
    v_cvt_pk_bf16_f32 v51, v26, v27
    v_fma_mix_f32 v24, v52, v248, v240 op_sel:[0,0,0] op_sel_hi:[1,0,0]
    s_waitcnt lgkmcnt(8)
    v_mfma_f32_32x32x16_bf16 v[176:191], a[184:187], v[104:107], v[176:191]
    ds_read_b64_tr_b16 a[136:137], v22 offset:0
    buffer_load_dwordx4 v[96:99], v1, s[24:27], s47 offen offset:2048
    v_fma_mix_f32 v25, v52, v249, v241 op_sel:[1,0,0] op_sel_hi:[1,0,0]
    v_cvt_pk_bf16_f32 v52, v24, v25
    v_mfma_f32_32x32x16_bf16 v[192:207], a[184:187], v[108:111], v[192:207]
    ds_read_b64_tr_b16 a[138:139], v22 offset:1024
    v_fma_mix_f32 v26, v53, v250, v242 op_sel:[0,0,0] op_sel_hi:[1,0,0]
    v_fma_mix_f32 v27, v53, v251, v243 op_sel:[1,0,0] op_sel_hi:[1,0,0]
    v_cvt_pk_bf16_f32 v53, v26, v27
    v_fma_mix_f32 v24, v54, v252, v244 op_sel:[0,0,0] op_sel_hi:[1,0,0]
    v_mfma_f32_32x32x16_bf16 v[208:223], a[188:191], v[104:107], v[208:223]
    ds_read_b64_tr_b16 a[140:141], v23 offset:0
    buffer_load_dwordx4 v[100:103], v2, s[24:27], s47 offen offset:2048
    v_fma_mix_f32 v25, v54, v253, v245 op_sel:[1,0,0] op_sel_hi:[1,0,0]
    v_mfma_f32_32x32x16_bf16 v[224:239], a[188:191], v[108:111], v[224:239]
    ds_read_b64_tr_b16 a[142:143], v23 offset:1024
    v_cvt_pk_bf16_f32 v54, v24, v25
    v_fma_mix_f32 v26, v55, v254, v246 op_sel:[0,0,0] op_sel_hi:[1,0,0]
    v_fma_mix_f32 v27, v55, v255, v247 op_sel:[1,0,0] op_sel_hi:[1,0,0]
    v_cvt_pk_bf16_f32 v55, v26, v27
    s_waitcnt vmcnt(18)
    s_waitcnt lgkmcnt(4)
    v_mfma_f32_32x32x16_bf16 v[112:127], a[128:131], v[48:51], v[112:127]
    ds_read_b64_tr_b16 a[144:145], v20 offset:4096
    ds_read_b128 v[240:243], v30 offset:2176
    v_fma_mix_f32 v24, v56, v40, v32 op_sel:[0,0,0] op_sel_hi:[1,0,0]
    v_fma_mix_f32 v25, v56, v41, v33 op_sel:[1,0,0] op_sel_hi:[1,0,0]
    v_cvt_pk_bf16_f32 v56, v24, v25
    v_fma_mix_f32 v26, v57, v42, v34 op_sel:[0,0,0] op_sel_hi:[1,0,0]
    v_fma_mix_f32 v27, v57, v43, v35 op_sel:[1,0,0] op_sel_hi:[1,0,0]
    v_cvt_pk_bf16_f32 v57, v26, v27
    v_mfma_f32_32x32x16_bf16 v[128:143], a[128:131], v[52:55], v[128:143]
    ds_read_b64_tr_b16 a[146:147], v20 offset:5120
    ds_read_b128 v[244:247], v30 offset:2192
    v_fma_mix_f32 v24, v58, v44, v36 op_sel:[0,0,0] op_sel_hi:[1,0,0]
    v_fma_mix_f32 v25, v58, v45, v37 op_sel:[1,0,0] op_sel_hi:[1,0,0]
    v_cvt_pk_bf16_f32 v58, v24, v25
    v_fma_mix_f32 v26, v59, v46, v38 op_sel:[0,0,0] op_sel_hi:[1,0,0]
    v_fma_mix_f32 v27, v59, v47, v39 op_sel:[1,0,0] op_sel_hi:[1,0,0]
    v_cvt_pk_bf16_f32 v59, v26, v27
    v_fma_mix_f32 v24, v60, v40, v32 op_sel:[0,0,0] op_sel_hi:[1,0,0]
    v_mfma_f32_32x32x16_bf16 v[144:159], a[132:135], v[48:51], v[144:159]
    ds_read_b64_tr_b16 a[148:149], v21 offset:4096
    ds_read_b128 v[248:251], v30 offset:4736
    s_add_u32 m0, s38, 16384
    s_add_u32 s37, s38, 16384
    buffer_load_dwordx4 v7, s[16:19], s37 offen offset:0 nt lds
    v_mfma_f32_32x32x16_bf16 v[160:175], a[132:135], v[52:55], v[160:175]
    ds_read_b64_tr_b16 a[150:151], v21 offset:5120
    ds_read_b128 v[252:255], v30 offset:4752
    buffer_load_dwordx4 v8, s[16:19], s37 offen offset:1024 nt lds
    v_fma_mix_f32 v25, v60, v41, v33 op_sel:[1,0,0] op_sel_hi:[1,0,0]
    s_waitcnt lgkmcnt(8)
    v_mfma_f32_32x32x16_bf16 v[176:191], a[136:139], v[48:51], v[176:191]
    ds_read_b64_tr_b16 a[152:153], v22 offset:4096
    buffer_load_dwordx4 v9, s[16:19], s37 offen offset:2048 nt lds
    v_cvt_pk_bf16_f32 v60, v24, v25
    v_fma_mix_f32 v26, v61, v42, v34 op_sel:[0,0,0] op_sel_hi:[1,0,0]
    v_mfma_f32_32x32x16_bf16 v[192:207], a[136:139], v[52:55], v[192:207]
    ds_read_b64_tr_b16 a[154:155], v22 offset:5120
    buffer_load_dwordx4 v10, s[16:19], s37 offen offset:3072 nt lds
    v_fma_mix_f32 v27, v61, v43, v35 op_sel:[1,0,0] op_sel_hi:[1,0,0]
    v_cvt_pk_bf16_f32 v61, v26, v27
    v_fma_mix_f32 v24, v62, v44, v36 op_sel:[0,0,0] op_sel_hi:[1,0,0]
    v_mfma_f32_32x32x16_bf16 v[208:223], a[140:143], v[48:51], v[208:223]
    ds_read_b64_tr_b16 a[156:157], v23 offset:4096
    buffer_load_dwordx4 v[104:107], v1, s[24:27], s47 offen offset:3072
    v_fma_mix_f32 v25, v62, v45, v37 op_sel:[1,0,0] op_sel_hi:[1,0,0]
    v_cvt_pk_bf16_f32 v62, v24, v25
    v_mfma_f32_32x32x16_bf16 v[224:239], a[140:143], v[52:55], v[224:239]
    ds_read_b64_tr_b16 a[158:159], v23 offset:5120
    buffer_load_dwordx4 v[108:111], v2, s[24:27], s47 offen offset:3072
    v_fma_mix_f32 v26, v63, v46, v38 op_sel:[0,0,0] op_sel_hi:[1,0,0]
    v_fma_mix_f32 v27, v63, v47, v39 op_sel:[1,0,0] op_sel_hi:[1,0,0]
    v_cvt_pk_bf16_f32 v63, v26, v27
    s_waitcnt vmcnt(18)
    s_waitcnt lgkmcnt(4)
    v_mfma_f32_32x32x16_bf16 v[112:127], a[144:147], v[56:59], v[112:127]
    ds_read_b64_tr_b16 a[160:161], v20 offset:8192
    ds_read_b128 v[32:35], v30 offset:2240
    v_fma_mix_f32 v24, v64, v248, v240 op_sel:[0,0,0] op_sel_hi:[1,0,0]
    v_fma_mix_f32 v25, v64, v249, v241 op_sel:[1,0,0] op_sel_hi:[1,0,0]
    v_cvt_pk_bf16_f32 v64, v24, v25
    v_mfma_f32_32x32x16_bf16 v[128:143], a[144:147], v[60:63], v[128:143]
    ds_read_b64_tr_b16 a[162:163], v20 offset:9216
    ds_read_b128 v[36:39], v30 offset:2256
    v_fma_mix_f32 v26, v65, v250, v242 op_sel:[0,0,0] op_sel_hi:[1,0,0]
    v_fma_mix_f32 v27, v65, v251, v243 op_sel:[1,0,0] op_sel_hi:[1,0,0]
    v_mfma_f32_32x32x16_bf16 v[144:159], a[148:151], v[56:59], v[144:159]
    ds_read_b64_tr_b16 a[164:165], v21 offset:8192
    ds_read_b128 v[40:43], v30 offset:4800
    v_cvt_pk_bf16_f32 v65, v26, v27
    v_fma_mix_f32 v24, v66, v252, v244 op_sel:[0,0,0] op_sel_hi:[1,0,0]
    v_fma_mix_f32 v25, v66, v253, v245 op_sel:[1,0,0] op_sel_hi:[1,0,0]
    v_mfma_f32_32x32x16_bf16 v[160:175], a[148:151], v[60:63], v[160:175]
    ds_read_b64_tr_b16 a[166:167], v21 offset:9216
    ds_read_b128 v[44:47], v30 offset:4816
    v_cvt_pk_bf16_f32 v66, v24, v25
    v_fma_mix_f32 v26, v67, v254, v246 op_sel:[0,0,0] op_sel_hi:[1,0,0]
    v_fma_mix_f32 v27, v67, v255, v247 op_sel:[1,0,0] op_sel_hi:[1,0,0]
    s_waitcnt lgkmcnt(8)
    v_mfma_f32_32x32x16_bf16 v[176:191], a[152:155], v[56:59], v[176:191]
    ds_read_b64_tr_b16 a[168:169], v22 offset:8192
    v_cvt_pk_bf16_f32 v67, v26, v27
    v_fma_mix_f32 v24, v68, v248, v240 op_sel:[0,0,0] op_sel_hi:[1,0,0]
    v_fma_mix_f32 v25, v68, v249, v241 op_sel:[1,0,0] op_sel_hi:[1,0,0]
    v_mfma_f32_32x32x16_bf16 v[192:207], a[152:155], v[60:63], v[192:207]
    ds_read_b64_tr_b16 a[170:171], v22 offset:9216
    v_cvt_pk_bf16_f32 v68, v24, v25
    v_fma_mix_f32 v26, v69, v250, v242 op_sel:[0,0,0] op_sel_hi:[1,0,0]
    v_fma_mix_f32 v27, v69, v251, v243 op_sel:[1,0,0] op_sel_hi:[1,0,0]
    v_mfma_f32_32x32x16_bf16 v[208:223], a[156:159], v[56:59], v[208:223]
    ds_read_b64_tr_b16 a[172:173], v23 offset:8192
    v_cvt_pk_bf16_f32 v69, v26, v27
    v_fma_mix_f32 v24, v70, v252, v244 op_sel:[0,0,0] op_sel_hi:[1,0,0]
    v_fma_mix_f32 v25, v70, v253, v245 op_sel:[1,0,0] op_sel_hi:[1,0,0]
    v_cvt_pk_bf16_f32 v70, v24, v25
    v_mfma_f32_32x32x16_bf16 v[224:239], a[156:159], v[60:63], v[224:239]
    ds_read_b64_tr_b16 a[174:175], v23 offset:9216
    v_fma_mix_f32 v26, v71, v254, v246 op_sel:[0,0,0] op_sel_hi:[1,0,0]
    v_fma_mix_f32 v27, v71, v255, v247 op_sel:[1,0,0] op_sel_hi:[1,0,0]
    v_cvt_pk_bf16_f32 v71, v26, v27
    s_waitcnt vmcnt(12)
    s_waitcnt lgkmcnt(4)
    v_mfma_f32_32x32x16_bf16 v[112:127], a[160:163], v[64:67], v[112:127]
    ds_read_b64_tr_b16 a[176:177], v20 offset:12288
    ds_read_b128 v[240:243], v30 offset:2304
    v_fma_mix_f32 v24, v72, v40, v32 op_sel:[0,0,0] op_sel_hi:[1,0,0]
    v_fma_mix_f32 v25, v72, v41, v33 op_sel:[1,0,0] op_sel_hi:[1,0,0]
    v_cvt_pk_bf16_f32 v72, v24, v25
    v_mfma_f32_32x32x16_bf16 v[128:143], a[160:163], v[68:71], v[128:143]
    ds_read_b64_tr_b16 a[178:179], v20 offset:13312
    ds_read_b128 v[244:247], v30 offset:2320
    v_fma_mix_f32 v26, v73, v42, v34 op_sel:[0,0,0] op_sel_hi:[1,0,0]
    v_fma_mix_f32 v27, v73, v43, v35 op_sel:[1,0,0] op_sel_hi:[1,0,0]
    v_mfma_f32_32x32x16_bf16 v[144:159], a[164:167], v[64:67], v[144:159]
    ds_read_b64_tr_b16 a[180:181], v21 offset:12288
    ds_read_b128 v[248:251], v30 offset:4864
    v_cvt_pk_bf16_f32 v73, v26, v27
    v_fma_mix_f32 v24, v74, v44, v36 op_sel:[0,0,0] op_sel_hi:[1,0,0]
    v_fma_mix_f32 v25, v74, v45, v37 op_sel:[1,0,0] op_sel_hi:[1,0,0]
    v_mfma_f32_32x32x16_bf16 v[160:175], a[164:167], v[68:71], v[160:175]
    ds_read_b64_tr_b16 a[182:183], v21 offset:13312
    ds_read_b128 v[252:255], v30 offset:4880
    v_cvt_pk_bf16_f32 v74, v24, v25
    v_fma_mix_f32 v26, v75, v46, v38 op_sel:[0,0,0] op_sel_hi:[1,0,0]
    v_fma_mix_f32 v27, v75, v47, v39 op_sel:[1,0,0] op_sel_hi:[1,0,0]
    s_waitcnt lgkmcnt(8)
    v_mfma_f32_32x32x16_bf16 v[176:191], a[168:171], v[64:67], v[176:191]
    ds_read_b64_tr_b16 a[184:185], v22 offset:12288
    v_cvt_pk_bf16_f32 v75, v26, v27
    v_fma_mix_f32 v24, v76, v40, v32 op_sel:[0,0,0] op_sel_hi:[1,0,0]
    v_fma_mix_f32 v25, v76, v41, v33 op_sel:[1,0,0] op_sel_hi:[1,0,0]
    v_mfma_f32_32x32x16_bf16 v[192:207], a[168:171], v[68:71], v[192:207]
    ds_read_b64_tr_b16 a[186:187], v22 offset:13312
    v_cvt_pk_bf16_f32 v76, v24, v25
    v_fma_mix_f32 v26, v77, v42, v34 op_sel:[0,0,0] op_sel_hi:[1,0,0]
    v_fma_mix_f32 v27, v77, v43, v35 op_sel:[1,0,0] op_sel_hi:[1,0,0]
    v_mfma_f32_32x32x16_bf16 v[208:223], a[172:175], v[64:67], v[208:223]
    ds_read_b64_tr_b16 a[188:189], v23 offset:12288
    v_cvt_pk_bf16_f32 v77, v26, v27
    v_fma_mix_f32 v24, v78, v44, v36 op_sel:[0,0,0] op_sel_hi:[1,0,0]
    v_fma_mix_f32 v25, v78, v45, v37 op_sel:[1,0,0] op_sel_hi:[1,0,0]
    v_cvt_pk_bf16_f32 v78, v24, v25
    v_mfma_f32_32x32x16_bf16 v[224:239], a[172:175], v[68:71], v[224:239]
    ds_read_b64_tr_b16 a[190:191], v23 offset:13312
    v_fma_mix_f32 v26, v79, v46, v38 op_sel:[0,0,0] op_sel_hi:[1,0,0]
    v_fma_mix_f32 v27, v79, v47, v39 op_sel:[1,0,0] op_sel_hi:[1,0,0]
    v_cvt_pk_bf16_f32 v79, v26, v27
    s_barrier
    s_waitcnt vmcnt(10)
    s_waitcnt lgkmcnt(4)
    v_mfma_f32_32x32x16_bf16 v[112:127], a[176:179], v[72:75], v[112:127]
    ds_read_b64_tr_b16 a[128:129], v20 offset:16384
    ds_read_b128 v[32:35], v30 offset:2368
    v_fma_mix_f32 v24, v80, v248, v240 op_sel:[0,0,0] op_sel_hi:[1,0,0]
    v_fma_mix_f32 v25, v80, v249, v241 op_sel:[1,0,0] op_sel_hi:[1,0,0]
    v_cvt_pk_bf16_f32 v80, v24, v25
    v_mfma_f32_32x32x16_bf16 v[128:143], a[176:179], v[76:79], v[128:143]
    ds_read_b64_tr_b16 a[130:131], v20 offset:17408
    ds_read_b128 v[36:39], v30 offset:2384
    v_fma_mix_f32 v26, v81, v250, v242 op_sel:[0,0,0] op_sel_hi:[1,0,0]
    v_fma_mix_f32 v27, v81, v251, v243 op_sel:[1,0,0] op_sel_hi:[1,0,0]
    v_mfma_f32_32x32x16_bf16 v[144:159], a[180:183], v[72:75], v[144:159]
    ds_read_b64_tr_b16 a[132:133], v21 offset:16384
    ds_read_b128 v[40:43], v30 offset:4928
    v_cvt_pk_bf16_f32 v81, v26, v27
    v_fma_mix_f32 v24, v82, v252, v244 op_sel:[0,0,0] op_sel_hi:[1,0,0]
    v_fma_mix_f32 v25, v82, v253, v245 op_sel:[1,0,0] op_sel_hi:[1,0,0]
    v_mfma_f32_32x32x16_bf16 v[160:175], a[180:183], v[76:79], v[160:175]
    ds_read_b64_tr_b16 a[134:135], v21 offset:17408
    ds_read_b128 v[44:47], v30 offset:4944
    v_cvt_pk_bf16_f32 v82, v24, v25
    v_fma_mix_f32 v26, v83, v254, v246 op_sel:[0,0,0] op_sel_hi:[1,0,0]
    v_fma_mix_f32 v27, v83, v255, v247 op_sel:[1,0,0] op_sel_hi:[1,0,0]
    s_waitcnt lgkmcnt(8)
    v_mfma_f32_32x32x16_bf16 v[176:191], a[184:187], v[72:75], v[176:191]
    ds_read_b64_tr_b16 a[136:137], v22 offset:16384
    v_cvt_pk_bf16_f32 v83, v26, v27
    v_fma_mix_f32 v24, v84, v248, v240 op_sel:[0,0,0] op_sel_hi:[1,0,0]
    v_fma_mix_f32 v25, v84, v249, v241 op_sel:[1,0,0] op_sel_hi:[1,0,0]
    v_mfma_f32_32x32x16_bf16 v[192:207], a[184:187], v[76:79], v[192:207]
    ds_read_b64_tr_b16 a[138:139], v22 offset:17408
    v_cvt_pk_bf16_f32 v84, v24, v25
    v_fma_mix_f32 v26, v85, v250, v242 op_sel:[0,0,0] op_sel_hi:[1,0,0]
    v_fma_mix_f32 v27, v85, v251, v243 op_sel:[1,0,0] op_sel_hi:[1,0,0]
    v_mfma_f32_32x32x16_bf16 v[208:223], a[188:191], v[72:75], v[208:223]
    ds_read_b64_tr_b16 a[140:141], v23 offset:16384
    v_cvt_pk_bf16_f32 v85, v26, v27
    v_fma_mix_f32 v24, v86, v252, v244 op_sel:[0,0,0] op_sel_hi:[1,0,0]
    v_fma_mix_f32 v25, v86, v253, v245 op_sel:[1,0,0] op_sel_hi:[1,0,0]
    v_cvt_pk_bf16_f32 v86, v24, v25
    v_mfma_f32_32x32x16_bf16 v[224:239], a[188:191], v[76:79], v[224:239]
    ds_read_b64_tr_b16 a[142:143], v23 offset:17408
    v_fma_mix_f32 v26, v87, v254, v246 op_sel:[0,0,0] op_sel_hi:[1,0,0]
    v_fma_mix_f32 v27, v87, v255, v247 op_sel:[1,0,0] op_sel_hi:[1,0,0]
    v_cvt_pk_bf16_f32 v87, v26, v27
    s_waitcnt vmcnt(8)
    s_waitcnt lgkmcnt(4)
    v_mfma_f32_32x32x16_bf16 v[112:127], a[128:131], v[80:83], v[112:127]
    ds_read_b64_tr_b16 a[144:145], v20 offset:20480
    ds_read_b128 v[240:243], v30 offset:2432
    v_fma_mix_f32 v24, v88, v40, v32 op_sel:[0,0,0] op_sel_hi:[1,0,0]
    v_fma_mix_f32 v25, v88, v41, v33 op_sel:[1,0,0] op_sel_hi:[1,0,0]
    v_cvt_pk_bf16_f32 v88, v24, v25
    v_fma_mix_f32 v26, v89, v42, v34 op_sel:[0,0,0] op_sel_hi:[1,0,0]
    v_fma_mix_f32 v27, v89, v43, v35 op_sel:[1,0,0] op_sel_hi:[1,0,0]
    v_mfma_f32_32x32x16_bf16 v[128:143], a[128:131], v[84:87], v[128:143]
    ds_read_b64_tr_b16 a[146:147], v20 offset:21504
    ds_read_b128 v[244:247], v30 offset:2448
    v_cvt_pk_bf16_f32 v89, v26, v27
    v_fma_mix_f32 v24, v90, v44, v36 op_sel:[0,0,0] op_sel_hi:[1,0,0]
    v_fma_mix_f32 v25, v90, v45, v37 op_sel:[1,0,0] op_sel_hi:[1,0,0]
    v_cvt_pk_bf16_f32 v90, v24, v25
    v_mfma_f32_32x32x16_bf16 v[144:159], a[132:135], v[80:83], v[144:159]
    ds_read_b64_tr_b16 a[148:149], v21 offset:20480
    ds_read_b128 v[248:251], v30 offset:4992
    v_fma_mix_f32 v26, v91, v46, v38 op_sel:[0,0,0] op_sel_hi:[1,0,0]
    v_fma_mix_f32 v27, v91, v47, v39 op_sel:[1,0,0] op_sel_hi:[1,0,0]
    v_cvt_pk_bf16_f32 v91, v26, v27
    v_fma_mix_f32 v24, v92, v40, v32 op_sel:[0,0,0] op_sel_hi:[1,0,0]
    v_fma_mix_f32 v25, v92, v41, v33 op_sel:[1,0,0] op_sel_hi:[1,0,0]
    v_mfma_f32_32x32x16_bf16 v[160:175], a[132:135], v[84:87], v[160:175]
    ds_read_b64_tr_b16 a[150:151], v21 offset:21504
    ds_read_b128 v[252:255], v30 offset:5008
    v_cvt_pk_bf16_f32 v92, v24, v25
    v_fma_mix_f32 v26, v93, v42, v34 op_sel:[0,0,0] op_sel_hi:[1,0,0]
    v_fma_mix_f32 v27, v93, v43, v35 op_sel:[1,0,0] op_sel_hi:[1,0,0]
    v_cvt_pk_bf16_f32 v93, v26, v27
    s_waitcnt lgkmcnt(8)
    v_mfma_f32_32x32x16_bf16 v[176:191], a[136:139], v[80:83], v[176:191]
    ds_read_b64_tr_b16 a[152:153], v22 offset:20480
    s_add_u32 m0, s38, 65536
    s_add_u32 s37, s38, 0
    buffer_load_dwordx4 v11, s[20:23], s37 offen offset:0 nt lds
    v_mfma_f32_32x32x16_bf16 v[192:207], a[136:139], v[84:87], v[192:207]
    ds_read_b64_tr_b16 a[154:155], v22 offset:21504
    buffer_load_dwordx4 v11, s[20:23], s37 offen offset:1024 nt lds
    v_fma_mix_f32 v24, v94, v44, v36 op_sel:[0,0,0] op_sel_hi:[1,0,0]
    v_fma_mix_f32 v25, v94, v45, v37 op_sel:[1,0,0] op_sel_hi:[1,0,0]
    v_mfma_f32_32x32x16_bf16 v[208:223], a[140:143], v[80:83], v[208:223]
    ds_read_b64_tr_b16 a[156:157], v23 offset:20480
    buffer_load_dwordx4 v11, s[20:23], s37 offen offset:2048 nt lds
    v_cvt_pk_bf16_f32 v94, v24, v25
    v_fma_mix_f32 v26, v95, v46, v38 op_sel:[0,0,0] op_sel_hi:[1,0,0]
    v_mfma_f32_32x32x16_bf16 v[224:239], a[140:143], v[84:87], v[224:239]
    ds_read_b64_tr_b16 a[158:159], v23 offset:21504
    buffer_load_dwordx4 v11, s[20:23], s37 offen offset:3072 nt lds
    v_fma_mix_f32 v27, v95, v47, v39 op_sel:[1,0,0] op_sel_hi:[1,0,0]
    v_cvt_pk_bf16_f32 v95, v26, v27
    s_waitcnt vmcnt(10)
    s_waitcnt lgkmcnt(4)
    v_mfma_f32_32x32x16_bf16 v[112:127], a[144:147], v[88:91], v[112:127]
    ds_read_b64_tr_b16 a[160:161], v20 offset:24576
    ds_read_b128 v[32:35], v30 offset:2496
    v_fma_mix_f32 v24, v96, v248, v240 op_sel:[0,0,0] op_sel_hi:[1,0,0]
    v_fma_mix_f32 v25, v96, v249, v241 op_sel:[1,0,0] op_sel_hi:[1,0,0]
    v_cvt_pk_bf16_f32 v96, v24, v25
    v_mfma_f32_32x32x16_bf16 v[128:143], a[144:147], v[92:95], v[128:143]
    ds_read_b64_tr_b16 a[162:163], v20 offset:25600
    ds_read_b128 v[36:39], v30 offset:2512
    v_fma_mix_f32 v26, v97, v250, v242 op_sel:[0,0,0] op_sel_hi:[1,0,0]
    v_fma_mix_f32 v27, v97, v251, v243 op_sel:[1,0,0] op_sel_hi:[1,0,0]
    v_mfma_f32_32x32x16_bf16 v[144:159], a[148:151], v[88:91], v[144:159]
    ds_read_b64_tr_b16 a[164:165], v21 offset:24576
    ds_read_b128 v[40:43], v30 offset:5056
    v_cvt_pk_bf16_f32 v97, v26, v27
    v_fma_mix_f32 v24, v98, v252, v244 op_sel:[0,0,0] op_sel_hi:[1,0,0]
    v_fma_mix_f32 v25, v98, v253, v245 op_sel:[1,0,0] op_sel_hi:[1,0,0]
    v_mfma_f32_32x32x16_bf16 v[160:175], a[148:151], v[92:95], v[160:175]
    ds_read_b64_tr_b16 a[166:167], v21 offset:25600
    ds_read_b128 v[44:47], v30 offset:5072
    v_cvt_pk_bf16_f32 v98, v24, v25
    v_fma_mix_f32 v26, v99, v254, v246 op_sel:[0,0,0] op_sel_hi:[1,0,0]
    v_fma_mix_f32 v27, v99, v255, v247 op_sel:[1,0,0] op_sel_hi:[1,0,0]
    s_waitcnt lgkmcnt(8)
    v_mfma_f32_32x32x16_bf16 v[176:191], a[152:155], v[88:91], v[176:191]
    ds_read_b64_tr_b16 a[168:169], v22 offset:24576
    v_cvt_pk_bf16_f32 v99, v26, v27
    v_fma_mix_f32 v24, v100, v248, v240 op_sel:[0,0,0] op_sel_hi:[1,0,0]
    v_fma_mix_f32 v25, v100, v249, v241 op_sel:[1,0,0] op_sel_hi:[1,0,0]
    v_mfma_f32_32x32x16_bf16 v[192:207], a[152:155], v[92:95], v[192:207]
    ds_read_b64_tr_b16 a[170:171], v22 offset:25600
    v_cvt_pk_bf16_f32 v100, v24, v25
    v_fma_mix_f32 v26, v101, v250, v242 op_sel:[0,0,0] op_sel_hi:[1,0,0]
    v_fma_mix_f32 v27, v101, v251, v243 op_sel:[1,0,0] op_sel_hi:[1,0,0]
    v_mfma_f32_32x32x16_bf16 v[208:223], a[156:159], v[88:91], v[208:223]
    ds_read_b64_tr_b16 a[172:173], v23 offset:24576
    v_cvt_pk_bf16_f32 v101, v26, v27
    v_fma_mix_f32 v24, v102, v252, v244 op_sel:[0,0,0] op_sel_hi:[1,0,0]
    v_fma_mix_f32 v25, v102, v253, v245 op_sel:[1,0,0] op_sel_hi:[1,0,0]
    v_cvt_pk_bf16_f32 v102, v24, v25
    v_mfma_f32_32x32x16_bf16 v[224:239], a[156:159], v[92:95], v[224:239]
    ds_read_b64_tr_b16 a[174:175], v23 offset:25600
    v_fma_mix_f32 v26, v103, v254, v246 op_sel:[0,0,0] op_sel_hi:[1,0,0]
    v_fma_mix_f32 v27, v103, v255, v247 op_sel:[1,0,0] op_sel_hi:[1,0,0]
    v_cvt_pk_bf16_f32 v103, v26, v27
    s_waitcnt vmcnt(4)
    s_waitcnt lgkmcnt(4)
    v_mfma_f32_32x32x16_bf16 v[112:127], a[160:163], v[96:99], v[112:127]
    ds_read_b64_tr_b16 a[176:177], v20 offset:28672
    v_fma_mix_f32 v24, v104, v40, v32 op_sel:[0,0,0] op_sel_hi:[1,0,0]
    v_fma_mix_f32 v25, v104, v41, v33 op_sel:[1,0,0] op_sel_hi:[1,0,0]
    v_cvt_pk_bf16_f32 v104, v24, v25
    v_mfma_f32_32x32x16_bf16 v[128:143], a[160:163], v[100:103], v[128:143]
    ds_read_b64_tr_b16 a[178:179], v20 offset:29696
    v_fma_mix_f32 v26, v105, v42, v34 op_sel:[0,0,0] op_sel_hi:[1,0,0]
    v_fma_mix_f32 v27, v105, v43, v35 op_sel:[1,0,0] op_sel_hi:[1,0,0]
    v_cvt_pk_bf16_f32 v105, v26, v27
    v_mfma_f32_32x32x16_bf16 v[144:159], a[164:167], v[96:99], v[144:159]
    ds_read_b64_tr_b16 a[180:181], v21 offset:28672
    v_fma_mix_f32 v24, v106, v44, v36 op_sel:[0,0,0] op_sel_hi:[1,0,0]
    v_fma_mix_f32 v25, v106, v45, v37 op_sel:[1,0,0] op_sel_hi:[1,0,0]
    v_cvt_pk_bf16_f32 v106, v24, v25
    v_mfma_f32_32x32x16_bf16 v[160:175], a[164:167], v[100:103], v[160:175]
    ds_read_b64_tr_b16 a[182:183], v21 offset:29696
    v_fma_mix_f32 v26, v107, v46, v38 op_sel:[0,0,0] op_sel_hi:[1,0,0]
    v_fma_mix_f32 v27, v107, v47, v39 op_sel:[1,0,0] op_sel_hi:[1,0,0]
    v_cvt_pk_bf16_f32 v107, v26, v27
    s_waitcnt lgkmcnt(4)
    v_mfma_f32_32x32x16_bf16 v[176:191], a[168:171], v[96:99], v[176:191]
    ds_read_b64_tr_b16 a[184:185], v22 offset:28672
    v_fma_mix_f32 v24, v108, v40, v32 op_sel:[0,0,0] op_sel_hi:[1,0,0]
    v_fma_mix_f32 v25, v108, v41, v33 op_sel:[1,0,0] op_sel_hi:[1,0,0]
    v_cvt_pk_bf16_f32 v108, v24, v25
    v_mfma_f32_32x32x16_bf16 v[192:207], a[168:171], v[100:103], v[192:207]
    ds_read_b64_tr_b16 a[186:187], v22 offset:29696
    v_fma_mix_f32 v26, v109, v42, v34 op_sel:[0,0,0] op_sel_hi:[1,0,0]
    v_fma_mix_f32 v27, v109, v43, v35 op_sel:[1,0,0] op_sel_hi:[1,0,0]
    v_cvt_pk_bf16_f32 v109, v26, v27
    v_mfma_f32_32x32x16_bf16 v[208:223], a[172:175], v[96:99], v[208:223]
    ds_read_b64_tr_b16 a[188:189], v23 offset:28672
    v_fma_mix_f32 v24, v110, v44, v36 op_sel:[0,0,0] op_sel_hi:[1,0,0]
    v_fma_mix_f32 v25, v110, v45, v37 op_sel:[1,0,0] op_sel_hi:[1,0,0]
    v_cvt_pk_bf16_f32 v110, v24, v25
    v_mfma_f32_32x32x16_bf16 v[224:239], a[172:175], v[100:103], v[224:239]
    ds_read_b64_tr_b16 a[190:191], v23 offset:29696
    v_fma_mix_f32 v26, v111, v46, v38 op_sel:[0,0,0] op_sel_hi:[1,0,0]
    v_fma_mix_f32 v27, v111, v47, v39 op_sel:[1,0,0] op_sel_hi:[1,0,0]
    v_cvt_pk_bf16_f32 v111, v26, v27
    s_waitcnt vmcnt(0)
    s_barrier
    s_waitcnt lgkmcnt(4)
    v_mfma_f32_32x32x16_bf16 v[112:127], a[176:179], v[104:107], v[112:127]
    ds_read_b128 a[128:131], v12 offset:0
    v_mfma_f32_32x32x16_bf16 v[128:143], a[176:179], v[108:111], v[128:143]
    ds_read_b128 a[132:135], v13 offset:0
    v_mfma_f32_32x32x16_bf16 v[144:159], a[180:183], v[104:107], v[144:159]
    ds_read_b128 a[136:139], v14 offset:0
    v_mfma_f32_32x32x16_bf16 v[160:175], a[180:183], v[108:111], v[160:175]
    ds_read_b128 a[140:143], v15 offset:0
    s_waitcnt lgkmcnt(4)
    v_mfma_f32_32x32x16_bf16 v[176:191], a[184:187], v[104:107], v[176:191]
    ds_read_b128 a[144:147], v16 offset:0
    v_mfma_f32_32x32x16_bf16 v[192:207], a[184:187], v[108:111], v[192:207]
    ds_read_b128 a[148:151], v17 offset:0
    v_mfma_f32_32x32x16_bf16 v[208:223], a[188:191], v[104:107], v[208:223]
    ds_read_b128 a[152:155], v18 offset:0
    v_mfma_f32_32x32x16_bf16 v[224:239], a[188:191], v[108:111], v[224:239]
    ds_read_b128 a[156:159], v19 offset:0
    ds_read_b128 a[192:195], v12 offset:8192
    ds_read_b128 a[196:199], v13 offset:8192
    ds_read_b128 a[200:203], v14 offset:8192
    ds_read_b128 a[204:207], v15 offset:8192
    ds_read_b128 a[208:211], v16 offset:8192
    ds_read_b128 a[212:215], v17 offset:8192
    ds_read_b128 a[216:219], v18 offset:8192
    ds_read_b128 a[220:223], v19 offset:8192
    v_cvt_pk_bf16_f32 v48, v112, v113
    v_cvt_pk_bf16_f32 v49, v114, v115
    v_cvt_pk_bf16_f32 v50, v116, v117
    v_cvt_pk_bf16_f32 v51, v118, v119
    v_cvt_pk_bf16_f32 v52, v128, v129
    v_cvt_pk_bf16_f32 v53, v130, v131
    v_cvt_pk_bf16_f32 v54, v132, v133
    v_cvt_pk_bf16_f32 v55, v134, v135
    v_cvt_pk_bf16_f32 v56, v120, v121
    v_cvt_pk_bf16_f32 v57, v122, v123
    v_cvt_pk_bf16_f32 v58, v124, v125
    v_cvt_pk_bf16_f32 v59, v126, v127
    v_cvt_pk_bf16_f32 v60, v136, v137
    v_cvt_pk_bf16_f32 v61, v138, v139
    v_cvt_pk_bf16_f32 v62, v140, v141
    v_cvt_pk_bf16_f32 v63, v142, v143
    v_lshlrev_b32 v31, 10, v29
    v_add_u32 v31, 32768, v31
    s_waitcnt lgkmcnt(12)
    v_mfma_f32_32x32x16_bf16 v[112:127], a[128:131], v[48:51], 0
    s_add_u32 m0, s38, 81920
    s_add_u32 s37, s38, 16384
    v_cvt_pk_bf16_f32 v64, v144, v145
    v_cvt_pk_bf16_f32 v65, v146, v147
    v_cvt_pk_bf16_f32 v66, v148, v149
    v_cvt_pk_bf16_f32 v67, v150, v151
    v_mfma_f32_32x32x16_bf16 v[128:143], a[128:131], v[52:55], 0
    buffer_load_dwordx4 v11, s[20:23], s37 offen offset:0 nt lds
    buffer_load_dwordx4 v11, s[20:23], s37 offen offset:1024 nt lds
    v_cvt_pk_bf16_f32 v68, v160, v161
    v_cvt_pk_bf16_f32 v69, v162, v163
    v_cvt_pk_bf16_f32 v70, v164, v165
    v_cvt_pk_bf16_f32 v71, v166, v167
    v_mfma_f32_32x32x16_bf16 v[112:127], a[132:135], v[56:59], v[112:127]
    buffer_load_dwordx4 v11, s[20:23], s37 offen offset:2048 nt lds
    buffer_load_dwordx4 v11, s[20:23], s37 offen offset:3072 nt lds
    v_cvt_pk_bf16_f32 v72, v152, v153
    v_cvt_pk_bf16_f32 v73, v154, v155
    v_cvt_pk_bf16_f32 v74, v156, v157
    v_cvt_pk_bf16_f32 v75, v158, v159
    v_mfma_f32_32x32x16_bf16 v[128:143], a[132:135], v[60:63], v[128:143]
    s_add_u32 m0, s38, 32768
    s_add_u32 s37, s38, 32768
    v_cvt_pk_bf16_f32 v76, v168, v169
    v_cvt_pk_bf16_f32 v77, v170, v171
    v_cvt_pk_bf16_f32 v78, v172, v173
    v_cvt_pk_bf16_f32 v79, v174, v175
    v_mfma_f32_32x32x16_bf16 v[112:127], a[136:139], v[64:67], v[112:127]
    buffer_load_dwordx4 v7, s[16:19], s37 offen offset:0 nt lds
    buffer_load_dwordx4 v8, s[16:19], s37 offen offset:1024 nt lds
    v_cvt_pk_bf16_f32 v80, v176, v177
    v_cvt_pk_bf16_f32 v81, v178, v179
    v_cvt_pk_bf16_f32 v82, v180, v181
    v_cvt_pk_bf16_f32 v83, v182, v183
    v_mfma_f32_32x32x16_bf16 v[128:143], a[136:139], v[68:71], v[128:143]
    buffer_load_dwordx4 v9, s[16:19], s37 offen offset:2048 nt lds
    buffer_load_dwordx4 v10, s[16:19], s37 offen offset:3072 nt lds
    v_cvt_pk_bf16_f32 v84, v192, v193
    v_cvt_pk_bf16_f32 v85, v194, v195
    v_cvt_pk_bf16_f32 v86, v196, v197
    v_cvt_pk_bf16_f32 v87, v198, v199
    v_mfma_f32_32x32x16_bf16 v[112:127], a[140:143], v[72:75], v[112:127]
    s_add_u32 m0, s38, 98304
    s_add_u32 s37, s38, 32768
    v_cvt_pk_bf16_f32 v88, v184, v185
    v_cvt_pk_bf16_f32 v89, v186, v187
    v_cvt_pk_bf16_f32 v90, v188, v189
    v_cvt_pk_bf16_f32 v91, v190, v191
    v_mfma_f32_32x32x16_bf16 v[128:143], a[140:143], v[76:79], v[128:143]
    buffer_load_dwordx4 v11, s[20:23], s37 offen offset:0 nt lds
    buffer_load_dwordx4 v11, s[20:23], s37 offen offset:1024 nt lds
    v_cvt_pk_bf16_f32 v92, v200, v201
    v_cvt_pk_bf16_f32 v93, v202, v203
    v_cvt_pk_bf16_f32 v94, v204, v205
    v_cvt_pk_bf16_f32 v95, v206, v207
    s_waitcnt lgkmcnt(8)
    v_mfma_f32_32x32x16_bf16 v[112:127], a[144:147], v[80:83], v[112:127]
    buffer_load_dwordx4 v11, s[20:23], s37 offen offset:2048 nt lds
    buffer_load_dwordx4 v11, s[20:23], s37 offen offset:3072 nt lds
    v_cvt_pk_bf16_f32 v96, v208, v209
    v_cvt_pk_bf16_f32 v97, v210, v211
    v_cvt_pk_bf16_f32 v98, v212, v213
    v_cvt_pk_bf16_f32 v99, v214, v215
    v_mfma_f32_32x32x16_bf16 v[128:143], a[144:147], v[84:87], v[128:143]
    v_cvt_pk_bf16_f32 v100, v224, v225
    v_cvt_pk_bf16_f32 v101, v226, v227
    v_cvt_pk_bf16_f32 v102, v228, v229
    v_cvt_pk_bf16_f32 v103, v230, v231
    v_mfma_f32_32x32x16_bf16 v[112:127], a[148:151], v[88:91], v[112:127]
    v_cvt_pk_bf16_f32 v104, v216, v217
    v_cvt_pk_bf16_f32 v105, v218, v219
    v_cvt_pk_bf16_f32 v106, v220, v221
    v_cvt_pk_bf16_f32 v107, v222, v223
    v_mfma_f32_32x32x16_bf16 v[128:143], a[148:151], v[92:95], v[128:143]
    v_cvt_pk_bf16_f32 v108, v232, v233
    v_cvt_pk_bf16_f32 v109, v234, v235
    v_cvt_pk_bf16_f32 v110, v236, v237
    v_cvt_pk_bf16_f32 v111, v238, v239
    v_mfma_f32_32x32x16_bf16 v[112:127], a[152:155], v[96:99], v[112:127]
    v_mfma_f32_32x32x16_bf16 v[128:143], a[152:155], v[100:103], v[128:143]
    v_mfma_f32_32x32x16_bf16 v[112:127], a[156:159], v[104:107], v[112:127]
    v_mfma_f32_32x32x16_bf16 v[128:143], a[156:159], v[108:111], v[128:143]
    v_sub_u32 v20, v20, v31
    v_sub_u32 v21, v21, v31
    v_sub_u32 v22, v22, v31
    v_sub_u32 v23, v23, v31
    v_mov_b32 v24, 0
    v_mov_b32 v25, 0
    v_mov_b32 v26, 0
    v_mov_b32 v27, 0
    v_and_b32 v47, 63, v0
    v_lshlrev_b32 v47, 7, v47
    s_nop 3
    v_max3_f32 v32, v112, v113, v114
    v_max3_f32 v33, v128, v129, v130
    v_max3_f32 v32, v32, v115, v116
    v_max3_f32 v33, v33, v131, v132
    v_max3_f32 v32, v32, v117, v118
    v_max3_f32 v33, v33, v133, v134
    v_max3_f32 v32, v32, v119, v120
    v_max3_f32 v33, v33, v135, v136
    v_max3_f32 v32, v32, v121, v122
    v_max3_f32 v33, v33, v137, v138
    v_max3_f32 v32, v32, v123, v124
    v_max3_f32 v33, v33, v139, v140
    v_max3_f32 v32, v32, v125, v126
    v_max3_f32 v33, v33, v141, v142
    v_max_f32 v32, v32, v127
    v_max_f32 v33, v33, v143
    v_mov_b32 v34, v32
    v_mov_b32 v35, v33
    s_nop 0
    v_permlane32_swap_b32 v32, v34
    v_permlane32_swap_b32 v33, v35
    s_nop 0
    v_max_f32 v32, v32, v34
    v_max_f32 v33, v33, v35
    v_sub_f32 v208, 0, v32
    v_sub_f32 v224, 0, v33
    v_mov_b32 v209, v208
    v_mov_b32 v225, v224
    v_mov_b32 v210, v208
    v_mov_b32 v226, v224
    v_mov_b32 v211, v208
    v_mov_b32 v227, v224
    v_mov_b32 v212, v208
    v_mov_b32 v228, v224
    v_mov_b32 v213, v208
    v_mov_b32 v229, v224
    v_mov_b32 v214, v208
    v_mov_b32 v230, v224
    v_mov_b32 v215, v208
    v_mov_b32 v231, v224
    v_mov_b32 v216, v208
    v_mov_b32 v232, v224
    v_mov_b32 v217, v208
    v_mov_b32 v233, v224
    v_mov_b32 v218, v208
    v_mov_b32 v234, v224
    v_mov_b32 v219, v208
    v_mov_b32 v235, v224
    v_mov_b32 v220, v208
    v_mov_b32 v236, v224
    v_mov_b32 v221, v208
    v_mov_b32 v237, v224
    v_mov_b32 v222, v208
    v_mov_b32 v238, v224
    v_mov_b32 v223, v208
    v_mov_b32 v239, v224
    s_waitcnt lgkmcnt(4)
    v_mfma_f32_32x32x16_bf16 v[144:159], a[192:195], v[48:51], v[208:223]
    ds_read_b128 a[128:131], v12 offset:16384
    v_add_f32 v112, v112, v208
    v_add_f32 v113, v113, v208
    v_exp_f32 v112, v112
    v_exp_f32 v113, v113
    v_add_f32 v24, v24, v112
    v_add_f32 v25, v25, v113
    v_cvt_pk_bf16_f32 v176, v112, v113
    v_mfma_f32_32x32x16_bf16 v[160:175], a[192:195], v[52:55], v[224:239]
    ds_read_b128 a[132:135], v13 offset:16384
    v_and_b32 v5, 63, v0
    v_add_f32 v114, v114, v208
    v_add_f32 v115, v115, v208
    v_exp_f32 v114, v114
    v_exp_f32 v115, v115
    v_add_f32 v24, v24, v114
    v_add_f32 v25, v25, v115
    v_cvt_pk_bf16_f32 v177, v114, v115
    v_mfma_f32_32x32x16_bf16 v[144:159], a[196:199], v[56:59], v[144:159]
    ds_read_b128 a[136:139], v14 offset:16384
    v_lshrrev_b32 v43, 4, v5
    v_bfe_u32 v44, v5, 2, 2
    v_and_b32 v45, 3, v5
    v_lshlrev_b32 v45, 3, v45
    v_add_f32 v116, v116, v208
    v_add_f32 v117, v117, v208
    v_exp_f32 v116, v116
    v_exp_f32 v117, v117
    v_add_f32 v24, v24, v116
    v_add_f32 v25, v25, v117
    v_cvt_pk_bf16_f32 v178, v116, v117
    v_mfma_f32_32x32x16_bf16 v[160:175], a[196:199], v[60:63], v[160:175]
    ds_read_b128 a[140:143], v15 offset:16384
    v_lshlrev_b32 v46, 3, v43
    v_add_u32 v46, v46, v44
    v_mul_u32_u24 v46, 160, v46
    v_add3_u32 v4, v46, v45, s53
    v_add_f32 v118, v118, v208
    v_add_f32 v119, v119, v208
    v_exp_f32 v118, v118
    v_exp_f32 v119, v119
    v_add_f32 v24, v24, v118
    v_add_f32 v25, v25, v119
    v_cvt_pk_bf16_f32 v179, v118, v119
    v_mfma_f32_32x32x16_bf16 v[144:159], a[200:203], v[64:67], v[144:159]
    ds_read_b128 a[144:147], v16 offset:16384
    v_lshlrev_b32 v46, 2, v43
    v_add_u32 v46, v46, v44
    v_mul_u32_u24 v46, s83, v46
    v_add3_u32 v6, v46, v45, s53
    s_lshl_b32 s41, s83, 4
    v_add_u32 v3, s41, v6
    v_add_f32 v120, v120, v208
    v_add_f32 v121, v121, v208
    v_exp_f32 v120, v120
    v_exp_f32 v121, v121
    v_add_f32 v24, v24, v120
    v_add_f32 v25, v25, v121
    v_cvt_pk_bf16_f32 v180, v120, v121
    v_mfma_f32_32x32x16_bf16 v[160:175], a[200:203], v[68:71], v[160:175]
    ds_read_b128 a[148:151], v17 offset:16384
    v_add_u32 v43, 0, v5
    v_mul_u32_u24 v44, 6554, v43
    v_lshrrev_b32 v44, 16, v44
    v_mul_u32_u24 v45, 10, v44
    v_sub_u32 v45, v43, v45
    v_mul_u32_u24 v44, 1280, v44
    v_lshl_add_u32 v36, v45, 4, v44
    v_add_f32 v122, v122, v208
    v_add_f32 v123, v123, v208
    v_exp_f32 v122, v122
    v_exp_f32 v123, v123
    v_add_f32 v24, v24, v122
    v_add_f32 v25, v25, v123
    v_cvt_pk_bf16_f32 v181, v122, v123
    v_mfma_f32_32x32x16_bf16 v[144:159], a[204:207], v[72:75], v[144:159]
    ds_read_b128 a[152:155], v18 offset:16384
    v_add_u32 v43, 64, v5
    v_mul_u32_u24 v44, 6554, v43
    v_lshrrev_b32 v44, 16, v44
    v_mul_u32_u24 v45, 10, v44
    v_sub_u32 v45, v43, v45
    v_mul_u32_u24 v44, 1280, v44
    v_lshl_add_u32 v37, v45, 4, v44
    v_add_f32 v124, v124, v208
    v_add_f32 v125, v125, v208
    v_exp_f32 v124, v124
    v_exp_f32 v125, v125
    v_add_f32 v24, v24, v124
    v_add_f32 v25, v25, v125
    v_cvt_pk_bf16_f32 v182, v124, v125
    v_mfma_f32_32x32x16_bf16 v[160:175], a[204:207], v[76:79], v[160:175]
    ds_read_b128 a[156:159], v19 offset:16384
    v_add_u32 v43, 128, v5
    v_mul_u32_u24 v44, 6554, v43
    v_lshrrev_b32 v44, 16, v44
    v_mul_u32_u24 v45, 10, v44
    v_sub_u32 v45, v43, v45
    v_mul_u32_u24 v44, 1280, v44
    v_lshl_add_u32 v38, v45, 4, v44
    v_add_f32 v126, v126, v208
    v_add_f32 v127, v127, v208
    v_exp_f32 v126, v126
    v_exp_f32 v127, v127
    v_add_f32 v24, v24, v126
    v_add_f32 v25, v25, v127
    v_cvt_pk_bf16_f32 v183, v126, v127
    s_waitcnt lgkmcnt(8)
    v_mfma_f32_32x32x16_bf16 v[144:159], a[208:211], v[80:83], v[144:159]
    v_add_u32 v43, 192, v5
    v_mul_u32_u24 v44, 6554, v43
    v_lshrrev_b32 v44, 16, v44
    v_mul_u32_u24 v45, 10, v44
    v_sub_u32 v45, v43, v45
    v_mul_u32_u24 v44, 1280, v44
    v_lshl_add_u32 v39, v45, 4, v44
    v_add_f32 v128, v128, v224
    v_add_f32 v129, v129, v224
    v_exp_f32 v128, v128
    v_exp_f32 v129, v129
    v_add_f32 v26, v26, v128
    v_add_f32 v27, v27, v129
    v_cvt_pk_bf16_f32 v184, v128, v129
    v_mfma_f32_32x32x16_bf16 v[160:175], a[208:211], v[84:87], v[160:175]
    v_add_u32 v43, 256, v5
    v_mul_u32_u24 v44, 6554, v43
    v_lshrrev_b32 v44, 16, v44
    v_mul_u32_u24 v45, 10, v44
    v_sub_u32 v45, v43, v45
    v_mul_u32_u24 v44, 1280, v44
    v_lshl_add_u32 v40, v45, 4, v44
    v_add_f32 v130, v130, v224
    v_add_f32 v131, v131, v224
    v_exp_f32 v130, v130
    v_exp_f32 v131, v131
    v_add_f32 v26, v26, v130
    v_add_f32 v27, v27, v131
    v_cvt_pk_bf16_f32 v185, v130, v131
    v_mfma_f32_32x32x16_bf16 v[144:159], a[212:215], v[88:91], v[144:159]
    v_add_f32 v132, v132, v224
    v_add_f32 v133, v133, v224
    v_exp_f32 v132, v132
    v_exp_f32 v133, v133
    v_add_f32 v26, v26, v132
    v_add_f32 v27, v27, v133
    v_cvt_pk_bf16_f32 v186, v132, v133
    v_mfma_f32_32x32x16_bf16 v[160:175], a[212:215], v[92:95], v[160:175]
    v_add_f32 v134, v134, v224
    v_add_f32 v135, v135, v224
    v_exp_f32 v134, v134
    v_exp_f32 v135, v135
    v_add_f32 v26, v26, v134
    v_add_f32 v27, v27, v135
    v_cvt_pk_bf16_f32 v187, v134, v135
    v_mfma_f32_32x32x16_bf16 v[144:159], a[216:219], v[96:99], v[144:159]
    v_add_f32 v136, v136, v224
    v_add_f32 v137, v137, v224
    v_exp_f32 v136, v136
    v_exp_f32 v137, v137
    v_add_f32 v26, v26, v136
    v_add_f32 v27, v27, v137
    v_cvt_pk_bf16_f32 v188, v136, v137
    v_mfma_f32_32x32x16_bf16 v[160:175], a[216:219], v[100:103], v[160:175]
    v_add_f32 v138, v138, v224
    v_add_f32 v139, v139, v224
    v_exp_f32 v138, v138
    v_exp_f32 v139, v139
    v_add_f32 v26, v26, v138
    v_add_f32 v27, v27, v139
    v_cvt_pk_bf16_f32 v189, v138, v139
    v_mfma_f32_32x32x16_bf16 v[144:159], a[220:223], v[104:107], v[144:159]
    v_add_f32 v140, v140, v224
    v_add_f32 v141, v141, v224
    v_exp_f32 v140, v140
    v_exp_f32 v141, v141
    v_add_f32 v26, v26, v140
    v_add_f32 v27, v27, v141
    v_cvt_pk_bf16_f32 v190, v140, v141
    v_mfma_f32_32x32x16_bf16 v[160:175], a[220:223], v[108:111], v[160:175]
    v_add_f32 v142, v142, v224
    v_add_f32 v143, v143, v224
    v_exp_f32 v142, v142
    v_exp_f32 v143, v143
    v_add_f32 v26, v26, v142
    v_add_f32 v27, v27, v143
    v_cvt_pk_bf16_f32 v191, v142, v143
    s_waitcnt lgkmcnt(4)
    v_mfma_f32_32x32x16_bf16 v[112:127], a[128:131], v[48:51], v[208:223]
    ds_read_b64_tr_b16 a[160:161], v20 offset:0
    v_exp_f32 v144, v144
    v_exp_f32 v145, v145
    v_mfma_f32_32x32x16_bf16 v[128:143], a[128:131], v[52:55], v[224:239]
    ds_read_b64_tr_b16 a[162:163], v20 offset:2048
    s_add_u32 m0, s53, 0
    v_add_f32 v24, v24, v144
    v_add_f32 v25, v25, v145
    v_cvt_pk_bf16_f32 v192, v144, v145
    v_mfma_f32_32x32x16_bf16 v[112:127], a[132:135], v[56:59], v[112:127]
    ds_read_b64_tr_b16 a[164:165], v21 offset:0
    buffer_load_dwordx4 v36, s[64:67], s68 offen lds
    v_exp_f32 v146, v146
    v_exp_f32 v147, v147
    v_mfma_f32_32x32x16_bf16 v[128:143], a[132:135], v[60:63], v[128:143]
    ds_read_b64_tr_b16 a[166:167], v21 offset:2048
    s_add_u32 m0, s53, 1024
    v_add_f32 v24, v24, v146
    v_add_f32 v25, v25, v147
    v_cvt_pk_bf16_f32 v193, v146, v147
    v_mfma_f32_32x32x16_bf16 v[112:127], a[136:139], v[64:67], v[112:127]
    ds_read_b64_tr_b16 a[168:169], v22 offset:0
    buffer_load_dwordx4 v37, s[64:67], s68 offen lds
    v_exp_f32 v148, v148
    v_exp_f32 v149, v149
    v_mfma_f32_32x32x16_bf16 v[128:143], a[136:139], v[68:71], v[128:143]
    ds_read_b64_tr_b16 a[170:171], v22 offset:2048
    s_add_u32 m0, s53, 2048
    v_add_f32 v24, v24, v148
    v_add_f32 v25, v25, v149
    v_cvt_pk_bf16_f32 v194, v148, v149
    v_mfma_f32_32x32x16_bf16 v[112:127], a[140:143], v[72:75], v[112:127]
    ds_read_b64_tr_b16 a[172:173], v23 offset:0
    buffer_load_dwordx4 v38, s[64:67], s68 offen lds
    v_exp_f32 v150, v150
    v_exp_f32 v151, v151
    v_mfma_f32_32x32x16_bf16 v[128:143], a[140:143], v[76:79], v[128:143]
    ds_read_b64_tr_b16 a[174:175], v23 offset:2048
    s_add_u32 m0, s53, 3072
    v_add_f32 v24, v24, v150
    v_add_f32 v25, v25, v151
    v_cvt_pk_bf16_f32 v195, v150, v151
    s_waitcnt lgkmcnt(8)
    v_mfma_f32_32x32x16_bf16 v[112:127], a[144:147], v[80:83], v[112:127]
    ds_read_b64_tr_b16 a[176:177], v20 offset:4096
    buffer_load_dwordx4 v39, s[64:67], s68 offen lds
    v_exp_f32 v152, v152
    v_exp_f32 v153, v153
    v_mfma_f32_32x32x16_bf16 v[128:143], a[144:147], v[84:87], v[128:143]
    ds_read_b64_tr_b16 a[178:179], v20 offset:6144
    s_add_u32 m0, s53, 4096
    v_add_f32 v24, v24, v152
    v_add_f32 v25, v25, v153
    v_cvt_pk_bf16_f32 v196, v152, v153
    v_mfma_f32_32x32x16_bf16 v[112:127], a[148:151], v[88:91], v[112:127]
    ds_read_b64_tr_b16 a[180:181], v21 offset:4096
    buffer_load_dwordx4 v40, s[64:67], s68 offen lds
    v_exp_f32 v154, v154
    v_exp_f32 v155, v155
    v_mfma_f32_32x32x16_bf16 v[128:143], a[148:151], v[92:95], v[128:143]
    ds_read_b64_tr_b16 a[182:183], v21 offset:6144
    v_add_f32 v24, v24, v154
    v_add_f32 v25, v25, v155
    v_cvt_pk_bf16_f32 v197, v154, v155
    v_mfma_f32_32x32x16_bf16 v[112:127], a[152:155], v[96:99], v[112:127]
    ds_read_b64_tr_b16 a[184:185], v22 offset:4096
    v_exp_f32 v156, v156
    v_exp_f32 v157, v157
    v_mfma_f32_32x32x16_bf16 v[128:143], a[152:155], v[100:103], v[128:143]
    ds_read_b64_tr_b16 a[186:187], v22 offset:6144
    v_add_f32 v24, v24, v156
    v_add_f32 v25, v25, v157
    v_cvt_pk_bf16_f32 v198, v156, v157
    v_mfma_f32_32x32x16_bf16 v[112:127], a[156:159], v[104:107], v[112:127]
    ds_read_b64_tr_b16 a[188:189], v23 offset:4096
    v_exp_f32 v158, v158
    v_exp_f32 v159, v159
    v_mfma_f32_32x32x16_bf16 v[128:143], a[156:159], v[108:111], v[128:143]
    ds_read_b64_tr_b16 a[190:191], v23 offset:6144
    v_add_f32 v24, v24, v158
    v_add_f32 v25, v25, v159
    v_cvt_pk_bf16_f32 v199, v158, v159
    s_waitcnt lgkmcnt(12)
    v_mfma_f32_32x32x16_bf16 a[0:15], a[160:163], v[176:179], 0
    ds_read_b128 a[192:195], v12 offset:24576
    v_exp_f32 v160, v160
    v_exp_f32 v161, v161
    v_mfma_f32_32x32x16_bf16 a[16:31], a[160:163], v[184:187], 0
    ds_read_b128 a[196:199], v13 offset:24576
    v_add_f32 v26, v26, v160
    v_add_f32 v27, v27, v161
    v_cvt_pk_bf16_f32 v200, v160, v161
    v_mfma_f32_32x32x16_bf16 a[32:47], a[164:167], v[176:179], 0
    ds_read_b128 a[200:203], v14 offset:24576
    v_exp_f32 v162, v162
    v_exp_f32 v163, v163
    v_mfma_f32_32x32x16_bf16 a[48:63], a[164:167], v[184:187], 0
    ds_read_b128 a[204:207], v15 offset:24576
    v_add_f32 v26, v26, v162
    v_add_f32 v27, v27, v163
    v_cvt_pk_bf16_f32 v201, v162, v163
    s_waitcnt lgkmcnt(12)
    v_mfma_f32_32x32x16_bf16 a[64:79], a[168:171], v[176:179], 0
    ds_read_b128 a[208:211], v16 offset:24576
    v_exp_f32 v164, v164
    v_exp_f32 v165, v165
    v_mfma_f32_32x32x16_bf16 a[80:95], a[168:171], v[184:187], 0
    ds_read_b128 a[212:215], v17 offset:24576
    v_add_f32 v26, v26, v164
    v_add_f32 v27, v27, v165
    v_cvt_pk_bf16_f32 v202, v164, v165
    v_mfma_f32_32x32x16_bf16 a[96:111], a[172:175], v[176:179], 0
    ds_read_b128 a[216:219], v18 offset:24576
    v_exp_f32 v166, v166
    v_exp_f32 v167, v167
    v_mfma_f32_32x32x16_bf16 a[112:127], a[172:175], v[184:187], 0
    ds_read_b128 a[220:223], v19 offset:24576
    v_add_f32 v26, v26, v166
    v_add_f32 v27, v27, v167
    v_cvt_pk_bf16_f32 v203, v166, v167
    s_waitcnt lgkmcnt(12)
    v_mfma_f32_32x32x16_bf16 a[0:15], a[176:179], v[180:183], a[0:15]
    v_exp_f32 v168, v168
    v_exp_f32 v169, v169
    v_mfma_f32_32x32x16_bf16 a[16:31], a[176:179], v[188:191], a[16:31]
    v_add_f32 v26, v26, v168
    v_add_f32 v27, v27, v169
    v_cvt_pk_bf16_f32 v204, v168, v169
    v_mfma_f32_32x32x16_bf16 a[32:47], a[180:183], v[180:183], a[32:47]
    v_exp_f32 v170, v170
    v_exp_f32 v171, v171
    v_mfma_f32_32x32x16_bf16 a[48:63], a[180:183], v[188:191], a[48:63]
    v_add_f32 v26, v26, v170
    v_add_f32 v27, v27, v171
    v_cvt_pk_bf16_f32 v205, v170, v171
    s_waitcnt lgkmcnt(8)
    v_mfma_f32_32x32x16_bf16 a[64:79], a[184:187], v[180:183], a[64:79]
    v_exp_f32 v172, v172
    v_exp_f32 v173, v173
    v_mfma_f32_32x32x16_bf16 a[80:95], a[184:187], v[188:191], a[80:95]
    v_add_f32 v26, v26, v172
    v_add_f32 v27, v27, v173
    v_cvt_pk_bf16_f32 v206, v172, v173
    v_mfma_f32_32x32x16_bf16 a[96:111], a[188:191], v[180:183], a[96:111]
    v_exp_f32 v174, v174
    v_exp_f32 v175, v175
    v_mfma_f32_32x32x16_bf16 a[112:127], a[188:191], v[188:191], a[112:127]
    v_add_f32 v26, v26, v174
    v_add_f32 v27, v27, v175
    v_cvt_pk_bf16_f32 v207, v174, v175
    s_waitcnt lgkmcnt(0)
    s_waitcnt vmcnt(9)
    s_barrier
    v_mfma_f32_32x32x16_bf16 v[144:159], a[192:195], v[48:51], v[208:223]
    ds_read_b64_tr_b16 a[160:161], v20 offset:8192
    v_exp_f32 v112, v112
    v_exp_f32 v113, v113
    v_mfma_f32_32x32x16_bf16 v[160:175], a[192:195], v[52:55], v[224:239]
    ds_read_b64_tr_b16 a[162:163], v20 offset:10240
    s_add_u32 m0, s38, 49152
    v_add_f32 v24, v24, v112
    v_add_f32 v25, v25, v113
    v_cvt_pk_bf16_f32 v176, v112, v113
    v_mfma_f32_32x32x16_bf16 v[144:159], a[196:199], v[56:59], v[144:159]
    ds_read_b64_tr_b16 a[164:165], v21 offset:8192
    s_add_u32 s37, s38, 49152
    v_exp_f32 v114, v114
    v_exp_f32 v115, v115
    v_mfma_f32_32x32x16_bf16 v[160:175], a[196:199], v[60:63], v[160:175]
    ds_read_b64_tr_b16 a[166:167], v21 offset:10240
    buffer_load_dwordx4 v7, s[16:19], s37 offen offset:0 nt lds
    v_add_f32 v24, v24, v114
    v_add_f32 v25, v25, v115
    v_cvt_pk_bf16_f32 v177, v114, v115
    v_mfma_f32_32x32x16_bf16 v[144:159], a[200:203], v[64:67], v[144:159]
    ds_read_b64_tr_b16 a[168:169], v22 offset:8192
    buffer_load_dwordx4 v8, s[16:19], s37 offen offset:1024 nt lds
    v_exp_f32 v116, v116
    v_exp_f32 v117, v117
    v_mfma_f32_32x32x16_bf16 v[160:175], a[200:203], v[68:71], v[160:175]
    ds_read_b64_tr_b16 a[170:171], v22 offset:10240
    buffer_load_dwordx4 v9, s[16:19], s37 offen offset:2048 nt lds
    v_add_f32 v24, v24, v116
    v_add_f32 v25, v25, v117
    v_cvt_pk_bf16_f32 v178, v116, v117
    v_mfma_f32_32x32x16_bf16 v[144:159], a[204:207], v[72:75], v[144:159]
    ds_read_b64_tr_b16 a[172:173], v23 offset:8192
    buffer_load_dwordx4 v10, s[16:19], s37 offen offset:3072 nt lds
    v_exp_f32 v118, v118
    v_exp_f32 v119, v119
    v_mfma_f32_32x32x16_bf16 v[160:175], a[204:207], v[76:79], v[160:175]
    ds_read_b64_tr_b16 a[174:175], v23 offset:10240
    s_add_u32 m0, s38, 114688
    v_add_f32 v24, v24, v118
    v_add_f32 v25, v25, v119
    v_cvt_pk_bf16_f32 v179, v118, v119
    v_mfma_f32_32x32x16_bf16 v[144:159], a[208:211], v[80:83], v[144:159]
    ds_read_b64_tr_b16 a[176:177], v20 offset:12288
    s_add_u32 s37, s38, 49152
    v_exp_f32 v120, v120
    v_exp_f32 v121, v121
    v_mfma_f32_32x32x16_bf16 v[160:175], a[208:211], v[84:87], v[160:175]
    ds_read_b64_tr_b16 a[178:179], v20 offset:14336
    buffer_load_dwordx4 v11, s[20:23], s37 offen offset:0 nt lds
    v_add_f32 v24, v24, v120
    v_add_f32 v25, v25, v121
    v_cvt_pk_bf16_f32 v180, v120, v121
    v_mfma_f32_32x32x16_bf16 v[144:159], a[212:215], v[88:91], v[144:159]
    ds_read_b64_tr_b16 a[180:181], v21 offset:12288
    buffer_load_dwordx4 v11, s[20:23], s37 offen offset:1024 nt lds
    v_exp_f32 v122, v122
    v_exp_f32 v123, v123
    v_mfma_f32_32x32x16_bf16 v[160:175], a[212:215], v[92:95], v[160:175]
    ds_read_b64_tr_b16 a[182:183], v21 offset:14336
    buffer_load_dwordx4 v11, s[20:23], s37 offen offset:2048 nt lds
    v_add_f32 v24, v24, v122
    v_add_f32 v25, v25, v123
    v_cvt_pk_bf16_f32 v181, v122, v123
    v_mfma_f32_32x32x16_bf16 v[144:159], a[216:219], v[96:99], v[144:159]
    ds_read_b64_tr_b16 a[184:185], v22 offset:12288
    buffer_load_dwordx4 v11, s[20:23], s37 offen offset:3072 nt lds
    v_exp_f32 v124, v124
    v_exp_f32 v125, v125
    v_mfma_f32_32x32x16_bf16 v[160:175], a[216:219], v[100:103], v[160:175]
    ds_read_b64_tr_b16 a[186:187], v22 offset:14336
    s_add_u32 m0, s38, 0
    v_add_f32 v24, v24, v124
    v_add_f32 v25, v25, v125
    v_cvt_pk_bf16_f32 v182, v124, v125
    v_mfma_f32_32x32x16_bf16 v[144:159], a[220:223], v[104:107], v[144:159]
    ds_read_b64_tr_b16 a[188:189], v23 offset:12288
    s_add_u32 s37, s38, 65536
    v_exp_f32 v126, v126
    v_exp_f32 v127, v127
    v_mfma_f32_32x32x16_bf16 v[160:175], a[220:223], v[108:111], v[160:175]
    ds_read_b64_tr_b16 a[190:191], v23 offset:14336
    buffer_load_dwordx4 v7, s[16:19], s37 offen offset:0 nt lds
    v_add_f32 v24, v24, v126
    v_add_f32 v25, v25, v127
    v_cvt_pk_bf16_f32 v183, v126, v127
    s_waitcnt lgkmcnt(12)
    v_mfma_f32_32x32x16_bf16 a[0:15], a[160:163], v[192:195], a[0:15]
    ds_read_b128 a[128:131], v12 offset:32768
    buffer_load_dwordx4 v8, s[16:19], s37 offen offset:1024 nt lds
    v_exp_f32 v128, v128
    v_exp_f32 v129, v129
    v_mfma_f32_32x32x16_bf16 a[16:31], a[160:163], v[200:203], a[16:31]
    ds_read_b128 a[132:135], v13 offset:32768
    buffer_load_dwordx4 v9, s[16:19], s37 offen offset:2048 nt lds
    v_add_f32 v26, v26, v128
    v_add_f32 v27, v27, v129
    v_cvt_pk_bf16_f32 v184, v128, v129
    v_mfma_f32_32x32x16_bf16 a[32:47], a[164:167], v[192:195], a[32:47]
    ds_read_b128 a[136:139], v14 offset:32768
    buffer_load_dwordx4 v10, s[16:19], s37 offen offset:3072 nt lds
    v_exp_f32 v130, v130
    v_exp_f32 v131, v131
    v_mfma_f32_32x32x16_bf16 a[48:63], a[164:167], v[200:203], a[48:63]
    ds_read_b128 a[140:143], v15 offset:32768
    s_add_u32 m0, s38, 16384
    v_add_f32 v26, v26, v130
    v_add_f32 v27, v27, v131
    v_cvt_pk_bf16_f32 v185, v130, v131
    s_waitcnt lgkmcnt(12)
    v_mfma_f32_32x32x16_bf16 a[64:79], a[168:171], v[192:195], a[64:79]
    ds_read_b128 a[144:147], v16 offset:32768
    s_add_u32 s37, s38, 81920
    v_exp_f32 v132, v132
    v_exp_f32 v133, v133
    v_mfma_f32_32x32x16_bf16 a[80:95], a[168:171], v[200:203], a[80:95]
    ds_read_b128 a[148:151], v17 offset:32768
    buffer_load_dwordx4 v7, s[16:19], s37 offen offset:0 nt lds
    v_add_f32 v26, v26, v132
    v_add_f32 v27, v27, v133
    v_cvt_pk_bf16_f32 v186, v132, v133
    v_mfma_f32_32x32x16_bf16 a[96:111], a[172:175], v[192:195], a[96:111]
    ds_read_b128 a[152:155], v18 offset:32768
    buffer_load_dwordx4 v8, s[16:19], s37 offen offset:1024 nt lds
    v_exp_f32 v134, v134
    v_exp_f32 v135, v135
    v_mfma_f32_32x32x16_bf16 a[112:127], a[172:175], v[200:203], a[112:127]
    ds_read_b128 a[156:159], v19 offset:32768
    buffer_load_dwordx4 v9, s[16:19], s37 offen offset:2048 nt lds
    v_add_f32 v26, v26, v134
    v_add_f32 v27, v27, v135
    v_cvt_pk_bf16_f32 v187, v134, v135
    s_waitcnt lgkmcnt(12)
    v_mfma_f32_32x32x16_bf16 a[0:15], a[176:179], v[196:199], a[0:15]
    buffer_load_dwordx4 v10, s[16:19], s37 offen offset:3072 nt lds
    v_exp_f32 v136, v136
    v_exp_f32 v137, v137
    v_mfma_f32_32x32x16_bf16 a[16:31], a[176:179], v[204:207], a[16:31]
    v_add_f32 v26, v26, v136
    v_add_f32 v27, v27, v137
    v_cvt_pk_bf16_f32 v188, v136, v137
    v_mfma_f32_32x32x16_bf16 a[32:47], a[180:183], v[196:199], a[32:47]
    v_exp_f32 v138, v138
    v_exp_f32 v139, v139
    v_mfma_f32_32x32x16_bf16 a[48:63], a[180:183], v[204:207], a[48:63]
    v_add_f32 v26, v26, v138
    v_add_f32 v27, v27, v139
    v_cvt_pk_bf16_f32 v189, v138, v139
    s_waitcnt lgkmcnt(8)
    v_mfma_f32_32x32x16_bf16 a[64:79], a[184:187], v[196:199], a[64:79]
    v_exp_f32 v140, v140
    v_exp_f32 v141, v141
    v_mfma_f32_32x32x16_bf16 a[80:95], a[184:187], v[204:207], a[80:95]
    v_add_f32 v26, v26, v140
    v_add_f32 v27, v27, v141
    v_cvt_pk_bf16_f32 v190, v140, v141
    v_mfma_f32_32x32x16_bf16 a[96:111], a[188:191], v[196:199], a[96:111]
    v_exp_f32 v142, v142
    v_exp_f32 v143, v143
    v_mfma_f32_32x32x16_bf16 a[112:127], a[188:191], v[204:207], a[112:127]
    v_add_f32 v26, v26, v142
    v_add_f32 v27, v27, v143
    v_cvt_pk_bf16_f32 v191, v142, v143
    s_waitcnt lgkmcnt(4)
    v_mfma_f32_32x32x16_bf16 v[112:127], a[128:131], v[48:51], v[208:223]
    ds_read_b64_tr_b16 a[160:161], v20 offset:16384
    v_exp_f32 v144, v144
    v_exp_f32 v145, v145
    v_mfma_f32_32x32x16_bf16 v[128:143], a[128:131], v[52:55], v[224:239]
    ds_read_b64_tr_b16 a[162:163], v20 offset:18432
    v_add_f32 v24, v24, v144
    v_add_f32 v25, v25, v145
    v_cvt_pk_bf16_f32 v192, v144, v145
    v_mfma_f32_32x32x16_bf16 v[112:127], a[132:135], v[56:59], v[112:127]
    ds_read_b64_tr_b16 a[164:165], v21 offset:16384
    v_exp_f32 v146, v146
    v_exp_f32 v147, v147
    v_mfma_f32_32x32x16_bf16 v[128:143], a[132:135], v[60:63], v[128:143]
    ds_read_b64_tr_b16 a[166:167], v21 offset:18432
    v_add_f32 v24, v24, v146
    v_add_f32 v25, v25, v147
    v_cvt_pk_bf16_f32 v193, v146, v147
    v_mfma_f32_32x32x16_bf16 v[112:127], a[136:139], v[64:67], v[112:127]
    ds_read_b64_tr_b16 a[168:169], v22 offset:16384
    v_exp_f32 v148, v148
    v_exp_f32 v149, v149
    v_mfma_f32_32x32x16_bf16 v[128:143], a[136:139], v[68:71], v[128:143]
    ds_read_b64_tr_b16 a[170:171], v22 offset:18432
    v_add_f32 v24, v24, v148
    v_add_f32 v25, v25, v149
    v_cvt_pk_bf16_f32 v194, v148, v149
    v_mfma_f32_32x32x16_bf16 v[112:127], a[140:143], v[72:75], v[112:127]
    ds_read_b64_tr_b16 a[172:173], v23 offset:16384
    v_exp_f32 v150, v150
    v_exp_f32 v151, v151
    v_mfma_f32_32x32x16_bf16 v[128:143], a[140:143], v[76:79], v[128:143]
    ds_read_b64_tr_b16 a[174:175], v23 offset:18432
    v_add_f32 v24, v24, v150
    v_add_f32 v25, v25, v151
    v_cvt_pk_bf16_f32 v195, v150, v151
    s_waitcnt lgkmcnt(8)
    v_mfma_f32_32x32x16_bf16 v[112:127], a[144:147], v[80:83], v[112:127]
    ds_read_b64_tr_b16 a[176:177], v20 offset:20480
    v_exp_f32 v152, v152
    v_exp_f32 v153, v153
    v_mfma_f32_32x32x16_bf16 v[128:143], a[144:147], v[84:87], v[128:143]
    ds_read_b64_tr_b16 a[178:179], v20 offset:22528
    v_add_f32 v24, v24, v152
    v_add_f32 v25, v25, v153
    v_cvt_pk_bf16_f32 v196, v152, v153
    v_mfma_f32_32x32x16_bf16 v[112:127], a[148:151], v[88:91], v[112:127]
    ds_read_b64_tr_b16 a[180:181], v21 offset:20480
    v_exp_f32 v154, v154
    v_exp_f32 v155, v155
    v_mfma_f32_32x32x16_bf16 v[128:143], a[148:151], v[92:95], v[128:143]
    ds_read_b64_tr_b16 a[182:183], v21 offset:22528
    v_add_f32 v24, v24, v154
    v_add_f32 v25, v25, v155
    v_cvt_pk_bf16_f32 v197, v154, v155
    v_mfma_f32_32x32x16_bf16 v[112:127], a[152:155], v[96:99], v[112:127]
    ds_read_b64_tr_b16 a[184:185], v22 offset:20480
    v_exp_f32 v156, v156
    v_exp_f32 v157, v157
    v_mfma_f32_32x32x16_bf16 v[128:143], a[152:155], v[100:103], v[128:143]
    ds_read_b64_tr_b16 a[186:187], v22 offset:22528
    v_add_f32 v24, v24, v156
    v_add_f32 v25, v25, v157
    v_cvt_pk_bf16_f32 v198, v156, v157
    v_mfma_f32_32x32x16_bf16 v[112:127], a[156:159], v[104:107], v[112:127]
    ds_read_b64_tr_b16 a[188:189], v23 offset:20480
    v_exp_f32 v158, v158
    v_exp_f32 v159, v159
    v_mfma_f32_32x32x16_bf16 v[128:143], a[156:159], v[108:111], v[128:143]
    ds_read_b64_tr_b16 a[190:191], v23 offset:22528
    v_add_f32 v24, v24, v158
    v_add_f32 v25, v25, v159
    v_cvt_pk_bf16_f32 v199, v158, v159
    s_waitcnt lgkmcnt(12)
    v_mfma_f32_32x32x16_bf16 a[0:15], a[160:163], v[176:179], a[0:15]
    ds_read_b128 a[192:195], v12 offset:40960
    v_exp_f32 v160, v160
    v_exp_f32 v161, v161
    v_mfma_f32_32x32x16_bf16 a[16:31], a[160:163], v[184:187], a[16:31]
    ds_read_b128 a[196:199], v13 offset:40960
    v_add_f32 v26, v26, v160
    v_add_f32 v27, v27, v161
    v_cvt_pk_bf16_f32 v200, v160, v161
    v_mfma_f32_32x32x16_bf16 a[32:47], a[164:167], v[176:179], a[32:47]
    ds_read_b128 a[200:203], v14 offset:40960
    v_exp_f32 v162, v162
    v_exp_f32 v163, v163
    v_mfma_f32_32x32x16_bf16 a[48:63], a[164:167], v[184:187], a[48:63]
    ds_read_b128 a[204:207], v15 offset:40960
    v_add_f32 v26, v26, v162
    v_add_f32 v27, v27, v163
    v_cvt_pk_bf16_f32 v201, v162, v163
    s_waitcnt lgkmcnt(12)
    v_mfma_f32_32x32x16_bf16 a[64:79], a[168:171], v[176:179], a[64:79]
    ds_read_b128 a[208:211], v16 offset:40960
    v_exp_f32 v164, v164
    v_exp_f32 v165, v165
    v_mfma_f32_32x32x16_bf16 a[80:95], a[168:171], v[184:187], a[80:95]
    ds_read_b128 a[212:215], v17 offset:40960
    v_add_f32 v26, v26, v164
    v_add_f32 v27, v27, v165
    v_cvt_pk_bf16_f32 v202, v164, v165
    v_mfma_f32_32x32x16_bf16 a[96:111], a[172:175], v[176:179], a[96:111]
    ds_read_b128 a[216:219], v18 offset:40960
    v_exp_f32 v166, v166
    v_exp_f32 v167, v167
    v_mfma_f32_32x32x16_bf16 a[112:127], a[172:175], v[184:187], a[112:127]
    ds_read_b128 a[220:223], v19 offset:40960
    v_add_f32 v26, v26, v166
    v_add_f32 v27, v27, v167
    v_cvt_pk_bf16_f32 v203, v166, v167
    s_waitcnt lgkmcnt(12)
    v_mfma_f32_32x32x16_bf16 a[0:15], a[176:179], v[180:183], a[0:15]
    v_exp_f32 v168, v168
    v_exp_f32 v169, v169
    v_mfma_f32_32x32x16_bf16 a[16:31], a[176:179], v[188:191], a[16:31]
    v_add_f32 v26, v26, v168
    v_add_f32 v27, v27, v169
    v_cvt_pk_bf16_f32 v204, v168, v169
    v_mfma_f32_32x32x16_bf16 a[32:47], a[180:183], v[180:183], a[32:47]
    v_exp_f32 v170, v170
    v_exp_f32 v171, v171
    v_mfma_f32_32x32x16_bf16 a[48:63], a[180:183], v[188:191], a[48:63]
    v_add_f32 v26, v26, v170
    v_add_f32 v27, v27, v171
    v_cvt_pk_bf16_f32 v205, v170, v171
    s_waitcnt lgkmcnt(8)
    v_mfma_f32_32x32x16_bf16 a[64:79], a[184:187], v[180:183], a[64:79]
    v_exp_f32 v172, v172
    v_exp_f32 v173, v173
    v_mfma_f32_32x32x16_bf16 a[80:95], a[184:187], v[188:191], a[80:95]
    v_add_f32 v26, v26, v172
    v_add_f32 v27, v27, v173
    v_cvt_pk_bf16_f32 v206, v172, v173
    v_mfma_f32_32x32x16_bf16 a[96:111], a[188:191], v[180:183], a[96:111]
    v_exp_f32 v174, v174
    v_exp_f32 v175, v175
    v_mfma_f32_32x32x16_bf16 a[112:127], a[188:191], v[188:191], a[112:127]
    v_add_f32 v26, v26, v174
    v_add_f32 v27, v27, v175
    v_cvt_pk_bf16_f32 v207, v174, v175
    s_waitcnt lgkmcnt(0)
    s_waitcnt vmcnt(12)
    s_barrier
    v_mfma_f32_32x32x16_bf16 v[144:159], a[192:195], v[48:51], v[208:223]
    ds_read_b64_tr_b16 a[160:161], v20 offset:24576
    v_exp_f32 v112, v112
    v_exp_f32 v113, v113
    v_mfma_f32_32x32x16_bf16 v[160:175], a[192:195], v[52:55], v[224:239]
    ds_read_b64_tr_b16 a[162:163], v20 offset:26624
    s_add_u32 m0, s38, 65536
    v_add_f32 v24, v24, v112
    v_add_f32 v25, v25, v113
    v_cvt_pk_bf16_f32 v176, v112, v113
    v_mfma_f32_32x32x16_bf16 v[144:159], a[196:199], v[56:59], v[144:159]
    ds_read_b64_tr_b16 a[164:165], v21 offset:24576
    s_add_u32 s37, s38, 65536
    v_exp_f32 v114, v114
    v_exp_f32 v115, v115
    v_mfma_f32_32x32x16_bf16 v[160:175], a[196:199], v[60:63], v[160:175]
    ds_read_b64_tr_b16 a[166:167], v21 offset:26624
    buffer_load_dwordx4 v11, s[20:23], s37 offen offset:0 nt lds
    v_add_f32 v24, v24, v114
    v_add_f32 v25, v25, v115
    v_cvt_pk_bf16_f32 v177, v114, v115
    v_mfma_f32_32x32x16_bf16 v[144:159], a[200:203], v[64:67], v[144:159]
    ds_read_b64_tr_b16 a[168:169], v22 offset:24576
    buffer_load_dwordx4 v11, s[20:23], s37 offen offset:1024 nt lds
    v_exp_f32 v116, v116
    v_exp_f32 v117, v117
    v_mfma_f32_32x32x16_bf16 v[160:175], a[200:203], v[68:71], v[160:175]
    ds_read_b64_tr_b16 a[170:171], v22 offset:26624
    buffer_load_dwordx4 v11, s[20:23], s37 offen offset:2048 nt lds
    v_add_f32 v24, v24, v116
    v_add_f32 v25, v25, v117
    v_cvt_pk_bf16_f32 v178, v116, v117
    v_mfma_f32_32x32x16_bf16 v[144:159], a[204:207], v[72:75], v[144:159]
    ds_read_b64_tr_b16 a[172:173], v23 offset:24576
    buffer_load_dwordx4 v11, s[20:23], s37 offen offset:3072 nt lds
    v_exp_f32 v118, v118
    v_exp_f32 v119, v119
    v_mfma_f32_32x32x16_bf16 v[160:175], a[204:207], v[76:79], v[160:175]
    ds_read_b64_tr_b16 a[174:175], v23 offset:26624
    s_add_u32 m0, s38, 32768
    v_add_f32 v24, v24, v118
    v_add_f32 v25, v25, v119
    v_cvt_pk_bf16_f32 v179, v118, v119
    v_mfma_f32_32x32x16_bf16 v[144:159], a[208:211], v[80:83], v[144:159]
    ds_read_b64_tr_b16 a[176:177], v20 offset:28672
    s_add_u32 s37, s38, 98304
    v_exp_f32 v120, v120
    v_exp_f32 v121, v121
    v_mfma_f32_32x32x16_bf16 v[160:175], a[208:211], v[84:87], v[160:175]
    ds_read_b64_tr_b16 a[178:179], v20 offset:30720
    buffer_load_dwordx4 v7, s[16:19], s37 offen offset:0 nt lds
    v_add_f32 v24, v24, v120
    v_add_f32 v25, v25, v121
    v_cvt_pk_bf16_f32 v180, v120, v121
    v_mfma_f32_32x32x16_bf16 v[144:159], a[212:215], v[88:91], v[144:159]
    ds_read_b64_tr_b16 a[180:181], v21 offset:28672
    buffer_load_dwordx4 v8, s[16:19], s37 offen offset:1024 nt lds
    v_exp_f32 v122, v122
    v_exp_f32 v123, v123
    v_mfma_f32_32x32x16_bf16 v[160:175], a[212:215], v[92:95], v[160:175]
    ds_read_b64_tr_b16 a[182:183], v21 offset:30720
    buffer_load_dwordx4 v9, s[16:19], s37 offen offset:2048 nt lds
    v_add_f32 v24, v24, v122
    v_add_f32 v25, v25, v123
    v_cvt_pk_bf16_f32 v181, v122, v123
    v_mfma_f32_32x32x16_bf16 v[144:159], a[216:219], v[96:99], v[144:159]
    ds_read_b64_tr_b16 a[184:185], v22 offset:28672
    buffer_load_dwordx4 v10, s[16:19], s37 offen offset:3072 nt lds
    v_exp_f32 v124, v124
    v_exp_f32 v125, v125
    v_mfma_f32_32x32x16_bf16 v[160:175], a[216:219], v[100:103], v[160:175]
    ds_read_b64_tr_b16 a[186:187], v22 offset:30720
    v_add_f32 v24, v24, v124
    v_add_f32 v25, v25, v125
    v_cvt_pk_bf16_f32 v182, v124, v125
    v_mfma_f32_32x32x16_bf16 v[144:159], a[220:223], v[104:107], v[144:159]
    ds_read_b64_tr_b16 a[188:189], v23 offset:28672
    v_exp_f32 v126, v126
    v_exp_f32 v127, v127
    v_mfma_f32_32x32x16_bf16 v[160:175], a[220:223], v[108:111], v[160:175]
    ds_read_b64_tr_b16 a[190:191], v23 offset:30720
    v_add_f32 v24, v24, v126
    v_add_f32 v25, v25, v127
    v_cvt_pk_bf16_f32 v183, v126, v127
    s_waitcnt lgkmcnt(12)
    v_mfma_f32_32x32x16_bf16 a[0:15], a[160:163], v[192:195], a[0:15]
    ds_read_b128 a[128:131], v12 offset:49152
    v_exp_f32 v128, v128
    v_exp_f32 v129, v129
    v_mfma_f32_32x32x16_bf16 a[16:31], a[160:163], v[200:203], a[16:31]
    ds_read_b128 a[132:135], v13 offset:49152
    v_add_f32 v26, v26, v128
    v_add_f32 v27, v27, v129
    v_cvt_pk_bf16_f32 v184, v128, v129
    v_mfma_f32_32x32x16_bf16 a[32:47], a[164:167], v[192:195], a[32:47]
    ds_read_b128 a[136:139], v14 offset:49152
    v_exp_f32 v130, v130
    v_exp_f32 v131, v131
    v_mfma_f32_32x32x16_bf16 a[48:63], a[164:167], v[200:203], a[48:63]
    ds_read_b128 a[140:143], v15 offset:49152
    v_add_f32 v26, v26, v130
    v_add_f32 v27, v27, v131
    v_cvt_pk_bf16_f32 v185, v130, v131
    s_waitcnt lgkmcnt(12)
    v_mfma_f32_32x32x16_bf16 a[64:79], a[168:171], v[192:195], a[64:79]
    ds_read_b128 a[144:147], v16 offset:49152
    v_exp_f32 v132, v132
    v_exp_f32 v133, v133
    v_mfma_f32_32x32x16_bf16 a[80:95], a[168:171], v[200:203], a[80:95]
    ds_read_b128 a[148:151], v17 offset:49152
    v_add_f32 v26, v26, v132
    v_add_f32 v27, v27, v133
    v_cvt_pk_bf16_f32 v186, v132, v133
    v_mfma_f32_32x32x16_bf16 a[96:111], a[172:175], v[192:195], a[96:111]
    ds_read_b128 a[152:155], v18 offset:49152
    v_exp_f32 v134, v134
    v_exp_f32 v135, v135
    v_mfma_f32_32x32x16_bf16 a[112:127], a[172:175], v[200:203], a[112:127]
    ds_read_b128 a[156:159], v19 offset:49152
    v_add_f32 v26, v26, v134
    v_add_f32 v27, v27, v135
    v_cvt_pk_bf16_f32 v187, v134, v135
    s_waitcnt lgkmcnt(12)
    v_mfma_f32_32x32x16_bf16 a[0:15], a[176:179], v[196:199], a[0:15]
    v_exp_f32 v136, v136
    v_exp_f32 v137, v137
    v_mfma_f32_32x32x16_bf16 a[16:31], a[176:179], v[204:207], a[16:31]
    v_add_f32 v26, v26, v136
    v_add_f32 v27, v27, v137
    v_cvt_pk_bf16_f32 v188, v136, v137
    v_mfma_f32_32x32x16_bf16 a[32:47], a[180:183], v[196:199], a[32:47]
    v_exp_f32 v138, v138
    v_exp_f32 v139, v139
    v_mfma_f32_32x32x16_bf16 a[48:63], a[180:183], v[204:207], a[48:63]
    v_add_f32 v26, v26, v138
    v_add_f32 v27, v27, v139
    v_cvt_pk_bf16_f32 v189, v138, v139
    s_waitcnt lgkmcnt(8)
    v_mfma_f32_32x32x16_bf16 a[64:79], a[184:187], v[196:199], a[64:79]
    v_exp_f32 v140, v140
    v_exp_f32 v141, v141
    v_mfma_f32_32x32x16_bf16 a[80:95], a[184:187], v[204:207], a[80:95]
    v_add_f32 v26, v26, v140
    v_add_f32 v27, v27, v141
    v_cvt_pk_bf16_f32 v190, v140, v141
    v_mfma_f32_32x32x16_bf16 a[96:111], a[188:191], v[196:199], a[96:111]
    v_exp_f32 v142, v142
    v_exp_f32 v143, v143
    v_mfma_f32_32x32x16_bf16 a[112:127], a[188:191], v[204:207], a[112:127]
    v_add_f32 v26, v26, v142
    v_add_f32 v27, v27, v143
    v_cvt_pk_bf16_f32 v191, v142, v143
    s_waitcnt lgkmcnt(4)
    v_mfma_f32_32x32x16_bf16 v[112:127], a[128:131], v[48:51], v[208:223]
    ds_read_b64_tr_b16 a[160:161], v20 offset:32768
    v_exp_f32 v144, v144
    v_exp_f32 v145, v145
    v_mfma_f32_32x32x16_bf16 v[128:143], a[128:131], v[52:55], v[224:239]
    ds_read_b64_tr_b16 a[162:163], v20 offset:34816
    v_add_f32 v24, v24, v144
    v_add_f32 v25, v25, v145
    v_cvt_pk_bf16_f32 v192, v144, v145
    v_mfma_f32_32x32x16_bf16 v[112:127], a[132:135], v[56:59], v[112:127]
    ds_read_b64_tr_b16 a[164:165], v21 offset:32768
    ds_read_b64_tr_b16 a[224:225], v4 offset:0
    v_exp_f32 v146, v146
    v_exp_f32 v147, v147
    v_mfma_f32_32x32x16_bf16 v[128:143], a[132:135], v[60:63], v[128:143]
    ds_read_b64_tr_b16 a[166:167], v21 offset:34816
    ds_read_b64_tr_b16 a[226:227], v4 offset:640
    v_add_f32 v24, v24, v146
    v_add_f32 v25, v25, v147
    v_cvt_pk_bf16_f32 v193, v146, v147
    v_mfma_f32_32x32x16_bf16 v[112:127], a[136:139], v[64:67], v[112:127]
    ds_read_b64_tr_b16 a[168:169], v22 offset:32768
    ds_read_b64_tr_b16 a[228:229], v4 offset:32
    v_exp_f32 v148, v148
    v_exp_f32 v149, v149
    v_mfma_f32_32x32x16_bf16 v[128:143], a[136:139], v[68:71], v[128:143]
    ds_read_b64_tr_b16 a[170:171], v22 offset:34816
    ds_read_b64_tr_b16 a[230:231], v4 offset:672
    v_add_f32 v24, v24, v148
    v_add_f32 v25, v25, v149
    v_cvt_pk_bf16_f32 v194, v148, v149
    v_mfma_f32_32x32x16_bf16 v[112:127], a[140:143], v[72:75], v[112:127]
    ds_read_b64_tr_b16 a[172:173], v23 offset:32768
    ds_read_b64_tr_b16 a[232:233], v4 offset:64
    v_exp_f32 v150, v150
    v_exp_f32 v151, v151
    v_mfma_f32_32x32x16_bf16 v[128:143], a[140:143], v[76:79], v[128:143]
    ds_read_b64_tr_b16 a[174:175], v23 offset:34816
    ds_read_b64_tr_b16 a[234:235], v4 offset:704
    v_add_f32 v24, v24, v150
    v_add_f32 v25, v25, v151
    v_cvt_pk_bf16_f32 v195, v150, v151
    s_waitcnt lgkmcnt(14)
    v_mfma_f32_32x32x16_bf16 v[112:127], a[144:147], v[80:83], v[112:127]
    ds_read_b64_tr_b16 a[176:177], v20 offset:36864
    ds_read_b64_tr_b16 a[236:237], v4 offset:96
    v_exp_f32 v152, v152
    v_exp_f32 v153, v153
    v_mfma_f32_32x32x16_bf16 v[128:143], a[144:147], v[84:87], v[128:143]
    ds_read_b64_tr_b16 a[178:179], v20 offset:38912
    ds_read_b64_tr_b16 a[238:239], v4 offset:736
    v_add_f32 v24, v24, v152
    v_add_f32 v25, v25, v153
    v_cvt_pk_bf16_f32 v196, v152, v153
    v_mfma_f32_32x32x16_bf16 v[112:127], a[148:151], v[88:91], v[112:127]
    ds_read_b64_tr_b16 a[180:181], v21 offset:36864
    ds_read_b64_tr_b16 a[240:241], v4 offset:128
    v_exp_f32 v154, v154
    v_exp_f32 v155, v155
    v_mfma_f32_32x32x16_bf16 v[128:143], a[148:151], v[92:95], v[128:143]
    ds_read_b64_tr_b16 a[182:183], v21 offset:38912
    ds_read_b64_tr_b16 a[242:243], v4 offset:768
    v_add_f32 v24, v24, v154
    v_add_f32 v25, v25, v155
    v_cvt_pk_bf16_f32 v197, v154, v155
    v_mfma_f32_32x32x16_bf16 v[112:127], a[152:155], v[96:99], v[112:127]
    ds_read_b64_tr_b16 a[184:185], v22 offset:36864
    v_exp_f32 v156, v156
    v_exp_f32 v157, v157
    v_mfma_f32_32x32x16_bf16 v[128:143], a[152:155], v[100:103], v[128:143]
    ds_read_b64_tr_b16 a[186:187], v22 offset:38912
    v_add_f32 v24, v24, v156
    v_add_f32 v25, v25, v157
    v_cvt_pk_bf16_f32 v198, v156, v157
    v_mfma_f32_32x32x16_bf16 v[112:127], a[156:159], v[104:107], v[112:127]
    ds_read_b64_tr_b16 a[188:189], v23 offset:36864
    v_exp_f32 v158, v158
    v_exp_f32 v159, v159
    v_mfma_f32_32x32x16_bf16 v[128:143], a[156:159], v[108:111], v[128:143]
    ds_read_b64_tr_b16 a[190:191], v23 offset:38912
    v_add_f32 v24, v24, v158
    v_add_f32 v25, v25, v159
    v_cvt_pk_bf16_f32 v199, v158, v159
    s_waitcnt lgkmcnt(15)
    v_mfma_f32_32x32x16_bf16 a[0:15], a[160:163], v[176:179], a[0:15]
    ds_read_b128 a[192:195], v12 offset:57344
    v_exp_f32 v160, v160
    v_exp_f32 v161, v161
    v_mfma_f32_32x32x16_bf16 a[16:31], a[160:163], v[184:187], a[16:31]
    ds_read_b128 a[196:199], v13 offset:57344
    v_add_f32 v26, v26, v160
    v_add_f32 v27, v27, v161
    v_cvt_pk_bf16_f32 v200, v160, v161
    v_mfma_f32_32x32x16_bf16 a[32:47], a[164:167], v[176:179], a[32:47]
    ds_read_b128 a[200:203], v14 offset:57344
    v_exp_f32 v162, v162
    v_exp_f32 v163, v163
    v_mfma_f32_32x32x16_bf16 a[48:63], a[164:167], v[184:187], a[48:63]
    ds_read_b128 a[204:207], v15 offset:57344
    v_add_f32 v26, v26, v162
    v_add_f32 v27, v27, v163
    v_cvt_pk_bf16_f32 v201, v162, v163
    s_waitcnt lgkmcnt(15)
    v_mfma_f32_32x32x16_bf16 a[64:79], a[168:171], v[176:179], a[64:79]
    ds_read_b128 a[208:211], v16 offset:57344
    v_exp_f32 v164, v164
    v_exp_f32 v165, v165
    v_mfma_f32_32x32x16_bf16 a[80:95], a[168:171], v[184:187], a[80:95]
    ds_read_b128 a[212:215], v17 offset:57344
    v_add_f32 v26, v26, v164
    v_add_f32 v27, v27, v165
    v_cvt_pk_bf16_f32 v202, v164, v165
    v_mfma_f32_32x32x16_bf16 a[96:111], a[172:175], v[176:179], a[96:111]
    ds_read_b128 a[216:219], v18 offset:57344
    v_exp_f32 v166, v166
    v_exp_f32 v167, v167
    v_mfma_f32_32x32x16_bf16 a[112:127], a[172:175], v[184:187], a[112:127]
    ds_read_b128 a[220:223], v19 offset:57344
    v_add_f32 v26, v26, v166
    v_add_f32 v27, v27, v167
    v_cvt_pk_bf16_f32 v203, v166, v167
    s_waitcnt lgkmcnt(13)
    v_mfma_f32_32x32x16_bf16 a[0:15], a[176:179], v[180:183], a[0:15]
    v_exp_f32 v168, v168
    v_exp_f32 v169, v169
    v_mfma_f32_32x32x16_bf16 a[16:31], a[176:179], v[188:191], a[16:31]
    v_add_f32 v26, v26, v168
    v_add_f32 v27, v27, v169
    v_cvt_pk_bf16_f32 v204, v168, v169
    v_mfma_f32_32x32x16_bf16 a[32:47], a[180:183], v[180:183], a[32:47]
    v_exp_f32 v170, v170
    v_exp_f32 v171, v171
    v_mfma_f32_32x32x16_bf16 a[48:63], a[180:183], v[188:191], a[48:63]
    v_add_f32 v26, v26, v170
    v_add_f32 v27, v27, v171
    v_cvt_pk_bf16_f32 v205, v170, v171
    s_waitcnt lgkmcnt(8)
    v_mfma_f32_32x32x16_bf16 a[64:79], a[184:187], v[180:183], a[64:79]
    v_exp_f32 v172, v172
    v_exp_f32 v173, v173
    v_mfma_f32_32x32x16_bf16 a[80:95], a[184:187], v[188:191], a[80:95]
    v_add_f32 v26, v26, v172
    v_add_f32 v27, v27, v173
    v_cvt_pk_bf16_f32 v206, v172, v173
    v_mfma_f32_32x32x16_bf16 a[96:111], a[188:191], v[180:183], a[96:111]
    v_exp_f32 v174, v174
    v_exp_f32 v175, v175
    v_mfma_f32_32x32x16_bf16 a[112:127], a[188:191], v[188:191], a[112:127]
    v_add_f32 v26, v26, v174
    v_add_f32 v27, v27, v175
    v_cvt_pk_bf16_f32 v207, v174, v175
    s_waitcnt lgkmcnt(0)
    s_waitcnt vmcnt(12)
    s_barrier
    v_mfma_f32_32x32x16_bf16 v[144:159], a[192:195], v[48:51], v[208:223]
    ds_read_b64_tr_b16 a[160:161], v20 offset:40960
    v_exp_f32 v112, v112
    v_exp_f32 v113, v113
    v_mfma_f32_32x32x16_bf16 v[160:175], a[192:195], v[52:55], v[224:239]
    ds_read_b64_tr_b16 a[162:163], v20 offset:43008
    s_add_u32 m0, s38, 81920
    v_add_f32 v24, v24, v112
    v_add_f32 v25, v25, v113
    v_cvt_pk_bf16_f32 v176, v112, v113
    v_mfma_f32_32x32x16_bf16 v[144:159], a[196:199], v[56:59], v[144:159]
    ds_read_b64_tr_b16 a[164:165], v21 offset:40960
    s_add_u32 s37, s38, 81920
    v_exp_f32 v114, v114
    v_exp_f32 v115, v115
    v_mfma_f32_32x32x16_bf16 v[160:175], a[196:199], v[60:63], v[160:175]
    ds_read_b64_tr_b16 a[166:167], v21 offset:43008
    buffer_load_dwordx4 v11, s[20:23], s37 offen offset:0 nt lds
    v_add_f32 v24, v24, v114
    v_add_f32 v25, v25, v115
    v_cvt_pk_bf16_f32 v177, v114, v115
    v_mfma_f32_32x32x16_bf16 v[144:159], a[200:203], v[64:67], v[144:159]
    ds_read_b64_tr_b16 a[168:169], v22 offset:40960
    buffer_load_dwordx4 v11, s[20:23], s37 offen offset:1024 nt lds
    v_exp_f32 v116, v116
    v_exp_f32 v117, v117
    v_mfma_f32_32x32x16_bf16 v[160:175], a[200:203], v[68:71], v[160:175]
    ds_read_b64_tr_b16 a[170:171], v22 offset:43008
    buffer_load_dwordx4 v11, s[20:23], s37 offen offset:2048 nt lds
    v_add_f32 v24, v24, v116
    v_add_f32 v25, v25, v117
    v_cvt_pk_bf16_f32 v178, v116, v117
    v_mfma_f32_32x32x16_bf16 v[144:159], a[204:207], v[72:75], v[144:159]
    ds_read_b64_tr_b16 a[172:173], v23 offset:40960
    buffer_load_dwordx4 v11, s[20:23], s37 offen offset:3072 nt lds
    v_exp_f32 v118, v118
    v_exp_f32 v119, v119
    v_mfma_f32_32x32x16_bf16 v[160:175], a[204:207], v[76:79], v[160:175]
    ds_read_b64_tr_b16 a[174:175], v23 offset:43008
    s_add_u32 m0, s38, 49152
    v_add_f32 v24, v24, v118
    v_add_f32 v25, v25, v119
    v_cvt_pk_bf16_f32 v179, v118, v119
    v_mfma_f32_32x32x16_bf16 v[144:159], a[208:211], v[80:83], v[144:159]
    ds_read_b64_tr_b16 a[176:177], v20 offset:45056
    s_add_u32 s37, s38, 114688
    v_exp_f32 v120, v120
    v_exp_f32 v121, v121
    v_mfma_f32_32x32x16_bf16 v[160:175], a[208:211], v[84:87], v[160:175]
    ds_read_b64_tr_b16 a[178:179], v20 offset:47104
    buffer_load_dwordx4 v7, s[16:19], s37 offen offset:0 nt lds
    v_add_f32 v24, v24, v120
    v_add_f32 v25, v25, v121
    v_cvt_pk_bf16_f32 v180, v120, v121
    v_mfma_f32_32x32x16_bf16 v[144:159], a[212:215], v[88:91], v[144:159]
    ds_read_b64_tr_b16 a[180:181], v21 offset:45056
    buffer_load_dwordx4 v8, s[16:19], s37 offen offset:1024 nt lds
    v_exp_f32 v122, v122
    v_exp_f32 v123, v123
    v_mfma_f32_32x32x16_bf16 v[160:175], a[212:215], v[92:95], v[160:175]
    ds_read_b64_tr_b16 a[182:183], v21 offset:47104
    buffer_load_dwordx4 v9, s[16:19], s37 offen offset:2048 nt lds
    v_add_f32 v24, v24, v122
    v_add_f32 v25, v25, v123
    v_cvt_pk_bf16_f32 v181, v122, v123
    v_mfma_f32_32x32x16_bf16 v[144:159], a[216:219], v[96:99], v[144:159]
    ds_read_b64_tr_b16 a[184:185], v22 offset:45056
    buffer_load_dwordx4 v10, s[16:19], s37 offen offset:3072 nt lds
    v_exp_f32 v124, v124
    v_exp_f32 v125, v125
    v_mfma_f32_32x32x16_bf16 v[160:175], a[216:219], v[100:103], v[160:175]
    ds_read_b64_tr_b16 a[186:187], v22 offset:47104
    v_add_f32 v24, v24, v124
    v_add_f32 v25, v25, v125
    v_cvt_pk_bf16_f32 v182, v124, v125
    v_mfma_f32_32x32x16_bf16 v[144:159], a[220:223], v[104:107], v[144:159]
    ds_read_b64_tr_b16 a[188:189], v23 offset:45056
    buffer_store_dwordx4 a[224:227], v1, s[48:51], s69 offen offset:0 sc1
    v_exp_f32 v126, v126
    v_exp_f32 v127, v127
    v_mfma_f32_32x32x16_bf16 v[160:175], a[220:223], v[108:111], v[160:175]
    ds_read_b64_tr_b16 a[190:191], v23 offset:47104
    buffer_store_dwordx4 a[228:231], v1, s[48:51], s69 offen offset:1024 sc1
    v_add_f32 v24, v24, v126
    v_add_f32 v25, v25, v127
    v_cvt_pk_bf16_f32 v183, v126, v127
    s_waitcnt lgkmcnt(12)
    v_mfma_f32_32x32x16_bf16 a[0:15], a[160:163], v[192:195], a[0:15]
    ds_read_b128 a[128:131], v12 offset:0
    buffer_store_dwordx4 a[232:235], v1, s[48:51], s69 offen offset:2048 sc1
    v_exp_f32 v128, v128
    v_exp_f32 v129, v129
    v_mfma_f32_32x32x16_bf16 a[16:31], a[160:163], v[200:203], a[16:31]
    ds_read_b128 a[132:135], v13 offset:0
    buffer_store_dwordx4 a[236:239], v1, s[48:51], s69 offen offset:3072 sc1
    v_add_f32 v26, v26, v128
    v_add_f32 v27, v27, v129
    v_cvt_pk_bf16_f32 v184, v128, v129
    v_mfma_f32_32x32x16_bf16 a[32:47], a[164:167], v[192:195], a[32:47]
    ds_read_b128 a[136:139], v14 offset:0
    buffer_store_dwordx4 a[240:243], v1, s[48:51], s52 offen sc1
    v_exp_f32 v130, v130
    v_exp_f32 v131, v131
    v_mfma_f32_32x32x16_bf16 a[48:63], a[164:167], v[200:203], a[48:63]
    ds_read_b128 a[140:143], v15 offset:0
    v_add_u32 v43, 0, v5
    v_mul_u32_u24 v44, s82, v43
    v_lshrrev_b32 v44, 16, v44
    v_mul_u32_u24 v45, s81, v44
    v_sub_u32 v45, v43, v45
    v_mul_u32_u24 v44, s80, v44
    v_lshl_add_u32 v36, v45, 4, v44
    v_add_f32 v26, v26, v130
    v_add_f32 v27, v27, v131
    v_cvt_pk_bf16_f32 v185, v130, v131
    s_waitcnt lgkmcnt(12)
    v_mfma_f32_32x32x16_bf16 a[64:79], a[168:171], v[192:195], a[64:79]
    ds_read_b128 a[144:147], v16 offset:0
    v_add_u32 v43, 64, v5
    v_mul_u32_u24 v44, s82, v43
    v_lshrrev_b32 v44, 16, v44
    v_mul_u32_u24 v45, s81, v44
    v_sub_u32 v45, v43, v45
    v_mul_u32_u24 v44, s80, v44
    v_lshl_add_u32 v37, v45, 4, v44
    v_exp_f32 v132, v132
    v_exp_f32 v133, v133
    v_mfma_f32_32x32x16_bf16 a[80:95], a[168:171], v[200:203], a[80:95]
    ds_read_b128 a[148:151], v17 offset:0
    v_add_u32 v43, 128, v5
    v_mul_u32_u24 v44, s82, v43
    v_lshrrev_b32 v44, 16, v44
    v_mul_u32_u24 v45, s81, v44
    v_sub_u32 v45, v43, v45
    v_mul_u32_u24 v44, s80, v44
    v_lshl_add_u32 v38, v45, 4, v44
    v_add_f32 v26, v26, v132
    v_add_f32 v27, v27, v133
    v_cvt_pk_bf16_f32 v186, v132, v133
    v_mfma_f32_32x32x16_bf16 a[96:111], a[172:175], v[192:195], a[96:111]
    ds_read_b128 a[152:155], v18 offset:0
    v_add_u32 v43, 192, v5
    v_mul_u32_u24 v44, s82, v43
    v_lshrrev_b32 v44, 16, v44
    v_mul_u32_u24 v45, s81, v44
    v_sub_u32 v45, v43, v45
    v_mul_u32_u24 v44, s80, v44
    v_lshl_add_u32 v39, v45, 4, v44
    v_exp_f32 v134, v134
    v_exp_f32 v135, v135
    v_mfma_f32_32x32x16_bf16 a[112:127], a[172:175], v[200:203], a[112:127]
    ds_read_b128 a[156:159], v19 offset:0
    v_add_u32 v43, 256, v5
    v_mul_u32_u24 v44, s82, v43
    v_lshrrev_b32 v44, 16, v44
    v_mul_u32_u24 v45, s81, v44
    v_sub_u32 v45, v43, v45
    v_mul_u32_u24 v44, s80, v44
    v_lshl_add_u32 v40, v45, 4, v44
    v_add_f32 v26, v26, v134
    v_add_f32 v27, v27, v135
    v_cvt_pk_bf16_f32 v187, v134, v135
    s_waitcnt lgkmcnt(12)
    v_mfma_f32_32x32x16_bf16 a[0:15], a[176:179], v[196:199], a[0:15]
    v_add_u32 v43, 320, v5
    v_mul_u32_u24 v44, s82, v43
    v_lshrrev_b32 v44, 16, v44
    v_mul_u32_u24 v45, s81, v44
    v_sub_u32 v45, v43, v45
    v_mul_u32_u24 v44, s80, v44
    v_lshl_add_u32 v41, v45, 4, v44
    v_exp_f32 v136, v136
    v_exp_f32 v137, v137
    v_mfma_f32_32x32x16_bf16 a[16:31], a[176:179], v[204:207], a[16:31]
    v_add_u32 v43, 384, v5
    v_mul_u32_u24 v44, s82, v43
    v_lshrrev_b32 v44, 16, v44
    v_mul_u32_u24 v45, s81, v44
    v_sub_u32 v45, v43, v45
    v_mul_u32_u24 v44, s80, v44
    v_lshl_add_u32 v42, v45, 4, v44
    v_add_f32 v26, v26, v136
    v_add_f32 v27, v27, v137
    v_cvt_pk_bf16_f32 v188, v136, v137
    v_mfma_f32_32x32x16_bf16 a[32:47], a[180:183], v[196:199], a[32:47]
    v_exp_f32 v138, v138
    v_exp_f32 v139, v139
    v_mfma_f32_32x32x16_bf16 a[48:63], a[180:183], v[204:207], a[48:63]
    v_add_f32 v26, v26, v138
    v_add_f32 v27, v27, v139
    v_cvt_pk_bf16_f32 v189, v138, v139
    s_waitcnt lgkmcnt(8)
    v_mfma_f32_32x32x16_bf16 a[64:79], a[184:187], v[196:199], a[64:79]
    v_exp_f32 v140, v140
    v_exp_f32 v141, v141
    v_mfma_f32_32x32x16_bf16 a[80:95], a[184:187], v[204:207], a[80:95]
    v_add_f32 v26, v26, v140
    v_add_f32 v27, v27, v141
    v_cvt_pk_bf16_f32 v190, v140, v141
    v_mfma_f32_32x32x16_bf16 a[96:111], a[188:191], v[196:199], a[96:111]
    v_exp_f32 v142, v142
    v_exp_f32 v143, v143
    v_mfma_f32_32x32x16_bf16 a[112:127], a[188:191], v[204:207], a[112:127]
    v_add_f32 v26, v26, v142
    v_add_f32 v27, v27, v143
    v_cvt_pk_bf16_f32 v191, v142, v143
    s_waitcnt lgkmcnt(4)
    v_mfma_f32_32x32x16_bf16 v[112:127], a[128:131], v[48:51], v[208:223]
    ds_read_b64_tr_b16 a[160:161], v20 offset:49152
    v_exp_f32 v144, v144
    v_exp_f32 v145, v145
    v_mfma_f32_32x32x16_bf16 v[128:143], a[128:131], v[52:55], v[224:239]
    ds_read_b64_tr_b16 a[162:163], v20 offset:51200
    s_add_u32 m0, s53, 0
    v_add_f32 v24, v24, v144
    v_add_f32 v25, v25, v145
    v_cvt_pk_bf16_f32 v192, v144, v145
    v_mfma_f32_32x32x16_bf16 v[112:127], a[132:135], v[56:59], v[112:127]
    ds_read_b64_tr_b16 a[164:165], v21 offset:49152
    buffer_load_dwordx4 v36, s[72:75], s76 offen lds
    v_exp_f32 v146, v146
    v_exp_f32 v147, v147
    v_mfma_f32_32x32x16_bf16 v[128:143], a[132:135], v[60:63], v[128:143]
    ds_read_b64_tr_b16 a[166:167], v21 offset:51200
    s_add_u32 m0, s53, 1024
    v_add_f32 v24, v24, v146
    v_add_f32 v25, v25, v147
    v_cvt_pk_bf16_f32 v193, v146, v147
    v_mfma_f32_32x32x16_bf16 v[112:127], a[136:139], v[64:67], v[112:127]
    ds_read_b64_tr_b16 a[168:169], v22 offset:49152
    buffer_load_dwordx4 v37, s[72:75], s76 offen lds
    v_exp_f32 v148, v148
    v_exp_f32 v149, v149
    v_mfma_f32_32x32x16_bf16 v[128:143], a[136:139], v[68:71], v[128:143]
    ds_read_b64_tr_b16 a[170:171], v22 offset:51200
    s_add_u32 m0, s53, 2048
    v_add_f32 v24, v24, v148
    v_add_f32 v25, v25, v149
    v_cvt_pk_bf16_f32 v194, v148, v149
    v_mfma_f32_32x32x16_bf16 v[112:127], a[140:143], v[72:75], v[112:127]
    ds_read_b64_tr_b16 a[172:173], v23 offset:49152
    buffer_load_dwordx4 v38, s[72:75], s76 offen lds
    v_exp_f32 v150, v150
    v_exp_f32 v151, v151
    v_mfma_f32_32x32x16_bf16 v[128:143], a[140:143], v[76:79], v[128:143]
    ds_read_b64_tr_b16 a[174:175], v23 offset:51200
    s_add_u32 m0, s53, 3072
    v_add_f32 v24, v24, v150
    v_add_f32 v25, v25, v151
    v_cvt_pk_bf16_f32 v195, v150, v151
    s_waitcnt lgkmcnt(8)
    v_mfma_f32_32x32x16_bf16 v[112:127], a[144:147], v[80:83], v[112:127]
    ds_read_b64_tr_b16 a[176:177], v20 offset:53248
    buffer_load_dwordx4 v39, s[72:75], s76 offen lds
    v_exp_f32 v152, v152
    v_exp_f32 v153, v153
    v_mfma_f32_32x32x16_bf16 v[128:143], a[144:147], v[84:87], v[128:143]
    ds_read_b64_tr_b16 a[178:179], v20 offset:55296
    s_add_u32 m0, s53, 4096
    v_add_f32 v24, v24, v152
    v_add_f32 v25, v25, v153
    v_cvt_pk_bf16_f32 v196, v152, v153
    v_mfma_f32_32x32x16_bf16 v[112:127], a[148:151], v[88:91], v[112:127]
    ds_read_b64_tr_b16 a[180:181], v21 offset:53248
    buffer_load_dwordx4 v40, s[72:75], s76 offen lds
    v_exp_f32 v154, v154
    v_exp_f32 v155, v155
    v_mfma_f32_32x32x16_bf16 v[128:143], a[148:151], v[92:95], v[128:143]
    ds_read_b64_tr_b16 a[182:183], v21 offset:55296
    s_add_u32 m0, s53, 5120
    v_add_f32 v24, v24, v154
    v_add_f32 v25, v25, v155
    v_cvt_pk_bf16_f32 v197, v154, v155
    v_mfma_f32_32x32x16_bf16 v[112:127], a[152:155], v[96:99], v[112:127]
    ds_read_b64_tr_b16 a[184:185], v22 offset:53248
    buffer_load_dwordx4 v41, s[72:75], s76 offen lds
    v_exp_f32 v156, v156
    v_exp_f32 v157, v157
    v_mfma_f32_32x32x16_bf16 v[128:143], a[152:155], v[100:103], v[128:143]
    ds_read_b64_tr_b16 a[186:187], v22 offset:55296
    s_add_u32 m0, s53, 6144
    v_add_f32 v24, v24, v156
    v_add_f32 v25, v25, v157
    v_cvt_pk_bf16_f32 v198, v156, v157
    v_mfma_f32_32x32x16_bf16 v[112:127], a[156:159], v[104:107], v[112:127]
    ds_read_b64_tr_b16 a[188:189], v23 offset:53248
    buffer_load_dwordx4 v42, s[72:75], s76 offen lds
    v_exp_f32 v158, v158
    v_exp_f32 v159, v159
    v_mfma_f32_32x32x16_bf16 v[128:143], a[156:159], v[108:111], v[128:143]
    ds_read_b64_tr_b16 a[190:191], v23 offset:55296
    v_add_f32 v24, v24, v158
    v_add_f32 v25, v25, v159
    v_cvt_pk_bf16_f32 v199, v158, v159
    s_waitcnt lgkmcnt(12)
    v_mfma_f32_32x32x16_bf16 a[0:15], a[160:163], v[176:179], a[0:15]
    ds_read_b128 a[192:195], v12 offset:8192
    v_exp_f32 v160, v160
    v_exp_f32 v161, v161
    v_mfma_f32_32x32x16_bf16 a[16:31], a[160:163], v[184:187], a[16:31]
    ds_read_b128 a[196:199], v13 offset:8192
    v_add_f32 v26, v26, v160
    v_add_f32 v27, v27, v161
    v_cvt_pk_bf16_f32 v200, v160, v161
    v_mfma_f32_32x32x16_bf16 a[32:47], a[164:167], v[176:179], a[32:47]
    ds_read_b128 a[200:203], v14 offset:8192
    v_exp_f32 v162, v162
    v_exp_f32 v163, v163
    v_mfma_f32_32x32x16_bf16 a[48:63], a[164:167], v[184:187], a[48:63]
    ds_read_b128 a[204:207], v15 offset:8192
    v_add_f32 v26, v26, v162
    v_add_f32 v27, v27, v163
    v_cvt_pk_bf16_f32 v201, v162, v163
    s_waitcnt lgkmcnt(12)
    v_mfma_f32_32x32x16_bf16 a[64:79], a[168:171], v[176:179], a[64:79]
    ds_read_b128 a[208:211], v16 offset:8192
    v_exp_f32 v164, v164
    v_exp_f32 v165, v165
    v_mfma_f32_32x32x16_bf16 a[80:95], a[168:171], v[184:187], a[80:95]
    ds_read_b128 a[212:215], v17 offset:8192
    v_add_f32 v26, v26, v164
    v_add_f32 v27, v27, v165
    v_cvt_pk_bf16_f32 v202, v164, v165
    v_mfma_f32_32x32x16_bf16 a[96:111], a[172:175], v[176:179], a[96:111]
    ds_read_b128 a[216:219], v18 offset:8192
    v_exp_f32 v166, v166
    v_exp_f32 v167, v167
    v_mfma_f32_32x32x16_bf16 a[112:127], a[172:175], v[184:187], a[112:127]
    ds_read_b128 a[220:223], v19 offset:8192
    v_add_f32 v26, v26, v166
    v_add_f32 v27, v27, v167
    v_cvt_pk_bf16_f32 v203, v166, v167
    s_waitcnt lgkmcnt(12)
    v_mfma_f32_32x32x16_bf16 a[0:15], a[176:179], v[180:183], a[0:15]
    v_exp_f32 v168, v168
    v_exp_f32 v169, v169
    v_mfma_f32_32x32x16_bf16 a[16:31], a[176:179], v[188:191], a[16:31]
    v_add_f32 v26, v26, v168
    v_add_f32 v27, v27, v169
    v_cvt_pk_bf16_f32 v204, v168, v169
    v_mfma_f32_32x32x16_bf16 a[32:47], a[180:183], v[180:183], a[32:47]
    v_exp_f32 v170, v170
    v_exp_f32 v171, v171
    v_mfma_f32_32x32x16_bf16 a[48:63], a[180:183], v[188:191], a[48:63]
    v_add_f32 v26, v26, v170
    v_add_f32 v27, v27, v171
    v_cvt_pk_bf16_f32 v205, v170, v171
    s_waitcnt lgkmcnt(8)
    v_mfma_f32_32x32x16_bf16 a[64:79], a[184:187], v[180:183], a[64:79]
    v_exp_f32 v172, v172
    v_exp_f32 v173, v173
    v_mfma_f32_32x32x16_bf16 a[80:95], a[184:187], v[188:191], a[80:95]
    v_add_f32 v26, v26, v172
    v_add_f32 v27, v27, v173
    v_cvt_pk_bf16_f32 v206, v172, v173
    v_mfma_f32_32x32x16_bf16 a[96:111], a[188:191], v[180:183], a[96:111]
    v_exp_f32 v174, v174
    v_exp_f32 v175, v175
    v_mfma_f32_32x32x16_bf16 a[112:127], a[188:191], v[188:191], a[112:127]
    v_add_f32 v26, v26, v174
    v_add_f32 v27, v27, v175
    v_cvt_pk_bf16_f32 v207, v174, v175
    s_waitcnt lgkmcnt(0)
    s_waitcnt vmcnt(24)
    s_barrier
    v_mfma_f32_32x32x16_bf16 v[144:159], a[192:195], v[48:51], v[208:223]
    ds_read_b64_tr_b16 a[160:161], v20 offset:57344
    v_exp_f32 v112, v112
    v_exp_f32 v113, v113
    v_mfma_f32_32x32x16_bf16 v[160:175], a[192:195], v[52:55], v[224:239]
    ds_read_b64_tr_b16 a[162:163], v20 offset:59392
    s_add_u32 m0, s38, 98304
    v_add_f32 v24, v24, v112
    v_add_f32 v25, v25, v113
    v_cvt_pk_bf16_f32 v176, v112, v113
    v_mfma_f32_32x32x16_bf16 v[144:159], a[196:199], v[56:59], v[144:159]
    ds_read_b64_tr_b16 a[164:165], v21 offset:57344
    s_add_u32 s37, s38, 98304
    v_exp_f32 v114, v114
    v_exp_f32 v115, v115
    v_mfma_f32_32x32x16_bf16 v[160:175], a[196:199], v[60:63], v[160:175]
    ds_read_b64_tr_b16 a[166:167], v21 offset:59392
    buffer_load_dwordx4 v11, s[20:23], s37 offen offset:0 nt lds
    v_add_f32 v24, v24, v114
    v_add_f32 v25, v25, v115
    v_cvt_pk_bf16_f32 v177, v114, v115
    v_mfma_f32_32x32x16_bf16 v[144:159], a[200:203], v[64:67], v[144:159]
    ds_read_b64_tr_b16 a[168:169], v22 offset:57344
    buffer_load_dwordx4 v11, s[20:23], s37 offen offset:1024 nt lds
    v_exp_f32 v116, v116
    v_exp_f32 v117, v117
    v_mfma_f32_32x32x16_bf16 v[160:175], a[200:203], v[68:71], v[160:175]
    ds_read_b64_tr_b16 a[170:171], v22 offset:59392
    buffer_load_dwordx4 v11, s[20:23], s37 offen offset:2048 nt lds
    v_add_f32 v24, v24, v116
    v_add_f32 v25, v25, v117
    v_cvt_pk_bf16_f32 v178, v116, v117
    v_mfma_f32_32x32x16_bf16 v[144:159], a[204:207], v[72:75], v[144:159]
    ds_read_b64_tr_b16 a[172:173], v23 offset:57344
    buffer_load_dwordx4 v11, s[20:23], s37 offen offset:3072 nt lds
    v_exp_f32 v118, v118
    v_exp_f32 v119, v119
    v_mfma_f32_32x32x16_bf16 v[160:175], a[204:207], v[76:79], v[160:175]
    ds_read_b64_tr_b16 a[174:175], v23 offset:59392
    v_add_f32 v24, v24, v118
    v_add_f32 v25, v25, v119
    v_cvt_pk_bf16_f32 v179, v118, v119
    v_mfma_f32_32x32x16_bf16 v[144:159], a[208:211], v[80:83], v[144:159]
    ds_read_b64_tr_b16 a[176:177], v20 offset:61440
    v_exp_f32 v120, v120
    v_exp_f32 v121, v121
    v_mfma_f32_32x32x16_bf16 v[160:175], a[208:211], v[84:87], v[160:175]
    ds_read_b64_tr_b16 a[178:179], v20 offset:63488
    v_add_f32 v24, v24, v120
    v_add_f32 v25, v25, v121
    v_cvt_pk_bf16_f32 v180, v120, v121
    v_mfma_f32_32x32x16_bf16 v[144:159], a[212:215], v[88:91], v[144:159]
    ds_read_b64_tr_b16 a[180:181], v21 offset:61440
    v_exp_f32 v122, v122
    v_exp_f32 v123, v123
    v_mfma_f32_32x32x16_bf16 v[160:175], a[212:215], v[92:95], v[160:175]
    ds_read_b64_tr_b16 a[182:183], v21 offset:63488
    v_add_f32 v24, v24, v122
    v_add_f32 v25, v25, v123
    v_cvt_pk_bf16_f32 v181, v122, v123
    v_mfma_f32_32x32x16_bf16 v[144:159], a[216:219], v[96:99], v[144:159]
    ds_read_b64_tr_b16 a[184:185], v22 offset:61440
    v_exp_f32 v124, v124
    v_exp_f32 v125, v125
    v_mfma_f32_32x32x16_bf16 v[160:175], a[216:219], v[100:103], v[160:175]
    ds_read_b64_tr_b16 a[186:187], v22 offset:63488
    v_add_f32 v24, v24, v124
    v_add_f32 v25, v25, v125
    v_cvt_pk_bf16_f32 v182, v124, v125
    v_mfma_f32_32x32x16_bf16 v[144:159], a[220:223], v[104:107], v[144:159]
    ds_read_b64_tr_b16 a[188:189], v23 offset:61440
    v_exp_f32 v126, v126
    v_exp_f32 v127, v127
    v_mfma_f32_32x32x16_bf16 v[160:175], a[220:223], v[108:111], v[160:175]
    ds_read_b64_tr_b16 a[190:191], v23 offset:63488
    v_add_f32 v24, v24, v126
    v_add_f32 v25, v25, v127
    v_cvt_pk_bf16_f32 v183, v126, v127
    s_waitcnt lgkmcnt(12)
    v_mfma_f32_32x32x16_bf16 a[0:15], a[160:163], v[192:195], a[0:15]
    ds_read_b128 a[128:131], v12 offset:16384
    v_exp_f32 v128, v128
    v_exp_f32 v129, v129
    v_mfma_f32_32x32x16_bf16 a[16:31], a[160:163], v[200:203], a[16:31]
    ds_read_b128 a[132:135], v13 offset:16384
    v_add_f32 v26, v26, v128
    v_add_f32 v27, v27, v129
    v_cvt_pk_bf16_f32 v184, v128, v129
    v_mfma_f32_32x32x16_bf16 a[32:47], a[164:167], v[192:195], a[32:47]
    ds_read_b128 a[136:139], v14 offset:16384
    v_exp_f32 v130, v130
    v_exp_f32 v131, v131
    v_mfma_f32_32x32x16_bf16 a[48:63], a[164:167], v[200:203], a[48:63]
    ds_read_b128 a[140:143], v15 offset:16384
    v_add_f32 v26, v26, v130
    v_add_f32 v27, v27, v131
    v_cvt_pk_bf16_f32 v185, v130, v131
    s_waitcnt lgkmcnt(12)
    v_mfma_f32_32x32x16_bf16 a[64:79], a[168:171], v[192:195], a[64:79]
    ds_read_b128 a[144:147], v16 offset:16384
    v_exp_f32 v132, v132
    v_exp_f32 v133, v133
    v_mfma_f32_32x32x16_bf16 a[80:95], a[168:171], v[200:203], a[80:95]
    ds_read_b128 a[148:151], v17 offset:16384
    v_add_f32 v26, v26, v132
    v_add_f32 v27, v27, v133
    v_cvt_pk_bf16_f32 v186, v132, v133
    v_mfma_f32_32x32x16_bf16 a[96:111], a[172:175], v[192:195], a[96:111]
    ds_read_b128 a[152:155], v18 offset:16384
    v_exp_f32 v134, v134
    v_exp_f32 v135, v135
    v_mfma_f32_32x32x16_bf16 a[112:127], a[172:175], v[200:203], a[112:127]
    ds_read_b128 a[156:159], v19 offset:16384
    v_add_f32 v26, v26, v134
    v_add_f32 v27, v27, v135
    v_cvt_pk_bf16_f32 v187, v134, v135
    s_waitcnt lgkmcnt(12)
    v_mfma_f32_32x32x16_bf16 a[0:15], a[176:179], v[196:199], a[0:15]
    v_exp_f32 v136, v136
    v_exp_f32 v137, v137
    v_mfma_f32_32x32x16_bf16 a[16:31], a[176:179], v[204:207], a[16:31]
    v_add_f32 v26, v26, v136
    v_add_f32 v27, v27, v137
    v_cvt_pk_bf16_f32 v188, v136, v137
    v_mfma_f32_32x32x16_bf16 a[32:47], a[180:183], v[196:199], a[32:47]
    v_exp_f32 v138, v138
    v_exp_f32 v139, v139
    v_mfma_f32_32x32x16_bf16 a[48:63], a[180:183], v[204:207], a[48:63]
    v_add_f32 v26, v26, v138
    v_add_f32 v27, v27, v139
    v_cvt_pk_bf16_f32 v189, v138, v139
    s_waitcnt lgkmcnt(8)
    v_mfma_f32_32x32x16_bf16 a[64:79], a[184:187], v[196:199], a[64:79]
    v_exp_f32 v140, v140
    v_exp_f32 v141, v141
    v_mfma_f32_32x32x16_bf16 a[80:95], a[184:187], v[204:207], a[80:95]
    v_add_f32 v26, v26, v140
    v_add_f32 v27, v27, v141
    v_cvt_pk_bf16_f32 v190, v140, v141
    v_mfma_f32_32x32x16_bf16 a[96:111], a[188:191], v[196:199], a[96:111]
    v_exp_f32 v142, v142
    v_exp_f32 v143, v143
    v_mfma_f32_32x32x16_bf16 a[112:127], a[188:191], v[204:207], a[112:127]
    v_add_f32 v26, v26, v142
    v_add_f32 v27, v27, v143
    v_cvt_pk_bf16_f32 v191, v142, v143
    s_waitcnt lgkmcnt(4)
    v_mfma_f32_32x32x16_bf16 v[112:127], a[128:131], v[48:51], v[208:223]
    ds_read_b64_tr_b16 a[160:161], v20 offset:0
    v_exp_f32 v144, v144
    v_exp_f32 v145, v145
    v_mfma_f32_32x32x16_bf16 v[128:143], a[128:131], v[52:55], v[224:239]
    ds_read_b64_tr_b16 a[162:163], v20 offset:2048
    v_add_f32 v24, v24, v144
    v_add_f32 v25, v25, v145
    v_cvt_pk_bf16_f32 v192, v144, v145
    v_mfma_f32_32x32x16_bf16 v[112:127], a[132:135], v[56:59], v[112:127]
    ds_read_b64_tr_b16 a[164:165], v21 offset:0
    v_exp_f32 v146, v146
    v_exp_f32 v147, v147
    v_mfma_f32_32x32x16_bf16 v[128:143], a[132:135], v[60:63], v[128:143]
    ds_read_b64_tr_b16 a[166:167], v21 offset:2048
    v_add_f32 v24, v24, v146
    v_add_f32 v25, v25, v147
    v_cvt_pk_bf16_f32 v193, v146, v147
    v_mfma_f32_32x32x16_bf16 v[112:127], a[136:139], v[64:67], v[112:127]
    ds_read_b64_tr_b16 a[168:169], v22 offset:0
    v_exp_f32 v148, v148
    v_exp_f32 v149, v149
    v_mfma_f32_32x32x16_bf16 v[128:143], a[136:139], v[68:71], v[128:143]
    ds_read_b64_tr_b16 a[170:171], v22 offset:2048
    v_add_f32 v24, v24, v148
    v_add_f32 v25, v25, v149
    v_cvt_pk_bf16_f32 v194, v148, v149
    v_mfma_f32_32x32x16_bf16 v[112:127], a[140:143], v[72:75], v[112:127]
    ds_read_b64_tr_b16 a[172:173], v23 offset:0
    v_exp_f32 v150, v150
    v_exp_f32 v151, v151
    v_mfma_f32_32x32x16_bf16 v[128:143], a[140:143], v[76:79], v[128:143]
    ds_read_b64_tr_b16 a[174:175], v23 offset:2048
    v_add_f32 v24, v24, v150
    v_add_f32 v25, v25, v151
    v_cvt_pk_bf16_f32 v195, v150, v151
    s_waitcnt lgkmcnt(8)
    v_mfma_f32_32x32x16_bf16 v[112:127], a[144:147], v[80:83], v[112:127]
    ds_read_b64_tr_b16 a[176:177], v20 offset:4096
    v_exp_f32 v152, v152
    v_exp_f32 v153, v153
    v_mfma_f32_32x32x16_bf16 v[128:143], a[144:147], v[84:87], v[128:143]
    ds_read_b64_tr_b16 a[178:179], v20 offset:6144
    v_add_f32 v24, v24, v152
    v_add_f32 v25, v25, v153
    v_cvt_pk_bf16_f32 v196, v152, v153
    v_mfma_f32_32x32x16_bf16 v[112:127], a[148:151], v[88:91], v[112:127]
    ds_read_b64_tr_b16 a[180:181], v21 offset:4096
    v_exp_f32 v154, v154
    v_exp_f32 v155, v155
    v_mfma_f32_32x32x16_bf16 v[128:143], a[148:151], v[92:95], v[128:143]
    ds_read_b64_tr_b16 a[182:183], v21 offset:6144
    v_add_f32 v24, v24, v154
    v_add_f32 v25, v25, v155
    v_cvt_pk_bf16_f32 v197, v154, v155
    v_mfma_f32_32x32x16_bf16 v[112:127], a[152:155], v[96:99], v[112:127]
    ds_read_b64_tr_b16 a[184:185], v22 offset:4096
    v_exp_f32 v156, v156
    v_exp_f32 v157, v157
    v_mfma_f32_32x32x16_bf16 v[128:143], a[152:155], v[100:103], v[128:143]
    ds_read_b64_tr_b16 a[186:187], v22 offset:6144
    v_add_f32 v24, v24, v156
    v_add_f32 v25, v25, v157
    v_cvt_pk_bf16_f32 v198, v156, v157
    v_mfma_f32_32x32x16_bf16 v[112:127], a[156:159], v[104:107], v[112:127]
    ds_read_b64_tr_b16 a[188:189], v23 offset:4096
    v_exp_f32 v158, v158
    v_exp_f32 v159, v159
    v_mfma_f32_32x32x16_bf16 v[128:143], a[156:159], v[108:111], v[128:143]
    ds_read_b64_tr_b16 a[190:191], v23 offset:6144
    v_add_f32 v24, v24, v158
    v_add_f32 v25, v25, v159
    v_cvt_pk_bf16_f32 v199, v158, v159
    s_waitcnt lgkmcnt(12)
    v_mfma_f32_32x32x16_bf16 a[0:15], a[160:163], v[176:179], a[0:15]
    ds_read_b128 a[192:195], v12 offset:24576
    v_exp_f32 v160, v160
    v_exp_f32 v161, v161
    v_mfma_f32_32x32x16_bf16 a[16:31], a[160:163], v[184:187], a[16:31]
    ds_read_b128 a[196:199], v13 offset:24576
    v_add_f32 v26, v26, v160
    v_add_f32 v27, v27, v161
    v_cvt_pk_bf16_f32 v200, v160, v161
    v_mfma_f32_32x32x16_bf16 a[32:47], a[164:167], v[176:179], a[32:47]
    ds_read_b128 a[200:203], v14 offset:24576
    v_exp_f32 v162, v162
    v_exp_f32 v163, v163
    v_mfma_f32_32x32x16_bf16 a[48:63], a[164:167], v[184:187], a[48:63]
    ds_read_b128 a[204:207], v15 offset:24576
    v_add_f32 v26, v26, v162
    v_add_f32 v27, v27, v163
    v_cvt_pk_bf16_f32 v201, v162, v163
    s_waitcnt lgkmcnt(12)
    v_mfma_f32_32x32x16_bf16 a[64:79], a[168:171], v[176:179], a[64:79]
    ds_read_b128 a[208:211], v16 offset:24576
    v_exp_f32 v164, v164
    v_exp_f32 v165, v165
    v_mfma_f32_32x32x16_bf16 a[80:95], a[168:171], v[184:187], a[80:95]
    ds_read_b128 a[212:215], v17 offset:24576
    v_add_f32 v26, v26, v164
    v_add_f32 v27, v27, v165
    v_cvt_pk_bf16_f32 v202, v164, v165
    v_mfma_f32_32x32x16_bf16 a[96:111], a[172:175], v[176:179], a[96:111]
    ds_read_b128 a[216:219], v18 offset:24576
    v_exp_f32 v166, v166
    v_exp_f32 v167, v167
    v_mfma_f32_32x32x16_bf16 a[112:127], a[172:175], v[184:187], a[112:127]
    ds_read_b128 a[220:223], v19 offset:24576
    v_add_f32 v26, v26, v166
    v_add_f32 v27, v27, v167
    v_cvt_pk_bf16_f32 v203, v166, v167
    s_waitcnt lgkmcnt(12)
    v_mfma_f32_32x32x16_bf16 a[0:15], a[176:179], v[180:183], a[0:15]
    v_exp_f32 v168, v168
    v_exp_f32 v169, v169
    v_mfma_f32_32x32x16_bf16 a[16:31], a[176:179], v[188:191], a[16:31]
    v_add_f32 v26, v26, v168
    v_add_f32 v27, v27, v169
    v_cvt_pk_bf16_f32 v204, v168, v169
    v_mfma_f32_32x32x16_bf16 a[32:47], a[180:183], v[180:183], a[32:47]
    v_exp_f32 v170, v170
    v_exp_f32 v171, v171
    v_mfma_f32_32x32x16_bf16 a[48:63], a[180:183], v[188:191], a[48:63]
    v_add_f32 v26, v26, v170
    v_add_f32 v27, v27, v171
    v_cvt_pk_bf16_f32 v205, v170, v171
    s_waitcnt lgkmcnt(8)
    v_mfma_f32_32x32x16_bf16 a[64:79], a[184:187], v[180:183], a[64:79]
    v_exp_f32 v172, v172
    v_exp_f32 v173, v173
    v_mfma_f32_32x32x16_bf16 a[80:95], a[184:187], v[188:191], a[80:95]
    v_add_f32 v26, v26, v172
    v_add_f32 v27, v27, v173
    v_cvt_pk_bf16_f32 v206, v172, v173
    v_mfma_f32_32x32x16_bf16 a[96:111], a[188:191], v[180:183], a[96:111]
    v_exp_f32 v174, v174
    v_exp_f32 v175, v175
    v_mfma_f32_32x32x16_bf16 a[112:127], a[188:191], v[188:191], a[112:127]
    v_add_f32 v26, v26, v174
    v_add_f32 v27, v27, v175
    v_cvt_pk_bf16_f32 v207, v174, v175
    s_waitcnt lgkmcnt(0)
    s_waitcnt vmcnt(20)
    s_barrier
    v_mfma_f32_32x32x16_bf16 v[144:159], a[192:195], v[48:51], v[208:223]
    ds_read_b64_tr_b16 a[160:161], v20 offset:8192
    v_exp_f32 v112, v112
    v_exp_f32 v113, v113
    v_mfma_f32_32x32x16_bf16 v[160:175], a[192:195], v[52:55], v[224:239]
    ds_read_b64_tr_b16 a[162:163], v20 offset:10240
    s_add_u32 m0, s38, 114688
    v_add_f32 v24, v24, v112
    v_add_f32 v25, v25, v113
    v_cvt_pk_bf16_f32 v176, v112, v113
    v_mfma_f32_32x32x16_bf16 v[144:159], a[196:199], v[56:59], v[144:159]
    ds_read_b64_tr_b16 a[164:165], v21 offset:8192
    s_add_u32 s37, s38, 114688
    v_exp_f32 v114, v114
    v_exp_f32 v115, v115
    v_mfma_f32_32x32x16_bf16 v[160:175], a[196:199], v[60:63], v[160:175]
    ds_read_b64_tr_b16 a[166:167], v21 offset:10240
    buffer_load_dwordx4 v11, s[20:23], s37 offen offset:0 nt lds
    v_add_f32 v24, v24, v114
    v_add_f32 v25, v25, v115
    v_cvt_pk_bf16_f32 v177, v114, v115
    v_mfma_f32_32x32x16_bf16 v[144:159], a[200:203], v[64:67], v[144:159]
    ds_read_b64_tr_b16 a[168:169], v22 offset:8192
    buffer_load_dwordx4 v11, s[20:23], s37 offen offset:1024 nt lds
    v_exp_f32 v116, v116
    v_exp_f32 v117, v117
    v_mfma_f32_32x32x16_bf16 v[160:175], a[200:203], v[68:71], v[160:175]
    ds_read_b64_tr_b16 a[170:171], v22 offset:10240
    buffer_load_dwordx4 v11, s[20:23], s37 offen offset:2048 nt lds
    v_add_f32 v24, v24, v116
    v_add_f32 v25, v25, v117
    v_cvt_pk_bf16_f32 v178, v116, v117
    v_mfma_f32_32x32x16_bf16 v[144:159], a[204:207], v[72:75], v[144:159]
    ds_read_b64_tr_b16 a[172:173], v23 offset:8192
    buffer_load_dwordx4 v11, s[20:23], s37 offen offset:3072 nt lds
    v_exp_f32 v118, v118
    v_exp_f32 v119, v119
    v_mfma_f32_32x32x16_bf16 v[160:175], a[204:207], v[76:79], v[160:175]
    ds_read_b64_tr_b16 a[174:175], v23 offset:10240
    v_add_f32 v24, v24, v118
    v_add_f32 v25, v25, v119
    v_cvt_pk_bf16_f32 v179, v118, v119
    v_mfma_f32_32x32x16_bf16 v[144:159], a[208:211], v[80:83], v[144:159]
    ds_read_b64_tr_b16 a[176:177], v20 offset:12288
    v_exp_f32 v120, v120
    v_exp_f32 v121, v121
    v_mfma_f32_32x32x16_bf16 v[160:175], a[208:211], v[84:87], v[160:175]
    ds_read_b64_tr_b16 a[178:179], v20 offset:14336
    v_add_f32 v24, v24, v120
    v_add_f32 v25, v25, v121
    v_cvt_pk_bf16_f32 v180, v120, v121
    v_mfma_f32_32x32x16_bf16 v[144:159], a[212:215], v[88:91], v[144:159]
    ds_read_b64_tr_b16 a[180:181], v21 offset:12288
    v_exp_f32 v122, v122
    v_exp_f32 v123, v123
    v_mfma_f32_32x32x16_bf16 v[160:175], a[212:215], v[92:95], v[160:175]
    ds_read_b64_tr_b16 a[182:183], v21 offset:14336
    v_add_f32 v24, v24, v122
    v_add_f32 v25, v25, v123
    v_cvt_pk_bf16_f32 v181, v122, v123
    v_mfma_f32_32x32x16_bf16 v[144:159], a[216:219], v[96:99], v[144:159]
    ds_read_b64_tr_b16 a[184:185], v22 offset:12288
    v_exp_f32 v124, v124
    v_exp_f32 v125, v125
    v_mfma_f32_32x32x16_bf16 v[160:175], a[216:219], v[100:103], v[160:175]
    ds_read_b64_tr_b16 a[186:187], v22 offset:14336
    v_add_f32 v24, v24, v124
    v_add_f32 v25, v25, v125
    v_cvt_pk_bf16_f32 v182, v124, v125
    v_mfma_f32_32x32x16_bf16 v[144:159], a[220:223], v[104:107], v[144:159]
    ds_read_b64_tr_b16 a[188:189], v23 offset:12288
    v_exp_f32 v126, v126
    v_exp_f32 v127, v127
    v_mfma_f32_32x32x16_bf16 v[160:175], a[220:223], v[108:111], v[160:175]
    ds_read_b64_tr_b16 a[190:191], v23 offset:14336
    v_add_f32 v24, v24, v126
    v_add_f32 v25, v25, v127
    v_cvt_pk_bf16_f32 v183, v126, v127
    s_waitcnt lgkmcnt(12)
    v_mfma_f32_32x32x16_bf16 a[0:15], a[160:163], v[192:195], a[0:15]
    ds_read_b128 a[128:131], v12 offset:32768
    v_exp_f32 v128, v128
    v_exp_f32 v129, v129
    v_mfma_f32_32x32x16_bf16 a[16:31], a[160:163], v[200:203], a[16:31]
    ds_read_b128 a[132:135], v13 offset:32768
    v_add_f32 v26, v26, v128
    v_add_f32 v27, v27, v129
    v_cvt_pk_bf16_f32 v184, v128, v129
    v_mfma_f32_32x32x16_bf16 a[32:47], a[164:167], v[192:195], a[32:47]
    ds_read_b128 a[136:139], v14 offset:32768
    v_exp_f32 v130, v130
    v_exp_f32 v131, v131
    v_mfma_f32_32x32x16_bf16 a[48:63], a[164:167], v[200:203], a[48:63]
    ds_read_b128 a[140:143], v15 offset:32768
    v_add_f32 v26, v26, v130
    v_add_f32 v27, v27, v131
    v_cvt_pk_bf16_f32 v185, v130, v131
    s_waitcnt lgkmcnt(12)
    v_mfma_f32_32x32x16_bf16 a[64:79], a[168:171], v[192:195], a[64:79]
    ds_read_b128 a[144:147], v16 offset:32768
    v_exp_f32 v132, v132
    v_exp_f32 v133, v133
    v_mfma_f32_32x32x16_bf16 a[80:95], a[168:171], v[200:203], a[80:95]
    ds_read_b128 a[148:151], v17 offset:32768
    v_add_f32 v26, v26, v132
    v_add_f32 v27, v27, v133
    v_cvt_pk_bf16_f32 v186, v132, v133
    v_mfma_f32_32x32x16_bf16 a[96:111], a[172:175], v[192:195], a[96:111]
    ds_read_b128 a[152:155], v18 offset:32768
    v_exp_f32 v134, v134
    v_exp_f32 v135, v135
    v_mfma_f32_32x32x16_bf16 a[112:127], a[172:175], v[200:203], a[112:127]
    ds_read_b128 a[156:159], v19 offset:32768
    v_add_f32 v26, v26, v134
    v_add_f32 v27, v27, v135
    v_cvt_pk_bf16_f32 v187, v134, v135
    s_waitcnt lgkmcnt(12)
    v_mfma_f32_32x32x16_bf16 a[0:15], a[176:179], v[196:199], a[0:15]
    v_exp_f32 v136, v136
    v_exp_f32 v137, v137
    v_mfma_f32_32x32x16_bf16 a[16:31], a[176:179], v[204:207], a[16:31]
    v_add_f32 v26, v26, v136
    v_add_f32 v27, v27, v137
    v_cvt_pk_bf16_f32 v188, v136, v137
    v_mfma_f32_32x32x16_bf16 a[32:47], a[180:183], v[196:199], a[32:47]
    v_exp_f32 v138, v138
    v_exp_f32 v139, v139
    v_mfma_f32_32x32x16_bf16 a[48:63], a[180:183], v[204:207], a[48:63]
    v_add_f32 v26, v26, v138
    v_add_f32 v27, v27, v139
    v_cvt_pk_bf16_f32 v189, v138, v139
    s_waitcnt lgkmcnt(8)
    v_mfma_f32_32x32x16_bf16 a[64:79], a[184:187], v[196:199], a[64:79]
    v_exp_f32 v140, v140
    v_exp_f32 v141, v141
    v_mfma_f32_32x32x16_bf16 a[80:95], a[184:187], v[204:207], a[80:95]
    v_add_f32 v26, v26, v140
    v_add_f32 v27, v27, v141
    v_cvt_pk_bf16_f32 v190, v140, v141
    v_mfma_f32_32x32x16_bf16 a[96:111], a[188:191], v[196:199], a[96:111]
    v_exp_f32 v142, v142
    v_exp_f32 v143, v143
    v_mfma_f32_32x32x16_bf16 a[112:127], a[188:191], v[204:207], a[112:127]
    v_add_f32 v26, v26, v142
    v_add_f32 v27, v27, v143
    v_cvt_pk_bf16_f32 v191, v142, v143
    s_waitcnt lgkmcnt(4)
    v_mfma_f32_32x32x16_bf16 v[112:127], a[128:131], v[48:51], v[208:223]
    ds_read_b64_tr_b16 a[160:161], v20 offset:16384
    v_exp_f32 v144, v144
    v_exp_f32 v145, v145
    v_mfma_f32_32x32x16_bf16 v[128:143], a[128:131], v[52:55], v[224:239]
    ds_read_b64_tr_b16 a[162:163], v20 offset:18432
    s_waitcnt vmcnt(8)
    v_add_f32 v24, v24, v144
    v_add_f32 v25, v25, v145
    v_cvt_pk_bf16_f32 v192, v144, v145
    v_mfma_f32_32x32x16_bf16 v[112:127], a[132:135], v[56:59], v[112:127]
    ds_read_b64_tr_b16 a[164:165], v21 offset:16384
    ds_read_b64_tr_b16 a[224:225], v6 offset:0
    v_exp_f32 v146, v146
    v_exp_f32 v147, v147
    v_mfma_f32_32x32x16_bf16 v[128:143], a[132:135], v[60:63], v[128:143]
    ds_read_b64_tr_b16 a[166:167], v21 offset:18432
    ds_read_b64_tr_b16 a[226:227], v3 offset:0
    v_add_f32 v24, v24, v146
    v_add_f32 v25, v25, v147
    v_cvt_pk_bf16_f32 v193, v146, v147
    v_mfma_f32_32x32x16_bf16 v[112:127], a[136:139], v[64:67], v[112:127]
    ds_read_b64_tr_b16 a[168:169], v22 offset:16384
    ds_read_b64_tr_b16 a[228:229], v6 offset:32
    v_exp_f32 v148, v148
    v_exp_f32 v149, v149
    v_mfma_f32_32x32x16_bf16 v[128:143], a[136:139], v[68:71], v[128:143]
    ds_read_b64_tr_b16 a[170:171], v22 offset:18432
    ds_read_b64_tr_b16 a[230:231], v3 offset:32
    v_add_f32 v24, v24, v148
    v_add_f32 v25, v25, v149
    v_cvt_pk_bf16_f32 v194, v148, v149
    v_mfma_f32_32x32x16_bf16 v[112:127], a[140:143], v[72:75], v[112:127]
    ds_read_b64_tr_b16 a[172:173], v23 offset:16384
    ds_read_b64_tr_b16 a[232:233], v6 offset:64
    v_exp_f32 v150, v150
    v_exp_f32 v151, v151
    v_mfma_f32_32x32x16_bf16 v[128:143], a[140:143], v[76:79], v[128:143]
    ds_read_b64_tr_b16 a[174:175], v23 offset:18432
    ds_read_b64_tr_b16 a[234:235], v3 offset:64
    v_add_f32 v24, v24, v150
    v_add_f32 v25, v25, v151
    v_cvt_pk_bf16_f32 v195, v150, v151
    s_waitcnt lgkmcnt(14)
    v_mfma_f32_32x32x16_bf16 v[112:127], a[144:147], v[80:83], v[112:127]
    ds_read_b64_tr_b16 a[176:177], v20 offset:20480
    ds_read_b64_tr_b16 a[236:237], v6 offset:96
    v_exp_f32 v152, v152
    v_exp_f32 v153, v153
    v_mfma_f32_32x32x16_bf16 v[128:143], a[144:147], v[84:87], v[128:143]
    ds_read_b64_tr_b16 a[178:179], v20 offset:22528
    ds_read_b64_tr_b16 a[238:239], v3 offset:96
    v_add_f32 v24, v24, v152
    v_add_f32 v25, v25, v153
    v_cvt_pk_bf16_f32 v196, v152, v153
    v_mfma_f32_32x32x16_bf16 v[112:127], a[148:151], v[88:91], v[112:127]
    ds_read_b64_tr_b16 a[180:181], v21 offset:20480
    ds_read_b64_tr_b16 a[240:241], v6 offset:128
    v_exp_f32 v154, v154
    v_exp_f32 v155, v155
    v_mfma_f32_32x32x16_bf16 v[128:143], a[148:151], v[92:95], v[128:143]
    ds_read_b64_tr_b16 a[182:183], v21 offset:22528
    ds_read_b64_tr_b16 a[242:243], v3 offset:128
    v_add_f32 v24, v24, v154
    v_add_f32 v25, v25, v155
    v_cvt_pk_bf16_f32 v197, v154, v155
    v_mfma_f32_32x32x16_bf16 v[112:127], a[152:155], v[96:99], v[112:127]
    ds_read_b64_tr_b16 a[184:185], v22 offset:20480
    ds_read_b64_tr_b16 a[244:245], v6 offset:160
    v_exp_f32 v156, v156
    v_exp_f32 v157, v157
    v_mfma_f32_32x32x16_bf16 v[128:143], a[152:155], v[100:103], v[128:143]
    ds_read_b64_tr_b16 a[186:187], v22 offset:22528
    ds_read_b64_tr_b16 a[246:247], v3 offset:160
    v_add_f32 v24, v24, v156
    v_add_f32 v25, v25, v157
    v_cvt_pk_bf16_f32 v198, v156, v157
    v_mfma_f32_32x32x16_bf16 v[112:127], a[156:159], v[104:107], v[112:127]
    ds_read_b64_tr_b16 a[188:189], v23 offset:20480
    ds_read_b64_tr_b16 a[248:249], v6 offset:192
    v_exp_f32 v158, v158
    v_exp_f32 v159, v159
    v_mfma_f32_32x32x16_bf16 v[128:143], a[156:159], v[108:111], v[128:143]
    ds_read_b64_tr_b16 a[190:191], v23 offset:22528
    ds_read_b64_tr_b16 a[250:251], v3 offset:192
    v_add_f32 v24, v24, v158
    v_add_f32 v25, v25, v159
    v_cvt_pk_bf16_f32 v199, v158, v159
    s_waitcnt lgkmcnt(15)
    v_mfma_f32_32x32x16_bf16 a[0:15], a[160:163], v[176:179], a[0:15]
    ds_read_b128 a[192:195], v12 offset:40960
    v_exp_f32 v160, v160
    v_exp_f32 v161, v161
    v_mfma_f32_32x32x16_bf16 a[16:31], a[160:163], v[184:187], a[16:31]
    ds_read_b128 a[196:199], v13 offset:40960
    v_add_f32 v26, v26, v160
    v_add_f32 v27, v27, v161
    v_cvt_pk_bf16_f32 v200, v160, v161
    v_mfma_f32_32x32x16_bf16 a[32:47], a[164:167], v[176:179], a[32:47]
    ds_read_b128 a[200:203], v14 offset:40960
    v_exp_f32 v162, v162
    v_exp_f32 v163, v163
    v_mfma_f32_32x32x16_bf16 a[48:63], a[164:167], v[184:187], a[48:63]
    ds_read_b128 a[204:207], v15 offset:40960
    v_add_f32 v26, v26, v162
    v_add_f32 v27, v27, v163
    v_cvt_pk_bf16_f32 v201, v162, v163
    v_mfma_f32_32x32x16_bf16 a[64:79], a[168:171], v[176:179], a[64:79]
    ds_read_b128 a[208:211], v16 offset:40960
    v_exp_f32 v164, v164
    v_exp_f32 v165, v165
    v_mfma_f32_32x32x16_bf16 a[80:95], a[168:171], v[184:187], a[80:95]
    ds_read_b128 a[212:215], v17 offset:40960
    v_add_f32 v26, v26, v164
    v_add_f32 v27, v27, v165
    v_cvt_pk_bf16_f32 v202, v164, v165
    v_mfma_f32_32x32x16_bf16 a[96:111], a[172:175], v[176:179], a[96:111]
    ds_read_b128 a[216:219], v18 offset:40960
    v_exp_f32 v166, v166
    v_exp_f32 v167, v167
    v_mfma_f32_32x32x16_bf16 a[112:127], a[172:175], v[184:187], a[112:127]
    ds_read_b128 a[220:223], v19 offset:40960
    v_add_f32 v26, v26, v166
    v_add_f32 v27, v27, v167
    v_cvt_pk_bf16_f32 v203, v166, v167
    s_waitcnt lgkmcnt(15)
    v_mfma_f32_32x32x16_bf16 a[0:15], a[176:179], v[180:183], a[0:15]
    v_exp_f32 v168, v168
    v_exp_f32 v169, v169
    v_mfma_f32_32x32x16_bf16 a[16:31], a[176:179], v[188:191], a[16:31]
    v_add_f32 v26, v26, v168
    v_add_f32 v27, v27, v169
    v_cvt_pk_bf16_f32 v204, v168, v169
    v_mfma_f32_32x32x16_bf16 a[32:47], a[180:183], v[180:183], a[32:47]
    v_exp_f32 v170, v170
    v_exp_f32 v171, v171
    v_mfma_f32_32x32x16_bf16 a[48:63], a[180:183], v[188:191], a[48:63]
    v_add_f32 v26, v26, v170
    v_add_f32 v27, v27, v171
    v_cvt_pk_bf16_f32 v205, v170, v171
    s_waitcnt lgkmcnt(9)
    v_mfma_f32_32x32x16_bf16 a[64:79], a[184:187], v[180:183], a[64:79]
    v_exp_f32 v172, v172
    v_exp_f32 v173, v173
    v_mfma_f32_32x32x16_bf16 a[80:95], a[184:187], v[188:191], a[80:95]
    v_add_f32 v26, v26, v172
    v_add_f32 v27, v27, v173
    v_cvt_pk_bf16_f32 v206, v172, v173
    v_mfma_f32_32x32x16_bf16 a[96:111], a[188:191], v[180:183], a[96:111]
    v_exp_f32 v174, v174
    v_exp_f32 v175, v175
    v_mfma_f32_32x32x16_bf16 a[112:127], a[188:191], v[188:191], a[112:127]
    v_add_f32 v26, v26, v174
    v_add_f32 v27, v27, v175
    v_cvt_pk_bf16_f32 v207, v174, v175
    s_waitcnt lgkmcnt(0)
    s_waitcnt vmcnt(4)
    s_barrier
    v_mfma_f32_32x32x16_bf16 v[144:159], a[192:195], v[48:51], v[208:223]
    ds_read_b64_tr_b16 a[160:161], v20 offset:24576
    v_exp_f32 v112, v112
    v_exp_f32 v113, v113
    v_mfma_f32_32x32x16_bf16 v[160:175], a[192:195], v[52:55], v[224:239]
    ds_read_b64_tr_b16 a[162:163], v20 offset:26624
    v_add_f32 v24, v24, v112
    v_add_f32 v25, v25, v113
    v_cvt_pk_bf16_f32 v176, v112, v113
    v_mfma_f32_32x32x16_bf16 v[144:159], a[196:199], v[56:59], v[144:159]
    ds_read_b64_tr_b16 a[164:165], v21 offset:24576
    v_exp_f32 v114, v114
    v_exp_f32 v115, v115
    v_mfma_f32_32x32x16_bf16 v[160:175], a[196:199], v[60:63], v[160:175]
    ds_read_b64_tr_b16 a[166:167], v21 offset:26624
    v_add_f32 v24, v24, v114
    v_add_f32 v25, v25, v115
    v_cvt_pk_bf16_f32 v177, v114, v115
    v_mfma_f32_32x32x16_bf16 v[144:159], a[200:203], v[64:67], v[144:159]
    ds_read_b64_tr_b16 a[168:169], v22 offset:24576
    v_exp_f32 v116, v116
    v_exp_f32 v117, v117
    v_mfma_f32_32x32x16_bf16 v[160:175], a[200:203], v[68:71], v[160:175]
    ds_read_b64_tr_b16 a[170:171], v22 offset:26624
    v_add_f32 v24, v24, v116
    v_add_f32 v25, v25, v117
    v_cvt_pk_bf16_f32 v178, v116, v117
    v_mfma_f32_32x32x16_bf16 v[144:159], a[204:207], v[72:75], v[144:159]
    ds_read_b64_tr_b16 a[172:173], v23 offset:24576
    v_exp_f32 v118, v118
    v_exp_f32 v119, v119
    v_mfma_f32_32x32x16_bf16 v[160:175], a[204:207], v[76:79], v[160:175]
    ds_read_b64_tr_b16 a[174:175], v23 offset:26624
    v_add_f32 v24, v24, v118
    v_add_f32 v25, v25, v119
    v_cvt_pk_bf16_f32 v179, v118, v119
    v_mfma_f32_32x32x16_bf16 v[144:159], a[208:211], v[80:83], v[144:159]
    ds_read_b64_tr_b16 a[176:177], v20 offset:28672
    v_exp_f32 v120, v120
    v_exp_f32 v121, v121
    v_mfma_f32_32x32x16_bf16 v[160:175], a[208:211], v[84:87], v[160:175]
    ds_read_b64_tr_b16 a[178:179], v20 offset:30720
    v_add_f32 v24, v24, v120
    v_add_f32 v25, v25, v121
    v_cvt_pk_bf16_f32 v180, v120, v121
    v_mfma_f32_32x32x16_bf16 v[144:159], a[212:215], v[88:91], v[144:159]
    ds_read_b64_tr_b16 a[180:181], v21 offset:28672
    v_exp_f32 v122, v122
    v_exp_f32 v123, v123
    v_mfma_f32_32x32x16_bf16 v[160:175], a[212:215], v[92:95], v[160:175]
    ds_read_b64_tr_b16 a[182:183], v21 offset:30720
    v_add_f32 v24, v24, v122
    v_add_f32 v25, v25, v123
    v_cvt_pk_bf16_f32 v181, v122, v123
    v_mfma_f32_32x32x16_bf16 v[144:159], a[216:219], v[96:99], v[144:159]
    ds_read_b64_tr_b16 a[184:185], v22 offset:28672
    v_exp_f32 v124, v124
    v_exp_f32 v125, v125
    v_mfma_f32_32x32x16_bf16 v[160:175], a[216:219], v[100:103], v[160:175]
    ds_read_b64_tr_b16 a[186:187], v22 offset:30720
    v_add_f32 v24, v24, v124
    v_add_f32 v25, v25, v125
    v_cvt_pk_bf16_f32 v182, v124, v125
    v_mfma_f32_32x32x16_bf16 v[144:159], a[220:223], v[104:107], v[144:159]
    ds_read_b64_tr_b16 a[188:189], v23 offset:28672
    v_exp_f32 v126, v126
    v_exp_f32 v127, v127
    v_mfma_f32_32x32x16_bf16 v[160:175], a[220:223], v[108:111], v[160:175]
    ds_read_b64_tr_b16 a[190:191], v23 offset:30720
    v_add_f32 v24, v24, v126
    v_add_f32 v25, v25, v127
    v_cvt_pk_bf16_f32 v183, v126, v127
    s_waitcnt lgkmcnt(12)
    v_mfma_f32_32x32x16_bf16 a[0:15], a[160:163], v[192:195], a[0:15]
    ds_read_b128 a[128:131], v12 offset:49152
    v_exp_f32 v128, v128
    v_exp_f32 v129, v129
    v_mfma_f32_32x32x16_bf16 a[16:31], a[160:163], v[200:203], a[16:31]
    ds_read_b128 a[132:135], v13 offset:49152
    v_add_f32 v26, v26, v128
    v_add_f32 v27, v27, v129
    v_cvt_pk_bf16_f32 v184, v128, v129
    v_mfma_f32_32x32x16_bf16 a[32:47], a[164:167], v[192:195], a[32:47]
    ds_read_b128 a[136:139], v14 offset:49152
    v_exp_f32 v130, v130
    v_exp_f32 v131, v131
    v_mfma_f32_32x32x16_bf16 a[48:63], a[164:167], v[200:203], a[48:63]
    ds_read_b128 a[140:143], v15 offset:49152
    v_add_f32 v26, v26, v130
    v_add_f32 v27, v27, v131
    v_cvt_pk_bf16_f32 v185, v130, v131
    s_waitcnt lgkmcnt(12)
    v_mfma_f32_32x32x16_bf16 a[64:79], a[168:171], v[192:195], a[64:79]
    ds_read_b128 a[144:147], v16 offset:49152
    v_exp_f32 v132, v132
    v_exp_f32 v133, v133
    v_mfma_f32_32x32x16_bf16 a[80:95], a[168:171], v[200:203], a[80:95]
    ds_read_b128 a[148:151], v17 offset:49152
    v_add_f32 v26, v26, v132
    v_add_f32 v27, v27, v133
    v_cvt_pk_bf16_f32 v186, v132, v133
    v_mfma_f32_32x32x16_bf16 a[96:111], a[172:175], v[192:195], a[96:111]
    ds_read_b128 a[152:155], v18 offset:49152
    v_exp_f32 v134, v134
    v_exp_f32 v135, v135
    v_mfma_f32_32x32x16_bf16 a[112:127], a[172:175], v[200:203], a[112:127]
    ds_read_b128 a[156:159], v19 offset:49152
    v_add_f32 v26, v26, v134
    v_add_f32 v27, v27, v135
    v_cvt_pk_bf16_f32 v187, v134, v135
    s_waitcnt lgkmcnt(12)
    v_mfma_f32_32x32x16_bf16 a[0:15], a[176:179], v[196:199], a[0:15]
    v_exp_f32 v136, v136
    v_exp_f32 v137, v137
    v_mfma_f32_32x32x16_bf16 a[16:31], a[176:179], v[204:207], a[16:31]
    v_add_f32 v26, v26, v136
    v_add_f32 v27, v27, v137
    v_cvt_pk_bf16_f32 v188, v136, v137
    v_mfma_f32_32x32x16_bf16 a[32:47], a[180:183], v[196:199], a[32:47]
    v_exp_f32 v138, v138
    v_exp_f32 v139, v139
    v_mfma_f32_32x32x16_bf16 a[48:63], a[180:183], v[204:207], a[48:63]
    v_add_f32 v26, v26, v138
    v_add_f32 v27, v27, v139
    v_cvt_pk_bf16_f32 v189, v138, v139
    s_waitcnt lgkmcnt(8)
    v_mfma_f32_32x32x16_bf16 a[64:79], a[184:187], v[196:199], a[64:79]
    v_exp_f32 v140, v140
    v_exp_f32 v141, v141
    v_mfma_f32_32x32x16_bf16 a[80:95], a[184:187], v[204:207], a[80:95]
    v_add_f32 v26, v26, v140
    v_add_f32 v27, v27, v141
    v_cvt_pk_bf16_f32 v190, v140, v141
    v_mfma_f32_32x32x16_bf16 a[96:111], a[188:191], v[196:199], a[96:111]
    v_exp_f32 v142, v142
    v_exp_f32 v143, v143
    v_mfma_f32_32x32x16_bf16 a[112:127], a[188:191], v[204:207], a[112:127]
    v_add_f32 v26, v26, v142
    v_add_f32 v27, v27, v143
    v_cvt_pk_bf16_f32 v191, v142, v143
    s_waitcnt lgkmcnt(4)
    v_mfma_f32_32x32x16_bf16 v[112:127], a[128:131], v[48:51], v[208:223]
    ds_read_b64_tr_b16 a[160:161], v20 offset:32768
    v_exp_f32 v144, v144
    v_exp_f32 v145, v145
    v_mfma_f32_32x32x16_bf16 v[128:143], a[128:131], v[52:55], v[224:239]
    ds_read_b64_tr_b16 a[162:163], v20 offset:34816
    v_add_f32 v24, v24, v144
    v_add_f32 v25, v25, v145
    v_cvt_pk_bf16_f32 v192, v144, v145
    v_mfma_f32_32x32x16_bf16 v[112:127], a[132:135], v[56:59], v[112:127]
    ds_read_b64_tr_b16 a[164:165], v21 offset:32768
    buffer_store_dwordx4 a[224:227], v1, s[48:51], s77 offen offset:0 sc1
    v_exp_f32 v146, v146
    v_exp_f32 v147, v147
    v_mfma_f32_32x32x16_bf16 v[128:143], a[132:135], v[60:63], v[128:143]
    ds_read_b64_tr_b16 a[166:167], v21 offset:34816
    buffer_store_dwordx4 a[228:231], v1, s[48:51], s77 offen offset:1024 sc1
    v_add_f32 v24, v24, v146
    v_add_f32 v25, v25, v147
    v_cvt_pk_bf16_f32 v193, v146, v147
    v_mfma_f32_32x32x16_bf16 v[112:127], a[136:139], v[64:67], v[112:127]
    ds_read_b64_tr_b16 a[168:169], v22 offset:32768
    buffer_store_dwordx4 a[232:235], v1, s[48:51], s77 offen offset:2048 sc1
    v_exp_f32 v148, v148
    v_exp_f32 v149, v149
    v_mfma_f32_32x32x16_bf16 v[128:143], a[136:139], v[68:71], v[128:143]
    ds_read_b64_tr_b16 a[170:171], v22 offset:34816
    buffer_store_dwordx4 a[236:239], v1, s[48:51], s77 offen offset:3072 sc1
    v_add_f32 v24, v24, v148
    v_add_f32 v25, v25, v149
    v_cvt_pk_bf16_f32 v194, v148, v149
    v_mfma_f32_32x32x16_bf16 v[112:127], a[140:143], v[72:75], v[112:127]
    ds_read_b64_tr_b16 a[172:173], v23 offset:32768
    buffer_store_dwordx4 a[240:243], v1, s[48:51], s78 offen sc1
    v_exp_f32 v150, v150
    v_exp_f32 v151, v151
    v_mfma_f32_32x32x16_bf16 v[128:143], a[140:143], v[76:79], v[128:143]
    ds_read_b64_tr_b16 a[174:175], v23 offset:34816
    buffer_store_dwordx4 a[244:247], v1, s[48:51], s79 offen offset:1024 sc1
    v_add_f32 v24, v24, v150
    v_add_f32 v25, v25, v151
    v_cvt_pk_bf16_f32 v195, v150, v151
    s_waitcnt lgkmcnt(8)
    v_mfma_f32_32x32x16_bf16 v[112:127], a[144:147], v[80:83], v[112:127]
    ds_read_b64_tr_b16 a[176:177], v20 offset:36864
    buffer_store_dwordx4 a[248:251], v1, s[48:51], s79 offen offset:2048 sc1
    v_exp_f32 v152, v152
    v_exp_f32 v153, v153
    v_mfma_f32_32x32x16_bf16 v[128:143], a[144:147], v[84:87], v[128:143]
    ds_read_b64_tr_b16 a[178:179], v20 offset:38912
    v_add_f32 v24, v24, v152
    v_add_f32 v25, v25, v153
    v_cvt_pk_bf16_f32 v196, v152, v153
    v_mfma_f32_32x32x16_bf16 v[112:127], a[148:151], v[88:91], v[112:127]
    ds_read_b64_tr_b16 a[180:181], v21 offset:36864
    v_exp_f32 v154, v154
    v_exp_f32 v155, v155
    v_mfma_f32_32x32x16_bf16 v[128:143], a[148:151], v[92:95], v[128:143]
    ds_read_b64_tr_b16 a[182:183], v21 offset:38912
    v_add_f32 v24, v24, v154
    v_add_f32 v25, v25, v155
    v_cvt_pk_bf16_f32 v197, v154, v155
    v_mfma_f32_32x32x16_bf16 v[112:127], a[152:155], v[96:99], v[112:127]
    ds_read_b64_tr_b16 a[184:185], v22 offset:36864
    v_exp_f32 v156, v156
    v_exp_f32 v157, v157
    v_mfma_f32_32x32x16_bf16 v[128:143], a[152:155], v[100:103], v[128:143]
    ds_read_b64_tr_b16 a[186:187], v22 offset:38912
    v_add_f32 v24, v24, v156
    v_add_f32 v25, v25, v157
    v_cvt_pk_bf16_f32 v198, v156, v157
    v_mfma_f32_32x32x16_bf16 v[112:127], a[156:159], v[104:107], v[112:127]
    ds_read_b64_tr_b16 a[188:189], v23 offset:36864
    v_exp_f32 v158, v158
    v_exp_f32 v159, v159
    v_mfma_f32_32x32x16_bf16 v[128:143], a[156:159], v[108:111], v[128:143]
    ds_read_b64_tr_b16 a[190:191], v23 offset:38912
    v_add_f32 v24, v24, v158
    v_add_f32 v25, v25, v159
    v_cvt_pk_bf16_f32 v199, v158, v159
    s_waitcnt lgkmcnt(12)
    v_mfma_f32_32x32x16_bf16 a[0:15], a[160:163], v[176:179], a[0:15]
    ds_read_b128 a[192:195], v12 offset:57344
    v_exp_f32 v160, v160
    v_exp_f32 v161, v161
    v_mfma_f32_32x32x16_bf16 a[16:31], a[160:163], v[184:187], a[16:31]
    ds_read_b128 a[196:199], v13 offset:57344
    v_add_f32 v26, v26, v160
    v_add_f32 v27, v27, v161
    v_cvt_pk_bf16_f32 v200, v160, v161
    v_mfma_f32_32x32x16_bf16 a[32:47], a[164:167], v[176:179], a[32:47]
    ds_read_b128 a[200:203], v14 offset:57344
    v_exp_f32 v162, v162
    v_exp_f32 v163, v163
    v_mfma_f32_32x32x16_bf16 a[48:63], a[164:167], v[184:187], a[48:63]
    ds_read_b128 a[204:207], v15 offset:57344
    v_add_f32 v26, v26, v162
    v_add_f32 v27, v27, v163
    v_cvt_pk_bf16_f32 v201, v162, v163
    s_waitcnt lgkmcnt(12)
    v_mfma_f32_32x32x16_bf16 a[64:79], a[168:171], v[176:179], a[64:79]
    ds_read_b128 a[208:211], v16 offset:57344
    v_exp_f32 v164, v164
    v_exp_f32 v165, v165
    v_mfma_f32_32x32x16_bf16 a[80:95], a[168:171], v[184:187], a[80:95]
    ds_read_b128 a[212:215], v17 offset:57344
    v_add_f32 v26, v26, v164
    v_add_f32 v27, v27, v165
    v_cvt_pk_bf16_f32 v202, v164, v165
    v_mfma_f32_32x32x16_bf16 a[96:111], a[172:175], v[176:179], a[96:111]
    ds_read_b128 a[216:219], v18 offset:57344
    v_exp_f32 v166, v166
    v_exp_f32 v167, v167
    v_mfma_f32_32x32x16_bf16 a[112:127], a[172:175], v[184:187], a[112:127]
    ds_read_b128 a[220:223], v19 offset:57344
    v_add_f32 v26, v26, v166
    v_add_f32 v27, v27, v167
    v_cvt_pk_bf16_f32 v203, v166, v167
    s_waitcnt lgkmcnt(12)
    v_mfma_f32_32x32x16_bf16 a[0:15], a[176:179], v[180:183], a[0:15]
    v_exp_f32 v168, v168
    v_exp_f32 v169, v169
    v_mfma_f32_32x32x16_bf16 a[16:31], a[176:179], v[188:191], a[16:31]
    v_add_f32 v26, v26, v168
    v_add_f32 v27, v27, v169
    v_cvt_pk_bf16_f32 v204, v168, v169
    v_mfma_f32_32x32x16_bf16 a[32:47], a[180:183], v[180:183], a[32:47]
    v_exp_f32 v170, v170
    v_exp_f32 v171, v171
    v_mfma_f32_32x32x16_bf16 a[48:63], a[180:183], v[188:191], a[48:63]
    v_add_f32 v26, v26, v170
    v_add_f32 v27, v27, v171
    v_cvt_pk_bf16_f32 v205, v170, v171
    s_waitcnt lgkmcnt(8)
    v_mfma_f32_32x32x16_bf16 a[64:79], a[184:187], v[180:183], a[64:79]
    v_exp_f32 v172, v172
    v_exp_f32 v173, v173
    v_mfma_f32_32x32x16_bf16 a[80:95], a[184:187], v[188:191], a[80:95]
    v_add_f32 v26, v26, v172
    v_add_f32 v27, v27, v173
    v_cvt_pk_bf16_f32 v206, v172, v173
    v_mfma_f32_32x32x16_bf16 a[96:111], a[188:191], v[180:183], a[96:111]
    v_exp_f32 v174, v174
    v_exp_f32 v175, v175
    v_mfma_f32_32x32x16_bf16 a[112:127], a[188:191], v[188:191], a[112:127]
    v_add_f32 v26, v26, v174
    v_add_f32 v27, v27, v175
    v_cvt_pk_bf16_f32 v207, v174, v175
    s_waitcnt lgkmcnt(0)
    s_waitcnt vmcnt(7)
    s_barrier
    v_mfma_f32_32x32x16_bf16 v[144:159], a[192:195], v[48:51], v[208:223]
    ds_read_b64_tr_b16 a[160:161], v20 offset:40960
    v_exp_f32 v112, v112
    v_exp_f32 v113, v113
    v_mfma_f32_32x32x16_bf16 v[160:175], a[192:195], v[52:55], v[224:239]
    ds_read_b64_tr_b16 a[162:163], v20 offset:43008
    s_getpc_b64 s[42:43]
ka_kernel_pc_1:
    s_add_u32 s42, s42, kb_kernel-ka_kernel_pc_1
    s_addc_u32 s43, s43, 0
    s_lshr_b32 s41, s2, 3
    s_lshl_b32 s41, s41, 2
    s_add_u32 s41, s41, s32
    s_lshl_b32 s41, s41, 10
    s_min_u32 s41, s41, code_end-kb_kernel-1024
    s_add_u32 s42, s42, s41
    s_addc_u32 s43, s43, 0
    v_add_f32 v24, v24, v112
    v_add_f32 v25, v25, v113
    v_cvt_pk_bf16_f32 v176, v112, v113
    v_mfma_f32_32x32x16_bf16 v[144:159], a[196:199], v[56:59], v[144:159]
    ds_read_b64_tr_b16 a[164:165], v21 offset:40960
    global_load_dwordx4 v[240:243], v1, s[42:43]
    v_exp_f32 v114, v114
    v_exp_f32 v115, v115
    v_mfma_f32_32x32x16_bf16 v[160:175], a[196:199], v[60:63], v[160:175]
    ds_read_b64_tr_b16 a[166:167], v21 offset:43008
    v_add_f32 v24, v24, v114
    v_add_f32 v25, v25, v115
    v_cvt_pk_bf16_f32 v177, v114, v115
    v_mfma_f32_32x32x16_bf16 v[144:159], a[200:203], v[64:67], v[144:159]
    ds_read_b64_tr_b16 a[168:169], v22 offset:40960
    v_exp_f32 v116, v116
    v_exp_f32 v117, v117
    v_mfma_f32_32x32x16_bf16 v[160:175], a[200:203], v[68:71], v[160:175]
    ds_read_b64_tr_b16 a[170:171], v22 offset:43008
    v_add_f32 v24, v24, v116
    v_add_f32 v25, v25, v117
    v_cvt_pk_bf16_f32 v178, v116, v117
    v_mfma_f32_32x32x16_bf16 v[144:159], a[204:207], v[72:75], v[144:159]
    ds_read_b64_tr_b16 a[172:173], v23 offset:40960
    v_exp_f32 v118, v118
    v_exp_f32 v119, v119
    v_mfma_f32_32x32x16_bf16 v[160:175], a[204:207], v[76:79], v[160:175]
    ds_read_b64_tr_b16 a[174:175], v23 offset:43008
    v_add_f32 v24, v24, v118
    v_add_f32 v25, v25, v119
    v_cvt_pk_bf16_f32 v179, v118, v119
    v_mfma_f32_32x32x16_bf16 v[144:159], a[208:211], v[80:83], v[144:159]
    ds_read_b64_tr_b16 a[176:177], v20 offset:45056
    v_exp_f32 v120, v120
    v_exp_f32 v121, v121
    v_mfma_f32_32x32x16_bf16 v[160:175], a[208:211], v[84:87], v[160:175]
    ds_read_b64_tr_b16 a[178:179], v20 offset:47104
    v_add_f32 v24, v24, v120
    v_add_f32 v25, v25, v121
    v_cvt_pk_bf16_f32 v180, v120, v121
    v_mfma_f32_32x32x16_bf16 v[144:159], a[212:215], v[88:91], v[144:159]
    ds_read_b64_tr_b16 a[180:181], v21 offset:45056
    v_exp_f32 v122, v122
    v_exp_f32 v123, v123
    v_mfma_f32_32x32x16_bf16 v[160:175], a[212:215], v[92:95], v[160:175]
    ds_read_b64_tr_b16 a[182:183], v21 offset:47104
    v_add_f32 v24, v24, v122
    v_add_f32 v25, v25, v123
    v_cvt_pk_bf16_f32 v181, v122, v123
    v_mfma_f32_32x32x16_bf16 v[144:159], a[216:219], v[96:99], v[144:159]
    ds_read_b64_tr_b16 a[184:185], v22 offset:45056
    v_exp_f32 v124, v124
    v_exp_f32 v125, v125
    v_mfma_f32_32x32x16_bf16 v[160:175], a[216:219], v[100:103], v[160:175]
    ds_read_b64_tr_b16 a[186:187], v22 offset:47104
    v_add_f32 v24, v24, v124
    v_add_f32 v25, v25, v125
    v_cvt_pk_bf16_f32 v182, v124, v125
    v_mfma_f32_32x32x16_bf16 v[144:159], a[220:223], v[104:107], v[144:159]
    ds_read_b64_tr_b16 a[188:189], v23 offset:45056
    v_exp_f32 v126, v126
    v_exp_f32 v127, v127
    v_mfma_f32_32x32x16_bf16 v[160:175], a[220:223], v[108:111], v[160:175]
    ds_read_b64_tr_b16 a[190:191], v23 offset:47104
    v_add_f32 v24, v24, v126
    v_add_f32 v25, v25, v127
    v_cvt_pk_bf16_f32 v183, v126, v127
    s_waitcnt lgkmcnt(12)
    v_mfma_f32_32x32x16_bf16 a[0:15], a[160:163], v[192:195], a[0:15]
    v_exp_f32 v128, v128
    v_exp_f32 v129, v129
    v_mfma_f32_32x32x16_bf16 a[16:31], a[160:163], v[200:203], a[16:31]
    v_add_f32 v26, v26, v128
    v_add_f32 v27, v27, v129
    v_cvt_pk_bf16_f32 v184, v128, v129
    v_mfma_f32_32x32x16_bf16 a[32:47], a[164:167], v[192:195], a[32:47]
    v_exp_f32 v130, v130
    v_exp_f32 v131, v131
    v_mfma_f32_32x32x16_bf16 a[48:63], a[164:167], v[200:203], a[48:63]
    v_add_f32 v26, v26, v130
    v_add_f32 v27, v27, v131
    v_cvt_pk_bf16_f32 v185, v130, v131
    s_waitcnt lgkmcnt(8)
    v_mfma_f32_32x32x16_bf16 a[64:79], a[168:171], v[192:195], a[64:79]
    v_exp_f32 v132, v132
    v_exp_f32 v133, v133
    v_mfma_f32_32x32x16_bf16 a[80:95], a[168:171], v[200:203], a[80:95]
    v_add_f32 v26, v26, v132
    v_add_f32 v27, v27, v133
    v_cvt_pk_bf16_f32 v186, v132, v133
    v_mfma_f32_32x32x16_bf16 a[96:111], a[172:175], v[192:195], a[96:111]
    v_exp_f32 v134, v134
    v_exp_f32 v135, v135
    v_mfma_f32_32x32x16_bf16 a[112:127], a[172:175], v[200:203], a[112:127]
    v_add_f32 v26, v26, v134
    v_add_f32 v27, v27, v135
    v_cvt_pk_bf16_f32 v187, v134, v135
    s_waitcnt lgkmcnt(4)
    v_mfma_f32_32x32x16_bf16 a[0:15], a[176:179], v[196:199], a[0:15]
    v_exp_f32 v136, v136
    v_exp_f32 v137, v137
    v_mfma_f32_32x32x16_bf16 a[16:31], a[176:179], v[204:207], a[16:31]
    v_add_f32 v26, v26, v136
    v_add_f32 v27, v27, v137
    v_cvt_pk_bf16_f32 v188, v136, v137
    v_mfma_f32_32x32x16_bf16 a[32:47], a[180:183], v[196:199], a[32:47]
    v_exp_f32 v138, v138
    v_exp_f32 v139, v139
    v_mfma_f32_32x32x16_bf16 a[48:63], a[180:183], v[204:207], a[48:63]
    v_add_f32 v26, v26, v138
    v_add_f32 v27, v27, v139
    v_cvt_pk_bf16_f32 v189, v138, v139
    s_waitcnt lgkmcnt(0)
    v_mfma_f32_32x32x16_bf16 a[64:79], a[184:187], v[196:199], a[64:79]
    v_exp_f32 v140, v140
    v_exp_f32 v141, v141
    v_mfma_f32_32x32x16_bf16 a[80:95], a[184:187], v[204:207], a[80:95]
    v_add_f32 v26, v26, v140
    v_add_f32 v27, v27, v141
    v_cvt_pk_bf16_f32 v190, v140, v141
    v_mfma_f32_32x32x16_bf16 a[96:111], a[188:191], v[196:199], a[96:111]
    v_exp_f32 v142, v142
    v_exp_f32 v143, v143
    v_mfma_f32_32x32x16_bf16 a[112:127], a[188:191], v[204:207], a[112:127]
    v_add_f32 v26, v26, v142
    v_add_f32 v27, v27, v143
    v_cvt_pk_bf16_f32 v191, v142, v143
    ds_read_b64_tr_b16 a[160:161], v20 offset:49152
    ds_read_b64_tr_b16 a[162:163], v20 offset:51200
    ds_read_b64_tr_b16 a[164:165], v21 offset:49152
    ds_read_b64_tr_b16 a[166:167], v21 offset:51200
    ds_read_b64_tr_b16 a[168:169], v22 offset:49152
    ds_read_b64_tr_b16 a[170:171], v22 offset:51200
    ds_read_b64_tr_b16 a[172:173], v23 offset:49152
    ds_read_b64_tr_b16 a[174:175], v23 offset:51200
    s_waitcnt lgkmcnt(4)
    v_mfma_f32_32x32x16_bf16 a[0:15], a[160:163], v[176:179], a[0:15]
    ds_read_b64_tr_b16 a[176:177], v20 offset:53248
    v_exp_f32 v144, v144
    v_exp_f32 v145, v145
    v_add_f32 v24, v24, v144
    v_add_f32 v25, v25, v145
    v_cvt_pk_bf16_f32 v192, v144, v145
    v_mfma_f32_32x32x16_bf16 a[16:31], a[160:163], v[184:187], a[16:31]
    ds_read_b64_tr_b16 a[178:179], v20 offset:55296
    v_exp_f32 v146, v146
    v_exp_f32 v147, v147
    v_add_f32 v24, v24, v146
    v_add_f32 v25, v25, v147
    v_cvt_pk_bf16_f32 v193, v146, v147
    v_mfma_f32_32x32x16_bf16 a[32:47], a[164:167], v[176:179], a[32:47]
    ds_read_b64_tr_b16 a[180:181], v21 offset:53248
    v_exp_f32 v148, v148
    v_exp_f32 v149, v149
    v_add_f32 v24, v24, v148
    v_add_f32 v25, v25, v149
    v_cvt_pk_bf16_f32 v194, v148, v149
    v_mfma_f32_32x32x16_bf16 a[48:63], a[164:167], v[184:187], a[48:63]
    ds_read_b64_tr_b16 a[182:183], v21 offset:55296
    v_exp_f32 v150, v150
    v_exp_f32 v151, v151
    v_add_f32 v24, v24, v150
    v_add_f32 v25, v25, v151
    v_cvt_pk_bf16_f32 v195, v150, v151
    s_waitcnt lgkmcnt(4)
    v_mfma_f32_32x32x16_bf16 a[64:79], a[168:171], v[176:179], a[64:79]
    ds_read_b64_tr_b16 a[184:185], v22 offset:53248
    v_exp_f32 v152, v152
    v_exp_f32 v153, v153
    v_add_f32 v24, v24, v152
    v_add_f32 v25, v25, v153
    v_cvt_pk_bf16_f32 v196, v152, v153
    v_mfma_f32_32x32x16_bf16 a[80:95], a[168:171], v[184:187], a[80:95]
    ds_read_b64_tr_b16 a[186:187], v22 offset:55296
    v_exp_f32 v154, v154
    v_exp_f32 v155, v155
    v_add_f32 v24, v24, v154
    v_add_f32 v25, v25, v155
    v_cvt_pk_bf16_f32 v197, v154, v155
    v_mfma_f32_32x32x16_bf16 a[96:111], a[172:175], v[176:179], a[96:111]
    ds_read_b64_tr_b16 a[188:189], v23 offset:53248
    v_exp_f32 v156, v156
    v_exp_f32 v157, v157
    v_add_f32 v24, v24, v156
    v_add_f32 v25, v25, v157
    v_cvt_pk_bf16_f32 v198, v156, v157
    v_mfma_f32_32x32x16_bf16 a[112:127], a[172:175], v[184:187], a[112:127]
    ds_read_b64_tr_b16 a[190:191], v23 offset:55296
    v_exp_f32 v158, v158
    v_exp_f32 v159, v159
    v_add_f32 v24, v24, v158
    v_add_f32 v25, v25, v159
    v_cvt_pk_bf16_f32 v199, v158, v159
    s_waitcnt lgkmcnt(4)
    v_mfma_f32_32x32x16_bf16 a[0:15], a[176:179], v[180:183], a[0:15]
    v_exp_f32 v160, v160
    v_exp_f32 v161, v161
    v_add_f32 v26, v26, v160
    v_add_f32 v27, v27, v161
    v_cvt_pk_bf16_f32 v200, v160, v161
    v_mfma_f32_32x32x16_bf16 a[16:31], a[176:179], v[188:191], a[16:31]
    v_exp_f32 v162, v162
    v_exp_f32 v163, v163
    v_add_f32 v26, v26, v162
    v_add_f32 v27, v27, v163
    v_cvt_pk_bf16_f32 v201, v162, v163
    v_mfma_f32_32x32x16_bf16 a[32:47], a[180:183], v[180:183], a[32:47]
    v_exp_f32 v164, v164
    v_exp_f32 v165, v165
    v_add_f32 v26, v26, v164
    v_add_f32 v27, v27, v165
    v_cvt_pk_bf16_f32 v202, v164, v165
    v_mfma_f32_32x32x16_bf16 a[48:63], a[180:183], v[188:191], a[48:63]
    v_exp_f32 v166, v166
    v_exp_f32 v167, v167
    v_add_f32 v26, v26, v166
    v_add_f32 v27, v27, v167
    v_cvt_pk_bf16_f32 v203, v166, v167
    s_waitcnt lgkmcnt(0)
    v_mfma_f32_32x32x16_bf16 a[64:79], a[184:187], v[180:183], a[64:79]
    v_exp_f32 v168, v168
    v_exp_f32 v169, v169
    v_add_f32 v26, v26, v168
    v_add_f32 v27, v27, v169
    v_cvt_pk_bf16_f32 v204, v168, v169
    v_mfma_f32_32x32x16_bf16 a[80:95], a[184:187], v[188:191], a[80:95]
    v_exp_f32 v170, v170
    v_exp_f32 v171, v171
    v_add_f32 v26, v26, v170
    v_add_f32 v27, v27, v171
    v_cvt_pk_bf16_f32 v205, v170, v171
    v_mfma_f32_32x32x16_bf16 a[96:111], a[188:191], v[180:183], a[96:111]
    v_exp_f32 v172, v172
    v_exp_f32 v173, v173
    v_add_f32 v26, v26, v172
    v_add_f32 v27, v27, v173
    v_cvt_pk_bf16_f32 v206, v172, v173
    v_mfma_f32_32x32x16_bf16 a[112:127], a[188:191], v[188:191], a[112:127]
    v_exp_f32 v174, v174
    v_exp_f32 v175, v175
    v_add_f32 v26, v26, v174
    v_add_f32 v27, v27, v175
    v_cvt_pk_bf16_f32 v207, v174, v175
    ds_read_b64_tr_b16 a[160:161], v20 offset:57344
    ds_read_b64_tr_b16 a[162:163], v20 offset:59392
    ds_read_b64_tr_b16 a[164:165], v21 offset:57344
    ds_read_b64_tr_b16 a[166:167], v21 offset:59392
    ds_read_b64_tr_b16 a[168:169], v22 offset:57344
    ds_read_b64_tr_b16 a[170:171], v22 offset:59392
    ds_read_b64_tr_b16 a[172:173], v23 offset:57344
    ds_read_b64_tr_b16 a[174:175], v23 offset:59392
    s_waitcnt lgkmcnt(4)
    v_mfma_f32_32x32x16_bf16 a[0:15], a[160:163], v[192:195], a[0:15]
    ds_read_b64_tr_b16 a[176:177], v20 offset:61440
    v_mfma_f32_32x32x16_bf16 a[16:31], a[160:163], v[200:203], a[16:31]
    ds_read_b64_tr_b16 a[178:179], v20 offset:63488
    v_mfma_f32_32x32x16_bf16 a[32:47], a[164:167], v[192:195], a[32:47]
    ds_read_b64_tr_b16 a[180:181], v21 offset:61440
    v_add_f32 v24, v24, v25
    v_add_f32 v26, v26, v27
    v_mov_b32 v25, v24
    v_mov_b32 v27, v26
    v_mfma_f32_32x32x16_bf16 a[48:63], a[164:167], v[200:203], a[48:63]
    ds_read_b64_tr_b16 a[182:183], v21 offset:63488
    v_permlane32_swap_b32 v24, v25
    v_permlane32_swap_b32 v26, v27
    s_waitcnt lgkmcnt(4)
    v_mfma_f32_32x32x16_bf16 a[64:79], a[168:171], v[192:195], a[64:79]
    ds_read_b64_tr_b16 a[184:185], v22 offset:61440
    v_add_f32 v24, v24, v25
    v_add_f32 v26, v26, v27
    v_rcp_f32 v32, v24
    v_rcp_f32 v34, v26
    v_mfma_f32_32x32x16_bf16 a[80:95], a[168:171], v[200:203], a[80:95]
    ds_read_b64_tr_b16 a[186:187], v22 offset:63488
    v_mfma_f32_32x32x16_bf16 a[96:111], a[172:175], v[192:195], a[96:111]
    ds_read_b64_tr_b16 a[188:189], v23 offset:61440
    v_mfma_f32_32x32x16_bf16 a[112:127], a[172:175], v[200:203], a[112:127]
    ds_read_b64_tr_b16 a[190:191], v23 offset:63488
    s_waitcnt lgkmcnt(4)
    v_mfma_f32_32x32x16_bf16 a[0:15], a[176:179], v[196:199], a[0:15]
    v_mfma_f32_32x32x16_bf16 a[16:31], a[176:179], v[204:207], a[16:31]
    v_mfma_f32_32x32x16_bf16 a[32:47], a[180:183], v[196:199], a[32:47]
    v_mfma_f32_32x32x16_bf16 a[48:63], a[180:183], v[204:207], a[48:63]
    s_waitcnt lgkmcnt(0)
    v_mfma_f32_32x32x16_bf16 a[64:79], a[184:187], v[196:199], a[64:79]
    v_mfma_f32_32x32x16_bf16 a[80:95], a[184:187], v[204:207], a[80:95]
    v_mfma_f32_32x32x16_bf16 a[96:111], a[188:191], v[196:199], a[96:111]
    v_mfma_f32_32x32x16_bf16 a[112:127], a[188:191], v[204:207], a[112:127]
    v_mov_b32 v36, 0x4e800000
    v_cmp_gt_f32 vcc, v36, v24
    v_cmp_gt_f32 s[42:43], v36, v26
    s_nop 1
    s_and_b64 vcc, vcc, s[42:43]
    s_cmp_eq_u64 vcc, -1
    s_cbranch_scc0 ka_fallback
ka_epi:
    s_lshl_b32 s41, s34, 4
    s_lshl_b32 s42, s32, 2
    s_add_u32 s41, s41, s42
    s_lshl_b32 s41, s41, 17
    s_lshl_b32 s42, s33, 12
    s_add_u32 s40, s41, s42
    s_add_u32 s41, s40, 262144
    v_accvgpr_read_b32 v112, a0
    v_accvgpr_read_b32 v113, a1
    v_accvgpr_read_b32 v114, a2
    v_accvgpr_read_b32 v115, a3
    v_accvgpr_read_b32 v116, a4
    v_accvgpr_read_b32 v117, a5
    v_accvgpr_read_b32 v118, a6
    v_accvgpr_read_b32 v119, a7
    v_accvgpr_read_b32 v120, a8
    v_accvgpr_read_b32 v121, a9
    v_accvgpr_read_b32 v122, a10
    v_accvgpr_read_b32 v123, a11
    v_accvgpr_read_b32 v124, a12
    v_accvgpr_read_b32 v125, a13
    v_accvgpr_read_b32 v126, a14
    v_accvgpr_read_b32 v127, a15
    v_pk_mul_f32 v[112:113], v[112:113], v[32:33] op_sel_hi:[1,0]
    v_pk_mul_f32 v[114:115], v[114:115], v[32:33] op_sel_hi:[1,0]
    v_pk_mul_f32 v[116:117], v[116:117], v[32:33] op_sel_hi:[1,0]
    v_pk_mul_f32 v[118:119], v[118:119], v[32:33] op_sel_hi:[1,0]
    v_pk_mul_f32 v[120:121], v[120:121], v[32:33] op_sel_hi:[1,0]
    v_pk_mul_f32 v[122:123], v[122:123], v[32:33] op_sel_hi:[1,0]
    v_pk_mul_f32 v[124:125], v[124:125], v[32:33] op_sel_hi:[1,0]
    v_pk_mul_f32 v[126:127], v[126:127], v[32:33] op_sel_hi:[1,0]
    v_cvt_pk_bf16_f32 v176, v112, v113
    v_cvt_pk_bf16_f32 v177, v114, v115
    v_cvt_pk_bf16_f32 v178, v116, v117
    v_cvt_pk_bf16_f32 v179, v118, v119
    v_cvt_pk_bf16_f32 v180, v120, v121
    v_cvt_pk_bf16_f32 v181, v122, v123
    v_cvt_pk_bf16_f32 v182, v124, v125
    v_cvt_pk_bf16_f32 v183, v126, v127
    buffer_store_dwordx4 v[176:179], v28, s[28:31], s40 offen offset:0 sc1
    buffer_store_dwordx4 v[180:183], v28, s[28:31], s40 offen offset:512 sc1
    v_accvgpr_read_b32 v128, a16
    v_accvgpr_read_b32 v129, a17
    v_accvgpr_read_b32 v130, a18
    v_accvgpr_read_b32 v131, a19
    v_accvgpr_read_b32 v132, a20
    v_accvgpr_read_b32 v133, a21
    v_accvgpr_read_b32 v134, a22
    v_accvgpr_read_b32 v135, a23
    v_accvgpr_read_b32 v136, a24
    v_accvgpr_read_b32 v137, a25
    v_accvgpr_read_b32 v138, a26
    v_accvgpr_read_b32 v139, a27
    v_accvgpr_read_b32 v140, a28
    v_accvgpr_read_b32 v141, a29
    v_accvgpr_read_b32 v142, a30
    v_accvgpr_read_b32 v143, a31
    v_pk_mul_f32 v[128:129], v[128:129], v[34:35] op_sel_hi:[1,0]
    v_pk_mul_f32 v[130:131], v[130:131], v[34:35] op_sel_hi:[1,0]
    v_pk_mul_f32 v[132:133], v[132:133], v[34:35] op_sel_hi:[1,0]
    v_pk_mul_f32 v[134:135], v[134:135], v[34:35] op_sel_hi:[1,0]
    v_pk_mul_f32 v[136:137], v[136:137], v[34:35] op_sel_hi:[1,0]
    v_pk_mul_f32 v[138:139], v[138:139], v[34:35] op_sel_hi:[1,0]
    v_pk_mul_f32 v[140:141], v[140:141], v[34:35] op_sel_hi:[1,0]
    v_pk_mul_f32 v[142:143], v[142:143], v[34:35] op_sel_hi:[1,0]
    v_cvt_pk_bf16_f32 v184, v128, v129
    v_cvt_pk_bf16_f32 v185, v130, v131
    v_cvt_pk_bf16_f32 v186, v132, v133
    v_cvt_pk_bf16_f32 v187, v134, v135
    v_cvt_pk_bf16_f32 v188, v136, v137
    v_cvt_pk_bf16_f32 v189, v138, v139
    v_cvt_pk_bf16_f32 v190, v140, v141
    v_cvt_pk_bf16_f32 v191, v142, v143
    buffer_store_dwordx4 v[184:187], v28, s[28:31], s41 offen offset:0 sc1
    buffer_store_dwordx4 v[188:191], v28, s[28:31], s41 offen offset:512 sc1
    v_accvgpr_read_b32 v144, a32
    v_accvgpr_read_b32 v145, a33
    v_accvgpr_read_b32 v146, a34
    v_accvgpr_read_b32 v147, a35
    v_accvgpr_read_b32 v148, a36
    v_accvgpr_read_b32 v149, a37
    v_accvgpr_read_b32 v150, a38
    v_accvgpr_read_b32 v151, a39
    v_accvgpr_read_b32 v152, a40
    v_accvgpr_read_b32 v153, a41
    v_accvgpr_read_b32 v154, a42
    v_accvgpr_read_b32 v155, a43
    v_accvgpr_read_b32 v156, a44
    v_accvgpr_read_b32 v157, a45
    v_accvgpr_read_b32 v158, a46
    v_accvgpr_read_b32 v159, a47
    v_pk_mul_f32 v[144:145], v[144:145], v[32:33] op_sel_hi:[1,0]
    v_pk_mul_f32 v[146:147], v[146:147], v[32:33] op_sel_hi:[1,0]
    v_pk_mul_f32 v[148:149], v[148:149], v[32:33] op_sel_hi:[1,0]
    v_pk_mul_f32 v[150:151], v[150:151], v[32:33] op_sel_hi:[1,0]
    v_pk_mul_f32 v[152:153], v[152:153], v[32:33] op_sel_hi:[1,0]
    v_pk_mul_f32 v[154:155], v[154:155], v[32:33] op_sel_hi:[1,0]
    v_pk_mul_f32 v[156:157], v[156:157], v[32:33] op_sel_hi:[1,0]
    v_pk_mul_f32 v[158:159], v[158:159], v[32:33] op_sel_hi:[1,0]
    v_cvt_pk_bf16_f32 v192, v144, v145
    v_cvt_pk_bf16_f32 v193, v146, v147
    v_cvt_pk_bf16_f32 v194, v148, v149
    v_cvt_pk_bf16_f32 v195, v150, v151
    v_cvt_pk_bf16_f32 v196, v152, v153
    v_cvt_pk_bf16_f32 v197, v154, v155
    v_cvt_pk_bf16_f32 v198, v156, v157
    v_cvt_pk_bf16_f32 v199, v158, v159
    buffer_store_dwordx4 v[192:195], v28, s[28:31], s40 offen offset:1024 sc1
    buffer_store_dwordx4 v[196:199], v28, s[28:31], s40 offen offset:1536 sc1
    v_accvgpr_read_b32 v160, a48
    v_accvgpr_read_b32 v161, a49
    v_accvgpr_read_b32 v162, a50
    v_accvgpr_read_b32 v163, a51
    v_accvgpr_read_b32 v164, a52
    v_accvgpr_read_b32 v165, a53
    v_accvgpr_read_b32 v166, a54
    v_accvgpr_read_b32 v167, a55
    v_accvgpr_read_b32 v168, a56
    v_accvgpr_read_b32 v169, a57
    v_accvgpr_read_b32 v170, a58
    v_accvgpr_read_b32 v171, a59
    v_accvgpr_read_b32 v172, a60
    v_accvgpr_read_b32 v173, a61
    v_accvgpr_read_b32 v174, a62
    v_accvgpr_read_b32 v175, a63
    v_pk_mul_f32 v[160:161], v[160:161], v[34:35] op_sel_hi:[1,0]
    v_pk_mul_f32 v[162:163], v[162:163], v[34:35] op_sel_hi:[1,0]
    v_pk_mul_f32 v[164:165], v[164:165], v[34:35] op_sel_hi:[1,0]
    v_pk_mul_f32 v[166:167], v[166:167], v[34:35] op_sel_hi:[1,0]
    v_pk_mul_f32 v[168:169], v[168:169], v[34:35] op_sel_hi:[1,0]
    v_pk_mul_f32 v[170:171], v[170:171], v[34:35] op_sel_hi:[1,0]
    v_pk_mul_f32 v[172:173], v[172:173], v[34:35] op_sel_hi:[1,0]
    v_pk_mul_f32 v[174:175], v[174:175], v[34:35] op_sel_hi:[1,0]
    v_cvt_pk_bf16_f32 v200, v160, v161
    v_cvt_pk_bf16_f32 v201, v162, v163
    v_cvt_pk_bf16_f32 v202, v164, v165
    v_cvt_pk_bf16_f32 v203, v166, v167
    v_cvt_pk_bf16_f32 v204, v168, v169
    v_cvt_pk_bf16_f32 v205, v170, v171
    v_cvt_pk_bf16_f32 v206, v172, v173
    v_cvt_pk_bf16_f32 v207, v174, v175
    buffer_store_dwordx4 v[200:203], v28, s[28:31], s41 offen offset:1024 sc1
    buffer_store_dwordx4 v[204:207], v28, s[28:31], s41 offen offset:1536 sc1
    v_accvgpr_read_b32 v112, a64
    v_accvgpr_read_b32 v113, a65
    v_accvgpr_read_b32 v114, a66
    v_accvgpr_read_b32 v115, a67
    v_accvgpr_read_b32 v116, a68
    v_accvgpr_read_b32 v117, a69
    v_accvgpr_read_b32 v118, a70
    v_accvgpr_read_b32 v119, a71
    v_accvgpr_read_b32 v120, a72
    v_accvgpr_read_b32 v121, a73
    v_accvgpr_read_b32 v122, a74
    v_accvgpr_read_b32 v123, a75
    v_accvgpr_read_b32 v124, a76
    v_accvgpr_read_b32 v125, a77
    v_accvgpr_read_b32 v126, a78
    v_accvgpr_read_b32 v127, a79
    v_pk_mul_f32 v[112:113], v[112:113], v[32:33] op_sel_hi:[1,0]
    v_pk_mul_f32 v[114:115], v[114:115], v[32:33] op_sel_hi:[1,0]
    v_pk_mul_f32 v[116:117], v[116:117], v[32:33] op_sel_hi:[1,0]
    v_pk_mul_f32 v[118:119], v[118:119], v[32:33] op_sel_hi:[1,0]
    v_pk_mul_f32 v[120:121], v[120:121], v[32:33] op_sel_hi:[1,0]
    v_pk_mul_f32 v[122:123], v[122:123], v[32:33] op_sel_hi:[1,0]
    v_pk_mul_f32 v[124:125], v[124:125], v[32:33] op_sel_hi:[1,0]
    v_pk_mul_f32 v[126:127], v[126:127], v[32:33] op_sel_hi:[1,0]
    v_cvt_pk_bf16_f32 v176, v112, v113
    v_cvt_pk_bf16_f32 v177, v114, v115
    v_cvt_pk_bf16_f32 v178, v116, v117
    v_cvt_pk_bf16_f32 v179, v118, v119
    v_cvt_pk_bf16_f32 v180, v120, v121
    v_cvt_pk_bf16_f32 v181, v122, v123
    v_cvt_pk_bf16_f32 v182, v124, v125
    v_cvt_pk_bf16_f32 v183, v126, v127
    buffer_store_dwordx4 v[176:179], v28, s[28:31], s40 offen offset:2048 sc1
    buffer_store_dwordx4 v[180:183], v28, s[28:31], s40 offen offset:2560 sc1
    v_accvgpr_read_b32 v128, a80
    v_accvgpr_read_b32 v129, a81
    v_accvgpr_read_b32 v130, a82
    v_accvgpr_read_b32 v131, a83
    v_accvgpr_read_b32 v132, a84
    v_accvgpr_read_b32 v133, a85
    v_accvgpr_read_b32 v134, a86
    v_accvgpr_read_b32 v135, a87
    v_accvgpr_read_b32 v136, a88
    v_accvgpr_read_b32 v137, a89
    v_accvgpr_read_b32 v138, a90
    v_accvgpr_read_b32 v139, a91
    v_accvgpr_read_b32 v140, a92
    v_accvgpr_read_b32 v141, a93
    v_accvgpr_read_b32 v142, a94
    v_accvgpr_read_b32 v143, a95
    v_pk_mul_f32 v[128:129], v[128:129], v[34:35] op_sel_hi:[1,0]
    v_pk_mul_f32 v[130:131], v[130:131], v[34:35] op_sel_hi:[1,0]
    v_pk_mul_f32 v[132:133], v[132:133], v[34:35] op_sel_hi:[1,0]
    v_pk_mul_f32 v[134:135], v[134:135], v[34:35] op_sel_hi:[1,0]
    v_pk_mul_f32 v[136:137], v[136:137], v[34:35] op_sel_hi:[1,0]
    v_pk_mul_f32 v[138:139], v[138:139], v[34:35] op_sel_hi:[1,0]
    v_pk_mul_f32 v[140:141], v[140:141], v[34:35] op_sel_hi:[1,0]
    v_pk_mul_f32 v[142:143], v[142:143], v[34:35] op_sel_hi:[1,0]
    v_cvt_pk_bf16_f32 v184, v128, v129
    v_cvt_pk_bf16_f32 v185, v130, v131
    v_cvt_pk_bf16_f32 v186, v132, v133
    v_cvt_pk_bf16_f32 v187, v134, v135
    v_cvt_pk_bf16_f32 v188, v136, v137
    v_cvt_pk_bf16_f32 v189, v138, v139
    v_cvt_pk_bf16_f32 v190, v140, v141
    v_cvt_pk_bf16_f32 v191, v142, v143
    buffer_store_dwordx4 v[184:187], v28, s[28:31], s41 offen offset:2048 sc1
    buffer_store_dwordx4 v[188:191], v28, s[28:31], s41 offen offset:2560 sc1
    v_accvgpr_read_b32 v144, a96
    v_accvgpr_read_b32 v145, a97
    v_accvgpr_read_b32 v146, a98
    v_accvgpr_read_b32 v147, a99
    v_accvgpr_read_b32 v148, a100
    v_accvgpr_read_b32 v149, a101
    v_accvgpr_read_b32 v150, a102
    v_accvgpr_read_b32 v151, a103
    v_accvgpr_read_b32 v152, a104
    v_accvgpr_read_b32 v153, a105
    v_accvgpr_read_b32 v154, a106
    v_accvgpr_read_b32 v155, a107
    v_accvgpr_read_b32 v156, a108
    v_accvgpr_read_b32 v157, a109
    v_accvgpr_read_b32 v158, a110
    v_accvgpr_read_b32 v159, a111
    v_pk_mul_f32 v[144:145], v[144:145], v[32:33] op_sel_hi:[1,0]
    v_pk_mul_f32 v[146:147], v[146:147], v[32:33] op_sel_hi:[1,0]
    v_pk_mul_f32 v[148:149], v[148:149], v[32:33] op_sel_hi:[1,0]
    v_pk_mul_f32 v[150:151], v[150:151], v[32:33] op_sel_hi:[1,0]
    v_pk_mul_f32 v[152:153], v[152:153], v[32:33] op_sel_hi:[1,0]
    v_pk_mul_f32 v[154:155], v[154:155], v[32:33] op_sel_hi:[1,0]
    v_pk_mul_f32 v[156:157], v[156:157], v[32:33] op_sel_hi:[1,0]
    v_pk_mul_f32 v[158:159], v[158:159], v[32:33] op_sel_hi:[1,0]
    v_cvt_pk_bf16_f32 v192, v144, v145
    v_cvt_pk_bf16_f32 v193, v146, v147
    v_cvt_pk_bf16_f32 v194, v148, v149
    v_cvt_pk_bf16_f32 v195, v150, v151
    v_cvt_pk_bf16_f32 v196, v152, v153
    v_cvt_pk_bf16_f32 v197, v154, v155
    v_cvt_pk_bf16_f32 v198, v156, v157
    v_cvt_pk_bf16_f32 v199, v158, v159
    buffer_store_dwordx4 v[192:195], v28, s[28:31], s40 offen offset:3072 sc1
    buffer_store_dwordx4 v[196:199], v28, s[28:31], s40 offen offset:3584 sc1
    v_accvgpr_read_b32 v160, a112
    v_accvgpr_read_b32 v161, a113
    v_accvgpr_read_b32 v162, a114
    v_accvgpr_read_b32 v163, a115
    v_accvgpr_read_b32 v164, a116
    v_accvgpr_read_b32 v165, a117
    v_accvgpr_read_b32 v166, a118
    v_accvgpr_read_b32 v167, a119
    v_accvgpr_read_b32 v168, a120
    v_accvgpr_read_b32 v169, a121
    v_accvgpr_read_b32 v170, a122
    v_accvgpr_read_b32 v171, a123
    v_accvgpr_read_b32 v172, a124
    v_accvgpr_read_b32 v173, a125
    v_accvgpr_read_b32 v174, a126
    v_accvgpr_read_b32 v175, a127
    v_pk_mul_f32 v[160:161], v[160:161], v[34:35] op_sel_hi:[1,0]
    v_pk_mul_f32 v[162:163], v[162:163], v[34:35] op_sel_hi:[1,0]
    v_pk_mul_f32 v[164:165], v[164:165], v[34:35] op_sel_hi:[1,0]
    v_pk_mul_f32 v[166:167], v[166:167], v[34:35] op_sel_hi:[1,0]
    v_pk_mul_f32 v[168:169], v[168:169], v[34:35] op_sel_hi:[1,0]
    v_pk_mul_f32 v[170:171], v[170:171], v[34:35] op_sel_hi:[1,0]
    v_pk_mul_f32 v[172:173], v[172:173], v[34:35] op_sel_hi:[1,0]
    v_pk_mul_f32 v[174:175], v[174:175], v[34:35] op_sel_hi:[1,0]
    v_cvt_pk_bf16_f32 v200, v160, v161
    v_cvt_pk_bf16_f32 v201, v162, v163
    v_cvt_pk_bf16_f32 v202, v164, v165
    v_cvt_pk_bf16_f32 v203, v166, v167
    v_cvt_pk_bf16_f32 v204, v168, v169
    v_cvt_pk_bf16_f32 v205, v170, v171
    v_cvt_pk_bf16_f32 v206, v172, v173
    v_cvt_pk_bf16_f32 v207, v174, v175
    buffer_store_dwordx4 v[200:203], v28, s[28:31], s41 offen offset:3072 sc1
    buffer_store_dwordx4 v[204:207], v28, s[28:31], s41 offen offset:3584 sc1
    s_or_b32 s41, s2, s32
    s_cmp_eq_u32 s41, 0
    s_cbranch_scc0 ka_nosc
    v_and_b32 v32, 63, v0
    v_lshlrev_b32 v33, 2, v32
    s_mov_b32 s41, 7680
    s_mov_b32 s42, 10240
    buffer_load_dword v64, v33, s[48:51], s41 offen offset:0
    buffer_load_dword v80, v33, s[48:51], s42 offen offset:0
    buffer_load_dword v65, v33, s[48:51], s41 offen offset:256
    buffer_load_dword v81, v33, s[48:51], s42 offen offset:256
    buffer_load_dword v66, v33, s[48:51], s41 offen offset:512
    buffer_load_dword v82, v33, s[48:51], s42 offen offset:512
    buffer_load_dword v67, v33, s[48:51], s41 offen offset:768
    buffer_load_dword v83, v33, s[48:51], s42 offen offset:768
    buffer_load_dword v68, v33, s[48:51], s41 offen offset:1024
    buffer_load_dword v84, v33, s[48:51], s42 offen offset:1024
    buffer_load_dword v69, v33, s[48:51], s41 offen offset:1280
    buffer_load_dword v85, v33, s[48:51], s42 offen offset:1280
    buffer_load_dword v70, v33, s[48:51], s41 offen offset:1536
    buffer_load_dword v86, v33, s[48:51], s42 offen offset:1536
    buffer_load_dword v71, v33, s[48:51], s41 offen offset:1792
    buffer_load_dword v87, v33, s[48:51], s42 offen offset:1792
    buffer_load_dword v72, v33, s[48:51], s41 offen offset:2048
    buffer_load_dword v88, v33, s[48:51], s42 offen offset:2048
    buffer_load_dword v73, v33, s[48:51], s41 offen offset:2304
    buffer_load_dword v89, v33, s[48:51], s42 offen offset:2304
    v_mov_b32 v40, 0
    v_mov_b32 v41, 0
    v_mov_b32 v42, 0
    v_mov_b32 v43, 0
    v_mov_b32 v44, 0
    s_waitcnt vmcnt(0)
    v_add_f32 v40, v40, v80
    v_fmac_f32 v41, v80, v80
    v_fmac_f32 v42, v80, v64
    v_add_f32 v43, v43, v64
    v_fmac_f32 v44, v64, v64
    v_add_f32 v40, v40, v81
    v_fmac_f32 v41, v81, v81
    v_fmac_f32 v42, v81, v65
    v_add_f32 v43, v43, v65
    v_fmac_f32 v44, v65, v65
    v_add_f32 v40, v40, v82
    v_fmac_f32 v41, v82, v82
    v_fmac_f32 v42, v82, v66
    v_add_f32 v43, v43, v66
    v_fmac_f32 v44, v66, v66
    v_add_f32 v40, v40, v83
    v_fmac_f32 v41, v83, v83
    v_fmac_f32 v42, v83, v67
    v_add_f32 v43, v43, v67
    v_fmac_f32 v44, v67, v67
    v_add_f32 v40, v40, v84
    v_fmac_f32 v41, v84, v84
    v_fmac_f32 v42, v84, v68
    v_add_f32 v43, v43, v68
    v_fmac_f32 v44, v68, v68
    v_add_f32 v40, v40, v85
    v_fmac_f32 v41, v85, v85
    v_fmac_f32 v42, v85, v69
    v_add_f32 v43, v43, v69
    v_fmac_f32 v44, v69, v69
    v_add_f32 v40, v40, v86
    v_fmac_f32 v41, v86, v86
    v_fmac_f32 v42, v86, v70
    v_add_f32 v43, v43, v70
    v_fmac_f32 v44, v70, v70
    v_add_f32 v40, v40, v87
    v_fmac_f32 v41, v87, v87
    v_fmac_f32 v42, v87, v71
    v_add_f32 v43, v43, v71
    v_fmac_f32 v44, v71, v71
    v_add_f32 v40, v40, v88
    v_fmac_f32 v41, v88, v88
    v_fmac_f32 v42, v88, v72
    v_add_f32 v43, v43, v72
    v_fmac_f32 v44, v72, v72
    v_add_f32 v40, v40, v89
    v_fmac_f32 v41, v89, v89
    v_fmac_f32 v42, v89, v73
    v_add_f32 v43, v43, v73
    v_fmac_f32 v44, v73, v73
    s_nop 1
    v_add_f32_dpp v40, v40, v40 row_ror:8 row_mask:0xf bank_mask:0xf
    v_add_f32_dpp v41, v41, v41 row_ror:8 row_mask:0xf bank_mask:0xf
    v_add_f32_dpp v42, v42, v42 row_ror:8 row_mask:0xf bank_mask:0xf
    v_add_f32_dpp v43, v43, v43 row_ror:8 row_mask:0xf bank_mask:0xf
    v_add_f32_dpp v44, v44, v44 row_ror:8 row_mask:0xf bank_mask:0xf
    s_nop 1
    v_add_f32_dpp v40, v40, v40 row_ror:4 row_mask:0xf bank_mask:0xf
    v_add_f32_dpp v41, v41, v41 row_ror:4 row_mask:0xf bank_mask:0xf
    v_add_f32_dpp v42, v42, v42 row_ror:4 row_mask:0xf bank_mask:0xf
    v_add_f32_dpp v43, v43, v43 row_ror:4 row_mask:0xf bank_mask:0xf
    v_add_f32_dpp v44, v44, v44 row_ror:4 row_mask:0xf bank_mask:0xf
    s_nop 1
    v_add_f32_dpp v40, v40, v40 row_ror:2 row_mask:0xf bank_mask:0xf
    v_add_f32_dpp v41, v41, v41 row_ror:2 row_mask:0xf bank_mask:0xf
    v_add_f32_dpp v42, v42, v42 row_ror:2 row_mask:0xf bank_mask:0xf
    v_add_f32_dpp v43, v43, v43 row_ror:2 row_mask:0xf bank_mask:0xf
    v_add_f32_dpp v44, v44, v44 row_ror:2 row_mask:0xf bank_mask:0xf
    s_nop 1
    v_add_f32_dpp v40, v40, v40 row_ror:1 row_mask:0xf bank_mask:0xf
    v_add_f32_dpp v41, v41, v41 row_ror:1 row_mask:0xf bank_mask:0xf
    v_add_f32_dpp v42, v42, v42 row_ror:1 row_mask:0xf bank_mask:0xf
    v_add_f32_dpp v43, v43, v43 row_ror:1 row_mask:0xf bank_mask:0xf
    v_add_f32_dpp v44, v44, v44 row_ror:1 row_mask:0xf bank_mask:0xf
    v_mov_b32 v50, v40
    v_mov_b32 v51, v41
    v_mov_b32 v52, v42
    v_mov_b32 v53, v43
    v_mov_b32 v54, v44
    s_nop 0
    v_permlane16_swap_b32 v40, v50
    v_permlane16_swap_b32 v41, v51
    v_permlane16_swap_b32 v42, v52
    v_permlane16_swap_b32 v43, v53
    v_permlane16_swap_b32 v44, v54
    s_nop 0
    v_add_f32 v40, v40, v50
    v_add_f32 v41, v41, v51
    v_add_f32 v42, v42, v52
    v_add_f32 v43, v43, v53
    v_add_f32 v44, v44, v54
    v_mov_b32 v50, v40
    v_mov_b32 v51, v41
    v_mov_b32 v52, v42
    v_mov_b32 v53, v43
    v_mov_b32 v54, v44
    s_nop 0
    v_permlane32_swap_b32 v40, v50
    v_permlane32_swap_b32 v41, v51
    v_permlane32_swap_b32 v42, v52
    v_permlane32_swap_b32 v43, v53
    v_permlane32_swap_b32 v44, v54
    s_nop 0
    v_add_f32 v40, v40, v50
    v_add_f32 v41, v41, v51
    v_add_f32 v42, v42, v52
    v_add_f32 v43, v43, v53
    v_add_f32 v44, v44, v54
    v_mov_b32 v34, 0
    v_cmp_eq_u32 vcc, 0, v32
    s_nop 1
    v_cndmask_b32 v34, v34, v40, vcc
    v_cmp_eq_u32 vcc, 8, v32
    s_nop 1
    v_cndmask_b32 v34, v34, v41, vcc
    v_cmp_eq_u32 vcc, 16, v32
    s_nop 1
    v_cndmask_b32 v34, v34, v42, vcc
    v_cmp_eq_u32 vcc, 24, v32
    s_nop 1
    v_cndmask_b32 v34, v34, v43, vcc
    v_cmp_eq_u32 vcc, 32, v32
    s_nop 1
    v_cndmask_b32 v34, v34, v44, vcc
    v_cmp_gt_u32 vcc, 40, v32
    s_and_saveexec_b64 s[42:43], vcc
    s_mov_b32 s41, 16384
    buffer_store_dword v34, v33, s[48:51], s41 offen
    s_mov_b64 exec, s[42:43]
ka_nosc:
ka_end:
    s_endpgm
ka_fallback:
    s_waitcnt vmcnt(0) lgkmcnt(0)
    s_nop 7
    s_nop 7
    s_lshl_b32 s41, s32, 13
    s_add_u32 s41, s41, 131072
    v_add_u32 v12, s41, v12
    v_add_u32 v13, s41, v13
    v_add_u32 v14, s41, v14
    v_add_u32 v15, s41, v15
    v_add_u32 v16, s41, v16
    v_add_u32 v17, s41, v17
    v_add_u32 v18, s41, v18
    v_add_u32 v19, s41, v19
    s_sub_u32 s43, s41, 65536
    v_add_u32 v20, s43, v20
    v_add_u32 v21, s43, v21
    v_add_u32 v22, s43, v22
    v_add_u32 v23, s43, v23
    v_mov_b32 v32, 0xff800000
    v_mov_b32 v33, 0xff800000
    s_mov_b32 s42, 0
ka_fb1:
    s_add_u32 m0, s41, 0
    s_lshl_b32 s43, s42, 13
    s_add_u32 s43, s43, 0
    buffer_load_dwordx4 v7, s[16:19], s43 offen offset:0 lds
    buffer_load_dwordx4 v8, s[16:19], s43 offen offset:1024 lds
    buffer_load_dwordx4 v9, s[16:19], s43 offen offset:2048 lds
    buffer_load_dwordx4 v10, s[16:19], s43 offen offset:3072 lds
    s_add_u32 m0, s41, 4096
    s_lshl_b32 s43, s42, 13
    s_add_u32 s43, s43, 4096
    buffer_load_dwordx4 v7, s[16:19], s43 offen offset:0 lds
    buffer_load_dwordx4 v8, s[16:19], s43 offen offset:1024 lds
    buffer_load_dwordx4 v9, s[16:19], s43 offen offset:2048 lds
    buffer_load_dwordx4 v10, s[16:19], s43 offen offset:3072 lds
    s_waitcnt vmcnt(0)
    ds_read_b128 a[128:131], v12
    ds_read_b128 a[132:135], v13
    ds_read_b128 a[136:139], v14
    ds_read_b128 a[140:143], v15
    ds_read_b128 a[144:147], v16
    ds_read_b128 a[148:151], v17
    ds_read_b128 a[152:155], v18
    ds_read_b128 a[156:159], v19
    s_waitcnt lgkmcnt(0)
    v_mfma_f32_32x32x16_bf16 v[112:127], a[128:131], v[48:51], 0
    v_mfma_f32_32x32x16_bf16 v[128:143], a[128:131], v[52:55], 0
    v_mfma_f32_32x32x16_bf16 v[112:127], a[132:135], v[56:59], v[112:127]
    v_mfma_f32_32x32x16_bf16 v[128:143], a[132:135], v[60:63], v[128:143]
    v_mfma_f32_32x32x16_bf16 v[112:127], a[136:139], v[64:67], v[112:127]
    v_mfma_f32_32x32x16_bf16 v[128:143], a[136:139], v[68:71], v[128:143]
    v_mfma_f32_32x32x16_bf16 v[112:127], a[140:143], v[72:75], v[112:127]
    v_mfma_f32_32x32x16_bf16 v[128:143], a[140:143], v[76:79], v[128:143]
    v_mfma_f32_32x32x16_bf16 v[112:127], a[144:147], v[80:83], v[112:127]
    v_mfma_f32_32x32x16_bf16 v[128:143], a[144:147], v[84:87], v[128:143]
    v_mfma_f32_32x32x16_bf16 v[112:127], a[148:151], v[88:91], v[112:127]
    v_mfma_f32_32x32x16_bf16 v[128:143], a[148:151], v[92:95], v[128:143]
    v_mfma_f32_32x32x16_bf16 v[112:127], a[152:155], v[96:99], v[112:127]
    v_mfma_f32_32x32x16_bf16 v[128:143], a[152:155], v[100:103], v[128:143]
    v_mfma_f32_32x32x16_bf16 v[112:127], a[156:159], v[104:107], v[112:127]
    v_mfma_f32_32x32x16_bf16 v[128:143], a[156:159], v[108:111], v[128:143]
    s_nop 7
    s_nop 7
    v_max3_f32 v32, v32, v112, v113
    v_max3_f32 v32, v32, v114, v115
    v_max3_f32 v32, v32, v116, v117
    v_max3_f32 v32, v32, v118, v119
    v_max3_f32 v32, v32, v120, v121
    v_max3_f32 v32, v32, v122, v123
    v_max3_f32 v32, v32, v124, v125
    v_max3_f32 v32, v32, v126, v127
    v_max3_f32 v33, v33, v128, v129
    v_max3_f32 v33, v33, v130, v131
    v_max3_f32 v33, v33, v132, v133
    v_max3_f32 v33, v33, v134, v135
    v_max3_f32 v33, v33, v136, v137
    v_max3_f32 v33, v33, v138, v139
    v_max3_f32 v33, v33, v140, v141
    v_max3_f32 v33, v33, v142, v143
    s_add_u32 s42, s42, 1
    s_cmp_lt_u32 s42, 16
    s_cbranch_scc1 ka_fb1
    v_mov_b32 v34, v32
    v_mov_b32 v35, v33
    s_nop 1
    v_permlane32_swap_b32 v32, v34
    v_permlane32_swap_b32 v33, v35
    s_nop 0
    v_max_f32 v32, v32, v34
    v_max_f32 v33, v33, v35
    v_sub_f32 v208, 0, v32
    v_mov_b32 v209, v208
    v_mov_b32 v210, v208
    v_mov_b32 v211, v208
    v_mov_b32 v212, v208
    v_mov_b32 v213, v208
    v_mov_b32 v214, v208
    v_mov_b32 v215, v208
    v_mov_b32 v216, v208
    v_mov_b32 v217, v208
    v_mov_b32 v218, v208
    v_mov_b32 v219, v208
    v_mov_b32 v220, v208
    v_mov_b32 v221, v208
    v_mov_b32 v222, v208
    v_mov_b32 v223, v208
    v_sub_f32 v224, 0, v33
    v_mov_b32 v225, v224
    v_mov_b32 v226, v224
    v_mov_b32 v227, v224
    v_mov_b32 v228, v224
    v_mov_b32 v229, v224
    v_mov_b32 v230, v224
    v_mov_b32 v231, v224
    v_mov_b32 v232, v224
    v_mov_b32 v233, v224
    v_mov_b32 v234, v224
    v_mov_b32 v235, v224
    v_mov_b32 v236, v224
    v_mov_b32 v237, v224
    v_mov_b32 v238, v224
    v_mov_b32 v239, v224
    v_accvgpr_write_b32 a0, 0
    v_accvgpr_write_b32 a1, 0
    v_accvgpr_write_b32 a2, 0
    v_accvgpr_write_b32 a3, 0
    v_accvgpr_write_b32 a4, 0
    v_accvgpr_write_b32 a5, 0
    v_accvgpr_write_b32 a6, 0
    v_accvgpr_write_b32 a7, 0
    v_accvgpr_write_b32 a8, 0
    v_accvgpr_write_b32 a9, 0
    v_accvgpr_write_b32 a10, 0
    v_accvgpr_write_b32 a11, 0
    v_accvgpr_write_b32 a12, 0
    v_accvgpr_write_b32 a13, 0
    v_accvgpr_write_b32 a14, 0
    v_accvgpr_write_b32 a15, 0
    v_accvgpr_write_b32 a16, 0
    v_accvgpr_write_b32 a17, 0
    v_accvgpr_write_b32 a18, 0
    v_accvgpr_write_b32 a19, 0
    v_accvgpr_write_b32 a20, 0
    v_accvgpr_write_b32 a21, 0
    v_accvgpr_write_b32 a22, 0
    v_accvgpr_write_b32 a23, 0
    v_accvgpr_write_b32 a24, 0
    v_accvgpr_write_b32 a25, 0
    v_accvgpr_write_b32 a26, 0
    v_accvgpr_write_b32 a27, 0
    v_accvgpr_write_b32 a28, 0
    v_accvgpr_write_b32 a29, 0
    v_accvgpr_write_b32 a30, 0
    v_accvgpr_write_b32 a31, 0
    v_accvgpr_write_b32 a32, 0
    v_accvgpr_write_b32 a33, 0
    v_accvgpr_write_b32 a34, 0
    v_accvgpr_write_b32 a35, 0
    v_accvgpr_write_b32 a36, 0
    v_accvgpr_write_b32 a37, 0
    v_accvgpr_write_b32 a38, 0
    v_accvgpr_write_b32 a39, 0
    v_accvgpr_write_b32 a40, 0
    v_accvgpr_write_b32 a41, 0
    v_accvgpr_write_b32 a42, 0
    v_accvgpr_write_b32 a43, 0
    v_accvgpr_write_b32 a44, 0
    v_accvgpr_write_b32 a45, 0
    v_accvgpr_write_b32 a46, 0
    v_accvgpr_write_b32 a47, 0
    v_accvgpr_write_b32 a48, 0
    v_accvgpr_write_b32 a49, 0
    v_accvgpr_write_b32 a50, 0
    v_accvgpr_write_b32 a51, 0
    v_accvgpr_write_b32 a52, 0
    v_accvgpr_write_b32 a53, 0
    v_accvgpr_write_b32 a54, 0
    v_accvgpr_write_b32 a55, 0
    v_accvgpr_write_b32 a56, 0
    v_accvgpr_write_b32 a57, 0
    v_accvgpr_write_b32 a58, 0
    v_accvgpr_write_b32 a59, 0
    v_accvgpr_write_b32 a60, 0
    v_accvgpr_write_b32 a61, 0
    v_accvgpr_write_b32 a62, 0
    v_accvgpr_write_b32 a63, 0
    v_accvgpr_write_b32 a64, 0
    v_accvgpr_write_b32 a65, 0
    v_accvgpr_write_b32 a66, 0
    v_accvgpr_write_b32 a67, 0
    v_accvgpr_write_b32 a68, 0
    v_accvgpr_write_b32 a69, 0
    v_accvgpr_write_b32 a70, 0
    v_accvgpr_write_b32 a71, 0
    v_accvgpr_write_b32 a72, 0
    v_accvgpr_write_b32 a73, 0
    v_accvgpr_write_b32 a74, 0
    v_accvgpr_write_b32 a75, 0
    v_accvgpr_write_b32 a76, 0
    v_accvgpr_write_b32 a77, 0
    v_accvgpr_write_b32 a78, 0
    v_accvgpr_write_b32 a79, 0
    v_accvgpr_write_b32 a80, 0
    v_accvgpr_write_b32 a81, 0
    v_accvgpr_write_b32 a82, 0
    v_accvgpr_write_b32 a83, 0
    v_accvgpr_write_b32 a84, 0
    v_accvgpr_write_b32 a85, 0
    v_accvgpr_write_b32 a86, 0
    v_accvgpr_write_b32 a87, 0
    v_accvgpr_write_b32 a88, 0
    v_accvgpr_write_b32 a89, 0
    v_accvgpr_write_b32 a90, 0
    v_accvgpr_write_b32 a91, 0
    v_accvgpr_write_b32 a92, 0
    v_accvgpr_write_b32 a93, 0
    v_accvgpr_write_b32 a94, 0
    v_accvgpr_write_b32 a95, 0
    v_accvgpr_write_b32 a96, 0
    v_accvgpr_write_b32 a97, 0
    v_accvgpr_write_b32 a98, 0
    v_accvgpr_write_b32 a99, 0
    v_accvgpr_write_b32 a100, 0
    v_accvgpr_write_b32 a101, 0
    v_accvgpr_write_b32 a102, 0
    v_accvgpr_write_b32 a103, 0
    v_accvgpr_write_b32 a104, 0
    v_accvgpr_write_b32 a105, 0
    v_accvgpr_write_b32 a106, 0
    v_accvgpr_write_b32 a107, 0
    v_accvgpr_write_b32 a108, 0
    v_accvgpr_write_b32 a109, 0
    v_accvgpr_write_b32 a110, 0
    v_accvgpr_write_b32 a111, 0
    v_accvgpr_write_b32 a112, 0
    v_accvgpr_write_b32 a113, 0
    v_accvgpr_write_b32 a114, 0
    v_accvgpr_write_b32 a115, 0
    v_accvgpr_write_b32 a116, 0
    v_accvgpr_write_b32 a117, 0
    v_accvgpr_write_b32 a118, 0
    v_accvgpr_write_b32 a119, 0
    v_accvgpr_write_b32 a120, 0
    v_accvgpr_write_b32 a121, 0
    v_accvgpr_write_b32 a122, 0
    v_accvgpr_write_b32 a123, 0
    v_accvgpr_write_b32 a124, 0
    v_accvgpr_write_b32 a125, 0
    v_accvgpr_write_b32 a126, 0
    v_accvgpr_write_b32 a127, 0
    v_mov_b32 v24, 0
    v_mov_b32 v25, 0
    v_mov_b32 v26, 0
    v_mov_b32 v27, 0
    s_mov_b32 s42, 0
ka_fb2:
    s_add_u32 m0, s41, 0
    s_lshl_b32 s43, s42, 13
    s_add_u32 s43, s43, 0
    buffer_load_dwordx4 v7, s[16:19], s43 offen offset:0 lds
    buffer_load_dwordx4 v8, s[16:19], s43 offen offset:1024 lds
    buffer_load_dwordx4 v9, s[16:19], s43 offen offset:2048 lds
    buffer_load_dwordx4 v10, s[16:19], s43 offen offset:3072 lds
    s_add_u32 m0, s41, 4096
    s_lshl_b32 s43, s42, 13
    s_add_u32 s43, s43, 4096
    buffer_load_dwordx4 v7, s[16:19], s43 offen offset:0 lds
    buffer_load_dwordx4 v8, s[16:19], s43 offen offset:1024 lds
    buffer_load_dwordx4 v9, s[16:19], s43 offen offset:2048 lds
    buffer_load_dwordx4 v10, s[16:19], s43 offen offset:3072 lds
    s_waitcnt vmcnt(0)
    ds_read_b128 a[128:131], v12
    ds_read_b128 a[132:135], v13
    ds_read_b128 a[136:139], v14
    ds_read_b128 a[140:143], v15
    ds_read_b128 a[144:147], v16
    ds_read_b128 a[148:151], v17
    ds_read_b128 a[152:155], v18
    ds_read_b128 a[156:159], v19
    s_waitcnt lgkmcnt(0)
    v_mfma_f32_32x32x16_bf16 v[112:127], a[128:131], v[48:51], v[208:223]
    v_mfma_f32_32x32x16_bf16 v[128:143], a[128:131], v[52:55], v[224:239]
    v_mfma_f32_32x32x16_bf16 v[112:127], a[132:135], v[56:59], v[112:127]
    v_mfma_f32_32x32x16_bf16 v[128:143], a[132:135], v[60:63], v[128:143]
    v_mfma_f32_32x32x16_bf16 v[112:127], a[136:139], v[64:67], v[112:127]
    v_mfma_f32_32x32x16_bf16 v[128:143], a[136:139], v[68:71], v[128:143]
    v_mfma_f32_32x32x16_bf16 v[112:127], a[140:143], v[72:75], v[112:127]
    v_mfma_f32_32x32x16_bf16 v[128:143], a[140:143], v[76:79], v[128:143]
    v_mfma_f32_32x32x16_bf16 v[112:127], a[144:147], v[80:83], v[112:127]
    v_mfma_f32_32x32x16_bf16 v[128:143], a[144:147], v[84:87], v[128:143]
    v_mfma_f32_32x32x16_bf16 v[112:127], a[148:151], v[88:91], v[112:127]
    v_mfma_f32_32x32x16_bf16 v[128:143], a[148:151], v[92:95], v[128:143]
    v_mfma_f32_32x32x16_bf16 v[112:127], a[152:155], v[96:99], v[112:127]
    v_mfma_f32_32x32x16_bf16 v[128:143], a[152:155], v[100:103], v[128:143]
    v_mfma_f32_32x32x16_bf16 v[112:127], a[156:159], v[104:107], v[112:127]
    v_mfma_f32_32x32x16_bf16 v[128:143], a[156:159], v[108:111], v[128:143]
    s_nop 7
    s_nop 7
    v_exp_f32 v112, v112
    v_exp_f32 v113, v113
    v_exp_f32 v114, v114
    v_exp_f32 v115, v115
    v_exp_f32 v116, v116
    v_exp_f32 v117, v117
    v_exp_f32 v118, v118
    v_exp_f32 v119, v119
    v_exp_f32 v120, v120
    v_exp_f32 v121, v121
    v_exp_f32 v122, v122
    v_exp_f32 v123, v123
    v_exp_f32 v124, v124
    v_exp_f32 v125, v125
    v_exp_f32 v126, v126
    v_exp_f32 v127, v127
    v_add_f32 v24, v24, v112
    v_add_f32 v24, v24, v113
    v_add_f32 v24, v24, v114
    v_add_f32 v24, v24, v115
    v_add_f32 v24, v24, v116
    v_add_f32 v24, v24, v117
    v_add_f32 v24, v24, v118
    v_add_f32 v24, v24, v119
    v_add_f32 v24, v24, v120
    v_add_f32 v24, v24, v121
    v_add_f32 v24, v24, v122
    v_add_f32 v24, v24, v123
    v_add_f32 v24, v24, v124
    v_add_f32 v24, v24, v125
    v_add_f32 v24, v24, v126
    v_add_f32 v24, v24, v127
    v_cvt_pk_bf16_f32 v176, v112, v113
    v_cvt_pk_bf16_f32 v177, v114, v115
    v_cvt_pk_bf16_f32 v178, v116, v117
    v_cvt_pk_bf16_f32 v179, v118, v119
    v_cvt_pk_bf16_f32 v180, v120, v121
    v_cvt_pk_bf16_f32 v181, v122, v123
    v_cvt_pk_bf16_f32 v182, v124, v125
    v_cvt_pk_bf16_f32 v183, v126, v127
    v_exp_f32 v128, v128
    v_exp_f32 v129, v129
    v_exp_f32 v130, v130
    v_exp_f32 v131, v131
    v_exp_f32 v132, v132
    v_exp_f32 v133, v133
    v_exp_f32 v134, v134
    v_exp_f32 v135, v135
    v_exp_f32 v136, v136
    v_exp_f32 v137, v137
    v_exp_f32 v138, v138
    v_exp_f32 v139, v139
    v_exp_f32 v140, v140
    v_exp_f32 v141, v141
    v_exp_f32 v142, v142
    v_exp_f32 v143, v143
    v_add_f32 v26, v26, v128
    v_add_f32 v26, v26, v129
    v_add_f32 v26, v26, v130
    v_add_f32 v26, v26, v131
    v_add_f32 v26, v26, v132
    v_add_f32 v26, v26, v133
    v_add_f32 v26, v26, v134
    v_add_f32 v26, v26, v135
    v_add_f32 v26, v26, v136
    v_add_f32 v26, v26, v137
    v_add_f32 v26, v26, v138
    v_add_f32 v26, v26, v139
    v_add_f32 v26, v26, v140
    v_add_f32 v26, v26, v141
    v_add_f32 v26, v26, v142
    v_add_f32 v26, v26, v143
    v_cvt_pk_bf16_f32 v184, v128, v129
    v_cvt_pk_bf16_f32 v185, v130, v131
    v_cvt_pk_bf16_f32 v186, v132, v133
    v_cvt_pk_bf16_f32 v187, v134, v135
    v_cvt_pk_bf16_f32 v188, v136, v137
    v_cvt_pk_bf16_f32 v189, v138, v139
    v_cvt_pk_bf16_f32 v190, v140, v141
    v_cvt_pk_bf16_f32 v191, v142, v143
    s_add_u32 m0, s41, 0
    s_lshl_b32 s43, s42, 13
    s_add_u32 s43, s43, 0
    buffer_load_dwordx4 v11, s[20:23], s43 offen offset:0 lds
    buffer_load_dwordx4 v11, s[20:23], s43 offen offset:1024 lds
    buffer_load_dwordx4 v11, s[20:23], s43 offen offset:2048 lds
    buffer_load_dwordx4 v11, s[20:23], s43 offen offset:3072 lds
    s_add_u32 m0, s41, 4096
    s_lshl_b32 s43, s42, 13
    s_add_u32 s43, s43, 4096
    buffer_load_dwordx4 v11, s[20:23], s43 offen offset:0 lds
    buffer_load_dwordx4 v11, s[20:23], s43 offen offset:1024 lds
    buffer_load_dwordx4 v11, s[20:23], s43 offen offset:2048 lds
    buffer_load_dwordx4 v11, s[20:23], s43 offen offset:3072 lds
    s_waitcnt vmcnt(0)
    ds_read_b64_tr_b16 a[160:161], v20 offset:0
    ds_read_b64_tr_b16 a[162:163], v20 offset:2048
    ds_read_b64_tr_b16 a[164:165], v21 offset:0
    ds_read_b64_tr_b16 a[166:167], v21 offset:2048
    ds_read_b64_tr_b16 a[168:169], v22 offset:0
    ds_read_b64_tr_b16 a[170:171], v22 offset:2048
    ds_read_b64_tr_b16 a[172:173], v23 offset:0
    ds_read_b64_tr_b16 a[174:175], v23 offset:2048
    ds_read_b64_tr_b16 a[176:177], v20 offset:4096
    ds_read_b64_tr_b16 a[178:179], v20 offset:6144
    ds_read_b64_tr_b16 a[180:181], v21 offset:4096
    ds_read_b64_tr_b16 a[182:183], v21 offset:6144
    ds_read_b64_tr_b16 a[184:185], v22 offset:4096
    ds_read_b64_tr_b16 a[186:187], v22 offset:6144
    ds_read_b64_tr_b16 a[188:189], v23 offset:4096
    ds_read_b64_tr_b16 a[190:191], v23 offset:6144
    s_waitcnt lgkmcnt(0)
    v_mfma_f32_32x32x16_bf16 a[0:15], a[160:163], v[176:179], a[0:15]
    v_mfma_f32_32x32x16_bf16 a[16:31], a[160:163], v[184:187], a[16:31]
    v_mfma_f32_32x32x16_bf16 a[32:47], a[164:167], v[176:179], a[32:47]
    v_mfma_f32_32x32x16_bf16 a[48:63], a[164:167], v[184:187], a[48:63]
    v_mfma_f32_32x32x16_bf16 a[64:79], a[168:171], v[176:179], a[64:79]
    v_mfma_f32_32x32x16_bf16 a[80:95], a[168:171], v[184:187], a[80:95]
    v_mfma_f32_32x32x16_bf16 a[96:111], a[172:175], v[176:179], a[96:111]
    v_mfma_f32_32x32x16_bf16 a[112:127], a[172:175], v[184:187], a[112:127]
    v_mfma_f32_32x32x16_bf16 a[0:15], a[176:179], v[180:183], a[0:15]
    v_mfma_f32_32x32x16_bf16 a[16:31], a[176:179], v[188:191], a[16:31]
    v_mfma_f32_32x32x16_bf16 a[32:47], a[180:183], v[180:183], a[32:47]
    v_mfma_f32_32x32x16_bf16 a[48:63], a[180:183], v[188:191], a[48:63]
    v_mfma_f32_32x32x16_bf16 a[64:79], a[184:187], v[180:183], a[64:79]
    v_mfma_f32_32x32x16_bf16 a[80:95], a[184:187], v[188:191], a[80:95]
    v_mfma_f32_32x32x16_bf16 a[96:111], a[188:191], v[180:183], a[96:111]
    v_mfma_f32_32x32x16_bf16 a[112:127], a[188:191], v[188:191], a[112:127]
    s_add_u32 s42, s42, 1
    s_cmp_lt_u32 s42, 16
    s_cbranch_scc1 ka_fb2
    v_mov_b32 v25, v24
    v_mov_b32 v27, v26
    s_nop 1
    v_permlane32_swap_b32 v24, v25
    v_permlane32_swap_b32 v26, v27
    s_nop 0
    v_add_f32 v24, v24, v25
    v_add_f32 v26, v26, v27
    v_rcp_f32 v32, v24
    v_rcp_f32 v34, v26
    s_nop 7
    s_nop 7
    s_branch ka_epi
    s_endpgm
.globl kb_kernel
.p2align 8
.type kb_kernel,@function
kb_kernel:
    s_cmp_ge_u32 s2, 256
    s_cbranch_scc1 kb_end
    s_load_dwordx2 s[4:5], s[0:1], 112
    s_load_dwordx2 s[6:7], s[0:1], 0
    s_load_dwordx2 s[8:9], s[0:1], 96
    v_lshrrev_b32 v10, 6, v0
    s_nop 0
    v_readfirstlane_b32 s32, v10
    s_nop 0
    s_and_b32 s40, s2, 7
    s_lshr_b32 s41, s2, 3
    s_lshl_b32 s42, s40, 2
    s_and_b32 s43, s41, 3
    s_add_u32 s33, s42, s43
    s_lshr_b32 s34, s41, 2
    s_lshl_b32 s42, s40, 1
    s_and_b32 s43, s41, 1
    s_add_u32 s35, s42, s43
    s_lshr_b32 s36, s41, 1
    s_lshl_b32 s37, s33, 2
    s_add_u32 s37, s37, s32
    s_mul_i32 s38, s34, 5
    s_lshl_b32 s39, s35, 3
    s_lshl_b32 s40, s32, 1
    s_add_u32 s39, s39, s40
    s_mul_i32 s28, s36, 7
    s_min_u32 s28, s28, 101
    v_and_b32 v3, 63, v0
    v_lshlrev_b32 v1, 4, v3
    v_add_u32 v2, 4096, v1
    s_add_u32 s40, s32, 0
    s_and_b32 s40, s40, 3
    s_mul_i32 s40, s40, 131072
    v_add_u32 v7, s40, v1
    s_add_u32 s40, s32, 1
    s_and_b32 s40, s40, 3
    s_mul_i32 s40, s40, 131072
    v_add_u32 v8, s40, v1
    s_add_u32 s40, s32, 2
    s_and_b32 s40, s40, 3
    s_mul_i32 s40, s40, 131072
    v_add_u32 v9, s40, v1
    s_add_u32 s40, s32, 3
    s_and_b32 s40, s40, 3
    s_mul_i32 s40, s40, 131072
    v_add_u32 v10, s40, v1
    s_mul_i32 s40, s32, 32
    s_mul_i32 s41, s33, 512
    s_add_u32 s41, s41, s40
    s_lshl_b32 s44, s41, 10
    s_add_u32 s44, s44, 32505856
    s_mul_i32 s41, s34, 128
    s_add_u32 s41, s41, s40
    s_mul_i32 s45, s41, 5120
    s_add_u32 s45, s45, 18284544
    s_waitcnt lgkmcnt(0)
    s_mov_b32 s12, s4
    s_mov_b32 s13, s5
    s_mov_b32 s14, 49545216
    s_mov_b32 s15, 0x20000
    s_add_u32 s16, s4, 5963776
    s_addc_u32 s17, s5, 0
    s_mov_b32 s18, 2621440
    s_mov_b32 s19, 0x20000
    s_mov_b32 s20, s6
    s_mov_b32 s21, s7
    s_mov_b32 s22, 2621440
    s_mov_b32 s23, 0x20000
    s_mov_b32 s24, s8
    s_mov_b32 s25, s9
    s_mov_b32 s26, 2621440
    s_mov_b32 s27, 0x20000
    buffer_load_dwordx4 a[0:3], v1, s[12:15], s45 offen offset:0
    buffer_load_dwordx4 a[4:7], v1, s[12:15], s45 offen offset:1024
    buffer_load_dwordx4 a[8:11], v1, s[12:15], s45 offen offset:2048
    buffer_load_dwordx4 a[12:15], v1, s[12:15], s45 offen offset:3072
    buffer_load_dwordx4 a[16:19], v2, s[12:15], s45 offen
    buffer_load_dwordx4 v[96:99], v7, s[12:15], s44 offen
    buffer_load_dwordx4 v[100:103], v8, s[12:15], s44 offen
    buffer_load_dwordx4 v[104:107], v9, s[12:15], s44 offen
    buffer_load_dwordx4 v[108:111], v10, s[12:15], s44 offen
    s_add_u32 s44, s44, 1024
    s_add_u32 s45, s45, 5120
    buffer_load_dwordx4 a[20:23], v1, s[12:15], s45 offen offset:0
    buffer_load_dwordx4 a[24:27], v1, s[12:15], s45 offen offset:1024
    buffer_load_dwordx4 a[28:31], v1, s[12:15], s45 offen offset:2048
    buffer_load_dwordx4 a[32:35], v1, s[12:15], s45 offen offset:3072
    buffer_load_dwordx4 a[36:39], v2, s[12:15], s45 offen
    buffer_load_dwordx4 v[112:115], v7, s[12:15], s44 offen
    buffer_load_dwordx4 v[116:119], v8, s[12:15], s44 offen
    buffer_load_dwordx4 v[120:123], v9, s[12:15], s44 offen
    buffer_load_dwordx4 v[124:127], v10, s[12:15], s44 offen
    s_add_u32 s44, s44, 1024
    s_add_u32 s45, s45, 5120
    buffer_load_dwordx4 a[40:43], v1, s[12:15], s45 offen offset:0
    buffer_load_dwordx4 a[44:47], v1, s[12:15], s45 offen offset:1024
    buffer_load_dwordx4 a[48:51], v1, s[12:15], s45 offen offset:2048
    buffer_load_dwordx4 a[52:55], v1, s[12:15], s45 offen offset:3072
    buffer_load_dwordx4 a[56:59], v2, s[12:15], s45 offen
    buffer_load_dwordx4 v[128:131], v7, s[12:15], s44 offen
    buffer_load_dwordx4 v[132:135], v8, s[12:15], s44 offen
    buffer_load_dwordx4 v[136:139], v9, s[12:15], s44 offen
    buffer_load_dwordx4 v[140:143], v10, s[12:15], s44 offen
    s_add_u32 s44, s44, 1024
    s_add_u32 s45, s45, 5120
    buffer_load_dwordx4 a[60:63], v1, s[12:15], s45 offen offset:0
    buffer_load_dwordx4 a[64:67], v1, s[12:15], s45 offen offset:1024
    buffer_load_dwordx4 a[68:71], v1, s[12:15], s45 offen offset:2048
    buffer_load_dwordx4 a[72:75], v1, s[12:15], s45 offen offset:3072
    buffer_load_dwordx4 a[76:79], v2, s[12:15], s45 offen
    buffer_load_dwordx4 v[144:147], v7, s[12:15], s44 offen
    buffer_load_dwordx4 v[148:151], v8, s[12:15], s44 offen
    buffer_load_dwordx4 v[152:155], v9, s[12:15], s44 offen
    buffer_load_dwordx4 v[156:159], v10, s[12:15], s44 offen
    s_add_u32 s44, s44, 1024
    s_add_u32 s45, s45, 5120
    s_getreg_b32 s30, hwreg(HW_REG_XCC_ID, 0, 4)
    s_add_u32 s30, s30, 1
    s_lshl_b32 s40, s2, 2
    s_add_u32 s40, s40, 47104
    v_mov_b32 v11, s30
    v_mov_b32 v12, 0
    buffer_store_dword v11, v12, s[12:15], s40 offen
    v_and_b32 v11, 15, v3
    v_lshrrev_b32 v4, 4, v3
    s_lshl_b32 s40, s37, 4
    v_add_u32 v5, s40, v11
    s_mul_i32 s40, s37, 20
    s_lshr_b32 s43, s38, 1
    s_add_u32 s43, s43, s40
    s_lshl_b32 s48, s43, 10
    s_and_b32 s49, s34, 1
    v_lshlrev_b32 v231, 3, v3
    v_lshlrev_b32 v230, 7, v3
    v_mov_b32 v11, 0x40000000
    v_cmp_gt_u32 vcc, 20, v3
    s_nop 1
    v_cndmask_b32 v230, v11, v230, vcc
    v_and_b32 v228, 31, v3
    v_cmp_gt_u32 vcc, 28, v228
    v_lshlrev_b32 v228, 7, v228
    v_lshrrev_b32 v12, 5, v3
    v_mul_u32_u24 v12, 55296, v12
    v_add_u32 v228, v228, v12
    v_cndmask_b32 v228, v11, v228, vcc
    s_mul_i32 s40, s34, 160
    v_mul_u32_u24 v6, 1280, v5
    v_lshlrev_b32 v11, 3, v4
    v_add3_u32 v6, v6, v11, s40
    s_mul_i32 s68, s34, 122880
    s_mul_i32 s69, s34, 102400
    s_mul_i32 s29, s36, 143360
    s_waitcnt vmcnt(28)
    v_mfma_f32_16x16x32_bf16 v[16:19], a[0:3], v[96:99], 0
    buffer_load_dwordx4 a[80:83], v1, s[12:15], s45 offen offset:0
    v_mfma_f32_16x16x32_bf16 v[36:39], a[0:3], v[100:103], 0
    buffer_load_dwordx4 a[84:87], v1, s[12:15], s45 offen offset:1024
    v_mfma_f32_16x16x32_bf16 v[56:59], a[0:3], v[104:107], 0
    buffer_load_dwordx4 a[88:91], v1, s[12:15], s45 offen offset:2048
    v_mfma_f32_16x16x32_bf16 v[76:79], a[0:3], v[108:111], 0
    buffer_load_dwordx4 a[92:95], v1, s[12:15], s45 offen offset:3072
    v_mfma_f32_16x16x32_bf16 v[20:23], a[4:7], v[96:99], 0
    buffer_load_dwordx4 a[96:99], v2, s[12:15], s45 offen
    v_mfma_f32_16x16x32_bf16 v[40:43], a[4:7], v[100:103], 0
    buffer_load_dwordx4 v[160:163], v7, s[12:15], s44 offen
    v_mfma_f32_16x16x32_bf16 v[60:63], a[4:7], v[104:107], 0
    buffer_load_dwordx4 v[164:167], v8, s[12:15], s44 offen
    v_mfma_f32_16x16x32_bf16 v[80:83], a[4:7], v[108:111], 0
    buffer_load_dwordx4 v[168:171], v9, s[12:15], s44 offen
    v_mfma_f32_16x16x32_bf16 v[24:27], a[8:11], v[96:99], 0
    buffer_load_dwordx4 v[172:175], v10, s[12:15], s44 offen
    v_mfma_f32_16x16x32_bf16 v[44:47], a[8:11], v[100:103], 0
    s_add_u32 s44, s44, 1024
    s_add_u32 s45, s45, 5120
    v_mfma_f32_16x16x32_bf16 v[64:67], a[8:11], v[104:107], 0
    v_mfma_f32_16x16x32_bf16 v[84:87], a[8:11], v[108:111], 0
    v_mfma_f32_16x16x32_bf16 v[28:31], a[12:15], v[96:99], 0
    v_mfma_f32_16x16x32_bf16 v[48:51], a[12:15], v[100:103], 0
    v_mfma_f32_16x16x32_bf16 v[68:71], a[12:15], v[104:107], 0
    v_mfma_f32_16x16x32_bf16 v[88:91], a[12:15], v[108:111], 0
    v_mfma_f32_16x16x32_bf16 v[32:35], a[16:19], v[96:99], 0
    v_mfma_f32_16x16x32_bf16 v[52:55], a[16:19], v[100:103], 0
    v_mfma_f32_16x16x32_bf16 v[72:75], a[16:19], v[104:107], 0
    v_mfma_f32_16x16x32_bf16 v[92:95], a[16:19], v[108:111], 0
    s_waitcnt vmcnt(28)
    v_mfma_f32_16x16x32_bf16 v[16:19], a[20:23], v[112:115], v[16:19]
    buffer_load_dwordx4 a[0:3], v1, s[12:15], s45 offen offset:0
    v_mfma_f32_16x16x32_bf16 v[36:39], a[20:23], v[116:119], v[36:39]
    buffer_load_dwordx4 a[4:7], v1, s[12:15], s45 offen offset:1024
    v_mfma_f32_16x16x32_bf16 v[56:59], a[20:23], v[120:123], v[56:59]
    buffer_load_dwordx4 a[8:11], v1, s[12:15], s45 offen offset:2048
    v_mfma_f32_16x16x32_bf16 v[76:79], a[20:23], v[124:127], v[76:79]
    buffer_load_dwordx4 a[12:15], v1, s[12:15], s45 offen offset:3072
    v_mfma_f32_16x16x32_bf16 v[20:23], a[24:27], v[112:115], v[20:23]
    buffer_load_dwordx4 a[16:19], v2, s[12:15], s45 offen
    v_mfma_f32_16x16x32_bf16 v[40:43], a[24:27], v[116:119], v[40:43]
    buffer_load_dwordx4 v[96:99], v7, s[12:15], s44 offen
    v_mfma_f32_16x16x32_bf16 v[60:63], a[24:27], v[120:123], v[60:63]
    buffer_load_dwordx4 v[100:103], v8, s[12:15], s44 offen
    v_mfma_f32_16x16x32_bf16 v[80:83], a[24:27], v[124:127], v[80:83]
    buffer_load_dwordx4 v[104:107], v9, s[12:15], s44 offen
    v_mfma_f32_16x16x32_bf16 v[24:27], a[28:31], v[112:115], v[24:27]
    buffer_load_dwordx4 v[108:111], v10, s[12:15], s44 offen
    v_mfma_f32_16x16x32_bf16 v[44:47], a[28:31], v[116:119], v[44:47]
    s_add_u32 s44, s44, 1024
    s_add_u32 s45, s45, 5120
    v_mfma_f32_16x16x32_bf16 v[64:67], a[28:31], v[120:123], v[64:67]
    v_mfma_f32_16x16x32_bf16 v[84:87], a[28:31], v[124:127], v[84:87]
    v_mfma_f32_16x16x32_bf16 v[28:31], a[32:35], v[112:115], v[28:31]
    v_mfma_f32_16x16x32_bf16 v[48:51], a[32:35], v[116:119], v[48:51]
    v_mfma_f32_16x16x32_bf16 v[68:71], a[32:35], v[120:123], v[68:71]
    v_mfma_f32_16x16x32_bf16 v[88:91], a[32:35], v[124:127], v[88:91]
    v_mfma_f32_16x16x32_bf16 v[32:35], a[36:39], v[112:115], v[32:35]
    v_mfma_f32_16x16x32_bf16 v[52:55], a[36:39], v[116:119], v[52:55]
    v_mfma_f32_16x16x32_bf16 v[72:75], a[36:39], v[120:123], v[72:75]
    v_mfma_f32_16x16x32_bf16 v[92:95], a[36:39], v[124:127], v[92:95]
    s_waitcnt vmcnt(28)
    v_mfma_f32_16x16x32_bf16 v[16:19], a[40:43], v[128:131], v[16:19]
    buffer_load_dwordx4 a[20:23], v1, s[12:15], s45 offen offset:0
    v_mfma_f32_16x16x32_bf16 v[36:39], a[40:43], v[132:135], v[36:39]
    buffer_load_dwordx4 a[24:27], v1, s[12:15], s45 offen offset:1024
    v_mfma_f32_16x16x32_bf16 v[56:59], a[40:43], v[136:139], v[56:59]
    buffer_load_dwordx4 a[28:31], v1, s[12:15], s45 offen offset:2048
    v_mfma_f32_16x16x32_bf16 v[76:79], a[40:43], v[140:143], v[76:79]
    buffer_load_dwordx4 a[32:35], v1, s[12:15], s45 offen offset:3072
    v_mfma_f32_16x16x32_bf16 v[20:23], a[44:47], v[128:131], v[20:23]
    buffer_load_dwordx4 a[36:39], v2, s[12:15], s45 offen
    v_mfma_f32_16x16x32_bf16 v[40:43], a[44:47], v[132:135], v[40:43]
    buffer_load_dwordx4 v[112:115], v7, s[12:15], s44 offen
    v_mfma_f32_16x16x32_bf16 v[60:63], a[44:47], v[136:139], v[60:63]
    buffer_load_dwordx4 v[116:119], v8, s[12:15], s44 offen
    v_mfma_f32_16x16x32_bf16 v[80:83], a[44:47], v[140:143], v[80:83]
    buffer_load_dwordx4 v[120:123], v9, s[12:15], s44 offen
    v_mfma_f32_16x16x32_bf16 v[24:27], a[48:51], v[128:131], v[24:27]
    buffer_load_dwordx4 v[124:127], v10, s[12:15], s44 offen
    v_mfma_f32_16x16x32_bf16 v[44:47], a[48:51], v[132:135], v[44:47]
    s_add_u32 s44, s44, 1024
    s_add_u32 s45, s45, 5120
    v_mfma_f32_16x16x32_bf16 v[64:67], a[48:51], v[136:139], v[64:67]
    v_mfma_f32_16x16x32_bf16 v[84:87], a[48:51], v[140:143], v[84:87]
    v_mfma_f32_16x16x32_bf16 v[28:31], a[52:55], v[128:131], v[28:31]
    v_mfma_f32_16x16x32_bf16 v[48:51], a[52:55], v[132:135], v[48:51]
    v_mfma_f32_16x16x32_bf16 v[68:71], a[52:55], v[136:139], v[68:71]
    v_mfma_f32_16x16x32_bf16 v[88:91], a[52:55], v[140:143], v[88:91]
    v_mfma_f32_16x16x32_bf16 v[32:35], a[56:59], v[128:131], v[32:35]
    v_mfma_f32_16x16x32_bf16 v[52:55], a[56:59], v[132:135], v[52:55]
    v_mfma_f32_16x16x32_bf16 v[72:75], a[56:59], v[136:139], v[72:75]
    v_mfma_f32_16x16x32_bf16 v[92:95], a[56:59], v[140:143], v[92:95]
    s_waitcnt vmcnt(28)
    v_mfma_f32_16x16x32_bf16 v[16:19], a[60:63], v[144:147], v[16:19]
    buffer_load_dwordx4 a[40:43], v1, s[12:15], s45 offen offset:0
    v_mfma_f32_16x16x32_bf16 v[36:39], a[60:63], v[148:151], v[36:39]
    buffer_load_dwordx4 a[44:47], v1, s[12:15], s45 offen offset:1024
    v_mfma_f32_16x16x32_bf16 v[56:59], a[60:63], v[152:155], v[56:59]
    buffer_load_dwordx4 a[48:51], v1, s[12:15], s45 offen offset:2048
    v_mfma_f32_16x16x32_bf16 v[76:79], a[60:63], v[156:159], v[76:79]
    buffer_load_dwordx4 a[52:55], v1, s[12:15], s45 offen offset:3072
    v_mfma_f32_16x16x32_bf16 v[20:23], a[64:67], v[144:147], v[20:23]
    buffer_load_dwordx4 a[56:59], v2, s[12:15], s45 offen
    v_mfma_f32_16x16x32_bf16 v[40:43], a[64:67], v[148:151], v[40:43]
    buffer_load_dwordx4 v[128:131], v7, s[12:15], s44 offen
    v_mfma_f32_16x16x32_bf16 v[60:63], a[64:67], v[152:155], v[60:63]
    buffer_load_dwordx4 v[132:135], v8, s[12:15], s44 offen
    v_mfma_f32_16x16x32_bf16 v[80:83], a[64:67], v[156:159], v[80:83]
    buffer_load_dwordx4 v[136:139], v9, s[12:15], s44 offen
    v_mfma_f32_16x16x32_bf16 v[24:27], a[68:71], v[144:147], v[24:27]
    buffer_load_dwordx4 v[140:143], v10, s[12:15], s44 offen
    v_mfma_f32_16x16x32_bf16 v[44:47], a[68:71], v[148:151], v[44:47]
    s_add_u32 s44, s44, 1024
    s_add_u32 s45, s45, 5120
    v_mfma_f32_16x16x32_bf16 v[64:67], a[68:71], v[152:155], v[64:67]
    v_mfma_f32_16x16x32_bf16 v[84:87], a[68:71], v[156:159], v[84:87]
    v_mfma_f32_16x16x32_bf16 v[28:31], a[72:75], v[144:147], v[28:31]
    v_mfma_f32_16x16x32_bf16 v[48:51], a[72:75], v[148:151], v[48:51]
    v_mfma_f32_16x16x32_bf16 v[68:71], a[72:75], v[152:155], v[68:71]
    v_mfma_f32_16x16x32_bf16 v[88:91], a[72:75], v[156:159], v[88:91]
    v_mfma_f32_16x16x32_bf16 v[32:35], a[76:79], v[144:147], v[32:35]
    v_mfma_f32_16x16x32_bf16 v[52:55], a[76:79], v[148:151], v[52:55]
    v_mfma_f32_16x16x32_bf16 v[72:75], a[76:79], v[152:155], v[72:75]
    v_mfma_f32_16x16x32_bf16 v[92:95], a[76:79], v[156:159], v[92:95]
    s_waitcnt vmcnt(27)
    v_mfma_f32_16x16x32_bf16 v[16:19], a[80:83], v[160:163], v[16:19]
    buffer_load_dwordx4 a[60:63], v1, s[12:15], s45 offen offset:0
    v_mfma_f32_16x16x32_bf16 v[36:39], a[80:83], v[164:167], v[36:39]
    buffer_load_dwordx4 a[64:67], v1, s[12:15], s45 offen offset:1024
    v_mfma_f32_16x16x32_bf16 v[56:59], a[80:83], v[168:171], v[56:59]
    buffer_load_dwordx4 a[68:71], v1, s[12:15], s45 offen offset:2048
    v_mfma_f32_16x16x32_bf16 v[76:79], a[80:83], v[172:175], v[76:79]
    buffer_load_dwordx4 a[72:75], v1, s[12:15], s45 offen offset:3072
    v_mfma_f32_16x16x32_bf16 v[20:23], a[84:87], v[160:163], v[20:23]
    buffer_load_dwordx4 a[76:79], v2, s[12:15], s45 offen
    v_mfma_f32_16x16x32_bf16 v[40:43], a[84:87], v[164:167], v[40:43]
    buffer_load_dwordx4 v[144:147], v7, s[12:15], s44 offen
    v_mfma_f32_16x16x32_bf16 v[60:63], a[84:87], v[168:171], v[60:63]
    buffer_load_dwordx4 v[148:151], v8, s[12:15], s44 offen
    v_mfma_f32_16x16x32_bf16 v[80:83], a[84:87], v[172:175], v[80:83]
    buffer_load_dwordx4 v[152:155], v9, s[12:15], s44 offen
    v_mfma_f32_16x16x32_bf16 v[24:27], a[88:91], v[160:163], v[24:27]
    buffer_load_dwordx4 v[156:159], v10, s[12:15], s44 offen
    v_mfma_f32_16x16x32_bf16 v[44:47], a[88:91], v[164:167], v[44:47]
    s_add_u32 s44, s44, 1024
    s_add_u32 s45, s45, 5120
    v_mfma_f32_16x16x32_bf16 v[64:67], a[88:91], v[168:171], v[64:67]
    v_mfma_f32_16x16x32_bf16 v[84:87], a[88:91], v[172:175], v[84:87]
    v_mfma_f32_16x16x32_bf16 v[28:31], a[92:95], v[160:163], v[28:31]
    v_mfma_f32_16x16x32_bf16 v[48:51], a[92:95], v[164:167], v[48:51]
    v_mfma_f32_16x16x32_bf16 v[68:71], a[92:95], v[168:171], v[68:71]
    v_mfma_f32_16x16x32_bf16 v[88:91], a[92:95], v[172:175], v[88:91]
    v_mfma_f32_16x16x32_bf16 v[32:35], a[96:99], v[160:163], v[32:35]
    v_mfma_f32_16x16x32_bf16 v[52:55], a[96:99], v[164:167], v[52:55]
    v_mfma_f32_16x16x32_bf16 v[72:75], a[96:99], v[168:171], v[72:75]
    v_mfma_f32_16x16x32_bf16 v[92:95], a[96:99], v[172:175], v[92:95]
    s_waitcnt vmcnt(27)
    v_mfma_f32_16x16x32_bf16 v[16:19], a[0:3], v[96:99], v[16:19]
    buffer_load_dwordx4 a[80:83], v1, s[12:15], s45 offen offset:0
    v_mfma_f32_16x16x32_bf16 v[36:39], a[0:3], v[100:103], v[36:39]
    buffer_load_dwordx4 a[84:87], v1, s[12:15], s45 offen offset:1024
    v_mfma_f32_16x16x32_bf16 v[56:59], a[0:3], v[104:107], v[56:59]
    buffer_load_dwordx4 a[88:91], v1, s[12:15], s45 offen offset:2048
    v_mfma_f32_16x16x32_bf16 v[76:79], a[0:3], v[108:111], v[76:79]
    buffer_load_dwordx4 a[92:95], v1, s[12:15], s45 offen offset:3072
    v_mfma_f32_16x16x32_bf16 v[20:23], a[4:7], v[96:99], v[20:23]
    buffer_load_dwordx4 a[96:99], v2, s[12:15], s45 offen
    v_mfma_f32_16x16x32_bf16 v[40:43], a[4:7], v[100:103], v[40:43]
    buffer_load_dwordx4 v[160:163], v7, s[12:15], s44 offen
    v_mfma_f32_16x16x32_bf16 v[60:63], a[4:7], v[104:107], v[60:63]
    buffer_load_dwordx4 v[164:167], v8, s[12:15], s44 offen
    v_mfma_f32_16x16x32_bf16 v[80:83], a[4:7], v[108:111], v[80:83]
    buffer_load_dwordx4 v[168:171], v9, s[12:15], s44 offen
    v_mfma_f32_16x16x32_bf16 v[24:27], a[8:11], v[96:99], v[24:27]
    buffer_load_dwordx4 v[172:175], v10, s[12:15], s44 offen
    v_mfma_f32_16x16x32_bf16 v[44:47], a[8:11], v[100:103], v[44:47]
    s_add_u32 s44, s44, 1024
    s_add_u32 s45, s45, 5120
    v_mfma_f32_16x16x32_bf16 v[64:67], a[8:11], v[104:107], v[64:67]
    v_mfma_f32_16x16x32_bf16 v[84:87], a[8:11], v[108:111], v[84:87]
    v_mfma_f32_16x16x32_bf16 v[28:31], a[12:15], v[96:99], v[28:31]
    v_mfma_f32_16x16x32_bf16 v[48:51], a[12:15], v[100:103], v[48:51]
    v_mfma_f32_16x16x32_bf16 v[68:71], a[12:15], v[104:107], v[68:71]
    v_mfma_f32_16x16x32_bf16 v[88:91], a[12:15], v[108:111], v[88:91]
    v_mfma_f32_16x16x32_bf16 v[32:35], a[16:19], v[96:99], v[32:35]
    v_mfma_f32_16x16x32_bf16 v[52:55], a[16:19], v[100:103], v[52:55]
    v_mfma_f32_16x16x32_bf16 v[72:75], a[16:19], v[104:107], v[72:75]
    v_mfma_f32_16x16x32_bf16 v[92:95], a[16:19], v[108:111], v[92:95]
    s_waitcnt vmcnt(27)
    v_mfma_f32_16x16x32_bf16 v[16:19], a[20:23], v[112:115], v[16:19]
    buffer_load_dwordx4 a[0:3], v1, s[12:15], s45 offen offset:0
    v_mfma_f32_16x16x32_bf16 v[36:39], a[20:23], v[116:119], v[36:39]
    buffer_load_dwordx4 a[4:7], v1, s[12:15], s45 offen offset:1024
    v_mfma_f32_16x16x32_bf16 v[56:59], a[20:23], v[120:123], v[56:59]
    buffer_load_dwordx4 a[8:11], v1, s[12:15], s45 offen offset:2048
    v_mfma_f32_16x16x32_bf16 v[76:79], a[20:23], v[124:127], v[76:79]
    buffer_load_dwordx4 a[12:15], v1, s[12:15], s45 offen offset:3072
    v_mfma_f32_16x16x32_bf16 v[20:23], a[24:27], v[112:115], v[20:23]
    buffer_load_dwordx4 a[16:19], v2, s[12:15], s45 offen
    v_mfma_f32_16x16x32_bf16 v[40:43], a[24:27], v[116:119], v[40:43]
    buffer_load_dwordx4 v[96:99], v7, s[12:15], s44 offen
    v_mfma_f32_16x16x32_bf16 v[60:63], a[24:27], v[120:123], v[60:63]
    buffer_load_dwordx4 v[100:103], v8, s[12:15], s44 offen
    v_mfma_f32_16x16x32_bf16 v[80:83], a[24:27], v[124:127], v[80:83]
    buffer_load_dwordx4 v[104:107], v9, s[12:15], s44 offen
    v_mfma_f32_16x16x32_bf16 v[24:27], a[28:31], v[112:115], v[24:27]
    buffer_load_dwordx4 v[108:111], v10, s[12:15], s44 offen
    v_mfma_f32_16x16x32_bf16 v[44:47], a[28:31], v[116:119], v[44:47]
    s_add_u32 s44, s44, 1024
    s_add_u32 s45, s45, 5120
    v_mfma_f32_16x16x32_bf16 v[64:67], a[28:31], v[120:123], v[64:67]
    v_mfma_f32_16x16x32_bf16 v[84:87], a[28:31], v[124:127], v[84:87]
    v_mfma_f32_16x16x32_bf16 v[28:31], a[32:35], v[112:115], v[28:31]
    v_mfma_f32_16x16x32_bf16 v[48:51], a[32:35], v[116:119], v[48:51]
    v_mfma_f32_16x16x32_bf16 v[68:71], a[32:35], v[120:123], v[68:71]
    v_mfma_f32_16x16x32_bf16 v[88:91], a[32:35], v[124:127], v[88:91]
    v_mfma_f32_16x16x32_bf16 v[32:35], a[36:39], v[112:115], v[32:35]
    v_mfma_f32_16x16x32_bf16 v[52:55], a[36:39], v[116:119], v[52:55]
    v_mfma_f32_16x16x32_bf16 v[72:75], a[36:39], v[120:123], v[72:75]
    v_mfma_f32_16x16x32_bf16 v[92:95], a[36:39], v[124:127], v[92:95]
    s_waitcnt vmcnt(27)
    v_mfma_f32_16x16x32_bf16 v[16:19], a[40:43], v[128:131], v[16:19]
    buffer_load_dwordx4 a[20:23], v1, s[12:15], s45 offen offset:0
    v_mfma_f32_16x16x32_bf16 v[36:39], a[40:43], v[132:135], v[36:39]
    buffer_load_dwordx4 a[24:27], v1, s[12:15], s45 offen offset:1024
    v_mfma_f32_16x16x32_bf16 v[56:59], a[40:43], v[136:139], v[56:59]
    buffer_load_dwordx4 a[28:31], v1, s[12:15], s45 offen offset:2048
    v_mfma_f32_16x16x32_bf16 v[76:79], a[40:43], v[140:143], v[76:79]
    buffer_load_dwordx4 a[32:35], v1, s[12:15], s45 offen offset:3072
    v_mfma_f32_16x16x32_bf16 v[20:23], a[44:47], v[128:131], v[20:23]
    buffer_load_dwordx4 a[36:39], v2, s[12:15], s45 offen
    v_mfma_f32_16x16x32_bf16 v[40:43], a[44:47], v[132:135], v[40:43]
    buffer_load_dwordx4 v[112:115], v7, s[12:15], s44 offen
    v_mfma_f32_16x16x32_bf16 v[60:63], a[44:47], v[136:139], v[60:63]
    buffer_load_dwordx4 v[116:119], v8, s[12:15], s44 offen
    v_mfma_f32_16x16x32_bf16 v[80:83], a[44:47], v[140:143], v[80:83]
    buffer_load_dwordx4 v[120:123], v9, s[12:15], s44 offen
    v_mfma_f32_16x16x32_bf16 v[24:27], a[48:51], v[128:131], v[24:27]
    buffer_load_dwordx4 v[124:127], v10, s[12:15], s44 offen
    v_mfma_f32_16x16x32_bf16 v[44:47], a[48:51], v[132:135], v[44:47]
    s_add_u32 s44, s44, 1024
    s_add_u32 s45, s45, 5120
    v_mfma_f32_16x16x32_bf16 v[64:67], a[48:51], v[136:139], v[64:67]
    v_mfma_f32_16x16x32_bf16 v[84:87], a[48:51], v[140:143], v[84:87]
    v_mfma_f32_16x16x32_bf16 v[28:31], a[52:55], v[128:131], v[28:31]
    v_mfma_f32_16x16x32_bf16 v[48:51], a[52:55], v[132:135], v[48:51]
    v_mfma_f32_16x16x32_bf16 v[68:71], a[52:55], v[136:139], v[68:71]
    v_mfma_f32_16x16x32_bf16 v[88:91], a[52:55], v[140:143], v[88:91]
    v_mfma_f32_16x16x32_bf16 v[32:35], a[56:59], v[128:131], v[32:35]
    v_mfma_f32_16x16x32_bf16 v[52:55], a[56:59], v[132:135], v[52:55]
    v_mfma_f32_16x16x32_bf16 v[72:75], a[56:59], v[136:139], v[72:75]
    v_mfma_f32_16x16x32_bf16 v[92:95], a[56:59], v[140:143], v[92:95]
    s_waitcnt vmcnt(27)
    v_mfma_f32_16x16x32_bf16 v[16:19], a[60:63], v[144:147], v[16:19]
    buffer_load_dwordx4 a[40:43], v1, s[12:15], s45 offen offset:0
    v_mfma_f32_16x16x32_bf16 v[36:39], a[60:63], v[148:151], v[36:39]
    buffer_load_dwordx4 a[44:47], v1, s[12:15], s45 offen offset:1024
    v_mfma_f32_16x16x32_bf16 v[56:59], a[60:63], v[152:155], v[56:59]
    buffer_load_dwordx4 a[48:51], v1, s[12:15], s45 offen offset:2048
    v_mfma_f32_16x16x32_bf16 v[76:79], a[60:63], v[156:159], v[76:79]
    buffer_load_dwordx4 a[52:55], v1, s[12:15], s45 offen offset:3072
    v_mfma_f32_16x16x32_bf16 v[20:23], a[64:67], v[144:147], v[20:23]
    buffer_load_dwordx4 a[56:59], v2, s[12:15], s45 offen
    v_mfma_f32_16x16x32_bf16 v[40:43], a[64:67], v[148:151], v[40:43]
    buffer_load_dwordx4 v[128:131], v7, s[12:15], s44 offen
    v_mfma_f32_16x16x32_bf16 v[60:63], a[64:67], v[152:155], v[60:63]
    buffer_load_dwordx4 v[132:135], v8, s[12:15], s44 offen
    v_mfma_f32_16x16x32_bf16 v[80:83], a[64:67], v[156:159], v[80:83]
    buffer_load_dwordx4 v[136:139], v9, s[12:15], s44 offen
    v_mfma_f32_16x16x32_bf16 v[24:27], a[68:71], v[144:147], v[24:27]
    buffer_load_dwordx4 v[140:143], v10, s[12:15], s44 offen
    v_mfma_f32_16x16x32_bf16 v[44:47], a[68:71], v[148:151], v[44:47]
    s_add_u32 s44, s44, 1024
    s_add_u32 s45, s45, 5120
    v_mfma_f32_16x16x32_bf16 v[64:67], a[68:71], v[152:155], v[64:67]
    v_mfma_f32_16x16x32_bf16 v[84:87], a[68:71], v[156:159], v[84:87]
    v_mfma_f32_16x16x32_bf16 v[28:31], a[72:75], v[144:147], v[28:31]
    v_mfma_f32_16x16x32_bf16 v[48:51], a[72:75], v[148:151], v[48:51]
    v_mfma_f32_16x16x32_bf16 v[68:71], a[72:75], v[152:155], v[68:71]
    v_mfma_f32_16x16x32_bf16 v[88:91], a[72:75], v[156:159], v[88:91]
    v_mfma_f32_16x16x32_bf16 v[32:35], a[76:79], v[144:147], v[32:35]
    v_mfma_f32_16x16x32_bf16 v[52:55], a[76:79], v[148:151], v[52:55]
    v_mfma_f32_16x16x32_bf16 v[72:75], a[76:79], v[152:155], v[72:75]
    v_mfma_f32_16x16x32_bf16 v[92:95], a[76:79], v[156:159], v[92:95]
    s_waitcnt vmcnt(27)
    v_mfma_f32_16x16x32_bf16 v[16:19], a[80:83], v[160:163], v[16:19]
    buffer_load_dwordx4 a[60:63], v1, s[12:15], s45 offen offset:0
    v_mfma_f32_16x16x32_bf16 v[36:39], a[80:83], v[164:167], v[36:39]
    buffer_load_dwordx4 a[64:67], v1, s[12:15], s45 offen offset:1024
    v_mfma_f32_16x16x32_bf16 v[56:59], a[80:83], v[168:171], v[56:59]
    buffer_load_dwordx4 a[68:71], v1, s[12:15], s45 offen offset:2048
    v_mfma_f32_16x16x32_bf16 v[76:79], a[80:83], v[172:175], v[76:79]
    buffer_load_dwordx4 a[72:75], v1, s[12:15], s45 offen offset:3072
    v_mfma_f32_16x16x32_bf16 v[20:23], a[84:87], v[160:163], v[20:23]
    buffer_load_dwordx4 a[76:79], v2, s[12:15], s45 offen
    v_mfma_f32_16x16x32_bf16 v[40:43], a[84:87], v[164:167], v[40:43]
    buffer_load_dwordx4 v[144:147], v7, s[12:15], s44 offen
    v_mfma_f32_16x16x32_bf16 v[60:63], a[84:87], v[168:171], v[60:63]
    buffer_load_dwordx4 v[148:151], v8, s[12:15], s44 offen
    v_mfma_f32_16x16x32_bf16 v[80:83], a[84:87], v[172:175], v[80:83]
    buffer_load_dwordx4 v[152:155], v9, s[12:15], s44 offen
    v_mfma_f32_16x16x32_bf16 v[24:27], a[88:91], v[160:163], v[24:27]
    buffer_load_dwordx4 v[156:159], v10, s[12:15], s44 offen
    v_mfma_f32_16x16x32_bf16 v[44:47], a[88:91], v[164:167], v[44:47]
    s_add_u32 s44, s44, 1024
    s_add_u32 s45, s45, 5120
    v_mfma_f32_16x16x32_bf16 v[64:67], a[88:91], v[168:171], v[64:67]
    v_mfma_f32_16x16x32_bf16 v[84:87], a[88:91], v[172:175], v[84:87]
    v_mfma_f32_16x16x32_bf16 v[28:31], a[92:95], v[160:163], v[28:31]
    v_mfma_f32_16x16x32_bf16 v[48:51], a[92:95], v[164:167], v[48:51]
    v_mfma_f32_16x16x32_bf16 v[68:71], a[92:95], v[168:171], v[68:71]
    v_mfma_f32_16x16x32_bf16 v[88:91], a[92:95], v[172:175], v[88:91]
    v_mfma_f32_16x16x32_bf16 v[32:35], a[96:99], v[160:163], v[32:35]
    v_mfma_f32_16x16x32_bf16 v[52:55], a[96:99], v[164:167], v[52:55]
    v_mfma_f32_16x16x32_bf16 v[72:75], a[96:99], v[168:171], v[72:75]
    v_mfma_f32_16x16x32_bf16 v[92:95], a[96:99], v[172:175], v[92:95]
    s_waitcnt vmcnt(27)
    v_mfma_f32_16x16x32_bf16 v[16:19], a[0:3], v[96:99], v[16:19]
    buffer_load_dwordx4 a[80:83], v1, s[12:15], s45 offen offset:0
    v_mfma_f32_16x16x32_bf16 v[36:39], a[0:3], v[100:103], v[36:39]
    buffer_load_dwordx4 a[84:87], v1, s[12:15], s45 offen offset:1024
    v_mfma_f32_16x16x32_bf16 v[56:59], a[0:3], v[104:107], v[56:59]
    buffer_load_dwordx4 a[88:91], v1, s[12:15], s45 offen offset:2048
    v_mfma_f32_16x16x32_bf16 v[76:79], a[0:3], v[108:111], v[76:79]
    buffer_load_dwordx4 a[92:95], v1, s[12:15], s45 offen offset:3072
    v_mfma_f32_16x16x32_bf16 v[20:23], a[4:7], v[96:99], v[20:23]
    buffer_load_dwordx4 a[96:99], v2, s[12:15], s45 offen
    v_mfma_f32_16x16x32_bf16 v[40:43], a[4:7], v[100:103], v[40:43]
    buffer_load_dwordx4 v[160:163], v7, s[12:15], s44 offen
    v_mfma_f32_16x16x32_bf16 v[60:63], a[4:7], v[104:107], v[60:63]
    buffer_load_dwordx4 v[164:167], v8, s[12:15], s44 offen
    v_mfma_f32_16x16x32_bf16 v[80:83], a[4:7], v[108:111], v[80:83]
    buffer_load_dwordx4 v[168:171], v9, s[12:15], s44 offen
    v_mfma_f32_16x16x32_bf16 v[24:27], a[8:11], v[96:99], v[24:27]
    buffer_load_dwordx4 v[172:175], v10, s[12:15], s44 offen
    v_mfma_f32_16x16x32_bf16 v[44:47], a[8:11], v[100:103], v[44:47]
    s_add_u32 s44, s44, 1024
    s_add_u32 s45, s45, 5120
    v_mfma_f32_16x16x32_bf16 v[64:67], a[8:11], v[104:107], v[64:67]
    v_mfma_f32_16x16x32_bf16 v[84:87], a[8:11], v[108:111], v[84:87]
    v_mfma_f32_16x16x32_bf16 v[28:31], a[12:15], v[96:99], v[28:31]
    v_mfma_f32_16x16x32_bf16 v[48:51], a[12:15], v[100:103], v[48:51]
    v_mfma_f32_16x16x32_bf16 v[68:71], a[12:15], v[104:107], v[68:71]
    v_mfma_f32_16x16x32_bf16 v[88:91], a[12:15], v[108:111], v[88:91]
    v_mfma_f32_16x16x32_bf16 v[32:35], a[16:19], v[96:99], v[32:35]
    v_mfma_f32_16x16x32_bf16 v[52:55], a[16:19], v[100:103], v[52:55]
    v_mfma_f32_16x16x32_bf16 v[72:75], a[16:19], v[104:107], v[72:75]
    v_mfma_f32_16x16x32_bf16 v[92:95], a[16:19], v[108:111], v[92:95]
    s_waitcnt vmcnt(27)
    v_mfma_f32_16x16x32_bf16 v[16:19], a[20:23], v[112:115], v[16:19]
    buffer_load_dwordx4 a[0:3], v1, s[12:15], s45 offen offset:0
    v_mfma_f32_16x16x32_bf16 v[36:39], a[20:23], v[116:119], v[36:39]
    buffer_load_dwordx4 a[4:7], v1, s[12:15], s45 offen offset:1024
    v_mfma_f32_16x16x32_bf16 v[56:59], a[20:23], v[120:123], v[56:59]
    buffer_load_dwordx4 a[8:11], v1, s[12:15], s45 offen offset:2048
    v_mfma_f32_16x16x32_bf16 v[76:79], a[20:23], v[124:127], v[76:79]
    buffer_load_dwordx4 a[12:15], v1, s[12:15], s45 offen offset:3072
    v_mfma_f32_16x16x32_bf16 v[20:23], a[24:27], v[112:115], v[20:23]
    buffer_load_dwordx4 a[16:19], v2, s[12:15], s45 offen
    v_mfma_f32_16x16x32_bf16 v[40:43], a[24:27], v[116:119], v[40:43]
    buffer_load_dwordx4 v[96:99], v7, s[12:15], s44 offen
    v_mfma_f32_16x16x32_bf16 v[60:63], a[24:27], v[120:123], v[60:63]
    buffer_load_dwordx4 v[100:103], v8, s[12:15], s44 offen
    v_mfma_f32_16x16x32_bf16 v[80:83], a[24:27], v[124:127], v[80:83]
    buffer_load_dwordx4 v[104:107], v9, s[12:15], s44 offen
    v_mfma_f32_16x16x32_bf16 v[24:27], a[28:31], v[112:115], v[24:27]
    buffer_load_dwordx4 v[108:111], v10, s[12:15], s44 offen
    v_mfma_f32_16x16x32_bf16 v[44:47], a[28:31], v[116:119], v[44:47]
    s_add_u32 s44, s44, 1024
    s_add_u32 s45, s45, 5120
    v_mfma_f32_16x16x32_bf16 v[64:67], a[28:31], v[120:123], v[64:67]
    v_mfma_f32_16x16x32_bf16 v[84:87], a[28:31], v[124:127], v[84:87]
    v_mfma_f32_16x16x32_bf16 v[28:31], a[32:35], v[112:115], v[28:31]
    v_mfma_f32_16x16x32_bf16 v[48:51], a[32:35], v[116:119], v[48:51]
    v_mfma_f32_16x16x32_bf16 v[68:71], a[32:35], v[120:123], v[68:71]
    v_mfma_f32_16x16x32_bf16 v[88:91], a[32:35], v[124:127], v[88:91]
    v_mfma_f32_16x16x32_bf16 v[32:35], a[36:39], v[112:115], v[32:35]
    v_mfma_f32_16x16x32_bf16 v[52:55], a[36:39], v[116:119], v[52:55]
    v_mfma_f32_16x16x32_bf16 v[72:75], a[36:39], v[120:123], v[72:75]
    v_mfma_f32_16x16x32_bf16 v[92:95], a[36:39], v[124:127], v[92:95]
    s_waitcnt vmcnt(27)
    v_mfma_f32_16x16x32_bf16 v[16:19], a[40:43], v[128:131], v[16:19]
    buffer_load_dwordx4 a[20:23], v1, s[12:15], s45 offen offset:0
    v_mfma_f32_16x16x32_bf16 v[36:39], a[40:43], v[132:135], v[36:39]
    buffer_load_dwordx4 a[24:27], v1, s[12:15], s45 offen offset:1024
    v_mfma_f32_16x16x32_bf16 v[56:59], a[40:43], v[136:139], v[56:59]
    buffer_load_dwordx4 a[28:31], v1, s[12:15], s45 offen offset:2048
    v_mfma_f32_16x16x32_bf16 v[76:79], a[40:43], v[140:143], v[76:79]
    buffer_load_dwordx4 a[32:35], v1, s[12:15], s45 offen offset:3072
    v_mfma_f32_16x16x32_bf16 v[20:23], a[44:47], v[128:131], v[20:23]
    buffer_load_dwordx4 a[36:39], v2, s[12:15], s45 offen
    v_mfma_f32_16x16x32_bf16 v[40:43], a[44:47], v[132:135], v[40:43]
    buffer_load_dwordx4 v[112:115], v7, s[12:15], s44 offen
    v_mfma_f32_16x16x32_bf16 v[60:63], a[44:47], v[136:139], v[60:63]
    buffer_load_dwordx4 v[116:119], v8, s[12:15], s44 offen
    v_mfma_f32_16x16x32_bf16 v[80:83], a[44:47], v[140:143], v[80:83]
    buffer_load_dwordx4 v[120:123], v9, s[12:15], s44 offen
    v_mfma_f32_16x16x32_bf16 v[24:27], a[48:51], v[128:131], v[24:27]
    buffer_load_dwordx4 v[124:127], v10, s[12:15], s44 offen
    v_mfma_f32_16x16x32_bf16 v[44:47], a[48:51], v[132:135], v[44:47]
    s_add_u32 s44, s44, 1024
    s_add_u32 s45, s45, 5120
    v_mfma_f32_16x16x32_bf16 v[64:67], a[48:51], v[136:139], v[64:67]
    v_mfma_f32_16x16x32_bf16 v[84:87], a[48:51], v[140:143], v[84:87]
    v_mfma_f32_16x16x32_bf16 v[28:31], a[52:55], v[128:131], v[28:31]
    v_mfma_f32_16x16x32_bf16 v[48:51], a[52:55], v[132:135], v[48:51]
    v_mfma_f32_16x16x32_bf16 v[68:71], a[52:55], v[136:139], v[68:71]
    v_mfma_f32_16x16x32_bf16 v[88:91], a[52:55], v[140:143], v[88:91]
    v_mfma_f32_16x16x32_bf16 v[32:35], a[56:59], v[128:131], v[32:35]
    v_mfma_f32_16x16x32_bf16 v[52:55], a[56:59], v[132:135], v[52:55]
    v_mfma_f32_16x16x32_bf16 v[72:75], a[56:59], v[136:139], v[72:75]
    v_mfma_f32_16x16x32_bf16 v[92:95], a[56:59], v[140:143], v[92:95]
    s_waitcnt vmcnt(27)
    v_mfma_f32_16x16x32_bf16 v[16:19], a[60:63], v[144:147], v[16:19]
    buffer_load_dwordx4 a[40:43], v1, s[12:15], s45 offen offset:0
    v_mfma_f32_16x16x32_bf16 v[36:39], a[60:63], v[148:151], v[36:39]
    buffer_load_dwordx4 a[44:47], v1, s[12:15], s45 offen offset:1024
    v_mfma_f32_16x16x32_bf16 v[56:59], a[60:63], v[152:155], v[56:59]
    buffer_load_dwordx4 a[48:51], v1, s[12:15], s45 offen offset:2048
    v_mfma_f32_16x16x32_bf16 v[76:79], a[60:63], v[156:159], v[76:79]
    buffer_load_dwordx4 a[52:55], v1, s[12:15], s45 offen offset:3072
    v_mfma_f32_16x16x32_bf16 v[20:23], a[64:67], v[144:147], v[20:23]
    buffer_load_dwordx4 a[56:59], v2, s[12:15], s45 offen
    v_mfma_f32_16x16x32_bf16 v[40:43], a[64:67], v[148:151], v[40:43]
    buffer_load_dwordx4 v[128:131], v7, s[12:15], s44 offen
    v_mfma_f32_16x16x32_bf16 v[60:63], a[64:67], v[152:155], v[60:63]
    buffer_load_dwordx4 v[132:135], v8, s[12:15], s44 offen
    v_mfma_f32_16x16x32_bf16 v[80:83], a[64:67], v[156:159], v[80:83]
    buffer_load_dwordx4 v[136:139], v9, s[12:15], s44 offen
    v_mfma_f32_16x16x32_bf16 v[24:27], a[68:71], v[144:147], v[24:27]
    buffer_load_dwordx4 v[140:143], v10, s[12:15], s44 offen
    v_mfma_f32_16x16x32_bf16 v[44:47], a[68:71], v[148:151], v[44:47]
    s_add_u32 s44, s44, 1024
    s_add_u32 s45, s45, 5120
    v_mfma_f32_16x16x32_bf16 v[64:67], a[68:71], v[152:155], v[64:67]
    v_mfma_f32_16x16x32_bf16 v[84:87], a[68:71], v[156:159], v[84:87]
    v_mfma_f32_16x16x32_bf16 v[28:31], a[72:75], v[144:147], v[28:31]
    v_mfma_f32_16x16x32_bf16 v[48:51], a[72:75], v[148:151], v[48:51]
    v_mfma_f32_16x16x32_bf16 v[68:71], a[72:75], v[152:155], v[68:71]
    v_mfma_f32_16x16x32_bf16 v[88:91], a[72:75], v[156:159], v[88:91]
    v_mfma_f32_16x16x32_bf16 v[32:35], a[76:79], v[144:147], v[32:35]
    v_mfma_f32_16x16x32_bf16 v[52:55], a[76:79], v[148:151], v[52:55]
    v_mfma_f32_16x16x32_bf16 v[72:75], a[76:79], v[152:155], v[72:75]
    v_mfma_f32_16x16x32_bf16 v[92:95], a[76:79], v[156:159], v[92:95]
    s_waitcnt vmcnt(27)
    v_mfma_f32_16x16x32_bf16 v[16:19], a[80:83], v[160:163], v[16:19]
    buffer_load_dwordx4 a[60:63], v1, s[12:15], s45 offen offset:0
    v_mfma_f32_16x16x32_bf16 v[36:39], a[80:83], v[164:167], v[36:39]
    buffer_load_dwordx4 a[64:67], v1, s[12:15], s45 offen offset:1024
    v_mfma_f32_16x16x32_bf16 v[56:59], a[80:83], v[168:171], v[56:59]
    buffer_load_dwordx4 a[68:71], v1, s[12:15], s45 offen offset:2048
    v_mfma_f32_16x16x32_bf16 v[76:79], a[80:83], v[172:175], v[76:79]
    buffer_load_dwordx4 a[72:75], v1, s[12:15], s45 offen offset:3072
    v_mfma_f32_16x16x32_bf16 v[20:23], a[84:87], v[160:163], v[20:23]
    buffer_load_dwordx4 a[76:79], v2, s[12:15], s45 offen
    v_mfma_f32_16x16x32_bf16 v[40:43], a[84:87], v[164:167], v[40:43]
    buffer_load_dwordx4 v[144:147], v7, s[12:15], s44 offen
    v_mfma_f32_16x16x32_bf16 v[60:63], a[84:87], v[168:171], v[60:63]
    buffer_load_dwordx4 v[148:151], v8, s[12:15], s44 offen
    v_mfma_f32_16x16x32_bf16 v[80:83], a[84:87], v[172:175], v[80:83]
    buffer_load_dwordx4 v[152:155], v9, s[12:15], s44 offen
    v_mfma_f32_16x16x32_bf16 v[24:27], a[88:91], v[160:163], v[24:27]
    buffer_load_dwordx4 v[156:159], v10, s[12:15], s44 offen
    v_mfma_f32_16x16x32_bf16 v[44:47], a[88:91], v[164:167], v[44:47]
    s_add_u32 s44, s44, 1024
    s_add_u32 s45, s45, 5120
    v_mfma_f32_16x16x32_bf16 v[64:67], a[88:91], v[168:171], v[64:67]
    v_mfma_f32_16x16x32_bf16 v[84:87], a[88:91], v[172:175], v[84:87]
    v_mfma_f32_16x16x32_bf16 v[28:31], a[92:95], v[160:163], v[28:31]
    v_mfma_f32_16x16x32_bf16 v[48:51], a[92:95], v[164:167], v[48:51]
    v_mfma_f32_16x16x32_bf16 v[68:71], a[92:95], v[168:171], v[68:71]
    v_mfma_f32_16x16x32_bf16 v[88:91], a[92:95], v[172:175], v[88:91]
    v_mfma_f32_16x16x32_bf16 v[32:35], a[96:99], v[160:163], v[32:35]
    v_mfma_f32_16x16x32_bf16 v[52:55], a[96:99], v[164:167], v[52:55]
    v_mfma_f32_16x16x32_bf16 v[72:75], a[96:99], v[168:171], v[72:75]
    v_mfma_f32_16x16x32_bf16 v[92:95], a[96:99], v[172:175], v[92:95]
    s_waitcnt vmcnt(27)
    v_mfma_f32_16x16x32_bf16 v[16:19], a[0:3], v[96:99], v[16:19]
    buffer_load_dwordx4 a[80:83], v1, s[12:15], s45 offen offset:0
    v_mfma_f32_16x16x32_bf16 v[36:39], a[0:3], v[100:103], v[36:39]
    buffer_load_dwordx4 a[84:87], v1, s[12:15], s45 offen offset:1024
    v_mfma_f32_16x16x32_bf16 v[56:59], a[0:3], v[104:107], v[56:59]
    buffer_load_dwordx4 a[88:91], v1, s[12:15], s45 offen offset:2048
    v_mfma_f32_16x16x32_bf16 v[76:79], a[0:3], v[108:111], v[76:79]
    buffer_load_dwordx4 a[92:95], v1, s[12:15], s45 offen offset:3072
    v_mfma_f32_16x16x32_bf16 v[20:23], a[4:7], v[96:99], v[20:23]
    buffer_load_dwordx4 a[96:99], v2, s[12:15], s45 offen
    v_mfma_f32_16x16x32_bf16 v[40:43], a[4:7], v[100:103], v[40:43]
    buffer_load_dwordx4 v[160:163], v7, s[12:15], s44 offen
    v_mfma_f32_16x16x32_bf16 v[60:63], a[4:7], v[104:107], v[60:63]
    buffer_load_dwordx4 v[164:167], v8, s[12:15], s44 offen
    v_mfma_f32_16x16x32_bf16 v[80:83], a[4:7], v[108:111], v[80:83]
    buffer_load_dwordx4 v[168:171], v9, s[12:15], s44 offen
    v_mfma_f32_16x16x32_bf16 v[24:27], a[8:11], v[96:99], v[24:27]
    buffer_load_dwordx4 v[172:175], v10, s[12:15], s44 offen
    v_mfma_f32_16x16x32_bf16 v[44:47], a[8:11], v[100:103], v[44:47]
    s_add_u32 s44, s44, 1024
    s_add_u32 s45, s45, 5120
    v_mfma_f32_16x16x32_bf16 v[64:67], a[8:11], v[104:107], v[64:67]
    v_mfma_f32_16x16x32_bf16 v[84:87], a[8:11], v[108:111], v[84:87]
    v_mfma_f32_16x16x32_bf16 v[28:31], a[12:15], v[96:99], v[28:31]
    v_mfma_f32_16x16x32_bf16 v[48:51], a[12:15], v[100:103], v[48:51]
    v_mfma_f32_16x16x32_bf16 v[68:71], a[12:15], v[104:107], v[68:71]
    v_mfma_f32_16x16x32_bf16 v[88:91], a[12:15], v[108:111], v[88:91]
    v_mfma_f32_16x16x32_bf16 v[32:35], a[16:19], v[96:99], v[32:35]
    v_mfma_f32_16x16x32_bf16 v[52:55], a[16:19], v[100:103], v[52:55]
    v_mfma_f32_16x16x32_bf16 v[72:75], a[16:19], v[104:107], v[72:75]
    v_mfma_f32_16x16x32_bf16 v[92:95], a[16:19], v[108:111], v[92:95]
    s_waitcnt vmcnt(27)
    v_mfma_f32_16x16x32_bf16 v[16:19], a[20:23], v[112:115], v[16:19]
    buffer_load_dwordx4 a[0:3], v1, s[12:15], s45 offen offset:0
    v_mfma_f32_16x16x32_bf16 v[36:39], a[20:23], v[116:119], v[36:39]
    buffer_load_dwordx4 a[4:7], v1, s[12:15], s45 offen offset:1024
    v_mfma_f32_16x16x32_bf16 v[56:59], a[20:23], v[120:123], v[56:59]
    buffer_load_dwordx4 a[8:11], v1, s[12:15], s45 offen offset:2048
    v_mfma_f32_16x16x32_bf16 v[76:79], a[20:23], v[124:127], v[76:79]
    buffer_load_dwordx4 a[12:15], v1, s[12:15], s45 offen offset:3072
    v_mfma_f32_16x16x32_bf16 v[20:23], a[24:27], v[112:115], v[20:23]
    buffer_load_dwordx4 a[16:19], v2, s[12:15], s45 offen
    v_mfma_f32_16x16x32_bf16 v[40:43], a[24:27], v[116:119], v[40:43]
    buffer_load_dwordx4 v[96:99], v7, s[12:15], s44 offen
    v_mfma_f32_16x16x32_bf16 v[60:63], a[24:27], v[120:123], v[60:63]
    buffer_load_dwordx4 v[100:103], v8, s[12:15], s44 offen
    v_mfma_f32_16x16x32_bf16 v[80:83], a[24:27], v[124:127], v[80:83]
    buffer_load_dwordx4 v[104:107], v9, s[12:15], s44 offen
    v_mfma_f32_16x16x32_bf16 v[24:27], a[28:31], v[112:115], v[24:27]
    buffer_load_dwordx4 v[108:111], v10, s[12:15], s44 offen
    v_mfma_f32_16x16x32_bf16 v[44:47], a[28:31], v[116:119], v[44:47]
    s_add_u32 s44, s44, 1024
    s_add_u32 s45, s45, 5120
    v_mfma_f32_16x16x32_bf16 v[64:67], a[28:31], v[120:123], v[64:67]
    v_mfma_f32_16x16x32_bf16 v[84:87], a[28:31], v[124:127], v[84:87]
    v_mfma_f32_16x16x32_bf16 v[28:31], a[32:35], v[112:115], v[28:31]
    v_mfma_f32_16x16x32_bf16 v[48:51], a[32:35], v[116:119], v[48:51]
    v_mfma_f32_16x16x32_bf16 v[68:71], a[32:35], v[120:123], v[68:71]
    v_mfma_f32_16x16x32_bf16 v[88:91], a[32:35], v[124:127], v[88:91]
    v_mfma_f32_16x16x32_bf16 v[32:35], a[36:39], v[112:115], v[32:35]
    v_mfma_f32_16x16x32_bf16 v[52:55], a[36:39], v[116:119], v[52:55]
    v_mfma_f32_16x16x32_bf16 v[72:75], a[36:39], v[120:123], v[72:75]
    v_mfma_f32_16x16x32_bf16 v[92:95], a[36:39], v[124:127], v[92:95]
    s_waitcnt vmcnt(27)
    v_mfma_f32_16x16x32_bf16 v[16:19], a[40:43], v[128:131], v[16:19]
    buffer_load_dwordx4 a[20:23], v1, s[12:15], s45 offen offset:0
    v_mfma_f32_16x16x32_bf16 v[36:39], a[40:43], v[132:135], v[36:39]
    buffer_load_dwordx4 a[24:27], v1, s[12:15], s45 offen offset:1024
    v_mfma_f32_16x16x32_bf16 v[56:59], a[40:43], v[136:139], v[56:59]
    buffer_load_dwordx4 a[28:31], v1, s[12:15], s45 offen offset:2048
    v_mfma_f32_16x16x32_bf16 v[76:79], a[40:43], v[140:143], v[76:79]
    buffer_load_dwordx4 a[32:35], v1, s[12:15], s45 offen offset:3072
    v_mfma_f32_16x16x32_bf16 v[20:23], a[44:47], v[128:131], v[20:23]
    buffer_load_dwordx4 a[36:39], v2, s[12:15], s45 offen
    v_mfma_f32_16x16x32_bf16 v[40:43], a[44:47], v[132:135], v[40:43]
    buffer_load_dwordx4 v[112:115], v7, s[12:15], s44 offen
    v_mfma_f32_16x16x32_bf16 v[60:63], a[44:47], v[136:139], v[60:63]
    buffer_load_dwordx4 v[116:119], v8, s[12:15], s44 offen
    v_mfma_f32_16x16x32_bf16 v[80:83], a[44:47], v[140:143], v[80:83]
    buffer_load_dwordx4 v[120:123], v9, s[12:15], s44 offen
    v_mfma_f32_16x16x32_bf16 v[24:27], a[48:51], v[128:131], v[24:27]
    buffer_load_dwordx4 v[124:127], v10, s[12:15], s44 offen
    v_mfma_f32_16x16x32_bf16 v[44:47], a[48:51], v[132:135], v[44:47]
    s_add_u32 s44, s44, 1024
    s_add_u32 s45, s45, 5120
    v_mfma_f32_16x16x32_bf16 v[64:67], a[48:51], v[136:139], v[64:67]
    v_mfma_f32_16x16x32_bf16 v[84:87], a[48:51], v[140:143], v[84:87]
    v_mfma_f32_16x16x32_bf16 v[28:31], a[52:55], v[128:131], v[28:31]
    v_mfma_f32_16x16x32_bf16 v[48:51], a[52:55], v[132:135], v[48:51]
    v_mfma_f32_16x16x32_bf16 v[68:71], a[52:55], v[136:139], v[68:71]
    v_mfma_f32_16x16x32_bf16 v[88:91], a[52:55], v[140:143], v[88:91]
    v_mfma_f32_16x16x32_bf16 v[32:35], a[56:59], v[128:131], v[32:35]
    v_mfma_f32_16x16x32_bf16 v[52:55], a[56:59], v[132:135], v[52:55]
    v_mfma_f32_16x16x32_bf16 v[72:75], a[56:59], v[136:139], v[72:75]
    v_mfma_f32_16x16x32_bf16 v[92:95], a[56:59], v[140:143], v[92:95]
    s_waitcnt vmcnt(27)
    v_mfma_f32_16x16x32_bf16 v[16:19], a[60:63], v[144:147], v[16:19]
    buffer_load_dwordx4 a[40:43], v1, s[12:15], s45 offen offset:0
    v_mfma_f32_16x16x32_bf16 v[36:39], a[60:63], v[148:151], v[36:39]
    buffer_load_dwordx4 a[44:47], v1, s[12:15], s45 offen offset:1024
    v_mfma_f32_16x16x32_bf16 v[56:59], a[60:63], v[152:155], v[56:59]
    buffer_load_dwordx4 a[48:51], v1, s[12:15], s45 offen offset:2048
    v_mfma_f32_16x16x32_bf16 v[76:79], a[60:63], v[156:159], v[76:79]
    buffer_load_dwordx4 a[52:55], v1, s[12:15], s45 offen offset:3072
    v_mfma_f32_16x16x32_bf16 v[20:23], a[64:67], v[144:147], v[20:23]
    buffer_load_dwordx4 a[56:59], v2, s[12:15], s45 offen
    v_mfma_f32_16x16x32_bf16 v[40:43], a[64:67], v[148:151], v[40:43]
    buffer_load_dwordx4 v[128:131], v7, s[12:15], s44 offen
    v_mfma_f32_16x16x32_bf16 v[60:63], a[64:67], v[152:155], v[60:63]
    buffer_load_dwordx4 v[132:135], v8, s[12:15], s44 offen
    v_mfma_f32_16x16x32_bf16 v[80:83], a[64:67], v[156:159], v[80:83]
    buffer_load_dwordx4 v[136:139], v9, s[12:15], s44 offen
    v_mfma_f32_16x16x32_bf16 v[24:27], a[68:71], v[144:147], v[24:27]
    buffer_load_dwordx4 v[140:143], v10, s[12:15], s44 offen
    v_mfma_f32_16x16x32_bf16 v[44:47], a[68:71], v[148:151], v[44:47]
    s_add_u32 s44, s44, 1024
    s_add_u32 s45, s45, 5120
    v_mfma_f32_16x16x32_bf16 v[64:67], a[68:71], v[152:155], v[64:67]
    v_mfma_f32_16x16x32_bf16 v[84:87], a[68:71], v[156:159], v[84:87]
    v_mfma_f32_16x16x32_bf16 v[28:31], a[72:75], v[144:147], v[28:31]
    v_mfma_f32_16x16x32_bf16 v[48:51], a[72:75], v[148:151], v[48:51]
    v_mfma_f32_16x16x32_bf16 v[68:71], a[72:75], v[152:155], v[68:71]
    v_mfma_f32_16x16x32_bf16 v[88:91], a[72:75], v[156:159], v[88:91]
    v_mfma_f32_16x16x32_bf16 v[32:35], a[76:79], v[144:147], v[32:35]
    v_mfma_f32_16x16x32_bf16 v[52:55], a[76:79], v[148:151], v[52:55]
    v_mfma_f32_16x16x32_bf16 v[72:75], a[76:79], v[152:155], v[72:75]
    v_mfma_f32_16x16x32_bf16 v[92:95], a[76:79], v[156:159], v[92:95]
    s_waitcnt vmcnt(27)
    v_mfma_f32_16x16x32_bf16 v[16:19], a[80:83], v[160:163], v[16:19]
    buffer_load_dwordx4 a[60:63], v1, s[12:15], s45 offen offset:0
    v_mfma_f32_16x16x32_bf16 v[36:39], a[80:83], v[164:167], v[36:39]
    buffer_load_dwordx4 a[64:67], v1, s[12:15], s45 offen offset:1024
    v_mfma_f32_16x16x32_bf16 v[56:59], a[80:83], v[168:171], v[56:59]
    buffer_load_dwordx4 a[68:71], v1, s[12:15], s45 offen offset:2048
    v_mfma_f32_16x16x32_bf16 v[76:79], a[80:83], v[172:175], v[76:79]
    buffer_load_dwordx4 a[72:75], v1, s[12:15], s45 offen offset:3072
    v_mfma_f32_16x16x32_bf16 v[20:23], a[84:87], v[160:163], v[20:23]
    buffer_load_dwordx4 a[76:79], v2, s[12:15], s45 offen
    v_mfma_f32_16x16x32_bf16 v[40:43], a[84:87], v[164:167], v[40:43]
    buffer_load_dwordx4 v[144:147], v7, s[12:15], s44 offen
    v_mfma_f32_16x16x32_bf16 v[60:63], a[84:87], v[168:171], v[60:63]
    buffer_load_dwordx4 v[148:151], v8, s[12:15], s44 offen
    v_mfma_f32_16x16x32_bf16 v[80:83], a[84:87], v[172:175], v[80:83]
    buffer_load_dwordx4 v[152:155], v9, s[12:15], s44 offen
    v_mfma_f32_16x16x32_bf16 v[24:27], a[88:91], v[160:163], v[24:27]
    buffer_load_dwordx4 v[156:159], v10, s[12:15], s44 offen
    v_mfma_f32_16x16x32_bf16 v[44:47], a[88:91], v[164:167], v[44:47]
    s_add_u32 s44, s44, 1024
    s_add_u32 s45, s45, 5120
    v_mfma_f32_16x16x32_bf16 v[64:67], a[88:91], v[168:171], v[64:67]
    v_mfma_f32_16x16x32_bf16 v[84:87], a[88:91], v[172:175], v[84:87]
    v_mfma_f32_16x16x32_bf16 v[28:31], a[92:95], v[160:163], v[28:31]
    v_mfma_f32_16x16x32_bf16 v[48:51], a[92:95], v[164:167], v[48:51]
    v_mfma_f32_16x16x32_bf16 v[68:71], a[92:95], v[168:171], v[68:71]
    v_mfma_f32_16x16x32_bf16 v[88:91], a[92:95], v[172:175], v[88:91]
    v_mfma_f32_16x16x32_bf16 v[32:35], a[96:99], v[160:163], v[32:35]
    v_mfma_f32_16x16x32_bf16 v[52:55], a[96:99], v[164:167], v[52:55]
    v_mfma_f32_16x16x32_bf16 v[72:75], a[96:99], v[168:171], v[72:75]
    v_mfma_f32_16x16x32_bf16 v[92:95], a[96:99], v[172:175], v[92:95]
    s_waitcnt vmcnt(27)
    v_mfma_f32_16x16x32_bf16 v[16:19], a[0:3], v[96:99], v[16:19]
    buffer_load_dwordx4 a[80:83], v1, s[12:15], s45 offen offset:0
    v_mfma_f32_16x16x32_bf16 v[36:39], a[0:3], v[100:103], v[36:39]
    buffer_load_dwordx4 a[84:87], v1, s[12:15], s45 offen offset:1024
    v_mfma_f32_16x16x32_bf16 v[56:59], a[0:3], v[104:107], v[56:59]
    buffer_load_dwordx4 a[88:91], v1, s[12:15], s45 offen offset:2048
    v_mfma_f32_16x16x32_bf16 v[76:79], a[0:3], v[108:111], v[76:79]
    buffer_load_dwordx4 a[92:95], v1, s[12:15], s45 offen offset:3072
    v_mfma_f32_16x16x32_bf16 v[20:23], a[4:7], v[96:99], v[20:23]
    buffer_load_dwordx4 a[96:99], v2, s[12:15], s45 offen
    v_mfma_f32_16x16x32_bf16 v[40:43], a[4:7], v[100:103], v[40:43]
    buffer_load_dwordx4 v[160:163], v7, s[12:15], s44 offen
    v_mfma_f32_16x16x32_bf16 v[60:63], a[4:7], v[104:107], v[60:63]
    buffer_load_dwordx4 v[164:167], v8, s[12:15], s44 offen
    v_mfma_f32_16x16x32_bf16 v[80:83], a[4:7], v[108:111], v[80:83]
    buffer_load_dwordx4 v[168:171], v9, s[12:15], s44 offen
    v_mfma_f32_16x16x32_bf16 v[24:27], a[8:11], v[96:99], v[24:27]
    buffer_load_dwordx4 v[172:175], v10, s[12:15], s44 offen
    v_mfma_f32_16x16x32_bf16 v[44:47], a[8:11], v[100:103], v[44:47]
    s_add_u32 s44, s44, 1024
    s_add_u32 s45, s45, 5120
    v_mfma_f32_16x16x32_bf16 v[64:67], a[8:11], v[104:107], v[64:67]
    v_mfma_f32_16x16x32_bf16 v[84:87], a[8:11], v[108:111], v[84:87]
    v_mfma_f32_16x16x32_bf16 v[28:31], a[12:15], v[96:99], v[28:31]
    v_mfma_f32_16x16x32_bf16 v[48:51], a[12:15], v[100:103], v[48:51]
    v_mfma_f32_16x16x32_bf16 v[68:71], a[12:15], v[104:107], v[68:71]
    v_mfma_f32_16x16x32_bf16 v[88:91], a[12:15], v[108:111], v[88:91]
    v_mfma_f32_16x16x32_bf16 v[32:35], a[16:19], v[96:99], v[32:35]
    v_mfma_f32_16x16x32_bf16 v[52:55], a[16:19], v[100:103], v[52:55]
    v_mfma_f32_16x16x32_bf16 v[72:75], a[16:19], v[104:107], v[72:75]
    v_mfma_f32_16x16x32_bf16 v[92:95], a[16:19], v[108:111], v[92:95]
    s_waitcnt vmcnt(27)
    v_mfma_f32_16x16x32_bf16 v[16:19], a[20:23], v[112:115], v[16:19]
    buffer_load_dwordx4 a[0:3], v1, s[12:15], s45 offen offset:0
    v_mfma_f32_16x16x32_bf16 v[36:39], a[20:23], v[116:119], v[36:39]
    buffer_load_dwordx4 a[4:7], v1, s[12:15], s45 offen offset:1024
    v_mfma_f32_16x16x32_bf16 v[56:59], a[20:23], v[120:123], v[56:59]
    buffer_load_dwordx4 a[8:11], v1, s[12:15], s45 offen offset:2048
    v_mfma_f32_16x16x32_bf16 v[76:79], a[20:23], v[124:127], v[76:79]
    buffer_load_dwordx4 a[12:15], v1, s[12:15], s45 offen offset:3072
    v_mfma_f32_16x16x32_bf16 v[20:23], a[24:27], v[112:115], v[20:23]
    buffer_load_dwordx4 a[16:19], v2, s[12:15], s45 offen
    v_mfma_f32_16x16x32_bf16 v[40:43], a[24:27], v[116:119], v[40:43]
    buffer_load_dwordx4 v[96:99], v7, s[12:15], s44 offen
    v_mfma_f32_16x16x32_bf16 v[60:63], a[24:27], v[120:123], v[60:63]
    buffer_load_dwordx4 v[100:103], v8, s[12:15], s44 offen
    v_mfma_f32_16x16x32_bf16 v[80:83], a[24:27], v[124:127], v[80:83]
    buffer_load_dwordx4 v[104:107], v9, s[12:15], s44 offen
    v_mfma_f32_16x16x32_bf16 v[24:27], a[28:31], v[112:115], v[24:27]
    buffer_load_dwordx4 v[108:111], v10, s[12:15], s44 offen
    v_mfma_f32_16x16x32_bf16 v[44:47], a[28:31], v[116:119], v[44:47]
    s_add_u32 s44, s44, 1024
    s_add_u32 s45, s45, 5120
    v_mfma_f32_16x16x32_bf16 v[64:67], a[28:31], v[120:123], v[64:67]
    v_mfma_f32_16x16x32_bf16 v[84:87], a[28:31], v[124:127], v[84:87]
    v_mfma_f32_16x16x32_bf16 v[28:31], a[32:35], v[112:115], v[28:31]
    v_mfma_f32_16x16x32_bf16 v[48:51], a[32:35], v[116:119], v[48:51]
    v_mfma_f32_16x16x32_bf16 v[68:71], a[32:35], v[120:123], v[68:71]
    v_mfma_f32_16x16x32_bf16 v[88:91], a[32:35], v[124:127], v[88:91]
    v_mfma_f32_16x16x32_bf16 v[32:35], a[36:39], v[112:115], v[32:35]
    v_mfma_f32_16x16x32_bf16 v[52:55], a[36:39], v[116:119], v[52:55]
    v_mfma_f32_16x16x32_bf16 v[72:75], a[36:39], v[120:123], v[72:75]
    v_mfma_f32_16x16x32_bf16 v[92:95], a[36:39], v[124:127], v[92:95]
    s_waitcnt vmcnt(27)
    v_mfma_f32_16x16x32_bf16 v[16:19], a[40:43], v[128:131], v[16:19]
    buffer_load_dwordx4 a[20:23], v1, s[12:15], s45 offen offset:0
    v_mfma_f32_16x16x32_bf16 v[36:39], a[40:43], v[132:135], v[36:39]
    buffer_load_dwordx4 a[24:27], v1, s[12:15], s45 offen offset:1024
    v_mfma_f32_16x16x32_bf16 v[56:59], a[40:43], v[136:139], v[56:59]
    buffer_load_dwordx4 a[28:31], v1, s[12:15], s45 offen offset:2048
    v_mfma_f32_16x16x32_bf16 v[76:79], a[40:43], v[140:143], v[76:79]
    buffer_load_dwordx4 a[32:35], v1, s[12:15], s45 offen offset:3072
    v_mfma_f32_16x16x32_bf16 v[20:23], a[44:47], v[128:131], v[20:23]
    buffer_load_dwordx4 a[36:39], v2, s[12:15], s45 offen
    v_mfma_f32_16x16x32_bf16 v[40:43], a[44:47], v[132:135], v[40:43]
    buffer_load_dwordx4 v[112:115], v7, s[12:15], s44 offen
    v_mfma_f32_16x16x32_bf16 v[60:63], a[44:47], v[136:139], v[60:63]
    buffer_load_dwordx4 v[116:119], v8, s[12:15], s44 offen
    v_mfma_f32_16x16x32_bf16 v[80:83], a[44:47], v[140:143], v[80:83]
    buffer_load_dwordx4 v[120:123], v9, s[12:15], s44 offen
    v_mfma_f32_16x16x32_bf16 v[24:27], a[48:51], v[128:131], v[24:27]
    buffer_load_dwordx4 v[124:127], v10, s[12:15], s44 offen
    v_mfma_f32_16x16x32_bf16 v[44:47], a[48:51], v[132:135], v[44:47]
    s_add_u32 s44, s44, 1024
    s_add_u32 s45, s45, 5120
    v_mfma_f32_16x16x32_bf16 v[64:67], a[48:51], v[136:139], v[64:67]
    v_mfma_f32_16x16x32_bf16 v[84:87], a[48:51], v[140:143], v[84:87]
    v_mfma_f32_16x16x32_bf16 v[28:31], a[52:55], v[128:131], v[28:31]
    v_mfma_f32_16x16x32_bf16 v[48:51], a[52:55], v[132:135], v[48:51]
    v_mfma_f32_16x16x32_bf16 v[68:71], a[52:55], v[136:139], v[68:71]
    v_mfma_f32_16x16x32_bf16 v[88:91], a[52:55], v[140:143], v[88:91]
    v_mfma_f32_16x16x32_bf16 v[32:35], a[56:59], v[128:131], v[32:35]
    v_mfma_f32_16x16x32_bf16 v[52:55], a[56:59], v[132:135], v[52:55]
    v_mfma_f32_16x16x32_bf16 v[72:75], a[56:59], v[136:139], v[72:75]
    v_mfma_f32_16x16x32_bf16 v[92:95], a[56:59], v[140:143], v[92:95]
    s_waitcnt vmcnt(27)
    v_mfma_f32_16x16x32_bf16 v[16:19], a[60:63], v[144:147], v[16:19]
    buffer_load_dwordx4 a[40:43], v1, s[12:15], s45 offen offset:0
    v_mfma_f32_16x16x32_bf16 v[36:39], a[60:63], v[148:151], v[36:39]
    buffer_load_dwordx4 a[44:47], v1, s[12:15], s45 offen offset:1024
    v_mfma_f32_16x16x32_bf16 v[56:59], a[60:63], v[152:155], v[56:59]
    buffer_load_dwordx4 a[48:51], v1, s[12:15], s45 offen offset:2048
    v_mfma_f32_16x16x32_bf16 v[76:79], a[60:63], v[156:159], v[76:79]
    buffer_load_dwordx4 a[52:55], v1, s[12:15], s45 offen offset:3072
    v_mfma_f32_16x16x32_bf16 v[20:23], a[64:67], v[144:147], v[20:23]
    buffer_load_dwordx4 a[56:59], v2, s[12:15], s45 offen
    v_mfma_f32_16x16x32_bf16 v[40:43], a[64:67], v[148:151], v[40:43]
    buffer_load_dwordx4 v[128:131], v7, s[12:15], s44 offen
    v_mfma_f32_16x16x32_bf16 v[60:63], a[64:67], v[152:155], v[60:63]
    buffer_load_dwordx4 v[132:135], v8, s[12:15], s44 offen
    v_mfma_f32_16x16x32_bf16 v[80:83], a[64:67], v[156:159], v[80:83]
    buffer_load_dwordx4 v[136:139], v9, s[12:15], s44 offen
    v_mfma_f32_16x16x32_bf16 v[24:27], a[68:71], v[144:147], v[24:27]
    buffer_load_dwordx4 v[140:143], v10, s[12:15], s44 offen
    v_mfma_f32_16x16x32_bf16 v[44:47], a[68:71], v[148:151], v[44:47]
    s_add_u32 s44, s44, 1024
    s_add_u32 s45, s45, 5120
    v_mfma_f32_16x16x32_bf16 v[64:67], a[68:71], v[152:155], v[64:67]
    v_mfma_f32_16x16x32_bf16 v[84:87], a[68:71], v[156:159], v[84:87]
    v_mfma_f32_16x16x32_bf16 v[28:31], a[72:75], v[144:147], v[28:31]
    v_mfma_f32_16x16x32_bf16 v[48:51], a[72:75], v[148:151], v[48:51]
    v_mfma_f32_16x16x32_bf16 v[68:71], a[72:75], v[152:155], v[68:71]
    v_mfma_f32_16x16x32_bf16 v[88:91], a[72:75], v[156:159], v[88:91]
    v_mfma_f32_16x16x32_bf16 v[32:35], a[76:79], v[144:147], v[32:35]
    v_mfma_f32_16x16x32_bf16 v[52:55], a[76:79], v[148:151], v[52:55]
    v_mfma_f32_16x16x32_bf16 v[72:75], a[76:79], v[152:155], v[72:75]
    v_mfma_f32_16x16x32_bf16 v[92:95], a[76:79], v[156:159], v[92:95]
    s_waitcnt vmcnt(27)
    v_mfma_f32_16x16x32_bf16 v[16:19], a[80:83], v[160:163], v[16:19]
    buffer_load_dwordx4 a[60:63], v1, s[12:15], s45 offen offset:0
    v_mfma_f32_16x16x32_bf16 v[36:39], a[80:83], v[164:167], v[36:39]
    buffer_load_dwordx4 a[64:67], v1, s[12:15], s45 offen offset:1024
    v_mfma_f32_16x16x32_bf16 v[56:59], a[80:83], v[168:171], v[56:59]
    buffer_load_dwordx4 a[68:71], v1, s[12:15], s45 offen offset:2048
    v_mfma_f32_16x16x32_bf16 v[76:79], a[80:83], v[172:175], v[76:79]
    buffer_load_dwordx4 a[72:75], v1, s[12:15], s45 offen offset:3072
    v_mfma_f32_16x16x32_bf16 v[20:23], a[84:87], v[160:163], v[20:23]
    buffer_load_dwordx4 a[76:79], v2, s[12:15], s45 offen
    v_mfma_f32_16x16x32_bf16 v[40:43], a[84:87], v[164:167], v[40:43]
    buffer_load_dwordx4 v[144:147], v7, s[12:15], s44 offen
    v_mfma_f32_16x16x32_bf16 v[60:63], a[84:87], v[168:171], v[60:63]
    buffer_load_dwordx4 v[148:151], v8, s[12:15], s44 offen
    v_mfma_f32_16x16x32_bf16 v[80:83], a[84:87], v[172:175], v[80:83]
    buffer_load_dwordx4 v[152:155], v9, s[12:15], s44 offen
    v_mfma_f32_16x16x32_bf16 v[24:27], a[88:91], v[160:163], v[24:27]
    buffer_load_dwordx4 v[156:159], v10, s[12:15], s44 offen
    v_mfma_f32_16x16x32_bf16 v[44:47], a[88:91], v[164:167], v[44:47]
    s_add_u32 s44, s44, 1024
    s_add_u32 s45, s45, 5120
    v_mfma_f32_16x16x32_bf16 v[64:67], a[88:91], v[168:171], v[64:67]
    v_mfma_f32_16x16x32_bf16 v[84:87], a[88:91], v[172:175], v[84:87]
    v_mfma_f32_16x16x32_bf16 v[28:31], a[92:95], v[160:163], v[28:31]
    v_mfma_f32_16x16x32_bf16 v[48:51], a[92:95], v[164:167], v[48:51]
    v_mfma_f32_16x16x32_bf16 v[68:71], a[92:95], v[168:171], v[68:71]
    v_mfma_f32_16x16x32_bf16 v[88:91], a[92:95], v[172:175], v[88:91]
    v_mfma_f32_16x16x32_bf16 v[32:35], a[96:99], v[160:163], v[32:35]
    v_mfma_f32_16x16x32_bf16 v[52:55], a[96:99], v[164:167], v[52:55]
    v_mfma_f32_16x16x32_bf16 v[72:75], a[96:99], v[168:171], v[72:75]
    v_mfma_f32_16x16x32_bf16 v[92:95], a[96:99], v[172:175], v[92:95]
    s_waitcnt vmcnt(27)
    v_mfma_f32_16x16x32_bf16 v[16:19], a[0:3], v[96:99], v[16:19]
    buffer_load_dwordx4 a[80:83], v1, s[12:15], s45 offen offset:0
    v_mfma_f32_16x16x32_bf16 v[36:39], a[0:3], v[100:103], v[36:39]
    buffer_load_dwordx4 a[84:87], v1, s[12:15], s45 offen offset:1024
    v_mfma_f32_16x16x32_bf16 v[56:59], a[0:3], v[104:107], v[56:59]
    buffer_load_dwordx4 a[88:91], v1, s[12:15], s45 offen offset:2048
    v_mfma_f32_16x16x32_bf16 v[76:79], a[0:3], v[108:111], v[76:79]
    buffer_load_dwordx4 a[92:95], v1, s[12:15], s45 offen offset:3072
    v_mfma_f32_16x16x32_bf16 v[20:23], a[4:7], v[96:99], v[20:23]
    buffer_load_dwordx4 a[96:99], v2, s[12:15], s45 offen
    v_mfma_f32_16x16x32_bf16 v[40:43], a[4:7], v[100:103], v[40:43]
    buffer_load_dwordx4 v[160:163], v7, s[12:15], s44 offen
    v_mfma_f32_16x16x32_bf16 v[60:63], a[4:7], v[104:107], v[60:63]
    buffer_load_dwordx4 v[164:167], v8, s[12:15], s44 offen
    v_mfma_f32_16x16x32_bf16 v[80:83], a[4:7], v[108:111], v[80:83]
    buffer_load_dwordx4 v[168:171], v9, s[12:15], s44 offen
    v_mfma_f32_16x16x32_bf16 v[24:27], a[8:11], v[96:99], v[24:27]
    buffer_load_dwordx4 v[172:175], v10, s[12:15], s44 offen
    v_mfma_f32_16x16x32_bf16 v[44:47], a[8:11], v[100:103], v[44:47]
    s_add_u32 s44, s44, 1024
    s_add_u32 s45, s45, 5120
    v_mfma_f32_16x16x32_bf16 v[64:67], a[8:11], v[104:107], v[64:67]
    v_mfma_f32_16x16x32_bf16 v[84:87], a[8:11], v[108:111], v[84:87]
    v_mfma_f32_16x16x32_bf16 v[28:31], a[12:15], v[96:99], v[28:31]
    v_mfma_f32_16x16x32_bf16 v[48:51], a[12:15], v[100:103], v[48:51]
    v_mfma_f32_16x16x32_bf16 v[68:71], a[12:15], v[104:107], v[68:71]
    v_mfma_f32_16x16x32_bf16 v[88:91], a[12:15], v[108:111], v[88:91]
    v_mfma_f32_16x16x32_bf16 v[32:35], a[16:19], v[96:99], v[32:35]
    v_mfma_f32_16x16x32_bf16 v[52:55], a[16:19], v[100:103], v[52:55]
    v_mfma_f32_16x16x32_bf16 v[72:75], a[16:19], v[104:107], v[72:75]
    v_mfma_f32_16x16x32_bf16 v[92:95], a[16:19], v[108:111], v[92:95]
    s_waitcnt vmcnt(27)
    v_mfma_f32_16x16x32_bf16 v[16:19], a[20:23], v[112:115], v[16:19]
    buffer_load_dwordx4 a[0:3], v1, s[12:15], s45 offen offset:0
    v_mfma_f32_16x16x32_bf16 v[36:39], a[20:23], v[116:119], v[36:39]
    buffer_load_dwordx4 a[4:7], v1, s[12:15], s45 offen offset:1024
    v_mfma_f32_16x16x32_bf16 v[56:59], a[20:23], v[120:123], v[56:59]
    buffer_load_dwordx4 a[8:11], v1, s[12:15], s45 offen offset:2048
    v_mfma_f32_16x16x32_bf16 v[76:79], a[20:23], v[124:127], v[76:79]
    buffer_load_dwordx4 a[12:15], v1, s[12:15], s45 offen offset:3072
    v_mfma_f32_16x16x32_bf16 v[20:23], a[24:27], v[112:115], v[20:23]
    buffer_load_dwordx4 a[16:19], v2, s[12:15], s45 offen
    v_mfma_f32_16x16x32_bf16 v[40:43], a[24:27], v[116:119], v[40:43]
    buffer_load_dwordx4 v[96:99], v7, s[12:15], s44 offen
    v_mfma_f32_16x16x32_bf16 v[60:63], a[24:27], v[120:123], v[60:63]
    buffer_load_dwordx4 v[100:103], v8, s[12:15], s44 offen
    v_mfma_f32_16x16x32_bf16 v[80:83], a[24:27], v[124:127], v[80:83]
    buffer_load_dwordx4 v[104:107], v9, s[12:15], s44 offen
    v_mfma_f32_16x16x32_bf16 v[24:27], a[28:31], v[112:115], v[24:27]
    buffer_load_dwordx4 v[108:111], v10, s[12:15], s44 offen
    v_mfma_f32_16x16x32_bf16 v[44:47], a[28:31], v[116:119], v[44:47]
    s_add_u32 s44, s44, 1024
    s_add_u32 s45, s45, 5120
    v_mfma_f32_16x16x32_bf16 v[64:67], a[28:31], v[120:123], v[64:67]
    v_and_b32 v11, 31, v3
    v_lshlrev_b32 v11, 5, v11
    s_and_b32 s40, s2, 7
    s_lshl_b32 s40, s40, 2
    s_add_u32 s40, s40, 47104
    buffer_load_dword v218, v11, s[12:15], s40 offen sc1
    v_mfma_f32_16x16x32_bf16 v[84:87], a[28:31], v[124:127], v[84:87]
    v_mfma_f32_16x16x32_bf16 v[28:31], a[32:35], v[112:115], v[28:31]
    v_mfma_f32_16x16x32_bf16 v[48:51], a[32:35], v[116:119], v[48:51]
    v_mfma_f32_16x16x32_bf16 v[68:71], a[32:35], v[120:123], v[68:71]
    v_mfma_f32_16x16x32_bf16 v[88:91], a[32:35], v[124:127], v[88:91]
    v_mfma_f32_16x16x32_bf16 v[32:35], a[36:39], v[112:115], v[32:35]
    v_mfma_f32_16x16x32_bf16 v[52:55], a[36:39], v[116:119], v[52:55]
    v_mfma_f32_16x16x32_bf16 v[72:75], a[36:39], v[120:123], v[72:75]
    v_mfma_f32_16x16x32_bf16 v[92:95], a[36:39], v[124:127], v[92:95]
    s_waitcnt vmcnt(28)
    v_mfma_f32_16x16x32_bf16 v[16:19], a[40:43], v[128:131], v[16:19]
    buffer_load_dwordx4 a[20:23], v1, s[12:15], s45 offen offset:0
    v_mfma_f32_16x16x32_bf16 v[36:39], a[40:43], v[132:135], v[36:39]
    buffer_load_dwordx4 a[24:27], v1, s[12:15], s45 offen offset:1024
    v_mfma_f32_16x16x32_bf16 v[56:59], a[40:43], v[136:139], v[56:59]
    buffer_load_dwordx4 a[28:31], v1, s[12:15], s45 offen offset:2048
    v_mfma_f32_16x16x32_bf16 v[76:79], a[40:43], v[140:143], v[76:79]
    buffer_load_dwordx4 a[32:35], v1, s[12:15], s45 offen offset:3072
    v_mfma_f32_16x16x32_bf16 v[20:23], a[44:47], v[128:131], v[20:23]
    buffer_load_dwordx4 a[36:39], v2, s[12:15], s45 offen
    v_mfma_f32_16x16x32_bf16 v[40:43], a[44:47], v[132:135], v[40:43]
    buffer_load_dwordx4 v[112:115], v7, s[12:15], s44 offen
    v_mfma_f32_16x16x32_bf16 v[60:63], a[44:47], v[136:139], v[60:63]
    buffer_load_dwordx4 v[116:119], v8, s[12:15], s44 offen
    v_mfma_f32_16x16x32_bf16 v[80:83], a[44:47], v[140:143], v[80:83]
    buffer_load_dwordx4 v[120:123], v9, s[12:15], s44 offen
    v_mfma_f32_16x16x32_bf16 v[24:27], a[48:51], v[128:131], v[24:27]
    buffer_load_dwordx4 v[124:127], v10, s[12:15], s44 offen
    v_mfma_f32_16x16x32_bf16 v[44:47], a[48:51], v[132:135], v[44:47]
    v_mfma_f32_16x16x32_bf16 v[64:67], a[48:51], v[136:139], v[64:67]
    v_mfma_f32_16x16x32_bf16 v[84:87], a[48:51], v[140:143], v[84:87]
    v_mfma_f32_16x16x32_bf16 v[28:31], a[52:55], v[128:131], v[28:31]
    v_mfma_f32_16x16x32_bf16 v[48:51], a[52:55], v[132:135], v[48:51]
    v_mfma_f32_16x16x32_bf16 v[68:71], a[52:55], v[136:139], v[68:71]
    v_mfma_f32_16x16x32_bf16 v[88:91], a[52:55], v[140:143], v[88:91]
    v_mfma_f32_16x16x32_bf16 v[32:35], a[56:59], v[128:131], v[32:35]
    v_mfma_f32_16x16x32_bf16 v[52:55], a[56:59], v[132:135], v[52:55]
    v_mfma_f32_16x16x32_bf16 v[72:75], a[56:59], v[136:139], v[72:75]
    v_mfma_f32_16x16x32_bf16 v[92:95], a[56:59], v[140:143], v[92:95]
    s_waitcnt vmcnt(28)
    v_mfma_f32_16x16x32_bf16 v[16:19], a[60:63], v[144:147], v[16:19]
    buffer_load_dwordx2 v[208:209], v6, s[20:23], 0 offen offset:0
    v_mfma_f32_16x16x32_bf16 v[36:39], a[60:63], v[148:151], v[36:39]
    buffer_load_dwordx2 v[210:211], v6, s[20:23], 0 offen offset:32
    v_mfma_f32_16x16x32_bf16 v[56:59], a[60:63], v[152:155], v[56:59]
    buffer_load_dwordx2 v[212:213], v6, s[20:23], 0 offen offset:64
    v_mfma_f32_16x16x32_bf16 v[76:79], a[60:63], v[156:159], v[76:79]
    buffer_load_dwordx2 v[214:215], v6, s[20:23], 0 offen offset:96
    v_mfma_f32_16x16x32_bf16 v[20:23], a[64:67], v[144:147], v[20:23]
    buffer_load_dwordx2 v[216:217], v6, s[20:23], 0 offen offset:128
    v_mfma_f32_16x16x32_bf16 v[40:43], a[64:67], v[148:151], v[40:43]
    s_mul_i32 s40, s34, 320
    s_add_u32 s41, s40, 5120
    s_add_u32 s42, s40, 10240
    s_cmp_eq_u32 s32, 1
    s_cselect_b32 s41, s42, s41
    s_add_u32 s42, s40, 7680
    s_cmp_eq_u32 s32, 2
    s_cselect_b32 s41, s42, s41
    s_add_u32 s42, s40, 12800
    s_cmp_eq_u32 s32, 3
    s_cselect_b32 s41, s42, s41
    s_lshl_b32 s42, s32, 9
    s_add_u32 m0, s42, 159744
    s_mov_b64 exec, 0xfffff
    buffer_load_dwordx4 v1, s[12:15], s41 offen lds
    s_lshl_b32 s41, s28, 6
    s_add_u32 s41, s41, 24576
    s_mov_b32 m0, 161792
    s_mov_b64 exec, 0xfffffff
    buffer_load_dwordx4 v1, s[12:15], s41 offen lds
    s_mov_b64 exec, -1
    v_mfma_f32_16x16x32_bf16 v[60:63], a[64:67], v[152:155], v[60:63]
    v_mfma_f32_16x16x32_bf16 v[80:83], a[64:67], v[156:159], v[80:83]
    v_mfma_f32_16x16x32_bf16 v[24:27], a[68:71], v[144:147], v[24:27]
    v_mfma_f32_16x16x32_bf16 v[44:47], a[68:71], v[148:151], v[44:47]
    v_mfma_f32_16x16x32_bf16 v[64:67], a[68:71], v[152:155], v[64:67]
    v_mfma_f32_16x16x32_bf16 v[84:87], a[68:71], v[156:159], v[84:87]
    v_mfma_f32_16x16x32_bf16 v[28:31], a[72:75], v[144:147], v[28:31]
    v_mfma_f32_16x16x32_bf16 v[48:51], a[72:75], v[148:151], v[48:51]
    v_mfma_f32_16x16x32_bf16 v[68:71], a[72:75], v[152:155], v[68:71]
    v_mfma_f32_16x16x32_bf16 v[88:91], a[72:75], v[156:159], v[88:91]
    v_mfma_f32_16x16x32_bf16 v[32:35], a[76:79], v[144:147], v[32:35]
    v_mfma_f32_16x16x32_bf16 v[52:55], a[76:79], v[148:151], v[52:55]
    v_mfma_f32_16x16x32_bf16 v[72:75], a[76:79], v[152:155], v[72:75]
    v_mfma_f32_16x16x32_bf16 v[92:95], a[76:79], v[156:159], v[92:95]
    s_waitcnt vmcnt(26)
    v_mfma_f32_16x16x32_bf16 v[16:19], a[80:83], v[160:163], v[16:19]
    s_mul_i32 s40, s32, 12288
    s_add_u32 s46, s40, 0
    s_add_u32 s47, s40, s68
    s_add_u32 s47, s47, 23527424
    v_mfma_f32_16x16x32_bf16 v[36:39], a[80:83], v[164:167], v[36:39]
    s_add_u32 m0, s46, 0
    s_add_u32 s41, s47, 0
    v_mfma_f32_16x16x32_bf16 v[56:59], a[80:83], v[168:171], v[56:59]
    buffer_load_dwordx4 v1, s[12:15], s41 offen offset:0 lds
    v_mfma_f32_16x16x32_bf16 v[76:79], a[80:83], v[172:175], v[76:79]
    buffer_load_dwordx4 v1, s[12:15], s41 offen offset:1024 lds
    v_mfma_f32_16x16x32_bf16 v[20:23], a[84:87], v[160:163], v[20:23]
    buffer_load_dwordx4 v1, s[12:15], s41 offen offset:2048 lds
    v_mfma_f32_16x16x32_bf16 v[40:43], a[84:87], v[164:167], v[40:43]
    buffer_load_dwordx4 v1, s[12:15], s41 offen offset:3072 lds
    v_mfma_f32_16x16x32_bf16 v[60:63], a[84:87], v[168:171], v[60:63]
    s_add_u32 m0, s46, 4096
    s_add_u32 s41, s47, 4096
    v_mfma_f32_16x16x32_bf16 v[80:83], a[84:87], v[172:175], v[80:83]
    buffer_load_dwordx4 v1, s[12:15], s41 offen offset:0 lds
    v_mfma_f32_16x16x32_bf16 v[24:27], a[88:91], v[160:163], v[24:27]
    buffer_load_dwordx4 v1, s[12:15], s41 offen offset:1024 lds
    v_mfma_f32_16x16x32_bf16 v[44:47], a[88:91], v[164:167], v[44:47]
    buffer_load_dwordx4 v1, s[12:15], s41 offen offset:2048 lds
    v_mfma_f32_16x16x32_bf16 v[64:67], a[88:91], v[168:171], v[64:67]
    buffer_load_dwordx4 v1, s[12:15], s41 offen offset:3072 lds
    v_mfma_f32_16x16x32_bf16 v[84:87], a[88:91], v[172:175], v[84:87]
    s_add_u32 m0, s46, 8192
    s_add_u32 s41, s47, 8192
    v_mfma_f32_16x16x32_bf16 v[28:31], a[92:95], v[160:163], v[28:31]
    buffer_load_dwordx4 v1, s[12:15], s41 offen offset:0 lds
    v_mfma_f32_16x16x32_bf16 v[48:51], a[92:95], v[164:167], v[48:51]
    buffer_load_dwordx4 v1, s[12:15], s41 offen offset:1024 lds
    v_mfma_f32_16x16x32_bf16 v[68:71], a[92:95], v[168:171], v[68:71]
    buffer_load_dwordx4 v1, s[12:15], s41 offen offset:2048 lds
    v_mfma_f32_16x16x32_bf16 v[88:91], a[92:95], v[172:175], v[88:91]
    buffer_load_dwordx4 v1, s[12:15], s41 offen offset:3072 lds
    v_mfma_f32_16x16x32_bf16 v[32:35], a[96:99], v[160:163], v[32:35]
    v_mfma_f32_16x16x32_bf16 v[52:55], a[96:99], v[164:167], v[52:55]
    v_mfma_f32_16x16x32_bf16 v[72:75], a[96:99], v[168:171], v[72:75]
    v_mfma_f32_16x16x32_bf16 v[92:95], a[96:99], v[172:175], v[92:95]
    s_waitcnt vmcnt(29)
    v_mfma_f32_16x16x32_bf16 v[16:19], a[0:3], v[96:99], v[16:19]
    s_mul_i32 s40, s32, 12288
    s_add_u32 s46, s40, 49152
    s_add_u32 s47, s40, s68
    s_add_u32 s47, s47, 23576576
    v_mfma_f32_16x16x32_bf16 v[36:39], a[0:3], v[100:103], v[36:39]
    s_add_u32 m0, s46, 0
    s_add_u32 s41, s47, 0
    v_mfma_f32_16x16x32_bf16 v[56:59], a[0:3], v[104:107], v[56:59]
    buffer_load_dwordx4 v1, s[12:15], s41 offen offset:0 lds
    v_mfma_f32_16x16x32_bf16 v[76:79], a[0:3], v[108:111], v[76:79]
    buffer_load_dwordx4 v1, s[12:15], s41 offen offset:1024 lds
    v_mfma_f32_16x16x32_bf16 v[20:23], a[4:7], v[96:99], v[20:23]
    buffer_load_dwordx4 v1, s[12:15], s41 offen offset:2048 lds
    v_mfma_f32_16x16x32_bf16 v[40:43], a[4:7], v[100:103], v[40:43]
    buffer_load_dwordx4 v1, s[12:15], s41 offen offset:3072 lds
    v_mfma_f32_16x16x32_bf16 v[60:63], a[4:7], v[104:107], v[60:63]
    s_add_u32 m0, s46, 4096
    s_add_u32 s41, s47, 4096
    v_mfma_f32_16x16x32_bf16 v[80:83], a[4:7], v[108:111], v[80:83]
    buffer_load_dwordx4 v1, s[12:15], s41 offen offset:0 lds
    v_mfma_f32_16x16x32_bf16 v[24:27], a[8:11], v[96:99], v[24:27]
    buffer_load_dwordx4 v1, s[12:15], s41 offen offset:1024 lds
    v_mfma_f32_16x16x32_bf16 v[44:47], a[8:11], v[100:103], v[44:47]
    buffer_load_dwordx4 v1, s[12:15], s41 offen offset:2048 lds
    v_mfma_f32_16x16x32_bf16 v[64:67], a[8:11], v[104:107], v[64:67]
    buffer_load_dwordx4 v1, s[12:15], s41 offen offset:3072 lds
    v_mfma_f32_16x16x32_bf16 v[84:87], a[8:11], v[108:111], v[84:87]
    s_add_u32 m0, s46, 8192
    s_add_u32 s41, s47, 8192
    v_mfma_f32_16x16x32_bf16 v[28:31], a[12:15], v[96:99], v[28:31]
    buffer_load_dwordx4 v1, s[12:15], s41 offen offset:0 lds
    v_mfma_f32_16x16x32_bf16 v[48:51], a[12:15], v[100:103], v[48:51]
    buffer_load_dwordx4 v1, s[12:15], s41 offen offset:1024 lds
    v_mfma_f32_16x16x32_bf16 v[68:71], a[12:15], v[104:107], v[68:71]
    buffer_load_dwordx4 v1, s[12:15], s41 offen offset:2048 lds
    v_mfma_f32_16x16x32_bf16 v[88:91], a[12:15], v[108:111], v[88:91]
    buffer_load_dwordx4 v1, s[12:15], s41 offen offset:3072 lds
    v_mfma_f32_16x16x32_bf16 v[32:35], a[16:19], v[96:99], v[32:35]
    v_mfma_f32_16x16x32_bf16 v[52:55], a[16:19], v[100:103], v[52:55]
    v_mfma_f32_16x16x32_bf16 v[72:75], a[16:19], v[104:107], v[72:75]
    v_mfma_f32_16x16x32_bf16 v[92:95], a[16:19], v[108:111], v[92:95]
    s_waitcnt vmcnt(31)
    s_add_u32 s40, s32, 1
    s_and_b32 s40, s40, 3
    s_mul_i32 s40, s40, 15360
    s_add_u32 s40, s40, 98304
    v_add_u32 v12, s40, v1
    s_add_u32 s40, s32, 2
    s_and_b32 s40, s40, 3
    s_mul_i32 s40, s40, 15360
    s_add_u32 s40, s40, 103424
    v_add_u32 v13, s40, v1
    s_add_u32 s40, s32, 3
    s_and_b32 s40, s40, 3
    s_mul_i32 s40, s40, 15360
    s_add_u32 s40, s40, 108544
    v_add_u32 v14, s40, v1
    s_mul_i32 s40, s32, 15360
    s_add_u32 s40, s40, 98304
    v_add_u32 v11, s40, v1
    v_mfma_f32_16x16x32_bf16 v[36:39], a[20:23], v[116:119], v[36:39]
    v_mfma_f32_16x16x32_bf16 v[40:43], a[24:27], v[116:119], v[40:43]
    v_mfma_f32_16x16x32_bf16 v[44:47], a[28:31], v[116:119], v[44:47]
    v_mfma_f32_16x16x32_bf16 v[48:51], a[32:35], v[116:119], v[48:51]
    v_mfma_f32_16x16x32_bf16 v[52:55], a[36:39], v[116:119], v[52:55]
    v_mfma_f32_16x16x32_bf16 v[56:59], a[20:23], v[120:123], v[56:59]
    v_mfma_f32_16x16x32_bf16 v[60:63], a[24:27], v[120:123], v[60:63]
    v_mfma_f32_16x16x32_bf16 v[64:67], a[28:31], v[120:123], v[64:67]
    v_mfma_f32_16x16x32_bf16 v[68:71], a[32:35], v[120:123], v[68:71]
    ds_write_b128 v12, v[36:39] offset:0
    v_mfma_f32_16x16x32_bf16 v[72:75], a[36:39], v[120:123], v[72:75]
    ds_write_b128 v12, v[40:43] offset:1024
    v_mfma_f32_16x16x32_bf16 v[76:79], a[20:23], v[124:127], v[76:79]
    ds_write_b128 v12, v[44:47] offset:2048
    v_mfma_f32_16x16x32_bf16 v[80:83], a[24:27], v[124:127], v[80:83]
    ds_write_b128 v12, v[48:51] offset:3072
    v_mfma_f32_16x16x32_bf16 v[84:87], a[28:31], v[124:127], v[84:87]
    ds_write_b128 v12, v[52:55] offset:4096
    v_mfma_f32_16x16x32_bf16 v[88:91], a[32:35], v[124:127], v[88:91]
    ds_write_b128 v13, v[56:59] offset:0
    v_mfma_f32_16x16x32_bf16 v[92:95], a[36:39], v[124:127], v[92:95]
    ds_write_b128 v13, v[60:63] offset:1024
    v_mfma_f32_16x16x32_bf16 v[16:19], a[20:23], v[112:115], v[16:19]
    ds_write_b128 v13, v[64:67] offset:2048
    v_mfma_f32_16x16x32_bf16 v[20:23], a[24:27], v[112:115], v[20:23]
    ds_write_b128 v13, v[68:71] offset:3072
    v_mfma_f32_16x16x32_bf16 v[24:27], a[28:31], v[112:115], v[24:27]
    ds_write_b128 v13, v[72:75] offset:4096
    v_mfma_f32_16x16x32_bf16 v[28:31], a[32:35], v[112:115], v[28:31]
    ds_write_b128 v14, v[76:79] offset:0
    v_mfma_f32_16x16x32_bf16 v[32:35], a[36:39], v[112:115], v[32:35]
    ds_write_b128 v14, v[80:83] offset:1024
    s_nop 3
    ds_write_b128 v14, v[84:87] offset:2048
    ds_write_b128 v14, v[88:91] offset:3072
    ds_write_b128 v14, v[92:95] offset:4096
    s_waitcnt vmcnt(0)
    v_cmp_eq_u32 vcc, s30, v218
    s_waitcnt lgkmcnt(0)
    s_cmp_eq_u64 vcc, -1
    s_cselect_b32 s30, 1, 0
    s_and_b32 s40, s33, 3
    s_add_u32 s40, s40, 1
    s_lshr_b32 s40, s40, 1
    s_and_b32 s40, s40, 1
    s_and_b32 s31, s30, s40
    s_barrier
    ds_read_b128 v[36:39], v11 offset:0
    ds_read_b128 v[40:43], v11 offset:1024
    ds_read_b128 v[44:47], v11 offset:2048
    ds_read_b128 v[48:51], v11 offset:3072
    ds_read_b128 v[52:55], v11 offset:4096
    ds_read_b128 v[56:59], v11 offset:5120
    ds_read_b128 v[60:63], v11 offset:6144
    ds_read_b128 v[64:67], v11 offset:7168
    ds_read_b128 v[68:71], v11 offset:8192
    ds_read_b128 v[72:75], v11 offset:9216
    ds_read_b128 v[76:79], v11 offset:10240
    ds_read_b128 v[80:83], v11 offset:11264
    ds_read_b128 v[84:87], v11 offset:12288
    ds_read_b128 v[88:91], v11 offset:13312
    ds_read_b128 v[92:95], v11 offset:14336
    v_lshlrev_b32 v12, 4, v4
    v_add_u32 v12, 159744, v12
    ds_read_b128 v[96:99], v12 offset:0
    ds_read_b128 v[100:103], v12 offset:64
    ds_read_b128 v[104:107], v12 offset:128
    ds_read_b128 v[108:111], v12 offset:192
    ds_read_b128 v[112:115], v12 offset:256
    v_lshlrev_b32 v12, 4, v4
    v_add_u32 v12, 160256, v12
    ds_read_b128 v[116:119], v12 offset:0
    ds_read_b128 v[120:123], v12 offset:64
    ds_read_b128 v[124:127], v12 offset:128
    ds_read_b128 v[128:131], v12 offset:192
    ds_read_b128 v[132:135], v12 offset:256
    v_lshlrev_b32 v12, 4, v4
    v_add_u32 v12, 160768, v12
    ds_read_b128 v[136:139], v12 offset:0
    ds_read_b128 v[140:143], v12 offset:64
    ds_read_b128 v[144:147], v12 offset:128
    ds_read_b128 v[148:151], v12 offset:192
    ds_read_b128 v[152:155], v12 offset:256
    s_waitcnt lgkmcnt(15)
    v_pk_add_f32 v[16:17], v[16:17], v[36:37]
    v_pk_add_f32 v[18:19], v[18:19], v[38:39]
    v_pk_add_f32 v[20:21], v[20:21], v[40:41]
    v_pk_add_f32 v[22:23], v[22:23], v[42:43]
    v_pk_add_f32 v[24:25], v[24:25], v[44:45]
    v_pk_add_f32 v[26:27], v[26:27], v[46:47]
    v_pk_add_f32 v[28:29], v[28:29], v[48:49]
    v_pk_add_f32 v[30:31], v[30:31], v[50:51]
    v_pk_add_f32 v[32:33], v[32:33], v[52:53]
    v_pk_add_f32 v[34:35], v[34:35], v[54:55]
    v_pk_add_f32 v[16:17], v[16:17], v[56:57]
    v_pk_add_f32 v[18:19], v[18:19], v[58:59]
    v_pk_add_f32 v[20:21], v[20:21], v[60:61]
    v_pk_add_f32 v[22:23], v[22:23], v[62:63]
    v_pk_add_f32 v[24:25], v[24:25], v[64:65]
    v_pk_add_f32 v[26:27], v[26:27], v[66:67]
    v_pk_add_f32 v[28:29], v[28:29], v[68:69]
    v_pk_add_f32 v[30:31], v[30:31], v[70:71]
    v_pk_add_f32 v[32:33], v[32:33], v[72:73]
    v_pk_add_f32 v[34:35], v[34:35], v[74:75]
    v_pk_add_f32 v[16:17], v[16:17], v[76:77]
    v_pk_add_f32 v[18:19], v[18:19], v[78:79]
    v_pk_add_f32 v[20:21], v[20:21], v[80:81]
    v_pk_add_f32 v[22:23], v[22:23], v[82:83]
    v_pk_add_f32 v[24:25], v[24:25], v[84:85]
    v_pk_add_f32 v[26:27], v[26:27], v[86:87]
    v_pk_add_f32 v[28:29], v[28:29], v[88:89]
    v_pk_add_f32 v[30:31], v[30:31], v[90:91]
    v_pk_add_f32 v[32:33], v[32:33], v[92:93]
    v_pk_add_f32 v[34:35], v[34:35], v[94:95]
    s_barrier
    s_mul_i32 s40, s32, 6144
    s_add_u32 s46, s40, 98304
    s_add_u32 s47, s40, s68
    s_add_u32 s47, s47, 23625728
    s_add_u32 m0, s46, 0
    s_add_u32 s41, s47, 0
    buffer_load_dwordx4 v1, s[12:15], s41 offen offset:0 lds
    buffer_load_dwordx4 v1, s[12:15], s41 offen offset:1024 lds
    buffer_load_dwordx4 v1, s[12:15], s41 offen offset:2048 lds
    buffer_load_dwordx4 v1, s[12:15], s41 offen offset:3072 lds
    s_add_u32 m0, s46, 4096
    s_add_u32 s41, s47, 4096
    buffer_load_dwordx4 v1, s[12:15], s41 offen offset:0 lds
    buffer_load_dwordx4 v1, s[12:15], s41 offen offset:1024 lds
    v_lshlrev_b32 v156, 16, v208
    v_and_b32 v157, 0xffff0000, v208
    v_lshlrev_b32 v158, 16, v209
    v_and_b32 v159, 0xffff0000, v209
    v_lshlrev_b32 v160, 16, v210
    v_and_b32 v161, 0xffff0000, v210
    v_lshlrev_b32 v162, 16, v211
    v_and_b32 v163, 0xffff0000, v211
    v_lshlrev_b32 v164, 16, v212
    v_and_b32 v165, 0xffff0000, v212
    v_lshlrev_b32 v166, 16, v213
    v_and_b32 v167, 0xffff0000, v213
    v_lshlrev_b32 v168, 16, v214
    v_and_b32 v169, 0xffff0000, v214
    v_lshlrev_b32 v170, 16, v215
    v_and_b32 v171, 0xffff0000, v215
    v_lshlrev_b32 v172, 16, v216
    v_and_b32 v173, 0xffff0000, v216
    v_lshlrev_b32 v174, 16, v217
    v_and_b32 v175, 0xffff0000, v217
    s_waitcnt lgkmcnt(0)
    v_pk_fma_f32 v[156:157], v[16:17], v[96:97], v[156:157]
    v_pk_fma_f32 v[158:159], v[18:19], v[98:99], v[158:159]
    v_pk_fma_f32 v[160:161], v[20:21], v[100:101], v[160:161]
    v_pk_fma_f32 v[162:163], v[22:23], v[102:103], v[162:163]
    v_pk_fma_f32 v[164:165], v[24:25], v[104:105], v[164:165]
    v_pk_fma_f32 v[166:167], v[26:27], v[106:107], v[166:167]
    v_pk_fma_f32 v[168:169], v[28:29], v[108:109], v[168:169]
    v_pk_fma_f32 v[170:171], v[30:31], v[110:111], v[170:171]
    v_pk_fma_f32 v[172:173], v[32:33], v[112:113], v[172:173]
    v_pk_fma_f32 v[174:175], v[34:35], v[114:115], v[174:175]
    v_cvt_pk_bf16_f32 v232, v156, v157
    v_cvt_pk_bf16_f32 v233, v158, v159
    v_cvt_pk_bf16_f32 v234, v160, v161
    v_cvt_pk_bf16_f32 v235, v162, v163
    v_cvt_pk_bf16_f32 v236, v164, v165
    v_cvt_pk_bf16_f32 v237, v166, v167
    v_cvt_pk_bf16_f32 v238, v168, v169
    v_cvt_pk_bf16_f32 v239, v170, v171
    v_cvt_pk_bf16_f32 v240, v172, v173
    v_cvt_pk_bf16_f32 v241, v174, v175
    v_lshlrev_b32 v156, 16, v232
    v_and_b32 v157, 0xffff0000, v232
    v_lshlrev_b32 v158, 16, v233
    v_and_b32 v159, 0xffff0000, v233
    v_lshlrev_b32 v160, 16, v234
    v_and_b32 v161, 0xffff0000, v234
    v_lshlrev_b32 v162, 16, v235
    v_and_b32 v163, 0xffff0000, v235
    v_lshlrev_b32 v164, 16, v236
    v_and_b32 v165, 0xffff0000, v236
    v_lshlrev_b32 v166, 16, v237
    v_and_b32 v167, 0xffff0000, v237
    v_lshlrev_b32 v168, 16, v238
    v_and_b32 v169, 0xffff0000, v238
    v_lshlrev_b32 v170, 16, v239
    v_and_b32 v171, 0xffff0000, v239
    v_lshlrev_b32 v172, 16, v240
    v_and_b32 v173, 0xffff0000, v240
    v_lshlrev_b32 v174, 16, v241
    v_and_b32 v175, 0xffff0000, v241
    v_pk_mul_f32 v[16:17], v[156:157], v[116:117]
    v_pk_mul_f32 v[18:19], v[158:159], v[118:119]
    v_pk_mul_f32 v[20:21], v[160:161], v[120:121]
    v_pk_mul_f32 v[22:23], v[162:163], v[122:123]
    v_pk_mul_f32 v[24:25], v[164:165], v[124:125]
    v_pk_mul_f32 v[26:27], v[166:167], v[126:127]
    v_pk_mul_f32 v[28:29], v[168:169], v[128:129]
    v_pk_mul_f32 v[30:31], v[170:171], v[130:131]
    v_pk_mul_f32 v[32:33], v[172:173], v[132:133]
    v_pk_mul_f32 v[34:35], v[174:175], v[134:135]
    v_cvt_pk_bf16_f32 v46, v16, v17
    v_cvt_pk_bf16_f32 v47, v18, v19
    v_cvt_pk_bf16_f32 v48, v20, v21
    v_cvt_pk_bf16_f32 v49, v22, v23
    v_cvt_pk_bf16_f32 v50, v24, v25
    v_cvt_pk_bf16_f32 v51, v26, v27
    v_cvt_pk_bf16_f32 v52, v28, v29
    v_cvt_pk_bf16_f32 v53, v30, v31
    v_cvt_pk_bf16_f32 v54, v32, v33
    v_cvt_pk_bf16_f32 v55, v34, v35
    s_cmp_eq_u32 s49, 1
    s_cbranch_scc1 kb_kernel_odd_1
    s_add_u32 s47, s48, 29884416
    buffer_store_dwordx4 v[46:49], v1, s[12:15], s47 offen sc1
    s_add_u32 s47, s48, 29885440
    buffer_store_dwordx4 v[50:53], v1, s[12:15], s47 offen sc1
    s_add_u32 s47, s48, 29886464
    buffer_store_dwordx2 v[54:55], v231, s[12:15], s47 offen sc1
    s_branch kb_kernel_tse_2
kb_kernel_odd_1:
    s_add_u32 s47, s48, 29884928
    buffer_store_dwordx2 v[46:47], v231, s[12:15], s47 offen sc1
    s_add_u32 s47, s48, 29885440
    buffer_store_dwordx4 v[48:51], v1, s[12:15], s47 offen sc1
    s_add_u32 s47, s48, 29886464
    buffer_store_dwordx4 v[52:55], v1, s[12:15], s47 offen sc1
kb_kernel_tse_2:
    v_pk_add_f32 v[56:57], v[156:157], v[158:159]
    v_pk_mul_f32 v[58:59], v[156:157], v[156:157]
    v_pk_fma_f32 v[58:59], v[158:159], v[158:159], v[58:59]
    v_pk_add_f32 v[60:61], v[16:17], v[18:19]
    v_pk_mul_f32 v[62:63], v[16:17], v[116:117]
    v_pk_fma_f32 v[62:63], v[18:19], v[118:119], v[62:63]
    v_pk_mul_f32 v[64:65], v[16:17], v[16:17]
    v_pk_fma_f32 v[64:65], v[18:19], v[18:19], v[64:65]
    v_pk_mul_f32 v[66:67], v[16:17], v[136:137]
    v_pk_fma_f32 v[66:67], v[18:19], v[138:139], v[66:67]
    v_pk_add_f32 v[56:57], v[56:57], v[160:161]
    v_pk_fma_f32 v[58:59], v[160:161], v[160:161], v[58:59]
    v_pk_add_f32 v[60:61], v[60:61], v[20:21]
    v_pk_fma_f32 v[62:63], v[20:21], v[120:121], v[62:63]
    v_pk_fma_f32 v[64:65], v[20:21], v[20:21], v[64:65]
    v_pk_fma_f32 v[66:67], v[20:21], v[140:141], v[66:67]
    v_pk_add_f32 v[56:57], v[56:57], v[162:163]
    v_pk_fma_f32 v[58:59], v[162:163], v[162:163], v[58:59]
    v_pk_add_f32 v[60:61], v[60:61], v[22:23]
    v_pk_fma_f32 v[62:63], v[22:23], v[122:123], v[62:63]
    v_pk_fma_f32 v[64:65], v[22:23], v[22:23], v[64:65]
    v_pk_fma_f32 v[66:67], v[22:23], v[142:143], v[66:67]
    v_pk_add_f32 v[56:57], v[56:57], v[164:165]
    v_pk_fma_f32 v[58:59], v[164:165], v[164:165], v[58:59]
    v_pk_add_f32 v[60:61], v[60:61], v[24:25]
    v_pk_fma_f32 v[62:63], v[24:25], v[124:125], v[62:63]
    v_pk_fma_f32 v[64:65], v[24:25], v[24:25], v[64:65]
    v_pk_fma_f32 v[66:67], v[24:25], v[144:145], v[66:67]
    v_pk_add_f32 v[56:57], v[56:57], v[166:167]
    v_pk_fma_f32 v[58:59], v[166:167], v[166:167], v[58:59]
    v_pk_add_f32 v[60:61], v[60:61], v[26:27]
    v_pk_fma_f32 v[62:63], v[26:27], v[126:127], v[62:63]
    v_pk_fma_f32 v[64:65], v[26:27], v[26:27], v[64:65]
    v_pk_fma_f32 v[66:67], v[26:27], v[146:147], v[66:67]
    v_pk_add_f32 v[56:57], v[56:57], v[168:169]
    v_pk_fma_f32 v[58:59], v[168:169], v[168:169], v[58:59]
    v_pk_add_f32 v[60:61], v[60:61], v[28:29]
    v_pk_fma_f32 v[62:63], v[28:29], v[128:129], v[62:63]
    v_pk_fma_f32 v[64:65], v[28:29], v[28:29], v[64:65]
    v_pk_fma_f32 v[66:67], v[28:29], v[148:149], v[66:67]
    v_pk_add_f32 v[56:57], v[56:57], v[170:171]
    v_pk_fma_f32 v[58:59], v[170:171], v[170:171], v[58:59]
    v_pk_add_f32 v[60:61], v[60:61], v[30:31]
    v_pk_fma_f32 v[62:63], v[30:31], v[130:131], v[62:63]
    v_pk_fma_f32 v[64:65], v[30:31], v[30:31], v[64:65]
    v_pk_fma_f32 v[66:67], v[30:31], v[150:151], v[66:67]
    v_pk_add_f32 v[56:57], v[56:57], v[172:173]
    v_pk_fma_f32 v[58:59], v[172:173], v[172:173], v[58:59]
    v_pk_add_f32 v[60:61], v[60:61], v[32:33]
    v_pk_fma_f32 v[62:63], v[32:33], v[132:133], v[62:63]
    v_pk_fma_f32 v[64:65], v[32:33], v[32:33], v[64:65]
    v_pk_fma_f32 v[66:67], v[32:33], v[152:153], v[66:67]
    v_pk_add_f32 v[56:57], v[56:57], v[174:175]
    v_pk_fma_f32 v[58:59], v[174:175], v[174:175], v[58:59]
    v_pk_add_f32 v[60:61], v[60:61], v[34:35]
    v_pk_fma_f32 v[62:63], v[34:35], v[134:135], v[62:63]
    v_pk_fma_f32 v[64:65], v[34:35], v[34:35], v[64:65]
    v_pk_fma_f32 v[66:67], v[34:35], v[154:155], v[66:67]
    v_add_f32 v156, v56, v57
    v_add_f32 v157, v58, v59
    v_add_f32 v158, v60, v61
    v_add_f32 v159, v62, v63
    v_add_f32 v160, v64, v65
    v_add_f32 v161, v66, v67
    v_mov_b32 v172, v156
    v_mov_b32 v173, v157
    v_mov_b32 v174, v158
    v_mov_b32 v175, v159
    v_mov_b32 v176, v160
    v_mov_b32 v177, v161
    s_nop 0
    v_permlane16_swap_b32 v156, v172
    v_permlane16_swap_b32 v157, v173
    v_permlane16_swap_b32 v158, v174
    v_permlane16_swap_b32 v159, v175
    v_permlane16_swap_b32 v160, v176
    v_permlane16_swap_b32 v161, v177
    s_nop 0
    v_add_f32 v156, v156, v172
    v_add_f32 v157, v157, v173
    v_add_f32 v158, v158, v174
    v_add_f32 v159, v159, v175
    v_add_f32 v160, v160, v176
    v_add_f32 v161, v161, v177
    v_mov_b32 v172, v156
    v_mov_b32 v173, v157
    v_mov_b32 v174, v158
    v_mov_b32 v175, v159
    v_mov_b32 v176, v160
    v_mov_b32 v177, v161
    s_nop 0
    v_permlane32_swap_b32 v156, v172
    v_permlane32_swap_b32 v157, v173
    v_permlane32_swap_b32 v158, v174
    v_permlane32_swap_b32 v159, v175
    v_permlane32_swap_b32 v160, v176
    v_permlane32_swap_b32 v161, v177
    s_nop 0
    v_add_f32 v156, v156, v172
    v_add_f32 v157, v157, v173
    v_add_f32 v158, v158, v174
    v_add_f32 v159, v159, v175
    v_add_f32 v160, v160, v176
    v_add_f32 v161, v161, v177
    v_lshlrev_b32 v11, 5, v5
    s_lshl_b32 s40, s34, 16
    s_add_u32 s40, s40, 2686976
    v_cmp_gt_u32 vcc, 16, v3
    s_and_saveexec_b64 s[42:43], vcc
    buffer_store_dwordx4 v[156:159], v11, s[12:15], s40 offen sc1
    buffer_store_dwordx4 v[160:163], v11, s[12:15], s40 offen offset:16 sc1
    s_mov_b64 exec, s[42:43]
    v_add_u32 v14, 65536, v1
    v_add_u32 v15, 131072, v1
    ds_read_b128 a[80:83], v1 offset:0
    ds_read_b128 a[84:87], v1 offset:1024
    ds_read_b128 a[88:91], v1 offset:2048
    ds_read_b128 a[92:95], v1 offset:3072
    ds_read_b128 a[96:99], v1 offset:4096
    ds_read_b128 a[100:103], v1 offset:5120
    ds_read_b128 a[104:107], v1 offset:6144
    ds_read_b128 a[108:111], v1 offset:7168
    ds_read_b128 a[112:115], v1 offset:8192
    ds_read_b128 a[116:119], v1 offset:9216
    ds_read_b128 a[120:123], v1 offset:10240
    ds_read_b128 a[124:127], v1 offset:11264
    ds_read_b128 a[128:131], v1 offset:12288
    ds_read_b128 a[132:135], v1 offset:13312
    ds_read_b128 a[136:139], v1 offset:14336
    ds_read_b128 a[140:143], v1 offset:15360
    ds_read_b128 a[144:147], v1 offset:16384
    ds_read_b128 a[148:151], v1 offset:17408
    s_waitcnt lgkmcnt(12)
    v_mfma_f32_16x16x32_bf16 v[36:39], a[80:83], a[100:103], 0
    ds_read_b128 a[152:155], v1 offset:18432
    ds_read_b128 a[156:159], v1 offset:19456
    v_mfma_f32_16x16x32_bf16 v[40:43], a[84:87], a[100:103], 0
    ds_read_b128 a[160:163], v1 offset:20480
    v_mfma_f32_16x16x32_bf16 v[44:47], a[88:91], a[100:103], 0
    ds_read_b128 a[164:167], v1 offset:21504
    v_mfma_f32_16x16x32_bf16 v[48:51], a[92:95], a[100:103], 0
    ds_read_b128 a[168:171], v1 offset:22528
    v_mfma_f32_16x16x32_bf16 v[52:55], a[96:99], a[100:103], 0
    ds_read_b128 a[172:175], v1 offset:23552
    s_waitcnt lgkmcnt(12)
    v_mfma_f32_16x16x32_bf16 v[36:39], a[104:107], a[124:127], v[36:39]
    ds_read_b128 a[80:83], v1 offset:24576
    ds_read_b128 a[84:87], v1 offset:25600
    v_mfma_f32_16x16x32_bf16 v[40:43], a[108:111], a[124:127], v[40:43]
    ds_read_b128 a[88:91], v1 offset:26624
    v_mfma_f32_16x16x32_bf16 v[44:47], a[112:115], a[124:127], v[44:47]
    ds_read_b128 a[92:95], v1 offset:27648
    v_mfma_f32_16x16x32_bf16 v[48:51], a[116:119], a[124:127], v[48:51]
    ds_read_b128 a[96:99], v1 offset:28672
    v_mfma_f32_16x16x32_bf16 v[52:55], a[120:123], a[124:127], v[52:55]
    ds_read_b128 a[100:103], v1 offset:29696
    s_waitcnt lgkmcnt(12)
    v_mfma_f32_16x16x32_bf16 v[36:39], a[128:131], a[148:151], v[36:39]
    ds_read_b128 a[104:107], v1 offset:30720
    ds_read_b128 a[108:111], v1 offset:31744
    v_mfma_f32_16x16x32_bf16 v[40:43], a[132:135], a[148:151], v[40:43]
    ds_read_b128 a[112:115], v1 offset:32768
    v_mfma_f32_16x16x32_bf16 v[44:47], a[136:139], a[148:151], v[44:47]
    ds_read_b128 a[116:119], v1 offset:33792
    v_mfma_f32_16x16x32_bf16 v[48:51], a[140:143], a[148:151], v[48:51]
    ds_read_b128 a[120:123], v1 offset:34816
    v_mfma_f32_16x16x32_bf16 v[52:55], a[144:147], a[148:151], v[52:55]
    ds_read_b128 a[124:127], v1 offset:35840
    s_waitcnt lgkmcnt(12)
    v_mfma_f32_16x16x32_bf16 v[36:39], a[152:155], a[172:175], v[36:39]
    ds_read_b128 a[128:131], v1 offset:36864
    ds_read_b128 a[132:135], v1 offset:37888
    v_mfma_f32_16x16x32_bf16 v[40:43], a[156:159], a[172:175], v[40:43]
    ds_read_b128 a[136:139], v1 offset:38912
    v_mfma_f32_16x16x32_bf16 v[44:47], a[160:163], a[172:175], v[44:47]
    ds_read_b128 a[140:143], v1 offset:39936
    v_mfma_f32_16x16x32_bf16 v[48:51], a[164:167], a[172:175], v[48:51]
    ds_read_b128 a[144:147], v1 offset:40960
    v_mfma_f32_16x16x32_bf16 v[52:55], a[168:171], a[172:175], v[52:55]
    ds_read_b128 a[148:151], v1 offset:41984
    s_waitcnt lgkmcnt(12)
    v_mfma_f32_16x16x32_bf16 v[36:39], a[80:83], a[100:103], v[36:39]
    ds_read_b128 a[152:155], v1 offset:43008
    ds_read_b128 a[156:159], v1 offset:44032
    v_mfma_f32_16x16x32_bf16 v[40:43], a[84:87], a[100:103], v[40:43]
    ds_read_b128 a[160:163], v1 offset:45056
    v_mfma_f32_16x16x32_bf16 v[44:47], a[88:91], a[100:103], v[44:47]
    ds_read_b128 a[164:167], v1 offset:46080
    v_mfma_f32_16x16x32_bf16 v[48:51], a[92:95], a[100:103], v[48:51]
    ds_read_b128 a[168:171], v1 offset:47104
    v_mfma_f32_16x16x32_bf16 v[52:55], a[96:99], a[100:103], v[52:55]
    ds_read_b128 a[172:175], v1 offset:48128
    s_waitcnt lgkmcnt(12)
    v_mfma_f32_16x16x32_bf16 v[36:39], a[104:107], a[124:127], v[36:39]
    ds_read_b128 a[80:83], v1 offset:49152
    ds_read_b128 a[84:87], v1 offset:50176
    v_mfma_f32_16x16x32_bf16 v[40:43], a[108:111], a[124:127], v[40:43]
    ds_read_b128 a[88:91], v1 offset:51200
    v_mfma_f32_16x16x32_bf16 v[44:47], a[112:115], a[124:127], v[44:47]
    ds_read_b128 a[92:95], v1 offset:52224
    v_mfma_f32_16x16x32_bf16 v[48:51], a[116:119], a[124:127], v[48:51]
    ds_read_b128 a[96:99], v1 offset:53248
    v_mfma_f32_16x16x32_bf16 v[52:55], a[120:123], a[124:127], v[52:55]
    ds_read_b128 a[100:103], v1 offset:54272
    s_waitcnt lgkmcnt(12)
    v_mfma_f32_16x16x32_bf16 v[36:39], a[128:131], a[148:151], v[36:39]
    ds_read_b128 a[104:107], v1 offset:55296
    ds_read_b128 a[108:111], v1 offset:56320
    v_mfma_f32_16x16x32_bf16 v[40:43], a[132:135], a[148:151], v[40:43]
    ds_read_b128 a[112:115], v1 offset:57344
    v_mfma_f32_16x16x32_bf16 v[44:47], a[136:139], a[148:151], v[44:47]
    ds_read_b128 a[116:119], v1 offset:58368
    v_mfma_f32_16x16x32_bf16 v[48:51], a[140:143], a[148:151], v[48:51]
    ds_read_b128 a[120:123], v1 offset:59392
    v_mfma_f32_16x16x32_bf16 v[52:55], a[144:147], a[148:151], v[52:55]
    ds_read_b128 a[124:127], v1 offset:60416
    s_waitcnt lgkmcnt(12)
    v_mfma_f32_16x16x32_bf16 v[36:39], a[152:155], a[172:175], v[36:39]
    v_mfma_f32_16x16x32_bf16 v[40:43], a[156:159], a[172:175], v[40:43]
    v_mfma_f32_16x16x32_bf16 v[44:47], a[160:163], a[172:175], v[44:47]
    v_mfma_f32_16x16x32_bf16 v[48:51], a[164:167], a[172:175], v[48:51]
    v_mfma_f32_16x16x32_bf16 v[52:55], a[168:171], a[172:175], v[52:55]
    s_waitcnt lgkmcnt(6)
    v_mfma_f32_16x16x32_bf16 v[36:39], a[80:83], a[100:103], v[36:39]
    v_mfma_f32_16x16x32_bf16 v[40:43], a[84:87], a[100:103], v[40:43]
    v_mfma_f32_16x16x32_bf16 v[44:47], a[88:91], a[100:103], v[44:47]
    v_mfma_f32_16x16x32_bf16 v[48:51], a[92:95], a[100:103], v[48:51]
    v_mfma_f32_16x16x32_bf16 v[52:55], a[96:99], a[100:103], v[52:55]
    s_waitcnt lgkmcnt(0)
    v_mfma_f32_16x16x32_bf16 v[36:39], a[104:107], a[124:127], v[36:39]
    v_mfma_f32_16x16x32_bf16 v[40:43], a[108:111], a[124:127], v[40:43]
    v_mfma_f32_16x16x32_bf16 v[44:47], a[112:115], a[124:127], v[44:47]
    v_mfma_f32_16x16x32_bf16 v[48:51], a[116:119], a[124:127], v[48:51]
    v_mfma_f32_16x16x32_bf16 v[52:55], a[120:123], a[124:127], v[52:55]
    s_lshl_b32 s46, s33, 7
    s_lshl_b32 s43, s34, 2
    s_add_u32 s46, s46, s43
    s_add_u32 s46, s46, 32768
    s_waitcnt vmcnt(0)
    s_barrier
    s_cmp_eq_u32 s32, 0
    s_cbranch_scc0 kb_kernel_nosig_3
    s_mov_b64 exec, 1
    v_mov_b32 v11, 1
    v_mov_b32 v12, 0
    s_cmp_eq_u32 s30, 1
    s_cbranch_scc1 kb_kernel_stl_4
    buffer_store_dword v11, v12, s[12:15], s46 offen sc1
    s_branch kb_kernel_ste_5
kb_kernel_stl_4:
    buffer_store_dword v11, v12, s[12:15], s46 offen
kb_kernel_ste_5:
    s_mov_b64 exec, -1
kb_kernel_nosig_3:
    ds_read_b128 a[128:131], v1 offset:61440
    ds_read_b128 a[132:135], v1 offset:62464
    ds_read_b128 a[136:139], v1 offset:63488
    ds_read_b128 a[140:143], v1 offset:64512
    ds_read_b128 a[144:147], v14 offset:0
    ds_read_b128 a[148:151], v14 offset:1024
    ds_read_b128 a[152:155], v14 offset:2048
    ds_read_b128 a[156:159], v14 offset:3072
    ds_read_b128 a[160:163], v14 offset:4096
    ds_read_b128 a[164:167], v14 offset:5120
    ds_read_b128 a[168:171], v14 offset:6144
    ds_read_b128 a[172:175], v14 offset:7168
    ds_read_b128 a[80:83], v14 offset:8192
    ds_read_b128 a[84:87], v14 offset:9216
    ds_read_b128 a[88:91], v14 offset:10240
    ds_read_b128 a[92:95], v14 offset:11264
    ds_read_b128 a[96:99], v14 offset:12288
    ds_read_b128 a[100:103], v14 offset:13312
    s_waitcnt lgkmcnt(12)
    v_mfma_f32_16x16x32_bf16 v[36:39], a[128:131], a[148:151], v[36:39]
    ds_read_b128 a[104:107], v14 offset:14336
    ds_read_b128 a[108:111], v14 offset:15360
    v_mfma_f32_16x16x32_bf16 v[40:43], a[132:135], a[148:151], v[40:43]
    ds_read_b128 a[112:115], v14 offset:16384
    v_mfma_f32_16x16x32_bf16 v[44:47], a[136:139], a[148:151], v[44:47]
    ds_read_b128 a[116:119], v14 offset:17408
    v_mfma_f32_16x16x32_bf16 v[48:51], a[140:143], a[148:151], v[48:51]
    ds_read_b128 a[120:123], v14 offset:18432
    v_mfma_f32_16x16x32_bf16 v[52:55], a[144:147], a[148:151], v[52:55]
    ds_read_b128 a[124:127], v14 offset:19456
    s_waitcnt lgkmcnt(12)
    v_mfma_f32_16x16x32_bf16 v[36:39], a[152:155], a[172:175], v[36:39]
    ds_read_b128 a[128:131], v14 offset:20480
    ds_read_b128 a[132:135], v14 offset:21504
    v_mfma_f32_16x16x32_bf16 v[40:43], a[156:159], a[172:175], v[40:43]
    ds_read_b128 a[136:139], v14 offset:22528
    v_mfma_f32_16x16x32_bf16 v[44:47], a[160:163], a[172:175], v[44:47]
    ds_read_b128 a[140:143], v14 offset:23552
    v_mfma_f32_16x16x32_bf16 v[48:51], a[164:167], a[172:175], v[48:51]
    ds_read_b128 a[144:147], v14 offset:24576
    v_mfma_f32_16x16x32_bf16 v[52:55], a[168:171], a[172:175], v[52:55]
    ds_read_b128 a[148:151], v14 offset:25600
    s_waitcnt lgkmcnt(12)
    v_mfma_f32_16x16x32_bf16 v[36:39], a[80:83], a[100:103], v[36:39]
    ds_read_b128 a[152:155], v14 offset:26624
    ds_read_b128 a[156:159], v14 offset:27648
    v_mfma_f32_16x16x32_bf16 v[40:43], a[84:87], a[100:103], v[40:43]
    ds_read_b128 a[160:163], v14 offset:28672
    v_mfma_f32_16x16x32_bf16 v[44:47], a[88:91], a[100:103], v[44:47]
    ds_read_b128 a[164:167], v14 offset:29696
    v_mfma_f32_16x16x32_bf16 v[48:51], a[92:95], a[100:103], v[48:51]
    ds_read_b128 a[168:171], v14 offset:30720
    v_mfma_f32_16x16x32_bf16 v[52:55], a[96:99], a[100:103], v[52:55]
    ds_read_b128 a[172:175], v14 offset:31744
    s_waitcnt lgkmcnt(12)
    v_mfma_f32_16x16x32_bf16 v[36:39], a[104:107], a[124:127], v[36:39]
    ds_read_b128 a[80:83], v14 offset:32768
    ds_read_b128 a[84:87], v14 offset:33792
    v_mfma_f32_16x16x32_bf16 v[40:43], a[108:111], a[124:127], v[40:43]
    ds_read_b128 a[88:91], v14 offset:34816
    v_mfma_f32_16x16x32_bf16 v[44:47], a[112:115], a[124:127], v[44:47]
    ds_read_b128 a[92:95], v14 offset:35840
    v_mfma_f32_16x16x32_bf16 v[48:51], a[116:119], a[124:127], v[48:51]
    ds_read_b128 a[96:99], v14 offset:36864
    v_mfma_f32_16x16x32_bf16 v[52:55], a[120:123], a[124:127], v[52:55]
    ds_read_b128 a[100:103], v14 offset:37888
    s_waitcnt lgkmcnt(12)
    v_mfma_f32_16x16x32_bf16 v[36:39], a[128:131], a[148:151], v[36:39]
    ds_read_b128 a[104:107], v14 offset:38912
    ds_read_b128 a[108:111], v14 offset:39936
    v_mfma_f32_16x16x32_bf16 v[40:43], a[132:135], a[148:151], v[40:43]
    ds_read_b128 a[112:115], v14 offset:40960
    v_mfma_f32_16x16x32_bf16 v[44:47], a[136:139], a[148:151], v[44:47]
    ds_read_b128 a[116:119], v14 offset:41984
    v_mfma_f32_16x16x32_bf16 v[48:51], a[140:143], a[148:151], v[48:51]
    ds_read_b128 a[120:123], v14 offset:43008
    v_mfma_f32_16x16x32_bf16 v[52:55], a[144:147], a[148:151], v[52:55]
    ds_read_b128 a[124:127], v14 offset:44032
    s_waitcnt lgkmcnt(12)
    v_mfma_f32_16x16x32_bf16 v[36:39], a[152:155], a[172:175], v[36:39]
    ds_read_b128 a[128:131], v14 offset:45056
    ds_read_b128 a[132:135], v14 offset:46080
    v_mfma_f32_16x16x32_bf16 v[40:43], a[156:159], a[172:175], v[40:43]
    ds_read_b128 a[136:139], v14 offset:47104
    v_mfma_f32_16x16x32_bf16 v[44:47], a[160:163], a[172:175], v[44:47]
    ds_read_b128 a[140:143], v14 offset:48128
    v_mfma_f32_16x16x32_bf16 v[48:51], a[164:167], a[172:175], v[48:51]
    ds_read_b128 a[144:147], v14 offset:49152
    v_mfma_f32_16x16x32_bf16 v[52:55], a[168:171], a[172:175], v[52:55]
    ds_read_b128 a[148:151], v14 offset:50176
    s_waitcnt lgkmcnt(12)
    v_mfma_f32_16x16x32_bf16 v[36:39], a[80:83], a[100:103], v[36:39]
    ds_read_b128 a[152:155], v14 offset:51200
    ds_read_b128 a[156:159], v14 offset:52224
    v_mfma_f32_16x16x32_bf16 v[40:43], a[84:87], a[100:103], v[40:43]
    ds_read_b128 a[160:163], v14 offset:53248
    v_mfma_f32_16x16x32_bf16 v[44:47], a[88:91], a[100:103], v[44:47]
    ds_read_b128 a[164:167], v14 offset:54272
    v_mfma_f32_16x16x32_bf16 v[48:51], a[92:95], a[100:103], v[48:51]
    ds_read_b128 a[168:171], v14 offset:55296
    v_mfma_f32_16x16x32_bf16 v[52:55], a[96:99], a[100:103], v[52:55]
    ds_read_b128 a[172:175], v14 offset:56320
    s_waitcnt lgkmcnt(12)
    v_mfma_f32_16x16x32_bf16 v[36:39], a[104:107], a[124:127], v[36:39]
    v_mfma_f32_16x16x32_bf16 v[40:43], a[108:111], a[124:127], v[40:43]
    v_mfma_f32_16x16x32_bf16 v[44:47], a[112:115], a[124:127], v[44:47]
    v_mfma_f32_16x16x32_bf16 v[48:51], a[116:119], a[124:127], v[48:51]
    v_mfma_f32_16x16x32_bf16 v[52:55], a[120:123], a[124:127], v[52:55]
    s_waitcnt lgkmcnt(6)
    v_mfma_f32_16x16x32_bf16 v[36:39], a[128:131], a[148:151], v[36:39]
    v_mfma_f32_16x16x32_bf16 v[40:43], a[132:135], a[148:151], v[40:43]
    v_mfma_f32_16x16x32_bf16 v[44:47], a[136:139], a[148:151], v[44:47]
    v_mfma_f32_16x16x32_bf16 v[48:51], a[140:143], a[148:151], v[48:51]
    v_mfma_f32_16x16x32_bf16 v[52:55], a[144:147], a[148:151], v[52:55]
    s_waitcnt lgkmcnt(0)
    v_mfma_f32_16x16x32_bf16 v[36:39], a[152:155], a[172:175], v[36:39]
    v_mfma_f32_16x16x32_bf16 v[40:43], a[156:159], a[172:175], v[40:43]
    v_mfma_f32_16x16x32_bf16 v[44:47], a[160:163], a[172:175], v[44:47]
    v_mfma_f32_16x16x32_bf16 v[48:51], a[164:167], a[172:175], v[48:51]
    v_mfma_f32_16x16x32_bf16 v[52:55], a[168:171], a[172:175], v[52:55]
    s_lshl_b32 s40, s33, 7
    s_add_u32 s40, s40, 32768
    v_and_b32 v11, 7, v3
    v_lshlrev_b32 v11, 2, v11
    v_add_u32 v11, s40, v11
    s_mov_b32 s43, 0
kb_kernel_poll_6:
    buffer_load_dword v13, v11, s[12:15], 0 offen sc1
    s_waitcnt vmcnt(0)
    v_cmp_ne_u32 vcc, 0, v13
    s_add_u32 s43, s43, 1
    s_cmp_eq_u64 vcc, -1
    s_cbranch_scc1 kb_kernel_pdone_7
    s_cmp_lt_u32 s43, 0x40000
    s_cbranch_scc1 kb_kernel_poll_6
kb_kernel_pdone_7:
    s_mul_i32 s44, s37, 20480
    s_add_u32 s44, s44, 29884416
    v_lshlrev_b32 v11, 5, v5
    v_lshlrev_b32 v12, 17, v4
    v_add_u32 v11, v11, v12
    s_mov_b32 s47, 2686976
    buffer_load_dwordx4 v[100:103], v11, s[12:15], s47 offen offset:0 sc1
    buffer_load_dwordx4 v[104:107], v11, s[12:15], s47 offen offset:16 sc1
    s_mov_b32 s47, 2752512
    buffer_load_dwordx4 v[108:111], v11, s[12:15], s47 offen offset:0 sc1
    buffer_load_dwordx4 v[112:115], v11, s[12:15], s47 offen offset:16 sc1
    v_lshlrev_b32 v12, 2, v3
    s_mov_b32 s47, 16384
    buffer_load_dword v116, v12, s[12:15], s47 offen
    s_add_u32 s45, s44, 0
    buffer_load_dwordx4 a[0:3], v1, s[12:15], s45 offen offset:0 sc1
    buffer_load_dwordx4 a[4:7], v1, s[12:15], s45 offen offset:1024 sc1
    buffer_load_dwordx2 a[8:9], v231, s[12:15], s45 offen offset:2048 sc1
    buffer_load_dwordx2 a[10:11], v231, s[12:15], s45 offen offset:2560 sc1
    buffer_load_dwordx4 a[12:15], v1, s[12:15], s45 offen offset:3072 sc1
    s_add_u32 s45, s44, 4096
    buffer_load_dwordx4 a[16:19], v1, s[12:15], s45 offen offset:0 sc1
    buffer_load_dwordx4 a[20:23], v1, s[12:15], s45 offen offset:1024 sc1
    ds_read_b128 a[80:83], v1 offset:0
    ds_read_b128 a[84:87], v1 offset:1024
    ds_read_b128 a[88:91], v1 offset:2048
    ds_read_b128 a[92:95], v1 offset:3072
    ds_read_b128 a[96:99], v1 offset:4096
    ds_read_b128 a[104:107], v1 offset:6144
    ds_read_b128 a[108:111], v1 offset:7168
    ds_read_b128 a[112:115], v1 offset:8192
    ds_read_b128 a[116:119], v1 offset:9216
    ds_read_b128 a[120:123], v1 offset:10240
    ds_read_b128 a[128:131], v1 offset:12288
    ds_read_b128 a[132:135], v1 offset:13312
    ds_read_b128 a[136:139], v1 offset:14336
    ds_read_b128 a[140:143], v1 offset:15360
    ds_read_b128 a[144:147], v1 offset:16384
    s_waitcnt vmcnt(7)
    v_add_f32 v132, v100, v108
    v_add_f32 v133, v101, v109
    v_add_f32 v134, v102, v110
    v_add_f32 v135, v103, v111
    v_add_f32 v136, v104, v112
    v_add_f32 v137, v105, v113
    v_mov_b32 v144, v132
    v_mov_b32 v145, v133
    v_mov_b32 v146, v134
    v_mov_b32 v147, v135
    v_mov_b32 v148, v136
    v_mov_b32 v149, v137
    s_nop 0
    v_permlane16_swap_b32 v132, v144
    v_permlane16_swap_b32 v133, v145
    v_permlane16_swap_b32 v134, v146
    v_permlane16_swap_b32 v135, v147
    v_permlane16_swap_b32 v136, v148
    v_permlane16_swap_b32 v137, v149
    s_nop 0
    v_add_f32 v132, v132, v144
    v_add_f32 v133, v133, v145
    v_add_f32 v134, v134, v146
    v_add_f32 v135, v135, v147
    v_add_f32 v136, v136, v148
    v_add_f32 v137, v137, v149
    v_mov_b32 v144, v132
    v_mov_b32 v145, v133
    v_mov_b32 v146, v134
    v_mov_b32 v147, v135
    v_mov_b32 v148, v136
    v_mov_b32 v149, v137
    s_nop 0
    v_permlane32_swap_b32 v132, v144
    v_permlane32_swap_b32 v133, v145
    v_permlane32_swap_b32 v134, v146
    v_permlane32_swap_b32 v135, v147
    v_permlane32_swap_b32 v136, v148
    v_permlane32_swap_b32 v137, v149
    s_nop 0
    v_add_f32 v132, v132, v144
    v_add_f32 v133, v133, v145
    v_add_f32 v134, v134, v146
    v_add_f32 v135, v135, v147
    v_add_f32 v136, v136, v148
    v_add_f32 v137, v137, v149
    s_nop 1
    v_add_f32_dpp v116, v116, v116 quad_perm:[1,0,3,2] row_mask:0xf bank_mask:0xf
    s_nop 1
    v_add_f32_dpp v116, v116, v116 quad_perm:[2,3,0,1] row_mask:0xf bank_mask:0xf
    s_nop 1
    v_add_f32_dpp v116, v116, v116 row_half_mirror row_mask:0xf bank_mask:0xf
    s_nop 0
    v_readlane_b32 s56, v116, 0
    v_readlane_b32 s57, v116, 8
    v_readlane_b32 s58, v116, 16
    v_readlane_b32 s59, v116, 24
    v_readlane_b32 s60, v116, 32
    s_nop 1
    v_mov_b32 v138, s56
    v_mov_b32 v139, s57
    v_mov_b32 v140, s58
    v_mov_b32 v141, s59
    v_mov_b32 v142, s60
    v_mul_f32 v252, 0x3acccccd, v132
    v_mul_f32 v254, 0x3acccccd, v133
    v_fma_f32 v254, -v252, v252, v254
    v_max_f32 v254, 0, v254
    v_add_f32 v254, 0x3727c5ac, v254
    v_rsq_f32 v254, v254
    v_fma_f32 v148, -v252, v138, v134
    v_mul_f32 v146, v254, v148
    v_add_f32 v146, v141, v146
    v_mul_f32 v146, 0x3acccccd, v146
    v_mul_f32 v148, v139, v252
    v_fma_f32 v148, -2.0, v135, v148
    v_fma_f32 v148, v148, v252, v136
    v_mul_f32 v148, v148, v254
    v_fma_f32 v149, -v252, v140, v137
    v_fma_f32 v148, 2.0, v149, v148
    v_mul_f32 v148, v148, v254
    v_add_f32 v148, v142, v148
    v_mul_f32 v148, 0x3acccccd, v148
    v_fma_f32 v147, -v146, v146, v148
    v_max_f32 v147, 0, v147
    v_add_f32 v147, 0x3727c5ac, v147
    v_rsq_f32 v147, v147
    s_nop 0
    v_mul_f32 v100, v147, v254
    v_mul_f32 v101, v100, v252
    v_sub_f32 v101, 0, v101
    v_mov_b32 v102, v147
    v_mul_f32 v103, v147, v146
    v_sub_f32 v103, 0, v103
    v_mov_b32 v104, 0xc0135761
    v_mov_b32 v106, 0xbdd2d3e8
    s_waitcnt vmcnt(6)
    s_waitcnt lgkmcnt(10)
    v_mfma_f32_16x16x32_bf16 v[16:19], a[80:83], a[0:3], 0
    ds_read_b128 a[152:155], v1 offset:18432
    buffer_load_dwordx4 a[24:27], v1, s[12:15], s45 offen offset:2048 sc1
    v_mfma_f32_16x16x32_bf16 v[20:23], a[84:87], a[0:3], 0
    ds_read_b128 a[156:159], v1 offset:19456
    v_mfma_f32_16x16x32_bf16 v[24:27], a[88:91], a[0:3], 0
    ds_read_b128 a[160:163], v1 offset:20480
    v_mfma_f32_16x16x32_bf16 v[28:31], a[92:95], a[0:3], 0
    ds_read_b128 a[164:167], v1 offset:21504
    v_mfma_f32_16x16x32_bf16 v[32:35], a[96:99], a[0:3], 0
    ds_read_b128 a[168:171], v1 offset:22528
    s_waitcnt vmcnt(6)
    s_waitcnt lgkmcnt(10)
    v_mfma_f32_16x16x32_bf16 v[16:19], a[104:107], a[4:7], v[16:19]
    ds_read_b128 a[80:83], v1 offset:24576
    buffer_load_dwordx2 a[28:29], v231, s[12:15], s45 offen offset:3072 sc1
    v_mfma_f32_16x16x32_bf16 v[20:23], a[108:111], a[4:7], v[20:23]
    ds_read_b128 a[84:87], v1 offset:25600
    buffer_load_dwordx2 a[30:31], v231, s[12:15], s45 offen offset:3584 sc1
    v_mfma_f32_16x16x32_bf16 v[24:27], a[112:115], a[4:7], v[24:27]
    ds_read_b128 a[88:91], v1 offset:26624
    v_mfma_f32_16x16x32_bf16 v[28:31], a[116:119], a[4:7], v[28:31]
    ds_read_b128 a[92:95], v1 offset:27648
    v_mfma_f32_16x16x32_bf16 v[32:35], a[120:123], a[4:7], v[32:35]
    ds_read_b128 a[96:99], v1 offset:28672
    s_waitcnt vmcnt(6)
    s_waitcnt lgkmcnt(10)
    v_mfma_f32_16x16x32_bf16 v[16:19], a[128:131], a[8:11], v[16:19]
    ds_read_b128 a[104:107], v1 offset:30720
    s_add_u32 s45, s44, 8192
    v_mfma_f32_16x16x32_bf16 v[20:23], a[132:135], a[8:11], v[20:23]
    ds_read_b128 a[108:111], v1 offset:31744
    buffer_load_dwordx4 a[32:35], v1, s[12:15], s45 offen offset:0 sc1
    v_mfma_f32_16x16x32_bf16 v[24:27], a[136:139], a[8:11], v[24:27]
    ds_read_b128 a[112:115], v1 offset:32768
    v_mfma_f32_16x16x32_bf16 v[28:31], a[140:143], a[8:11], v[28:31]
    ds_read_b128 a[116:119], v1 offset:33792
    v_mfma_f32_16x16x32_bf16 v[32:35], a[144:147], a[8:11], v[32:35]
    ds_read_b128 a[120:123], v1 offset:34816
    s_waitcnt vmcnt(6)
    s_waitcnt lgkmcnt(10)
    v_mfma_f32_16x16x32_bf16 v[16:19], a[152:155], a[12:15], v[16:19]
    ds_read_b128 a[128:131], v1 offset:36864
    buffer_load_dwordx4 a[36:39], v1, s[12:15], s45 offen offset:1024 sc1
    v_mfma_f32_16x16x32_bf16 v[20:23], a[156:159], a[12:15], v[20:23]
    ds_read_b128 a[132:135], v1 offset:37888
    v_mfma_f32_16x16x32_bf16 v[24:27], a[160:163], a[12:15], v[24:27]
    ds_read_b128 a[136:139], v1 offset:38912
    v_mfma_f32_16x16x32_bf16 v[28:31], a[164:167], a[12:15], v[28:31]
    ds_read_b128 a[140:143], v1 offset:39936
    v_mfma_f32_16x16x32_bf16 v[32:35], a[168:171], a[12:15], v[32:35]
    ds_read_b128 a[144:147], v1 offset:40960
    s_waitcnt vmcnt(6)
    s_waitcnt lgkmcnt(10)
    v_mfma_f32_16x16x32_bf16 v[16:19], a[80:83], a[16:19], v[16:19]
    ds_read_b128 a[152:155], v1 offset:43008
    buffer_load_dwordx4 a[40:43], v1, s[12:15], s45 offen offset:2048 sc1
    v_mfma_f32_16x16x32_bf16 v[20:23], a[84:87], a[16:19], v[20:23]
    ds_read_b128 a[156:159], v1 offset:44032
    v_mfma_f32_16x16x32_bf16 v[24:27], a[88:91], a[16:19], v[24:27]
    ds_read_b128 a[160:163], v1 offset:45056
    v_mfma_f32_16x16x32_bf16 v[28:31], a[92:95], a[16:19], v[28:31]
    ds_read_b128 a[164:167], v1 offset:46080
    v_mfma_f32_16x16x32_bf16 v[32:35], a[96:99], a[16:19], v[32:35]
    ds_read_b128 a[168:171], v1 offset:47104
    s_waitcnt vmcnt(6)
    s_waitcnt lgkmcnt(10)
    v_mfma_f32_16x16x32_bf16 v[16:19], a[104:107], a[20:23], v[16:19]
    ds_read_b128 a[80:83], v1 offset:49152
    buffer_load_dwordx4 a[44:47], v1, s[12:15], s45 offen offset:3072 sc1
    v_mfma_f32_16x16x32_bf16 v[20:23], a[108:111], a[20:23], v[20:23]
    ds_read_b128 a[84:87], v1 offset:50176
    v_mfma_f32_16x16x32_bf16 v[24:27], a[112:115], a[20:23], v[24:27]
    ds_read_b128 a[88:91], v1 offset:51200
    v_mfma_f32_16x16x32_bf16 v[28:31], a[116:119], a[20:23], v[28:31]
    ds_read_b128 a[92:95], v1 offset:52224
    v_mfma_f32_16x16x32_bf16 v[32:35], a[120:123], a[20:23], v[32:35]
    ds_read_b128 a[96:99], v1 offset:53248
    s_waitcnt vmcnt(6)
    s_waitcnt lgkmcnt(10)
    v_mfma_f32_16x16x32_bf16 v[16:19], a[128:131], a[24:27], v[16:19]
    ds_read_b128 a[104:107], v1 offset:55296
    s_add_u32 s45, s44, 12288
    v_mfma_f32_16x16x32_bf16 v[20:23], a[132:135], a[24:27], v[20:23]
    ds_read_b128 a[108:111], v1 offset:56320
    buffer_load_dwordx2 a[48:49], v231, s[12:15], s45 offen offset:0 sc1
    v_mfma_f32_16x16x32_bf16 v[24:27], a[136:139], a[24:27], v[24:27]
    ds_read_b128 a[112:115], v1 offset:57344
    buffer_load_dwordx2 a[50:51], v231, s[12:15], s45 offen offset:512 sc1
    v_mfma_f32_16x16x32_bf16 v[28:31], a[140:143], a[24:27], v[28:31]
    ds_read_b128 a[116:119], v1 offset:58368
    v_mfma_f32_16x16x32_bf16 v[32:35], a[144:147], a[24:27], v[32:35]
    ds_read_b128 a[120:123], v1 offset:59392
    s_waitcnt vmcnt(6)
    s_waitcnt lgkmcnt(10)
    v_mfma_f32_16x16x32_bf16 v[16:19], a[152:155], a[28:31], v[16:19]
    ds_read_b128 a[128:131], v1 offset:61440
    buffer_load_dwordx4 a[52:55], v1, s[12:15], s45 offen offset:1024 sc1
    v_mfma_f32_16x16x32_bf16 v[20:23], a[156:159], a[28:31], v[20:23]
    ds_read_b128 a[132:135], v1 offset:62464
    v_mfma_f32_16x16x32_bf16 v[24:27], a[160:163], a[28:31], v[24:27]
    ds_read_b128 a[136:139], v1 offset:63488
    v_mfma_f32_16x16x32_bf16 v[28:31], a[164:167], a[28:31], v[28:31]
    ds_read_b128 a[140:143], v1 offset:64512
    v_mfma_f32_16x16x32_bf16 v[32:35], a[168:171], a[28:31], v[32:35]
    ds_read_b128 a[144:147], v14 offset:0
    s_waitcnt vmcnt(6)
    s_waitcnt lgkmcnt(10)
    v_mfma_f32_16x16x32_bf16 v[16:19], a[80:83], a[32:35], v[16:19]
    ds_read_b128 a[152:155], v14 offset:2048
    buffer_load_dwordx4 a[56:59], v1, s[12:15], s45 offen offset:2048 sc1
    v_mfma_f32_16x16x32_bf16 v[20:23], a[84:87], a[32:35], v[20:23]
    ds_read_b128 a[156:159], v14 offset:3072
    v_mfma_f32_16x16x32_bf16 v[24:27], a[88:91], a[32:35], v[24:27]
    ds_read_b128 a[160:163], v14 offset:4096
    v_mfma_f32_16x16x32_bf16 v[28:31], a[92:95], a[32:35], v[28:31]
    ds_read_b128 a[164:167], v14 offset:5120
    v_mfma_f32_16x16x32_bf16 v[32:35], a[96:99], a[32:35], v[32:35]
    ds_read_b128 a[168:171], v14 offset:6144
    s_waitcnt vmcnt(6)
    s_waitcnt lgkmcnt(10)
    v_mfma_f32_16x16x32_bf16 v[16:19], a[104:107], a[36:39], v[16:19]
    ds_read_b128 a[80:83], v14 offset:8192
    buffer_load_dwordx4 a[60:63], v1, s[12:15], s45 offen offset:3072 sc1
    v_mfma_f32_16x16x32_bf16 v[20:23], a[108:111], a[36:39], v[20:23]
    ds_read_b128 a[84:87], v14 offset:9216
    v_mfma_f32_16x16x32_bf16 v[24:27], a[112:115], a[36:39], v[24:27]
    ds_read_b128 a[88:91], v14 offset:10240
    v_mfma_f32_16x16x32_bf16 v[28:31], a[116:119], a[36:39], v[28:31]
    ds_read_b128 a[92:95], v14 offset:11264
    v_mfma_f32_16x16x32_bf16 v[32:35], a[120:123], a[36:39], v[32:35]
    ds_read_b128 a[96:99], v14 offset:12288
    s_waitcnt vmcnt(6)
    s_waitcnt lgkmcnt(10)
    v_mfma_f32_16x16x32_bf16 v[16:19], a[128:131], a[40:43], v[16:19]
    ds_read_b128 a[104:107], v14 offset:14336
    s_add_u32 s45, s44, 16384
    v_mfma_f32_16x16x32_bf16 v[20:23], a[132:135], a[40:43], v[20:23]
    ds_read_b128 a[108:111], v14 offset:15360
    buffer_load_dwordx4 a[64:67], v1, s[12:15], s45 offen offset:0 sc1
    v_mfma_f32_16x16x32_bf16 v[24:27], a[136:139], a[40:43], v[24:27]
    ds_read_b128 a[112:115], v14 offset:16384
    v_mfma_f32_16x16x32_bf16 v[28:31], a[140:143], a[40:43], v[28:31]
    ds_read_b128 a[116:119], v14 offset:17408
    v_mfma_f32_16x16x32_bf16 v[32:35], a[144:147], a[40:43], v[32:35]
    ds_read_b128 a[120:123], v14 offset:18432
    s_waitcnt vmcnt(6)
    s_waitcnt lgkmcnt(10)
    v_mfma_f32_16x16x32_bf16 v[16:19], a[152:155], a[44:47], v[16:19]
    ds_read_b128 a[128:131], v14 offset:20480
    buffer_load_dwordx2 a[68:69], v231, s[12:15], s45 offen offset:1024 sc1
    v_mfma_f32_16x16x32_bf16 v[20:23], a[156:159], a[44:47], v[20:23]
    ds_read_b128 a[132:135], v14 offset:21504
    buffer_load_dwordx2 a[70:71], v231, s[12:15], s45 offen offset:1536 sc1
    v_mfma_f32_16x16x32_bf16 v[24:27], a[160:163], a[44:47], v[24:27]
    ds_read_b128 a[136:139], v14 offset:22528
    v_mfma_f32_16x16x32_bf16 v[28:31], a[164:167], a[44:47], v[28:31]
    ds_read_b128 a[140:143], v14 offset:23552
    v_mfma_f32_16x16x32_bf16 v[32:35], a[168:171], a[44:47], v[32:35]
    ds_read_b128 a[144:147], v14 offset:24576
    s_waitcnt vmcnt(6)
    s_waitcnt lgkmcnt(10)
    v_mfma_f32_16x16x32_bf16 v[16:19], a[80:83], a[48:51], v[16:19]
    ds_read_b128 a[152:155], v14 offset:26624
    buffer_load_dwordx4 a[72:75], v1, s[12:15], s45 offen offset:2048 sc1
    v_mfma_f32_16x16x32_bf16 v[20:23], a[84:87], a[48:51], v[20:23]
    ds_read_b128 a[156:159], v14 offset:27648
    s_mul_i32 s40, s32, 9216
    s_add_u32 s46, s40, 122880
    s_add_u32 s47, s40, s69
    s_add_u32 s47, s47, 24510464
    v_mfma_f32_16x16x32_bf16 v[24:27], a[88:91], a[48:51], v[24:27]
    ds_read_b128 a[160:163], v14 offset:28672
    s_add_u32 m0, s46, 0
    s_add_u32 s41, s47, 0
    v_mfma_f32_16x16x32_bf16 v[28:31], a[92:95], a[48:51], v[28:31]
    ds_read_b128 a[164:167], v14 offset:29696
    v_mfma_f32_16x16x32_bf16 v[32:35], a[96:99], a[48:51], v[32:35]
    ds_read_b128 a[168:171], v14 offset:30720
    s_waitcnt vmcnt(6)
    s_waitcnt lgkmcnt(10)
    v_mfma_f32_16x16x32_bf16 v[16:19], a[104:107], a[52:55], v[16:19]
    ds_read_b128 a[80:83], v14 offset:32768
    buffer_load_dwordx4 a[76:79], v1, s[12:15], s45 offen offset:3072 sc1
    v_mfma_f32_16x16x32_bf16 v[20:23], a[108:111], a[52:55], v[20:23]
    ds_read_b128 a[84:87], v14 offset:33792
    buffer_load_dwordx4 v1, s[12:15], s41 offen offset:0 lds
    v_mfma_f32_16x16x32_bf16 v[24:27], a[112:115], a[52:55], v[24:27]
    ds_read_b128 a[88:91], v14 offset:34816
    buffer_load_dwordx4 v1, s[12:15], s41 offen offset:1024 lds
    v_mfma_f32_16x16x32_bf16 v[28:31], a[116:119], a[52:55], v[28:31]
    ds_read_b128 a[92:95], v14 offset:35840
    v_mfma_f32_16x16x32_bf16 v[32:35], a[120:123], a[52:55], v[32:35]
    ds_read_b128 a[96:99], v14 offset:36864
    s_waitcnt vmcnt(8)
    s_waitcnt lgkmcnt(10)
    v_mfma_f32_16x16x32_bf16 v[16:19], a[128:131], a[56:59], v[16:19]
    ds_read_b128 a[104:107], v14 offset:38912
    buffer_load_dwordx4 v1, s[12:15], s41 offen offset:2048 lds
    v_mfma_f32_16x16x32_bf16 v[20:23], a[132:135], a[56:59], v[20:23]
    ds_read_b128 a[108:111], v14 offset:39936
    v_mfma_f32_16x16x32_bf16 v[24:27], a[136:139], a[56:59], v[24:27]
    ds_read_b128 a[112:115], v14 offset:40960
    v_mfma_f32_16x16x32_bf16 v[28:31], a[140:143], a[56:59], v[28:31]
    ds_read_b128 a[116:119], v14 offset:41984
    v_mfma_f32_16x16x32_bf16 v[32:35], a[144:147], a[56:59], v[32:35]
    ds_read_b128 a[120:123], v14 offset:43008
    s_waitcnt vmcnt(8)
    s_waitcnt lgkmcnt(10)
    v_mfma_f32_16x16x32_bf16 v[16:19], a[152:155], a[60:63], v[16:19]
    ds_read_b128 a[128:131], v14 offset:45056
    buffer_load_dwordx4 v1, s[12:15], s41 offen offset:3072 lds
    v_mfma_f32_16x16x32_bf16 v[20:23], a[156:159], a[60:63], v[20:23]
    ds_read_b128 a[132:135], v14 offset:46080
    s_add_u32 m0, s46, 4096
    s_add_u32 s41, s47, 4096
    v_mfma_f32_16x16x32_bf16 v[24:27], a[160:163], a[60:63], v[24:27]
    ds_read_b128 a[136:139], v14 offset:47104
    v_mfma_f32_16x16x32_bf16 v[28:31], a[164:167], a[60:63], v[28:31]
    ds_read_b128 a[140:143], v14 offset:48128
    v_mfma_f32_16x16x32_bf16 v[32:35], a[168:171], a[60:63], v[32:35]
    ds_read_b128 a[144:147], v14 offset:49152
    s_waitcnt vmcnt(8)
    s_waitcnt lgkmcnt(10)
    v_mfma_f32_16x16x32_bf16 v[16:19], a[80:83], a[64:67], v[16:19]
    ds_read_b128 a[152:155], v14 offset:51200
    buffer_load_dwordx4 v1, s[12:15], s41 offen offset:0 lds
    v_mfma_f32_16x16x32_bf16 v[20:23], a[84:87], a[64:67], v[20:23]
    ds_read_b128 a[156:159], v14 offset:52224
    buffer_load_dwordx4 v1, s[12:15], s41 offen offset:1024 lds
    v_mfma_f32_16x16x32_bf16 v[24:27], a[88:91], a[64:67], v[24:27]
    ds_read_b128 a[160:163], v14 offset:53248
    v_mfma_f32_16x16x32_bf16 v[28:31], a[92:95], a[64:67], v[28:31]
    ds_read_b128 a[164:167], v14 offset:54272
    v_mfma_f32_16x16x32_bf16 v[32:35], a[96:99], a[64:67], v[32:35]
    ds_read_b128 a[168:171], v14 offset:55296
    s_waitcnt vmcnt(8)
    s_waitcnt lgkmcnt(10)
    v_mfma_f32_16x16x32_bf16 v[16:19], a[104:107], a[68:71], v[16:19]
    buffer_load_dwordx4 v1, s[12:15], s41 offen offset:2048 lds
    v_mfma_f32_16x16x32_bf16 v[20:23], a[108:111], a[68:71], v[20:23]
    v_mfma_f32_16x16x32_bf16 v[24:27], a[112:115], a[68:71], v[24:27]
    v_mfma_f32_16x16x32_bf16 v[28:31], a[116:119], a[68:71], v[28:31]
    v_mfma_f32_16x16x32_bf16 v[32:35], a[120:123], a[68:71], v[32:35]
    s_waitcnt vmcnt(8)
    s_waitcnt lgkmcnt(5)
    v_mfma_f32_16x16x32_bf16 v[16:19], a[128:131], a[72:75], v[16:19]
    buffer_load_dwordx4 v1, s[12:15], s41 offen offset:3072 lds
    v_mfma_f32_16x16x32_bf16 v[20:23], a[132:135], a[72:75], v[20:23]
    s_add_u32 m0, s46, 8192
    s_add_u32 s41, s47, 8192
    v_mfma_f32_16x16x32_bf16 v[24:27], a[136:139], a[72:75], v[24:27]
    v_mfma_f32_16x16x32_bf16 v[28:31], a[140:143], a[72:75], v[28:31]
    v_mfma_f32_16x16x32_bf16 v[32:35], a[144:147], a[72:75], v[32:35]
    s_waitcnt vmcnt(8)
    s_waitcnt lgkmcnt(0)
    v_mfma_f32_16x16x32_bf16 v[16:19], a[152:155], a[76:79], v[16:19]
    buffer_load_dwordx4 v1, s[12:15], s41 offen offset:0 lds
    v_mfma_f32_16x16x32_bf16 v[20:23], a[156:159], a[76:79], v[20:23]
    v_mfma_f32_16x16x32_bf16 v[24:27], a[160:163], a[76:79], v[24:27]
    v_mfma_f32_16x16x32_bf16 v[28:31], a[164:167], a[76:79], v[28:31]
    v_mfma_f32_16x16x32_bf16 v[32:35], a[168:171], a[76:79], v[32:35]
    s_barrier
    s_mul_i32 s40, s32, 16384
    s_add_u32 s46, s40, 0
    s_add_u32 s47, s40, s69
    s_add_u32 s47, s47, 24547328
    s_add_u32 m0, s46, 0
    s_add_u32 s41, s47, 0
    buffer_load_dwordx4 v1, s[12:15], s41 offen offset:0 lds
    v_pk_mul_f32 v[16:17], v[16:17], v[100:101] op_sel_hi:[1,0]
    v_pk_mul_f32 v[18:19], v[18:19], v[100:101] op_sel_hi:[1,0]
    v_pk_mul_f32 v[20:21], v[20:21], v[100:101] op_sel_hi:[1,0]
    v_pk_mul_f32 v[22:23], v[22:23], v[100:101] op_sel_hi:[1,0]
    v_pk_mul_f32 v[24:25], v[24:25], v[100:101] op_sel_hi:[1,0]
    v_pk_mul_f32 v[26:27], v[26:27], v[100:101] op_sel_hi:[1,0]
    v_pk_mul_f32 v[28:29], v[28:29], v[100:101] op_sel_hi:[1,0]
    v_pk_mul_f32 v[30:31], v[30:31], v[100:101] op_sel_hi:[1,0]
    v_pk_mul_f32 v[32:33], v[32:33], v[100:101] op_sel_hi:[1,0]
    v_pk_mul_f32 v[34:35], v[34:35], v[100:101] op_sel_hi:[1,0]
    v_fmac_f32_dpp v16, v36, v101 row_newbcast:0 row_mask:0xf bank_mask:0xf
    v_fmac_f32_dpp v17, v37, v101 row_newbcast:0 row_mask:0xf bank_mask:0xf
    v_fmac_f32_dpp v18, v38, v101 row_newbcast:0 row_mask:0xf bank_mask:0xf
    v_fmac_f32_dpp v19, v39, v101 row_newbcast:0 row_mask:0xf bank_mask:0xf
    v_fmac_f32_dpp v20, v40, v101 row_newbcast:0 row_mask:0xf bank_mask:0xf
    buffer_load_dwordx4 v1, s[12:15], s41 offen offset:1024 lds
    v_fmac_f32_dpp v21, v41, v101 row_newbcast:0 row_mask:0xf bank_mask:0xf
    v_fmac_f32_dpp v22, v42, v101 row_newbcast:0 row_mask:0xf bank_mask:0xf
    v_fmac_f32_dpp v23, v43, v101 row_newbcast:0 row_mask:0xf bank_mask:0xf
    v_fmac_f32_dpp v24, v44, v101 row_newbcast:0 row_mask:0xf bank_mask:0xf
    v_fmac_f32_dpp v25, v45, v101 row_newbcast:0 row_mask:0xf bank_mask:0xf
    buffer_load_dwordx4 v1, s[12:15], s41 offen offset:2048 lds
    v_fmac_f32_dpp v26, v46, v101 row_newbcast:0 row_mask:0xf bank_mask:0xf
    v_fmac_f32_dpp v27, v47, v101 row_newbcast:0 row_mask:0xf bank_mask:0xf
    v_fmac_f32_dpp v28, v48, v101 row_newbcast:0 row_mask:0xf bank_mask:0xf
    v_fmac_f32_dpp v29, v49, v101 row_newbcast:0 row_mask:0xf bank_mask:0xf
    v_fmac_f32_dpp v30, v50, v101 row_newbcast:0 row_mask:0xf bank_mask:0xf
    buffer_load_dwordx4 v1, s[12:15], s41 offen offset:3072 lds
    v_fmac_f32_dpp v31, v51, v101 row_newbcast:0 row_mask:0xf bank_mask:0xf
    v_fmac_f32_dpp v32, v52, v101 row_newbcast:0 row_mask:0xf bank_mask:0xf
    v_fmac_f32_dpp v33, v53, v101 row_newbcast:0 row_mask:0xf bank_mask:0xf
    v_fmac_f32_dpp v34, v54, v101 row_newbcast:0 row_mask:0xf bank_mask:0xf
    v_fmac_f32_dpp v35, v55, v101 row_newbcast:0 row_mask:0xf bank_mask:0xf
    s_add_u32 m0, s46, 4096
    s_add_u32 s41, s47, 4096
    v_fmac_f32_dpp v16, v36, v102 row_newbcast:1 row_mask:0xf bank_mask:0xf
    v_fmac_f32_dpp v17, v37, v102 row_newbcast:1 row_mask:0xf bank_mask:0xf
    v_fmac_f32_dpp v18, v38, v102 row_newbcast:1 row_mask:0xf bank_mask:0xf
    v_fmac_f32_dpp v19, v39, v102 row_newbcast:1 row_mask:0xf bank_mask:0xf
    v_fmac_f32_dpp v20, v40, v102 row_newbcast:1 row_mask:0xf bank_mask:0xf
    buffer_load_dwordx4 v1, s[12:15], s41 offen offset:0 lds
    v_fmac_f32_dpp v21, v41, v102 row_newbcast:1 row_mask:0xf bank_mask:0xf
    v_fmac_f32_dpp v22, v42, v102 row_newbcast:1 row_mask:0xf bank_mask:0xf
    v_fmac_f32_dpp v23, v43, v102 row_newbcast:1 row_mask:0xf bank_mask:0xf
    v_fmac_f32_dpp v24, v44, v102 row_newbcast:1 row_mask:0xf bank_mask:0xf
    v_fmac_f32_dpp v25, v45, v102 row_newbcast:1 row_mask:0xf bank_mask:0xf
    buffer_load_dwordx4 v1, s[12:15], s41 offen offset:1024 lds
    v_fmac_f32_dpp v26, v46, v102 row_newbcast:1 row_mask:0xf bank_mask:0xf
    v_fmac_f32_dpp v27, v47, v102 row_newbcast:1 row_mask:0xf bank_mask:0xf
    v_fmac_f32_dpp v28, v48, v102 row_newbcast:1 row_mask:0xf bank_mask:0xf
    v_fmac_f32_dpp v29, v49, v102 row_newbcast:1 row_mask:0xf bank_mask:0xf
    v_fmac_f32_dpp v30, v50, v102 row_newbcast:1 row_mask:0xf bank_mask:0xf
    buffer_load_dwordx4 v1, s[12:15], s41 offen offset:2048 lds
    v_fmac_f32_dpp v31, v51, v102 row_newbcast:1 row_mask:0xf bank_mask:0xf
    v_fmac_f32_dpp v32, v52, v102 row_newbcast:1 row_mask:0xf bank_mask:0xf
    v_fmac_f32_dpp v33, v53, v102 row_newbcast:1 row_mask:0xf bank_mask:0xf
    v_fmac_f32_dpp v34, v54, v102 row_newbcast:1 row_mask:0xf bank_mask:0xf
    v_fmac_f32_dpp v35, v55, v102 row_newbcast:1 row_mask:0xf bank_mask:0xf
    buffer_load_dwordx4 v1, s[12:15], s41 offen offset:3072 lds
    v_fmac_f32_dpp v16, v36, v103 row_newbcast:2 row_mask:0xf bank_mask:0xf
    v_fmac_f32_dpp v17, v37, v103 row_newbcast:2 row_mask:0xf bank_mask:0xf
    v_fmac_f32_dpp v18, v38, v103 row_newbcast:2 row_mask:0xf bank_mask:0xf
    v_fmac_f32_dpp v19, v39, v103 row_newbcast:2 row_mask:0xf bank_mask:0xf
    v_fmac_f32_dpp v20, v40, v103 row_newbcast:2 row_mask:0xf bank_mask:0xf
    s_add_u32 m0, s46, 8192
    s_add_u32 s41, s47, 8192
    v_fmac_f32_dpp v21, v41, v103 row_newbcast:2 row_mask:0xf bank_mask:0xf
    v_fmac_f32_dpp v22, v42, v103 row_newbcast:2 row_mask:0xf bank_mask:0xf
    v_fmac_f32_dpp v23, v43, v103 row_newbcast:2 row_mask:0xf bank_mask:0xf
    v_fmac_f32_dpp v24, v44, v103 row_newbcast:2 row_mask:0xf bank_mask:0xf
    v_fmac_f32_dpp v25, v45, v103 row_newbcast:2 row_mask:0xf bank_mask:0xf
    buffer_load_dwordx4 v1, s[12:15], s41 offen offset:0 lds
    v_fmac_f32_dpp v26, v46, v103 row_newbcast:2 row_mask:0xf bank_mask:0xf
    v_fmac_f32_dpp v27, v47, v103 row_newbcast:2 row_mask:0xf bank_mask:0xf
    v_fmac_f32_dpp v28, v48, v103 row_newbcast:2 row_mask:0xf bank_mask:0xf
    v_fmac_f32_dpp v29, v49, v103 row_newbcast:2 row_mask:0xf bank_mask:0xf
    v_fmac_f32_dpp v30, v50, v103 row_newbcast:2 row_mask:0xf bank_mask:0xf
    buffer_load_dwordx4 v1, s[12:15], s41 offen offset:1024 lds
    v_fmac_f32_dpp v31, v51, v103 row_newbcast:2 row_mask:0xf bank_mask:0xf
    v_fmac_f32_dpp v32, v52, v103 row_newbcast:2 row_mask:0xf bank_mask:0xf
    v_fmac_f32_dpp v33, v53, v103 row_newbcast:2 row_mask:0xf bank_mask:0xf
    v_fmac_f32_dpp v34, v54, v103 row_newbcast:2 row_mask:0xf bank_mask:0xf
    v_fmac_f32_dpp v35, v55, v103 row_newbcast:2 row_mask:0xf bank_mask:0xf
    buffer_load_dwordx4 v1, s[12:15], s41 offen offset:2048 lds
    v_pk_mul_f32 v[132:133], v[16:17], v[16:17]
    v_pk_mul_f32 v[134:135], v[18:19], v[18:19]
    v_pk_mul_f32 v[136:137], v[20:21], v[20:21]
    v_pk_mul_f32 v[138:139], v[22:23], v[22:23]
    v_pk_mul_f32 v[140:141], v[24:25], v[24:25]
    v_pk_mul_f32 v[142:143], v[26:27], v[26:27]
    v_pk_mul_f32 v[144:145], v[28:29], v[28:29]
    v_pk_mul_f32 v[146:147], v[30:31], v[30:31]
    v_pk_mul_f32 v[148:149], v[32:33], v[32:33]
    v_pk_mul_f32 v[150:151], v[34:35], v[34:35]
    buffer_load_dwordx4 v1, s[12:15], s41 offen offset:3072 lds
    s_add_u32 m0, s46, 12288
    s_add_u32 s41, s47, 12288
    v_pk_fma_f32 v[132:133], v[132:133], v[106:107], v[104:105] op_sel_hi:[1,0,0]
    v_pk_fma_f32 v[134:135], v[134:135], v[106:107], v[104:105] op_sel_hi:[1,0,0]
    v_pk_fma_f32 v[136:137], v[136:137], v[106:107], v[104:105] op_sel_hi:[1,0,0]
    v_pk_fma_f32 v[138:139], v[138:139], v[106:107], v[104:105] op_sel_hi:[1,0,0]
    v_pk_fma_f32 v[140:141], v[140:141], v[106:107], v[104:105] op_sel_hi:[1,0,0]
    v_pk_fma_f32 v[142:143], v[142:143], v[106:107], v[104:105] op_sel_hi:[1,0,0]
    v_pk_fma_f32 v[144:145], v[144:145], v[106:107], v[104:105] op_sel_hi:[1,0,0]
    v_pk_fma_f32 v[146:147], v[146:147], v[106:107], v[104:105] op_sel_hi:[1,0,0]
    v_pk_fma_f32 v[148:149], v[148:149], v[106:107], v[104:105] op_sel_hi:[1,0,0]
    v_pk_fma_f32 v[150:151], v[150:151], v[106:107], v[104:105] op_sel_hi:[1,0,0]
    buffer_load_dwordx4 v1, s[12:15], s41 offen offset:0 lds
    buffer_load_dwordx4 v1, s[12:15], s41 offen offset:1024 lds
    v_pk_mul_f32 v[132:133], v[132:133], v[16:17]
    v_pk_mul_f32 v[134:135], v[134:135], v[18:19]
    v_pk_mul_f32 v[136:137], v[136:137], v[20:21]
    v_pk_mul_f32 v[138:139], v[138:139], v[22:23]
    v_pk_mul_f32 v[140:141], v[140:141], v[24:25]
    v_pk_mul_f32 v[142:143], v[142:143], v[26:27]
    v_pk_mul_f32 v[144:145], v[144:145], v[28:29]
    v_pk_mul_f32 v[146:147], v[146:147], v[30:31]
    v_pk_mul_f32 v[148:149], v[148:149], v[32:33]
    v_pk_mul_f32 v[150:151], v[150:151], v[34:35]
    v_exp_f32 v132, v132
    v_exp_f32 v133, v133
    v_exp_f32 v134, v134
    v_exp_f32 v135, v135
    v_exp_f32 v136, v136
    buffer_load_dwordx4 v1, s[12:15], s41 offen offset:2048 lds
    v_exp_f32 v137, v137
    v_exp_f32 v138, v138
    v_exp_f32 v139, v139
    v_exp_f32 v140, v140
    v_exp_f32 v141, v141
    buffer_load_dwordx4 v1, s[12:15], s41 offen offset:3072 lds
    v_exp_f32 v142, v142
    v_exp_f32 v143, v143
    v_exp_f32 v144, v144
    v_exp_f32 v145, v145
    v_exp_f32 v146, v146
    v_exp_f32 v147, v147
    v_exp_f32 v148, v148
    v_exp_f32 v149, v149
    v_exp_f32 v150, v150
    v_exp_f32 v151, v151
    v_pk_add_f32 v[132:133], v[132:133], 1.0 op_sel_hi:[1,0]
    v_pk_add_f32 v[134:135], v[134:135], 1.0 op_sel_hi:[1,0]
    v_pk_add_f32 v[136:137], v[136:137], 1.0 op_sel_hi:[1,0]
    v_pk_add_f32 v[138:139], v[138:139], 1.0 op_sel_hi:[1,0]
    v_pk_add_f32 v[140:141], v[140:141], 1.0 op_sel_hi:[1,0]
    v_pk_add_f32 v[142:143], v[142:143], 1.0 op_sel_hi:[1,0]
    v_pk_add_f32 v[144:145], v[144:145], 1.0 op_sel_hi:[1,0]
    v_pk_add_f32 v[146:147], v[146:147], 1.0 op_sel_hi:[1,0]
    v_pk_add_f32 v[148:149], v[148:149], 1.0 op_sel_hi:[1,0]
    v_pk_add_f32 v[150:151], v[150:151], 1.0 op_sel_hi:[1,0]
    v_rcp_f32 v132, v132
    v_rcp_f32 v133, v133
    v_rcp_f32 v134, v134
    v_rcp_f32 v135, v135
    v_rcp_f32 v136, v136
    v_rcp_f32 v137, v137
    v_rcp_f32 v138, v138
    v_rcp_f32 v139, v139
    v_rcp_f32 v140, v140
    v_rcp_f32 v141, v141
    v_rcp_f32 v142, v142
    v_rcp_f32 v143, v143
    v_rcp_f32 v144, v144
    v_rcp_f32 v145, v145
    v_rcp_f32 v146, v146
    v_rcp_f32 v147, v147
    v_rcp_f32 v148, v148
    v_rcp_f32 v149, v149
    v_rcp_f32 v150, v150
    v_rcp_f32 v151, v151
    v_pk_mul_f32 v[16:17], v[16:17], v[132:133]
    v_pk_mul_f32 v[18:19], v[18:19], v[134:135]
    v_pk_mul_f32 v[20:21], v[20:21], v[136:137]
    v_pk_mul_f32 v[22:23], v[22:23], v[138:139]
    v_pk_mul_f32 v[24:25], v[24:25], v[140:141]
    v_pk_mul_f32 v[26:27], v[26:27], v[142:143]
    v_pk_mul_f32 v[28:29], v[28:29], v[144:145]
    v_pk_mul_f32 v[30:31], v[30:31], v[146:147]
    v_pk_mul_f32 v[32:33], v[32:33], v[148:149]
    v_pk_mul_f32 v[34:35], v[34:35], v[150:151]
    v_cvt_pk_bf16_f32 v152, v16, v17
    v_cvt_pk_bf16_f32 v153, v18, v19
    v_cvt_pk_bf16_f32 v154, v20, v21
    v_cvt_pk_bf16_f32 v155, v22, v23
    v_cvt_pk_bf16_f32 v156, v24, v25
    v_cvt_pk_bf16_f32 v157, v26, v27
    v_cvt_pk_bf16_f32 v158, v28, v29
    v_cvt_pk_bf16_f32 v159, v30, v31
    v_cvt_pk_bf16_f32 v160, v32, v33
    v_cvt_pk_bf16_f32 v161, v34, v35
    s_cmp_eq_u32 s49, 1
    s_cbranch_scc1 kb_kernel_odd_8
    s_add_u32 s45, s48, 5963776
    buffer_store_dwordx4 v[152:155], v1, s[12:15], s45 offen sc1
    s_add_u32 s45, s48, 5964800
    buffer_store_dwordx4 v[156:159], v1, s[12:15], s45 offen sc1
    s_add_u32 s45, s48, 5965824
    buffer_store_dwordx2 v[160:161], v231, s[12:15], s45 offen sc1
    s_branch kb_kernel_tse_9
kb_kernel_odd_8:
    s_add_u32 s45, s48, 5964288
    buffer_store_dwordx2 v[152:153], v231, s[12:15], s45 offen sc1
    s_add_u32 s45, s48, 5964800
    buffer_store_dwordx4 v[154:157], v1, s[12:15], s45 offen sc1
    s_add_u32 s45, s48, 5965824
    buffer_store_dwordx4 v[158:161], v1, s[12:15], s45 offen sc1
kb_kernel_tse_9:
    s_lshl_b32 s45, s33, 7
    s_lshl_b32 s43, s34, 2
    s_add_u32 s45, s45, s43
    s_add_u32 s45, s45, 36864
    s_waitcnt vmcnt(0)
    s_barrier
    s_cmp_eq_u32 s32, 0
    s_cbranch_scc0 kb_kernel_nosig_10
    s_mov_b64 exec, 1
    v_mov_b32 v11, 1
    v_mov_b32 v12, 0
    s_cmp_eq_u32 s31, 1
    s_cbranch_scc1 kb_kernel_stl_11
    buffer_store_dword v11, v12, s[12:15], s45 offen sc1
    s_branch kb_kernel_ste_12
kb_kernel_stl_11:
    buffer_store_dword v11, v12, s[12:15], s45 offen
kb_kernel_ste_12:
    s_mov_b64 exec, -1
kb_kernel_nosig_10:
    v_lshlrev_b32 v11, 8, v4
    v_add_u32 v12, -1, v5
    v_ashrrev_i32 v13, 4, v12
    v_mul_i32_i24 v13, 20480, v13
    v_and_b32 v16, 15, v12
    v_lshlrev_b32 v16, 4, v16
    v_add3_u32 v13, v13, v16, v11
    v_cmp_gt_i32 vcc, 0, v12
    v_mov_b32 v16, 0x40000000
    s_nop 0
    v_cndmask_b32 v7, v13, v16, vcc
    v_ashrrev_i32 v13, 4, v12
    v_mul_i32_i24 v13, 20480, v13
    v_and_b32 v17, 15, v12
    v_lshlrev_b32 v17, 3, v17
    v_lshrrev_b32 v18, 1, v11
    v_add3_u32 v13, v13, v17, v18
    v_cndmask_b32 v224, v13, v16, vcc
    v_add_u32 v12, 1, v5
    v_ashrrev_i32 v13, 4, v12
    v_mul_i32_i24 v13, 20480, v13
    v_and_b32 v16, 15, v12
    v_lshlrev_b32 v16, 4, v16
    v_add3_u32 v13, v13, v16, v11
    v_cmp_gt_i32 vcc, 0, v12
    v_mov_b32 v16, 0x40000000
    s_nop 0
    v_cndmask_b32 v8, v13, v16, vcc
    v_ashrrev_i32 v13, 4, v12
    v_mul_i32_i24 v13, 20480, v13
    v_and_b32 v17, 15, v12
    v_lshlrev_b32 v17, 3, v17
    v_lshrrev_b32 v18, 1, v11
    v_add3_u32 v13, v13, v17, v18
    v_cndmask_b32 v225, v13, v16, vcc
    v_add_u32 v12, -2, v5
    v_ashrrev_i32 v13, 4, v12
    v_mul_i32_i24 v13, 20480, v13
    v_and_b32 v16, 15, v12
    v_lshlrev_b32 v16, 4, v16
    v_add3_u32 v13, v13, v16, v11
    v_cmp_gt_i32 vcc, 0, v12
    v_mov_b32 v16, 0x40000000
    s_nop 0
    v_cndmask_b32 v9, v13, v16, vcc
    v_ashrrev_i32 v13, 4, v12
    v_mul_i32_i24 v13, 20480, v13
    v_and_b32 v17, 15, v12
    v_lshlrev_b32 v17, 3, v17
    v_lshrrev_b32 v18, 1, v11
    v_add3_u32 v13, v13, v17, v18
    v_cndmask_b32 v226, v13, v16, vcc
    v_add_u32 v12, 2, v5
    v_ashrrev_i32 v13, 4, v12
    v_mul_i32_i24 v13, 20480, v13
    v_and_b32 v16, 15, v12
    v_lshlrev_b32 v16, 4, v16
    v_add3_u32 v13, v13, v16, v11
    v_cmp_gt_i32 vcc, 0, v12
    v_mov_b32 v16, 0x40000000
    s_nop 0
    v_cndmask_b32 v10, v13, v16, vcc
    v_ashrrev_i32 v13, 4, v12
    v_mul_i32_i24 v13, 20480, v13
    v_and_b32 v17, 15, v12
    v_lshlrev_b32 v17, 3, v17
    v_lshrrev_b32 v18, 1, v11
    v_add3_u32 v13, v13, v17, v18
    v_cndmask_b32 v227, v13, v16, vcc
    s_sub_u32 s40, s33, 1
    s_max_i32 s40, s40, 0
    s_add_u32 s41, s33, 1
    s_min_u32 s41, s41, 31
    v_mov_b32 v11, s41
    v_cmp_gt_u32 vcc, 16, v3
    v_mov_b32 v16, s33
    s_nop 0
    v_cndmask_b32 v11, v11, v16, vcc
    v_cmp_gt_u32 vcc, 8, v3
    v_mov_b32 v16, s40
    s_nop 0
    v_cndmask_b32 v11, v11, v16, vcc
    v_lshlrev_b32 v11, 7, v11
    v_and_b32 v16, 7, v3
    v_lshlrev_b32 v16, 2, v16
    v_add_u32 v11, v11, v16
    v_add_u32 v11, 36864, v11
    s_mov_b32 s43, 0
kb_kernel_poll_13:
    buffer_load_dword v13, v11, s[12:15], 0 offen sc1
    s_waitcnt vmcnt(0)
    v_cmp_ne_u32 vcc, 0, v13
    s_add_u32 s43, s43, 1
    s_cmp_eq_u64 vcc, -1
    s_cbranch_scc1 kb_kernel_pdone_14
    s_cmp_lt_u32 s43, 0x40000
    s_cbranch_scc1 kb_kernel_poll_13
kb_kernel_pdone_14:
    s_barrier
    ds_read_b128 a[80:83], v14 offset:57344
    ds_read_b128 a[84:87], v14 offset:58368
    ds_read_b128 a[88:91], v14 offset:59392
    ds_read_b128 a[92:95], v14 offset:60416
    ds_read_b128 a[96:99], v14 offset:61440
    ds_read_b128 a[100:103], v14 offset:62464
    ds_read_b128 a[104:107], v14 offset:63488
    ds_read_b128 a[108:111], v14 offset:64512
    ds_read_b128 a[112:115], v15 offset:0
    ds_read_b128 a[116:119], v15 offset:1024
    ds_read_b128 a[120:123], v15 offset:2048
    ds_read_b128 a[124:127], v15 offset:3072
    ds_read_b128 a[128:131], v15 offset:4096
    ds_read_b128 a[132:135], v15 offset:5120
    ds_read_b128 a[136:139], v15 offset:6144
    s_mov_b32 s45, 0
    buffer_load_dwordx4 a[0:3], v7, s[16:19], s45 offen sc1
    s_mov_b32 s45, 1024
    buffer_load_dwordx4 a[4:7], v7, s[16:19], s45 offen sc1
    s_mov_b32 s45, 2048
    buffer_load_dwordx2 a[8:9], v224, s[16:19], s45 offen sc1
    buffer_load_dwordx2 a[10:11], v224, s[16:19], s45 offen offset:512 sc1
    s_mov_b32 s45, 3072
    buffer_load_dwordx4 a[12:15], v7, s[16:19], s45 offen sc1
    s_mov_b32 s45, 4096
    buffer_load_dwordx4 a[16:19], v7, s[16:19], s45 offen sc1
    s_mov_b32 s45, 5120
    buffer_load_dwordx4 a[20:23], v8, s[16:19], s45 offen sc1
    s_waitcnt vmcnt(6)
    s_waitcnt lgkmcnt(10)
    v_mfma_f32_16x16x32_bf16 v[16:19], a[80:83], a[0:3], 0
    ds_read_b128 a[140:143], v15 offset:7168
    s_mov_b32 s45, 6144
    v_mfma_f32_16x16x32_bf16 v[20:23], a[84:87], a[0:3], 0
    ds_read_b128 a[144:147], v15 offset:8192
    buffer_load_dwordx4 a[24:27], v8, s[16:19], s45 offen sc1
    v_mfma_f32_16x16x32_bf16 v[24:27], a[88:91], a[0:3], 0
    ds_read_b128 a[148:151], v15 offset:9216
    v_mfma_f32_16x16x32_bf16 v[28:31], a[92:95], a[0:3], 0
    ds_read_b128 a[152:155], v15 offset:10240
    v_mfma_f32_16x16x32_bf16 v[32:35], a[96:99], a[0:3], 0
    ds_read_b128 a[156:159], v15 offset:11264
    s_waitcnt vmcnt(6)
    s_waitcnt lgkmcnt(10)
    v_mfma_f32_16x16x32_bf16 v[16:19], a[100:103], a[4:7], v[16:19]
    ds_read_b128 a[80:83], v15 offset:12288
    s_mov_b32 s45, 7168
    v_mfma_f32_16x16x32_bf16 v[20:23], a[104:107], a[4:7], v[20:23]
    ds_read_b128 a[84:87], v15 offset:13312
    buffer_load_dwordx2 a[28:29], v225, s[16:19], s45 offen sc1
    v_mfma_f32_16x16x32_bf16 v[24:27], a[108:111], a[4:7], v[24:27]
    ds_read_b128 a[88:91], v15 offset:14336
    buffer_load_dwordx2 a[30:31], v225, s[16:19], s45 offen offset:512 sc1
    v_mfma_f32_16x16x32_bf16 v[28:31], a[112:115], a[4:7], v[28:31]
    ds_read_b128 a[92:95], v15 offset:15360
    v_mfma_f32_16x16x32_bf16 v[32:35], a[116:119], a[4:7], v[32:35]
    ds_read_b128 a[96:99], v15 offset:16384
    s_waitcnt vmcnt(6)
    s_waitcnt lgkmcnt(10)
    v_mfma_f32_16x16x32_bf16 v[16:19], a[120:123], a[8:11], v[16:19]
    ds_read_b128 a[100:103], v15 offset:17408
    s_mov_b32 s45, 8192
    v_mfma_f32_16x16x32_bf16 v[20:23], a[124:127], a[8:11], v[20:23]
    ds_read_b128 a[104:107], v15 offset:18432
    buffer_load_dwordx4 a[32:35], v8, s[16:19], s45 offen sc1
    v_mfma_f32_16x16x32_bf16 v[24:27], a[128:131], a[8:11], v[24:27]
    ds_read_b128 a[108:111], v15 offset:19456
    v_mfma_f32_16x16x32_bf16 v[28:31], a[132:135], a[8:11], v[28:31]
    ds_read_b128 a[112:115], v15 offset:20480
    v_mfma_f32_16x16x32_bf16 v[32:35], a[136:139], a[8:11], v[32:35]
    ds_read_b128 a[116:119], v15 offset:21504
    v_lshlrev_b32 v12, 4, v4
    v_add_u32 v12, 160256, v12
    ds_read_b128 v[156:159], v12 offset:0
    ds_read_b128 v[160:163], v12 offset:64
    ds_read_b128 v[164:167], v12 offset:128
    ds_read_b128 v[168:171], v12 offset:192
    ds_read_b128 v[172:175], v12 offset:256
    v_lshlrev_b32 v12, 4, v4
    v_add_u32 v12, 160768, v12
    ds_read_b128 v[176:179], v12 offset:0
    ds_read_b128 v[180:183], v12 offset:64
    ds_read_b128 v[184:187], v12 offset:128
    ds_read_b128 v[188:191], v12 offset:192
    ds_read_b128 v[192:195], v12 offset:256
    v_lshlrev_b32 v132, 16, v232
    v_and_b32 v133, 0xffff0000, v232
    v_lshlrev_b32 v134, 16, v233
    v_and_b32 v135, 0xffff0000, v233
    v_lshlrev_b32 v136, 16, v234
    v_and_b32 v137, 0xffff0000, v234
    v_lshlrev_b32 v138, 16, v235
    v_and_b32 v139, 0xffff0000, v235
    v_lshlrev_b32 v140, 16, v236
    v_and_b32 v141, 0xffff0000, v236
    v_lshlrev_b32 v142, 16, v237
    v_and_b32 v143, 0xffff0000, v237
    v_lshlrev_b32 v144, 16, v238
    v_and_b32 v145, 0xffff0000, v238
    v_lshlrev_b32 v146, 16, v239
    v_and_b32 v147, 0xffff0000, v239
    v_lshlrev_b32 v148, 16, v240
    v_and_b32 v149, 0xffff0000, v240
    v_lshlrev_b32 v150, 16, v241
    v_and_b32 v151, 0xffff0000, v241
    v_pk_add_f32 v[132:133], v[132:133], v[252:253] op_sel_hi:[1,0] neg_lo:[0,1] neg_hi:[0,1]
    v_pk_add_f32 v[134:135], v[134:135], v[252:253] op_sel_hi:[1,0] neg_lo:[0,1] neg_hi:[0,1]
    v_pk_add_f32 v[136:137], v[136:137], v[252:253] op_sel_hi:[1,0] neg_lo:[0,1] neg_hi:[0,1]
    v_pk_add_f32 v[138:139], v[138:139], v[252:253] op_sel_hi:[1,0] neg_lo:[0,1] neg_hi:[0,1]
    v_pk_add_f32 v[140:141], v[140:141], v[252:253] op_sel_hi:[1,0] neg_lo:[0,1] neg_hi:[0,1]
    v_pk_add_f32 v[142:143], v[142:143], v[252:253] op_sel_hi:[1,0] neg_lo:[0,1] neg_hi:[0,1]
    v_pk_add_f32 v[144:145], v[144:145], v[252:253] op_sel_hi:[1,0] neg_lo:[0,1] neg_hi:[0,1]
    v_pk_add_f32 v[146:147], v[146:147], v[252:253] op_sel_hi:[1,0] neg_lo:[0,1] neg_hi:[0,1]
    v_pk_add_f32 v[148:149], v[148:149], v[252:253] op_sel_hi:[1,0] neg_lo:[0,1] neg_hi:[0,1]
    v_pk_add_f32 v[150:151], v[150:151], v[252:253] op_sel_hi:[1,0] neg_lo:[0,1] neg_hi:[0,1]
    v_pk_mul_f32 v[132:133], v[132:133], v[254:255] op_sel_hi:[1,0]
    v_pk_mul_f32 v[134:135], v[134:135], v[254:255] op_sel_hi:[1,0]
    v_pk_mul_f32 v[136:137], v[136:137], v[254:255] op_sel_hi:[1,0]
    v_pk_mul_f32 v[138:139], v[138:139], v[254:255] op_sel_hi:[1,0]
    v_pk_mul_f32 v[140:141], v[140:141], v[254:255] op_sel_hi:[1,0]
    v_pk_mul_f32 v[142:143], v[142:143], v[254:255] op_sel_hi:[1,0]
    v_pk_mul_f32 v[144:145], v[144:145], v[254:255] op_sel_hi:[1,0]
    v_pk_mul_f32 v[146:147], v[146:147], v[254:255] op_sel_hi:[1,0]
    v_pk_mul_f32 v[148:149], v[148:149], v[254:255] op_sel_hi:[1,0]
    v_pk_mul_f32 v[150:151], v[150:151], v[254:255] op_sel_hi:[1,0]
    s_waitcnt lgkmcnt(0)
    v_pk_fma_f32 v[132:133], v[132:133], v[156:157], v[176:177]
    v_pk_fma_f32 v[134:135], v[134:135], v[158:159], v[178:179]
    v_pk_fma_f32 v[136:137], v[136:137], v[160:161], v[180:181]
    v_pk_fma_f32 v[138:139], v[138:139], v[162:163], v[182:183]
    v_pk_fma_f32 v[140:141], v[140:141], v[164:165], v[184:185]
    v_pk_fma_f32 v[142:143], v[142:143], v[166:167], v[186:187]
    v_pk_fma_f32 v[144:145], v[144:145], v[168:169], v[188:189]
    v_pk_fma_f32 v[146:147], v[146:147], v[170:171], v[190:191]
    v_pk_fma_f32 v[148:149], v[148:149], v[172:173], v[192:193]
    v_pk_fma_f32 v[150:151], v[150:151], v[174:175], v[194:195]
    s_waitcnt vmcnt(6)
    v_mfma_f32_16x16x32_bf16 v[16:19], a[140:143], a[12:15], v[16:19]
    ds_read_b128 a[120:123], v15 offset:22528
    s_mov_b32 s45, 9216
    v_mfma_f32_16x16x32_bf16 v[20:23], a[144:147], a[12:15], v[20:23]
    ds_read_b128 a[124:127], v15 offset:23552
    buffer_load_dwordx4 a[36:39], v8, s[16:19], s45 offen sc1
    v_mfma_f32_16x16x32_bf16 v[24:27], a[148:151], a[12:15], v[24:27]
    ds_read_b128 a[128:131], v15 offset:24576
    v_mfma_f32_16x16x32_bf16 v[28:31], a[152:155], a[12:15], v[28:31]
    ds_read_b128 a[132:135], v15 offset:25600
    v_mfma_f32_16x16x32_bf16 v[32:35], a[156:159], a[12:15], v[32:35]
    ds_read_b128 a[136:139], v15 offset:26624
    s_waitcnt vmcnt(6)
    v_mfma_f32_16x16x32_bf16 v[16:19], a[80:83], a[16:19], v[16:19]
    ds_read_b128 a[140:143], v15 offset:27648
    s_mov_b32 s45, 10240
    v_mfma_f32_16x16x32_bf16 v[20:23], a[84:87], a[16:19], v[20:23]
    ds_read_b128 a[144:147], v1 offset:0
    buffer_load_dwordx4 a[40:43], v9, s[16:19], s45 offen sc1
    v_mfma_f32_16x16x32_bf16 v[24:27], a[88:91], a[16:19], v[24:27]
    ds_read_b128 a[148:151], v1 offset:1024
    v_mfma_f32_16x16x32_bf16 v[28:31], a[92:95], a[16:19], v[28:31]
    ds_read_b128 a[152:155], v1 offset:2048
    v_mfma_f32_16x16x32_bf16 v[32:35], a[96:99], a[16:19], v[32:35]
    ds_read_b128 a[156:159], v1 offset:3072
    s_waitcnt vmcnt(6)
    v_mfma_f32_16x16x32_bf16 v[16:19], a[100:103], a[20:23], v[16:19]
    ds_read_b128 a[80:83], v1 offset:4096
    s_mov_b32 s45, 11264
    v_mfma_f32_16x16x32_bf16 v[20:23], a[104:107], a[20:23], v[20:23]
    ds_read_b128 a[84:87], v1 offset:5120
    buffer_load_dwordx4 a[44:47], v9, s[16:19], s45 offen sc1
    v_mfma_f32_16x16x32_bf16 v[24:27], a[108:111], a[20:23], v[24:27]
    ds_read_b128 a[88:91], v1 offset:6144
    v_mfma_f32_16x16x32_bf16 v[28:31], a[112:115], a[20:23], v[28:31]
    ds_read_b128 a[92:95], v1 offset:7168
    v_mfma_f32_16x16x32_bf16 v[32:35], a[116:119], a[20:23], v[32:35]
    ds_read_b128 a[96:99], v1 offset:8192
    s_waitcnt vmcnt(6)
    s_waitcnt lgkmcnt(10)
    v_mfma_f32_16x16x32_bf16 v[16:19], a[120:123], a[24:27], v[16:19]
    ds_read_b128 a[100:103], v1 offset:9216
    s_mov_b32 s45, 12288
    v_mfma_f32_16x16x32_bf16 v[20:23], a[124:127], a[24:27], v[20:23]
    ds_read_b128 a[104:107], v1 offset:10240
    buffer_load_dwordx2 a[48:49], v226, s[16:19], s45 offen sc1
    v_mfma_f32_16x16x32_bf16 v[24:27], a[128:131], a[24:27], v[24:27]
    ds_read_b128 a[108:111], v1 offset:11264
    buffer_load_dwordx2 a[50:51], v226, s[16:19], s45 offen offset:512 sc1
    v_mfma_f32_16x16x32_bf16 v[28:31], a[132:135], a[24:27], v[28:31]
    ds_read_b128 a[112:115], v1 offset:12288
    v_mfma_f32_16x16x32_bf16 v[32:35], a[136:139], a[24:27], v[32:35]
    ds_read_b128 a[116:119], v1 offset:13312
    s_waitcnt vmcnt(6)
    s_waitcnt lgkmcnt(10)
    v_mfma_f32_16x16x32_bf16 v[16:19], a[140:143], a[28:31], v[16:19]
    ds_read_b128 a[120:123], v1 offset:14336
    s_mov_b32 s45, 13312
    v_mfma_f32_16x16x32_bf16 v[20:23], a[144:147], a[28:31], v[20:23]
    ds_read_b128 a[124:127], v1 offset:15360
    buffer_load_dwordx4 a[52:55], v9, s[16:19], s45 offen sc1
    v_mfma_f32_16x16x32_bf16 v[24:27], a[148:151], a[28:31], v[24:27]
    ds_read_b128 a[128:131], v1 offset:16384
    v_mfma_f32_16x16x32_bf16 v[28:31], a[152:155], a[28:31], v[28:31]
    ds_read_b128 a[132:135], v1 offset:17408
    v_mfma_f32_16x16x32_bf16 v[32:35], a[156:159], a[28:31], v[32:35]
    ds_read_b128 a[136:139], v1 offset:18432
    s_waitcnt vmcnt(6)
    s_waitcnt lgkmcnt(10)
    v_mfma_f32_16x16x32_bf16 v[16:19], a[80:83], a[32:35], v[16:19]
    ds_read_b128 a[140:143], v1 offset:19456
    s_mov_b32 s45, 14336
    v_mfma_f32_16x16x32_bf16 v[20:23], a[84:87], a[32:35], v[20:23]
    ds_read_b128 a[144:147], v1 offset:20480
    buffer_load_dwordx4 a[56:59], v9, s[16:19], s45 offen sc1
    v_mfma_f32_16x16x32_bf16 v[24:27], a[88:91], a[32:35], v[24:27]
    ds_read_b128 a[148:151], v1 offset:21504
    v_mfma_f32_16x16x32_bf16 v[28:31], a[92:95], a[32:35], v[28:31]
    ds_read_b128 a[152:155], v1 offset:22528
    v_mfma_f32_16x16x32_bf16 v[32:35], a[96:99], a[32:35], v[32:35]
    ds_read_b128 a[156:159], v1 offset:23552
    s_waitcnt vmcnt(6)
    s_waitcnt lgkmcnt(10)
    v_mfma_f32_16x16x32_bf16 v[16:19], a[100:103], a[36:39], v[16:19]
    ds_read_b128 a[80:83], v1 offset:24576
    s_mov_b32 s45, 15360
    v_mfma_f32_16x16x32_bf16 v[20:23], a[104:107], a[36:39], v[20:23]
    ds_read_b128 a[84:87], v1 offset:25600
    buffer_load_dwordx4 a[60:63], v10, s[16:19], s45 offen sc1
    v_mfma_f32_16x16x32_bf16 v[24:27], a[108:111], a[36:39], v[24:27]
    ds_read_b128 a[88:91], v1 offset:26624
    v_mfma_f32_16x16x32_bf16 v[28:31], a[112:115], a[36:39], v[28:31]
    ds_read_b128 a[92:95], v1 offset:27648
    v_mfma_f32_16x16x32_bf16 v[32:35], a[116:119], a[36:39], v[32:35]
    ds_read_b128 a[96:99], v1 offset:28672
    s_waitcnt vmcnt(6)
    s_waitcnt lgkmcnt(10)
    v_mfma_f32_16x16x32_bf16 v[16:19], a[120:123], a[40:43], v[16:19]
    ds_read_b128 a[100:103], v1 offset:29696
    s_mov_b32 s45, 16384
    v_mfma_f32_16x16x32_bf16 v[20:23], a[124:127], a[40:43], v[20:23]
    ds_read_b128 a[104:107], v1 offset:30720
    buffer_load_dwordx4 a[64:67], v10, s[16:19], s45 offen sc1
    v_mfma_f32_16x16x32_bf16 v[24:27], a[128:131], a[40:43], v[24:27]
    ds_read_b128 a[108:111], v1 offset:31744
    v_mfma_f32_16x16x32_bf16 v[28:31], a[132:135], a[40:43], v[28:31]
    ds_read_b128 a[112:115], v1 offset:32768
    v_mfma_f32_16x16x32_bf16 v[32:35], a[136:139], a[40:43], v[32:35]
    ds_read_b128 a[116:119], v1 offset:33792
    s_waitcnt vmcnt(6)
    s_waitcnt lgkmcnt(10)
    v_mfma_f32_16x16x32_bf16 v[16:19], a[140:143], a[44:47], v[16:19]
    ds_read_b128 a[120:123], v1 offset:34816
    s_mov_b32 s45, 17408
    v_mfma_f32_16x16x32_bf16 v[20:23], a[144:147], a[44:47], v[20:23]
    ds_read_b128 a[124:127], v1 offset:35840
    buffer_load_dwordx2 a[68:69], v227, s[16:19], s45 offen sc1
    v_mfma_f32_16x16x32_bf16 v[24:27], a[148:151], a[44:47], v[24:27]
    ds_read_b128 a[128:131], v1 offset:36864
    buffer_load_dwordx2 a[70:71], v227, s[16:19], s45 offen offset:512 sc1
    v_mfma_f32_16x16x32_bf16 v[28:31], a[152:155], a[44:47], v[28:31]
    ds_read_b128 a[132:135], v1 offset:37888
    v_mfma_f32_16x16x32_bf16 v[32:35], a[156:159], a[44:47], v[32:35]
    ds_read_b128 a[136:139], v1 offset:38912
    s_waitcnt vmcnt(6)
    s_waitcnt lgkmcnt(10)
    v_mfma_f32_16x16x32_bf16 v[16:19], a[80:83], a[48:51], v[16:19]
    ds_read_b128 a[140:143], v1 offset:39936
    s_mov_b32 s45, 18432
    v_mfma_f32_16x16x32_bf16 v[20:23], a[84:87], a[48:51], v[20:23]
    ds_read_b128 a[144:147], v1 offset:40960
    buffer_load_dwordx4 a[72:75], v10, s[16:19], s45 offen sc1
    v_mfma_f32_16x16x32_bf16 v[24:27], a[88:91], a[48:51], v[24:27]
    ds_read_b128 a[148:151], v1 offset:41984
    v_mfma_f32_16x16x32_bf16 v[28:31], a[92:95], a[48:51], v[28:31]
    ds_read_b128 a[152:155], v1 offset:43008
    v_mfma_f32_16x16x32_bf16 v[32:35], a[96:99], a[48:51], v[32:35]
    ds_read_b128 a[156:159], v1 offset:44032
    s_waitcnt vmcnt(6)
    s_waitcnt lgkmcnt(10)
    v_mfma_f32_16x16x32_bf16 v[16:19], a[100:103], a[52:55], v[16:19]
    ds_read_b128 a[80:83], v1 offset:45056
    s_mov_b32 s45, 19456
    v_mfma_f32_16x16x32_bf16 v[20:23], a[104:107], a[52:55], v[20:23]
    ds_read_b128 a[84:87], v1 offset:46080
    buffer_load_dwordx4 a[76:79], v10, s[16:19], s45 offen sc1
    v_mfma_f32_16x16x32_bf16 v[24:27], a[108:111], a[52:55], v[24:27]
    ds_read_b128 a[88:91], v1 offset:47104
    v_mfma_f32_16x16x32_bf16 v[28:31], a[112:115], a[52:55], v[28:31]
    ds_read_b128 a[92:95], v1 offset:48128
    v_mfma_f32_16x16x32_bf16 v[32:35], a[116:119], a[52:55], v[32:35]
    ds_read_b128 a[96:99], v1 offset:49152
    s_waitcnt vmcnt(6)
    s_waitcnt lgkmcnt(10)
    v_mfma_f32_16x16x32_bf16 v[16:19], a[120:123], a[56:59], v[16:19]
    ds_read_b128 a[100:103], v1 offset:50176
    s_mul_i32 s40, s32, 14336
    s_add_u32 s46, s40, 65536
    s_add_u32 s47, s40, s29
    s_add_u32 s47, s47, 25362432
    v_mfma_f32_16x16x32_bf16 v[20:23], a[124:127], a[56:59], v[20:23]
    ds_read_b128 a[104:107], v1 offset:51200
    s_add_u32 m0, s46, 0
    s_add_u32 s41, s47, 0
    v_mfma_f32_16x16x32_bf16 v[24:27], a[128:131], a[56:59], v[24:27]
    ds_read_b128 a[108:111], v1 offset:52224
    buffer_load_dwordx4 v1, s[12:15], s41 offen offset:0 lds
    v_mfma_f32_16x16x32_bf16 v[28:31], a[132:135], a[56:59], v[28:31]
    ds_read_b128 a[112:115], v1 offset:53248
    buffer_load_dwordx4 v1, s[12:15], s41 offen offset:1024 lds
    v_mfma_f32_16x16x32_bf16 v[32:35], a[136:139], a[56:59], v[32:35]
    ds_read_b128 a[116:119], v1 offset:54272
    s_waitcnt vmcnt(7)
    s_waitcnt lgkmcnt(10)
    v_mfma_f32_16x16x32_bf16 v[16:19], a[140:143], a[60:63], v[16:19]
    ds_read_b128 a[120:123], v1 offset:55296
    buffer_load_dwordx4 v1, s[12:15], s41 offen offset:2048 lds
    v_mfma_f32_16x16x32_bf16 v[20:23], a[144:147], a[60:63], v[20:23]
    ds_read_b128 a[124:127], v1 offset:56320
    buffer_load_dwordx4 v1, s[12:15], s41 offen offset:3072 lds
    v_mfma_f32_16x16x32_bf16 v[24:27], a[148:151], a[60:63], v[24:27]
    ds_read_b128 a[128:131], v1 offset:57344
    s_add_u32 m0, s46, 4096
    s_add_u32 s41, s47, 4096
    v_mfma_f32_16x16x32_bf16 v[28:31], a[152:155], a[60:63], v[28:31]
    ds_read_b128 a[132:135], v1 offset:58368
    v_mfma_f32_16x16x32_bf16 v[32:35], a[156:159], a[60:63], v[32:35]
    ds_read_b128 a[136:139], v1 offset:59392
    s_waitcnt vmcnt(8)
    s_waitcnt lgkmcnt(10)
    v_mfma_f32_16x16x32_bf16 v[16:19], a[80:83], a[64:67], v[16:19]
    ds_read_b128 a[140:143], v1 offset:60416
    buffer_load_dwordx4 v1, s[12:15], s41 offen offset:0 lds
    v_mfma_f32_16x16x32_bf16 v[20:23], a[84:87], a[64:67], v[20:23]
    ds_read_b128 a[144:147], v1 offset:61440
    buffer_load_dwordx4 v1, s[12:15], s41 offen offset:1024 lds
    v_mfma_f32_16x16x32_bf16 v[24:27], a[88:91], a[64:67], v[24:27]
    ds_read_b128 a[148:151], v1 offset:62464
    buffer_load_dwordx4 v1, s[12:15], s41 offen offset:2048 lds
    v_mfma_f32_16x16x32_bf16 v[28:31], a[92:95], a[64:67], v[28:31]
    ds_read_b128 a[152:155], v1 offset:63488
    v_mfma_f32_16x16x32_bf16 v[32:35], a[96:99], a[64:67], v[32:35]
    ds_read_b128 a[156:159], v1 offset:64512
    s_waitcnt vmcnt(9)
    s_waitcnt lgkmcnt(10)
    v_mfma_f32_16x16x32_bf16 v[16:19], a[100:103], a[68:71], v[16:19]
    buffer_load_dwordx4 v1, s[12:15], s41 offen offset:3072 lds
    v_mfma_f32_16x16x32_bf16 v[20:23], a[104:107], a[68:71], v[20:23]
    s_add_u32 m0, s46, 8192
    s_add_u32 s41, s47, 8192
    v_mfma_f32_16x16x32_bf16 v[24:27], a[108:111], a[68:71], v[24:27]
    buffer_load_dwordx4 v1, s[12:15], s41 offen offset:0 lds
    v_mfma_f32_16x16x32_bf16 v[28:31], a[112:115], a[68:71], v[28:31]
    v_mfma_f32_16x16x32_bf16 v[32:35], a[116:119], a[68:71], v[32:35]
    s_waitcnt vmcnt(10)
    s_waitcnt lgkmcnt(5)
    v_mfma_f32_16x16x32_bf16 v[16:19], a[120:123], a[72:75], v[16:19]
    buffer_load_dwordx4 v1, s[12:15], s41 offen offset:1024 lds
    v_mfma_f32_16x16x32_bf16 v[20:23], a[124:127], a[72:75], v[20:23]
    buffer_load_dwordx4 v1, s[12:15], s41 offen offset:2048 lds
    v_mfma_f32_16x16x32_bf16 v[24:27], a[128:131], a[72:75], v[24:27]
    buffer_load_dwordx4 v1, s[12:15], s41 offen offset:3072 lds
    v_mfma_f32_16x16x32_bf16 v[28:31], a[132:135], a[72:75], v[28:31]
    v_mfma_f32_16x16x32_bf16 v[32:35], a[136:139], a[72:75], v[32:35]
    s_waitcnt vmcnt(12)
    s_waitcnt lgkmcnt(0)
    v_mfma_f32_16x16x32_bf16 v[16:19], a[140:143], a[76:79], v[16:19]
    s_add_u32 m0, s46, 12288
    s_add_u32 s41, s47, 12288
    v_mfma_f32_16x16x32_bf16 v[20:23], a[144:147], a[76:79], v[20:23]
    buffer_load_dwordx4 v1, s[12:15], s41 offen offset:0 lds
    v_mfma_f32_16x16x32_bf16 v[24:27], a[148:151], a[76:79], v[24:27]
    buffer_load_dwordx4 v1, s[12:15], s41 offen offset:1024 lds
    v_mfma_f32_16x16x32_bf16 v[28:31], a[152:155], a[76:79], v[28:31]
    v_mfma_f32_16x16x32_bf16 v[32:35], a[156:159], a[76:79], v[32:35]
    s_barrier
    s_mul_i32 s40, s32, 16384
    s_add_u32 s46, s40, 0
    s_add_u32 s47, s40, s29
    s_add_u32 s47, s47, 25419776
    s_add_u32 m0, s46, 0
    s_add_u32 s41, s47, 0
    buffer_load_dwordx4 v1, s[12:15], s41 offen offset:0 lds
    s_nop 1
    v_pk_add_f32 v[132:133], v[132:133], v[16:17]
    v_pk_add_f32 v[134:135], v[134:135], v[18:19]
    v_pk_add_f32 v[136:137], v[136:137], v[20:21]
    v_pk_add_f32 v[138:139], v[138:139], v[22:23]
    v_pk_add_f32 v[140:141], v[140:141], v[24:25]
    v_pk_add_f32 v[142:143], v[142:143], v[26:27]
    v_pk_add_f32 v[144:145], v[144:145], v[28:29]
    v_pk_add_f32 v[146:147], v[146:147], v[30:31]
    v_pk_add_f32 v[148:149], v[148:149], v[32:33]
    v_pk_add_f32 v[150:151], v[150:151], v[34:35]
    v_cvt_pk_bf16_f32 v242, v132, v133
    v_cvt_pk_bf16_f32 v243, v134, v135
    v_cvt_pk_bf16_f32 v244, v136, v137
    v_cvt_pk_bf16_f32 v245, v138, v139
    v_cvt_pk_bf16_f32 v246, v140, v141
    v_cvt_pk_bf16_f32 v247, v142, v143
    v_cvt_pk_bf16_f32 v248, v144, v145
    v_cvt_pk_bf16_f32 v249, v146, v147
    v_cvt_pk_bf16_f32 v250, v148, v149
    v_cvt_pk_bf16_f32 v251, v150, v151
    s_cmp_eq_u32 s49, 1
    s_cbranch_scc1 kb_kernel_odd_15
    s_add_u32 s45, s48, 8585216
    buffer_store_dwordx4 v[242:245], v1, s[12:15], s45 offen sc1
    s_add_u32 s45, s48, 8586240
    buffer_store_dwordx4 v[246:249], v1, s[12:15], s45 offen sc1
    s_add_u32 s45, s48, 8587264
    buffer_store_dwordx2 v[250:251], v231, s[12:15], s45 offen sc1
    s_branch kb_kernel_tse_16
kb_kernel_odd_15:
    s_add_u32 s45, s48, 8585728
    buffer_store_dwordx2 v[242:243], v231, s[12:15], s45 offen sc1
    s_add_u32 s45, s48, 8586240
    buffer_store_dwordx4 v[244:247], v1, s[12:15], s45 offen sc1
    s_add_u32 s45, s48, 8587264
    buffer_store_dwordx4 v[248:251], v1, s[12:15], s45 offen sc1
kb_kernel_tse_16:
    v_lshlrev_b32 v132, 16, v242
    v_and_b32 v133, 0xffff0000, v242
    v_lshlrev_b32 v134, 16, v243
    v_and_b32 v135, 0xffff0000, v243
    v_lshlrev_b32 v136, 16, v244
    v_and_b32 v137, 0xffff0000, v244
    v_lshlrev_b32 v138, 16, v245
    v_and_b32 v139, 0xffff0000, v245
    v_lshlrev_b32 v140, 16, v246
    v_and_b32 v141, 0xffff0000, v246
    v_lshlrev_b32 v142, 16, v247
    v_and_b32 v143, 0xffff0000, v247
    v_lshlrev_b32 v144, 16, v248
    v_and_b32 v145, 0xffff0000, v248
    v_lshlrev_b32 v146, 16, v249
    v_and_b32 v147, 0xffff0000, v249
    v_lshlrev_b32 v148, 16, v250
    v_and_b32 v149, 0xffff0000, v250
    v_lshlrev_b32 v150, 16, v251
    v_and_b32 v151, 0xffff0000, v251
    v_pk_add_f32 v[100:101], v[132:133], v[134:135]
    v_pk_mul_f32 v[102:103], v[132:133], v[132:133]
    v_pk_fma_f32 v[102:103], v[134:135], v[134:135], v[102:103]
    v_pk_add_f32 v[100:101], v[100:101], v[136:137]
    v_pk_fma_f32 v[102:103], v[136:137], v[136:137], v[102:103]
    v_pk_add_f32 v[100:101], v[100:101], v[138:139]
    v_pk_fma_f32 v[102:103], v[138:139], v[138:139], v[102:103]
    v_pk_add_f32 v[100:101], v[100:101], v[140:141]
    v_pk_fma_f32 v[102:103], v[140:141], v[140:141], v[102:103]
    v_pk_add_f32 v[100:101], v[100:101], v[142:143]
    v_pk_fma_f32 v[102:103], v[142:143], v[142:143], v[102:103]
    v_pk_add_f32 v[100:101], v[100:101], v[144:145]
    v_pk_fma_f32 v[102:103], v[144:145], v[144:145], v[102:103]
    v_pk_add_f32 v[100:101], v[100:101], v[146:147]
    v_pk_fma_f32 v[102:103], v[146:147], v[146:147], v[102:103]
    v_pk_add_f32 v[100:101], v[100:101], v[148:149]
    v_pk_fma_f32 v[102:103], v[148:149], v[148:149], v[102:103]
    v_pk_add_f32 v[100:101], v[100:101], v[150:151]
    v_pk_fma_f32 v[102:103], v[150:151], v[150:151], v[102:103]
    v_add_f32 v100, v100, v101
    v_add_f32 v101, v102, v103
    v_mov_b32 v104, v100
    v_mov_b32 v105, v101
    s_nop 0
    s_nop 0
    v_permlane16_swap_b32 v100, v104
    v_permlane16_swap_b32 v101, v105
    s_nop 0
    v_add_f32 v100, v100, v104
    v_add_f32 v101, v101, v105
    v_mov_b32 v104, v100
    v_mov_b32 v105, v101
    s_nop 0
    s_nop 0
    v_permlane32_swap_b32 v100, v104
    v_permlane32_swap_b32 v101, v105
    s_nop 0
    v_add_f32 v100, v100, v104
    v_add_f32 v101, v101, v105
    v_lshlrev_b32 v11, 3, v5
    s_lshl_b32 s45, s34, 14
    s_add_u32 s45, s45, 49283072
    v_cmp_gt_u32 vcc, 16, v3
    s_and_saveexec_b64 s[42:43], vcc
    buffer_store_dwordx2 v[100:101], v11, s[12:15], s45 offen sc1
    s_mov_b64 exec, s[42:43]
    s_lshl_b32 s45, s33, 7
    s_lshl_b32 s43, s34, 2
    s_add_u32 s45, s45, s43
    s_add_u32 s45, s45, 40960
    s_waitcnt vmcnt(0)
    s_barrier
    s_cmp_eq_u32 s32, 0
    s_cbranch_scc0 kb_kernel_nosig_17
    s_mov_b64 exec, 1
    v_mov_b32 v11, 1
    v_mov_b32 v12, 0
    s_cmp_eq_u32 s30, 1
    s_cbranch_scc1 kb_kernel_stl_18
    buffer_store_dword v11, v12, s[12:15], s45 offen sc1
    s_branch kb_kernel_ste_19
kb_kernel_stl_18:
    buffer_store_dword v11, v12, s[12:15], s45 offen
kb_kernel_ste_19:
    s_mov_b64 exec, -1
kb_kernel_nosig_17:
    buffer_load_dwordx4 v1, s[12:15], s41 offen offset:1024 lds
    buffer_load_dwordx4 v1, s[12:15], s41 offen offset:2048 lds
    buffer_load_dwordx4 v1, s[12:15], s41 offen offset:3072 lds
    s_add_u32 m0, s46, 4096
    s_add_u32 s41, s47, 4096
    buffer_load_dwordx4 v1, s[12:15], s41 offen offset:0 lds
    buffer_load_dwordx4 v1, s[12:15], s41 offen offset:1024 lds
    buffer_load_dwordx4 v1, s[12:15], s41 offen offset:2048 lds
    buffer_load_dwordx4 v1, s[12:15], s41 offen offset:3072 lds
    s_add_u32 m0, s46, 8192
    s_add_u32 s41, s47, 8192
    buffer_load_dwordx4 v1, s[12:15], s41 offen offset:0 lds
    buffer_load_dwordx4 v1, s[12:15], s41 offen offset:1024 lds
    buffer_load_dwordx4 v1, s[12:15], s41 offen offset:2048 lds
    buffer_load_dwordx4 v1, s[12:15], s41 offen offset:3072 lds
    s_add_u32 m0, s46, 12288
    s_add_u32 s41, s47, 12288
    buffer_load_dwordx4 v1, s[12:15], s41 offen offset:0 lds
    buffer_load_dwordx4 v1, s[12:15], s41 offen offset:1024 lds
    buffer_load_dwordx4 v1, s[12:15], s41 offen offset:2048 lds
    buffer_load_dwordx4 v1, s[12:15], s41 offen offset:3072 lds
    s_mul_i32 s40, s32, 5120
    s_add_u32 s46, s40, 122880
    s_add_u32 s47, s40, s29
    s_add_u32 s47, s47, 25485312
    s_add_u32 m0, s46, 0
    s_add_u32 s41, s47, 0
    buffer_load_dwordx4 v1, s[12:15], s41 offen offset:0 lds
    buffer_load_dwordx4 v1, s[12:15], s41 offen offset:1024 lds
    buffer_load_dwordx4 v1, s[12:15], s41 offen offset:2048 lds
    buffer_load_dwordx4 v1, s[12:15], s41 offen offset:3072 lds
    s_add_u32 m0, s46, 4096
    s_add_u32 s41, s47, 4096
    buffer_load_dwordx4 v1, s[12:15], s41 offen offset:0 lds
    v_add_u32 v8, 20480, v1
    s_lshl_b32 s40, s35, 8
    s_add_u32 s40, s40, 40960
    v_bfe_u32 v11, v3, 3, 1
    v_lshlrev_b32 v11, 7, v11
    v_and_b32 v16, 7, v3
    v_lshlrev_b32 v16, 2, v16
    v_add3_u32 v11, v11, v16, s40
    s_mov_b32 s43, 0
kb_kernel_poll_20:
    buffer_load_dword v13, v11, s[12:15], 0 offen sc1
    s_waitcnt vmcnt(0)
    v_cmp_ne_u32 vcc, 0, v13
    s_add_u32 s43, s43, 1
    s_cmp_eq_u64 vcc, -1
    s_cbranch_scc1 kb_kernel_pdone_21
    s_cmp_lt_u32 s43, 0x40000
    s_cbranch_scc1 kb_kernel_poll_20
kb_kernel_pdone_21:
    s_barrier
    ds_read_b128 a[160:163], v14 offset:0
    ds_read_b128 a[164:167], v14 offset:1024
    ds_read_b128 a[168:171], v14 offset:2048
    ds_read_b128 a[172:175], v14 offset:3072
    ds_read_b128 a[176:179], v14 offset:4096
    ds_read_b128 a[180:183], v14 offset:5120
    ds_read_b128 a[184:187], v14 offset:6144
    s_mul_i32 s44, s39, 20480
    s_add_u32 s44, s44, 8585216
    v_and_b32 v11, 15, v3
    s_lshl_b32 s40, s39, 4
    v_add_u32 v11, s40, v11
    v_lshlrev_b32 v11, 3, v11
    v_lshlrev_b32 v12, 15, v4
    v_add_u32 v11, v11, v12
    v_add_u32 v224, 20480, v231
    s_add_u32 s45, s44, 0
    buffer_load_dwordx4 a[0:3], v1, s[12:15], s45 offen offset:0 sc1
    buffer_load_dwordx4 a[4:7], v8, s[12:15], s45 offen offset:0 sc1
    buffer_load_dwordx4 a[8:11], v1, s[12:15], s45 offen offset:1024 sc1
    buffer_load_dwordx4 a[12:15], v8, s[12:15], s45 offen offset:1024 sc1
    buffer_load_dwordx2 a[16:17], v231, s[12:15], s45 offen offset:2048 sc1
    buffer_load_dwordx2 a[18:19], v231, s[12:15], s45 offen offset:2560 sc1
    buffer_load_dwordx2 a[20:21], v224, s[12:15], s45 offen offset:2048 sc1
    buffer_load_dwordx2 a[22:23], v224, s[12:15], s45 offen offset:2560 sc1
    s_mov_b32 s47, 49283072
    buffer_load_dwordx2 v[88:89], v11, s[12:15], s47 offen offset:0 sc1
    buffer_load_dwordx2 v[92:93], v11, s[12:15], s47 offen offset:128 sc1
    s_mov_b32 s47, 49299456
    buffer_load_dwordx2 v[90:91], v11, s[12:15], s47 offen offset:0 sc1
    buffer_load_dwordx2 v[94:95], v11, s[12:15], s47 offen offset:128 sc1
    s_add_u32 s40, s39, 0
    s_mul_i32 s40, s40, 54
    s_lshr_b32 s43, s28, 1
    s_add_u32 s43, s43, s40
    s_lshl_b32 s54, s43, 10
    s_add_u32 s40, s39, 1
    s_mul_i32 s40, s40, 54
    s_lshr_b32 s43, s28, 1
    s_add_u32 s43, s43, s40
    s_lshl_b32 s55, s43, 10
    s_and_b32 s56, s28, 1
    s_mul_i32 s40, s32, 14
    s_mul_i32 s41, s34, 54
    s_add_u32 s41, s41, s40
    s_mul_i32 s69, s41, 5120
    s_add_u32 s69, s69, 27656192
    s_waitcnt vmcnt(10)
    s_waitcnt lgkmcnt(0)
    v_mfma_f32_16x16x32_bf16 v[16:19], a[160:163], a[0:3], 0
    ds_read_b128 a[188:191], v14 offset:7168
    buffer_load_dwordx4 a[24:27], v1, s[12:15], s45 offen offset:3072 sc1
    v_mfma_f32_16x16x32_bf16 v[44:47], a[160:163], a[4:7], 0
    ds_read_b128 a[192:195], v14 offset:8192
    buffer_load_dwordx4 a[28:31], v8, s[12:15], s45 offen offset:3072 sc1
    v_mfma_f32_16x16x32_bf16 v[20:23], a[164:167], a[0:3], 0
    ds_read_b128 a[196:199], v14 offset:9216
    v_mfma_f32_16x16x32_bf16 v[48:51], a[164:167], a[4:7], 0
    ds_read_b128 a[200:203], v14 offset:10240
    v_mfma_f32_16x16x32_bf16 v[24:27], a[168:171], a[0:3], 0
    ds_read_b128 a[204:207], v14 offset:11264
    v_mfma_f32_16x16x32_bf16 v[52:55], a[168:171], a[4:7], 0
    ds_read_b128 a[208:211], v14 offset:12288
    v_mfma_f32_16x16x32_bf16 v[28:31], a[172:175], a[0:3], 0
    ds_read_b128 a[212:215], v14 offset:13312
    v_mfma_f32_16x16x32_bf16 v[56:59], a[172:175], a[4:7], 0
    v_mfma_f32_16x16x32_bf16 v[32:35], a[176:179], a[0:3], 0
    v_mfma_f32_16x16x32_bf16 v[60:63], a[176:179], a[4:7], 0
    v_mfma_f32_16x16x32_bf16 v[36:39], a[180:183], a[0:3], 0
    v_mfma_f32_16x16x32_bf16 v[64:67], a[180:183], a[4:7], 0
    v_mfma_f32_16x16x32_bf16 v[40:43], a[184:187], a[0:3], 0
    v_mfma_f32_16x16x32_bf16 v[68:71], a[184:187], a[4:7], 0
    s_waitcnt vmcnt(10)
    s_waitcnt lgkmcnt(0)
    v_mfma_f32_16x16x32_bf16 v[16:19], a[188:191], a[8:11], v[16:19]
    ds_read_b128 a[160:163], v14 offset:14336
    s_add_u32 s45, s44, 4096
    v_mfma_f32_16x16x32_bf16 v[44:47], a[188:191], a[12:15], v[44:47]
    ds_read_b128 a[164:167], v14 offset:15360
    buffer_load_dwordx4 a[32:35], v1, s[12:15], s45 offen offset:0 sc1
    v_mfma_f32_16x16x32_bf16 v[20:23], a[192:195], a[8:11], v[20:23]
    ds_read_b128 a[168:171], v14 offset:16384
    buffer_load_dwordx4 a[36:39], v8, s[12:15], s45 offen offset:0 sc1
    v_mfma_f32_16x16x32_bf16 v[48:51], a[192:195], a[12:15], v[48:51]
    ds_read_b128 a[172:175], v14 offset:17408
    v_mfma_f32_16x16x32_bf16 v[24:27], a[196:199], a[8:11], v[24:27]
    ds_read_b128 a[176:179], v14 offset:18432
    v_mfma_f32_16x16x32_bf16 v[52:55], a[196:199], a[12:15], v[52:55]
    ds_read_b128 a[180:183], v14 offset:19456
    v_mfma_f32_16x16x32_bf16 v[28:31], a[200:203], a[8:11], v[28:31]
    ds_read_b128 a[184:187], v14 offset:20480
    v_mfma_f32_16x16x32_bf16 v[56:59], a[200:203], a[12:15], v[56:59]
    v_mfma_f32_16x16x32_bf16 v[32:35], a[204:207], a[8:11], v[32:35]
    v_mfma_f32_16x16x32_bf16 v[60:63], a[204:207], a[12:15], v[60:63]
    v_mfma_f32_16x16x32_bf16 v[36:39], a[208:211], a[8:11], v[36:39]
    v_mfma_f32_16x16x32_bf16 v[64:67], a[208:211], a[12:15], v[64:67]
    v_mfma_f32_16x16x32_bf16 v[40:43], a[212:215], a[8:11], v[40:43]
    v_mfma_f32_16x16x32_bf16 v[68:71], a[212:215], a[12:15], v[68:71]
    s_waitcnt vmcnt(8)
    s_waitcnt lgkmcnt(0)
    v_mfma_f32_16x16x32_bf16 v[16:19], a[160:163], a[16:19], v[16:19]
    ds_read_b128 a[188:191], v14 offset:21504
    buffer_load_dwordx4 a[40:43], v1, s[12:15], s45 offen offset:1024 sc1
    v_mfma_f32_16x16x32_bf16 v[44:47], a[160:163], a[20:23], v[44:47]
    ds_read_b128 a[192:195], v14 offset:22528
    buffer_load_dwordx4 a[44:47], v8, s[12:15], s45 offen offset:1024 sc1
    v_mfma_f32_16x16x32_bf16 v[20:23], a[164:167], a[16:19], v[20:23]
    ds_read_b128 a[196:199], v14 offset:23552
    v_mfma_f32_16x16x32_bf16 v[48:51], a[164:167], a[20:23], v[48:51]
    ds_read_b128 a[200:203], v14 offset:24576
    v_mfma_f32_16x16x32_bf16 v[24:27], a[168:171], a[16:19], v[24:27]
    ds_read_b128 a[204:207], v14 offset:25600
    v_mfma_f32_16x16x32_bf16 v[52:55], a[168:171], a[20:23], v[52:55]
    ds_read_b128 a[208:211], v14 offset:26624
    v_mfma_f32_16x16x32_bf16 v[28:31], a[172:175], a[16:19], v[28:31]
    ds_read_b128 a[212:215], v14 offset:27648
    v_mfma_f32_16x16x32_bf16 v[56:59], a[172:175], a[20:23], v[56:59]
    v_mfma_f32_16x16x32_bf16 v[32:35], a[176:179], a[16:19], v[32:35]
    v_mfma_f32_16x16x32_bf16 v[60:63], a[176:179], a[20:23], v[60:63]
    v_mfma_f32_16x16x32_bf16 v[36:39], a[180:183], a[16:19], v[36:39]
    v_mfma_f32_16x16x32_bf16 v[64:67], a[180:183], a[20:23], v[64:67]
    v_mfma_f32_16x16x32_bf16 v[40:43], a[184:187], a[16:19], v[40:43]
    v_mfma_f32_16x16x32_bf16 v[68:71], a[184:187], a[20:23], v[68:71]
    s_waitcnt vmcnt(6)
    v_add_f32 v96, v88, v90
    v_add_f32 v97, v89, v91
    v_add_f32 v98, v92, v94
    v_add_f32 v99, v93, v95
    v_mov_b32 v100, v96
    v_mov_b32 v101, v97
    v_mov_b32 v102, v98
    v_mov_b32 v103, v99
    s_nop 0
    v_permlane16_swap_b32 v96, v100
    v_permlane16_swap_b32 v97, v101
    v_permlane16_swap_b32 v98, v102
    v_permlane16_swap_b32 v99, v103
    s_nop 0
    v_add_f32 v96, v96, v100
    v_add_f32 v97, v97, v101
    v_add_f32 v98, v98, v102
    v_add_f32 v99, v99, v103
    v_mov_b32 v100, v96
    v_mov_b32 v101, v97
    v_mov_b32 v102, v98
    v_mov_b32 v103, v99
    s_nop 0
    v_permlane32_swap_b32 v96, v100
    v_permlane32_swap_b32 v97, v101
    v_permlane32_swap_b32 v98, v102
    v_permlane32_swap_b32 v99, v103
    s_nop 0
    v_add_f32 v96, v96, v100
    v_add_f32 v97, v97, v101
    v_add_f32 v98, v98, v102
    v_add_f32 v99, v99, v103
    v_mul_f32 v72, 0x3acccccd, v96
    v_mul_f32 v74, 0x3acccccd, v97
    v_fma_f32 v74, -v72, v72, v74
    v_max_f32 v74, 0, v74
    v_add_f32 v74, 0x3727c5ac, v74
    v_rsq_f32 v74, v74
    v_mul_f32 v76, 0x3acccccd, v98
    v_mul_f32 v78, 0x3acccccd, v99
    v_fma_f32 v78, -v76, v76, v78
    v_max_f32 v78, 0, v78
    v_add_f32 v78, 0x3727c5ac, v78
    v_rsq_f32 v78, v78
    v_mov_b32 v80, 0xc0135761
    v_mov_b32 v82, 0xbdd2d3e8
    v_lshlrev_b32 v12, 4, v4
    v_add_u32 v12, 161792, v12
    ds_read_b128 v[112:115], v12 offset:0
    ds_read_b128 v[116:119], v12 offset:64
    ds_read_b128 v[120:123], v12 offset:128
    ds_read_b128 v[124:127], v12 offset:192
    ds_read_b128 v[128:131], v12 offset:256
    ds_read_b128 v[132:135], v12 offset:320
    ds_read_b128 v[136:139], v12 offset:384
    s_waitcnt vmcnt(4)
    s_waitcnt lgkmcnt(7)
    v_mfma_f32_16x16x32_bf16 v[16:19], a[188:191], a[24:27], v[16:19]
    ds_read_b128 a[160:163], v14 offset:28672
    buffer_load_dwordx4 a[48:51], v1, s[12:15], s45 offen offset:2048 sc1
    v_mfma_f32_16x16x32_bf16 v[44:47], a[188:191], a[28:31], v[44:47]
    ds_read_b128 a[164:167], v14 offset:29696
    buffer_load_dwordx4 a[52:55], v8, s[12:15], s45 offen offset:2048 sc1
    v_mfma_f32_16x16x32_bf16 v[20:23], a[192:195], a[24:27], v[20:23]
    ds_read_b128 a[168:171], v14 offset:30720
    v_mfma_f32_16x16x32_bf16 v[48:51], a[192:195], a[28:31], v[48:51]
    ds_read_b128 a[172:175], v14 offset:31744
    v_mfma_f32_16x16x32_bf16 v[24:27], a[196:199], a[24:27], v[24:27]
    ds_read_b128 a[176:179], v14 offset:32768
    v_mfma_f32_16x16x32_bf16 v[52:55], a[196:199], a[28:31], v[52:55]
    ds_read_b128 a[180:183], v14 offset:33792
    v_mfma_f32_16x16x32_bf16 v[28:31], a[200:203], a[24:27], v[28:31]
    ds_read_b128 a[184:187], v14 offset:34816
    v_mfma_f32_16x16x32_bf16 v[56:59], a[200:203], a[28:31], v[56:59]
    v_mfma_f32_16x16x32_bf16 v[32:35], a[204:207], a[24:27], v[32:35]
    v_mfma_f32_16x16x32_bf16 v[60:63], a[204:207], a[28:31], v[60:63]
    v_mfma_f32_16x16x32_bf16 v[36:39], a[208:211], a[24:27], v[36:39]
    v_mfma_f32_16x16x32_bf16 v[64:67], a[208:211], a[28:31], v[64:67]
    v_mfma_f32_16x16x32_bf16 v[40:43], a[212:215], a[24:27], v[40:43]
    v_mfma_f32_16x16x32_bf16 v[68:71], a[212:215], a[28:31], v[68:71]
    s_waitcnt vmcnt(4)
    s_waitcnt lgkmcnt(0)
    v_mfma_f32_16x16x32_bf16 v[16:19], a[160:163], a[32:35], v[16:19]
    ds_read_b128 a[188:191], v14 offset:35840
    buffer_load_dwordx2 a[56:57], v231, s[12:15], s45 offen offset:3072 sc1
    v_mfma_f32_16x16x32_bf16 v[44:47], a[160:163], a[36:39], v[44:47]
    ds_read_b128 a[192:195], v14 offset:36864
    buffer_load_dwordx2 a[58:59], v231, s[12:15], s45 offen offset:3584 sc1
    v_mfma_f32_16x16x32_bf16 v[20:23], a[164:167], a[32:35], v[20:23]
    ds_read_b128 a[196:199], v14 offset:37888
    buffer_load_dwordx2 a[60:61], v224, s[12:15], s45 offen offset:3072 sc1
    v_mfma_f32_16x16x32_bf16 v[48:51], a[164:167], a[36:39], v[48:51]
    ds_read_b128 a[200:203], v14 offset:38912
    buffer_load_dwordx2 a[62:63], v224, s[12:15], s45 offen offset:3584 sc1
    v_mfma_f32_16x16x32_bf16 v[24:27], a[168:171], a[32:35], v[24:27]
    ds_read_b128 a[204:207], v14 offset:39936
    v_mfma_f32_16x16x32_bf16 v[52:55], a[168:171], a[36:39], v[52:55]
    ds_read_b128 a[208:211], v14 offset:40960
    v_mfma_f32_16x16x32_bf16 v[28:31], a[172:175], a[32:35], v[28:31]
    ds_read_b128 a[212:215], v14 offset:41984
    v_mfma_f32_16x16x32_bf16 v[56:59], a[172:175], a[36:39], v[56:59]
    v_mfma_f32_16x16x32_bf16 v[32:35], a[176:179], a[32:35], v[32:35]
    v_mfma_f32_16x16x32_bf16 v[60:63], a[176:179], a[36:39], v[60:63]
    v_mfma_f32_16x16x32_bf16 v[36:39], a[180:183], a[32:35], v[36:39]
    v_mfma_f32_16x16x32_bf16 v[64:67], a[180:183], a[36:39], v[64:67]
    v_mfma_f32_16x16x32_bf16 v[40:43], a[184:187], a[32:35], v[40:43]
    v_mfma_f32_16x16x32_bf16 v[68:71], a[184:187], a[36:39], v[68:71]
    s_waitcnt vmcnt(6)
    s_waitcnt lgkmcnt(0)
    v_mfma_f32_16x16x32_bf16 v[16:19], a[188:191], a[40:43], v[16:19]
    ds_read_b128 a[160:163], v14 offset:43008
    s_add_u32 s45, s44, 8192
    v_mfma_f32_16x16x32_bf16 v[44:47], a[188:191], a[44:47], v[44:47]
    ds_read_b128 a[164:167], v14 offset:44032
    buffer_load_dwordx4 a[64:67], v1, s[12:15], s45 offen offset:0 sc1
    v_mfma_f32_16x16x32_bf16 v[20:23], a[192:195], a[40:43], v[20:23]
    ds_read_b128 a[168:171], v14 offset:45056
    buffer_load_dwordx4 a[68:71], v8, s[12:15], s45 offen offset:0 sc1
    v_mfma_f32_16x16x32_bf16 v[48:51], a[192:195], a[44:47], v[48:51]
    ds_read_b128 a[172:175], v14 offset:46080
    v_mfma_f32_16x16x32_bf16 v[24:27], a[196:199], a[40:43], v[24:27]
    ds_read_b128 a[176:179], v14 offset:47104
    v_mfma_f32_16x16x32_bf16 v[52:55], a[196:199], a[44:47], v[52:55]
    ds_read_b128 a[180:183], v14 offset:48128
    v_mfma_f32_16x16x32_bf16 v[28:31], a[200:203], a[40:43], v[28:31]
    ds_read_b128 a[184:187], v14 offset:49152
    v_mfma_f32_16x16x32_bf16 v[56:59], a[200:203], a[44:47], v[56:59]
    v_mfma_f32_16x16x32_bf16 v[32:35], a[204:207], a[40:43], v[32:35]
    v_mfma_f32_16x16x32_bf16 v[60:63], a[204:207], a[44:47], v[60:63]
    v_mfma_f32_16x16x32_bf16 v[36:39], a[208:211], a[40:43], v[36:39]
    v_mfma_f32_16x16x32_bf16 v[64:67], a[208:211], a[44:47], v[64:67]
    v_mfma_f32_16x16x32_bf16 v[40:43], a[212:215], a[40:43], v[40:43]
    v_mfma_f32_16x16x32_bf16 v[68:71], a[212:215], a[44:47], v[68:71]
    s_waitcnt vmcnt(6)
    s_waitcnt lgkmcnt(0)
    v_mfma_f32_16x16x32_bf16 v[16:19], a[160:163], a[48:51], v[16:19]
    ds_read_b128 a[188:191], v14 offset:50176
    buffer_load_dwordx4 a[72:75], v1, s[12:15], s45 offen offset:1024 sc1
    v_mfma_f32_16x16x32_bf16 v[44:47], a[160:163], a[52:55], v[44:47]
    ds_read_b128 a[192:195], v14 offset:51200
    buffer_load_dwordx4 a[76:79], v8, s[12:15], s45 offen offset:1024 sc1
    v_mfma_f32_16x16x32_bf16 v[20:23], a[164:167], a[48:51], v[20:23]
    ds_read_b128 a[196:199], v14 offset:52224
    v_mfma_f32_16x16x32_bf16 v[48:51], a[164:167], a[52:55], v[48:51]
    ds_read_b128 a[200:203], v14 offset:53248
    v_mfma_f32_16x16x32_bf16 v[24:27], a[168:171], a[48:51], v[24:27]
    ds_read_b128 a[204:207], v14 offset:54272
    v_mfma_f32_16x16x32_bf16 v[52:55], a[168:171], a[52:55], v[52:55]
    ds_read_b128 a[208:211], v14 offset:55296
    v_mfma_f32_16x16x32_bf16 v[28:31], a[172:175], a[48:51], v[28:31]
    ds_read_b128 a[212:215], v14 offset:56320
    v_mfma_f32_16x16x32_bf16 v[56:59], a[172:175], a[52:55], v[56:59]
    v_mfma_f32_16x16x32_bf16 v[32:35], a[176:179], a[48:51], v[32:35]
    v_mfma_f32_16x16x32_bf16 v[60:63], a[176:179], a[52:55], v[60:63]
    v_mfma_f32_16x16x32_bf16 v[36:39], a[180:183], a[48:51], v[36:39]
    v_mfma_f32_16x16x32_bf16 v[64:67], a[180:183], a[52:55], v[64:67]
    v_mfma_f32_16x16x32_bf16 v[40:43], a[184:187], a[48:51], v[40:43]
    v_mfma_f32_16x16x32_bf16 v[68:71], a[184:187], a[52:55], v[68:71]
    s_waitcnt vmcnt(4)
    s_waitcnt lgkmcnt(0)
    v_mfma_f32_16x16x32_bf16 v[16:19], a[188:191], a[56:59], v[16:19]
    ds_read_b128 a[160:163], v1 offset:0
    buffer_load_dwordx4 a[80:83], v1, s[12:15], s45 offen offset:2048 sc1
    v_mfma_f32_16x16x32_bf16 v[44:47], a[188:191], a[60:63], v[44:47]
    ds_read_b128 a[164:167], v1 offset:1024
    buffer_load_dwordx4 a[84:87], v8, s[12:15], s45 offen offset:2048 sc1
    v_mfma_f32_16x16x32_bf16 v[20:23], a[192:195], a[56:59], v[20:23]
    ds_read_b128 a[168:171], v1 offset:2048
    v_mfma_f32_16x16x32_bf16 v[48:51], a[192:195], a[60:63], v[48:51]
    ds_read_b128 a[172:175], v1 offset:3072
    v_mfma_f32_16x16x32_bf16 v[24:27], a[196:199], a[56:59], v[24:27]
    ds_read_b128 a[176:179], v1 offset:4096
    v_mfma_f32_16x16x32_bf16 v[52:55], a[196:199], a[60:63], v[52:55]
    ds_read_b128 a[180:183], v1 offset:5120
    v_mfma_f32_16x16x32_bf16 v[28:31], a[200:203], a[56:59], v[28:31]
    ds_read_b128 a[184:187], v1 offset:6144
    v_mfma_f32_16x16x32_bf16 v[56:59], a[200:203], a[60:63], v[56:59]
    v_mfma_f32_16x16x32_bf16 v[32:35], a[204:207], a[56:59], v[32:35]
    v_mfma_f32_16x16x32_bf16 v[60:63], a[204:207], a[60:63], v[60:63]
    v_mfma_f32_16x16x32_bf16 v[36:39], a[208:211], a[56:59], v[36:39]
    v_mfma_f32_16x16x32_bf16 v[64:67], a[208:211], a[60:63], v[64:67]
    v_mfma_f32_16x16x32_bf16 v[40:43], a[212:215], a[56:59], v[40:43]
    v_mfma_f32_16x16x32_bf16 v[68:71], a[212:215], a[60:63], v[68:71]
    s_waitcnt vmcnt(4)
    s_waitcnt lgkmcnt(0)
    v_mfma_f32_16x16x32_bf16 v[16:19], a[160:163], a[64:67], v[16:19]
    ds_read_b128 a[188:191], v1 offset:7168
    buffer_load_dwordx4 a[88:91], v1, s[12:15], s45 offen offset:3072 sc1
    v_mfma_f32_16x16x32_bf16 v[44:47], a[160:163], a[68:71], v[44:47]
    ds_read_b128 a[192:195], v1 offset:8192
    buffer_load_dwordx4 a[92:95], v8, s[12:15], s45 offen offset:3072 sc1
    v_mfma_f32_16x16x32_bf16 v[20:23], a[164:167], a[64:67], v[20:23]
    ds_read_b128 a[196:199], v1 offset:9216
    s_add_u32 s46, s69, 56320
    v_mfma_f32_16x16x32_bf16 v[48:51], a[164:167], a[68:71], v[48:51]
    ds_read_b128 a[200:203], v1 offset:10240
    buffer_load_dwordx4 a[220:223], v1, s[12:15], s46 offen offset:0
    v_mfma_f32_16x16x32_bf16 v[24:27], a[168:171], a[64:67], v[24:27]
    ds_read_b128 a[204:207], v1 offset:11264
    buffer_load_dwordx4 a[224:227], v1, s[12:15], s46 offen offset:1024
    v_mfma_f32_16x16x32_bf16 v[52:55], a[168:171], a[68:71], v[52:55]
    ds_read_b128 a[208:211], v1 offset:12288
    buffer_load_dwordx4 a[228:231], v1, s[12:15], s46 offen offset:2048
    v_mfma_f32_16x16x32_bf16 v[28:31], a[172:175], a[64:67], v[28:31]
    ds_read_b128 a[212:215], v1 offset:13312
    buffer_load_dwordx4 a[232:235], v1, s[12:15], s46 offen offset:3072
    v_mfma_f32_16x16x32_bf16 v[56:59], a[172:175], a[68:71], v[56:59]
    buffer_load_dwordx4 a[236:239], v2, s[12:15], s46 offen
    v_mfma_f32_16x16x32_bf16 v[32:35], a[176:179], a[64:67], v[32:35]
    v_mfma_f32_16x16x32_bf16 v[60:63], a[176:179], a[68:71], v[60:63]
    v_mfma_f32_16x16x32_bf16 v[36:39], a[180:183], a[64:67], v[36:39]
    v_mfma_f32_16x16x32_bf16 v[64:67], a[180:183], a[68:71], v[64:67]
    v_mfma_f32_16x16x32_bf16 v[40:43], a[184:187], a[64:67], v[40:43]
    v_mfma_f32_16x16x32_bf16 v[68:71], a[184:187], a[68:71], v[68:71]
    s_waitcnt vmcnt(9)
    s_waitcnt lgkmcnt(0)
    v_mfma_f32_16x16x32_bf16 v[16:19], a[188:191], a[72:75], v[16:19]
    ds_read_b128 a[160:163], v1 offset:14336
    s_add_u32 s45, s44, 12288
    v_mfma_f32_16x16x32_bf16 v[44:47], a[188:191], a[76:79], v[44:47]
    ds_read_b128 a[164:167], v1 offset:15360
    buffer_load_dwordx2 a[96:97], v231, s[12:15], s45 offen offset:0 sc1
    v_mfma_f32_16x16x32_bf16 v[20:23], a[192:195], a[72:75], v[20:23]
    ds_read_b128 a[168:171], v1 offset:16384
    buffer_load_dwordx2 a[98:99], v231, s[12:15], s45 offen offset:512 sc1
    v_mfma_f32_16x16x32_bf16 v[48:51], a[192:195], a[76:79], v[48:51]
    ds_read_b128 a[172:175], v1 offset:17408
    buffer_load_dwordx2 a[100:101], v224, s[12:15], s45 offen offset:0 sc1
    v_mfma_f32_16x16x32_bf16 v[24:27], a[196:199], a[72:75], v[24:27]
    ds_read_b128 a[176:179], v1 offset:18432
    buffer_load_dwordx2 a[102:103], v224, s[12:15], s45 offen offset:512 sc1
    v_mfma_f32_16x16x32_bf16 v[52:55], a[196:199], a[76:79], v[52:55]
    ds_read_b128 a[180:183], v1 offset:19456
    v_mfma_f32_16x16x32_bf16 v[28:31], a[200:203], a[72:75], v[28:31]
    ds_read_b128 a[184:187], v1 offset:20480
    v_mfma_f32_16x16x32_bf16 v[56:59], a[200:203], a[76:79], v[56:59]
    v_mfma_f32_16x16x32_bf16 v[32:35], a[204:207], a[72:75], v[32:35]
    v_mfma_f32_16x16x32_bf16 v[60:63], a[204:207], a[76:79], v[60:63]
    v_mfma_f32_16x16x32_bf16 v[36:39], a[208:211], a[72:75], v[36:39]
    v_mfma_f32_16x16x32_bf16 v[64:67], a[208:211], a[76:79], v[64:67]
    v_mfma_f32_16x16x32_bf16 v[40:43], a[212:215], a[72:75], v[40:43]
    v_mfma_f32_16x16x32_bf16 v[68:71], a[212:215], a[76:79], v[68:71]
    s_waitcnt vmcnt(11)
    s_waitcnt lgkmcnt(0)
    v_mfma_f32_16x16x32_bf16 v[16:19], a[160:163], a[80:83], v[16:19]
    ds_read_b128 a[188:191], v1 offset:21504
    buffer_load_dwordx4 a[104:107], v1, s[12:15], s45 offen offset:1024 sc1
    v_mfma_f32_16x16x32_bf16 v[44:47], a[160:163], a[84:87], v[44:47]
    ds_read_b128 a[192:195], v1 offset:22528
    buffer_load_dwordx4 a[108:111], v8, s[12:15], s45 offen offset:1024 sc1
    v_mfma_f32_16x16x32_bf16 v[20:23], a[164:167], a[80:83], v[20:23]
    ds_read_b128 a[196:199], v1 offset:23552
    s_add_u32 s46, s69, 0
    v_mfma_f32_16x16x32_bf16 v[48:51], a[164:167], a[84:87], v[48:51]
    ds_read_b128 a[200:203], v1 offset:24576
    buffer_load_dwordx4 a[0:3], v1, s[12:15], s46 offen offset:0
    v_mfma_f32_16x16x32_bf16 v[24:27], a[168:171], a[80:83], v[24:27]
    ds_read_b128 a[204:207], v1 offset:25600
    buffer_load_dwordx4 a[4:7], v1, s[12:15], s46 offen offset:1024
    v_mfma_f32_16x16x32_bf16 v[52:55], a[168:171], a[84:87], v[52:55]
    ds_read_b128 a[208:211], v1 offset:26624
    buffer_load_dwordx4 a[8:11], v1, s[12:15], s46 offen offset:2048
    v_mfma_f32_16x16x32_bf16 v[28:31], a[172:175], a[80:83], v[28:31]
    ds_read_b128 a[212:215], v1 offset:27648
    buffer_load_dwordx4 a[12:15], v1, s[12:15], s46 offen offset:3072
    v_mfma_f32_16x16x32_bf16 v[56:59], a[172:175], a[84:87], v[56:59]
    buffer_load_dwordx4 a[16:19], v2, s[12:15], s46 offen
    v_mfma_f32_16x16x32_bf16 v[32:35], a[176:179], a[80:83], v[32:35]
    v_mfma_f32_16x16x32_bf16 v[60:63], a[176:179], a[84:87], v[60:63]
    v_mfma_f32_16x16x32_bf16 v[36:39], a[180:183], a[80:83], v[36:39]
    v_mfma_f32_16x16x32_bf16 v[64:67], a[180:183], a[84:87], v[64:67]
    v_mfma_f32_16x16x32_bf16 v[40:43], a[184:187], a[80:83], v[40:43]
    v_mfma_f32_16x16x32_bf16 v[68:71], a[184:187], a[84:87], v[68:71]
    s_waitcnt vmcnt(16)
    s_waitcnt lgkmcnt(0)
    v_mfma_f32_16x16x32_bf16 v[16:19], a[188:191], a[88:91], v[16:19]
    ds_read_b128 a[160:163], v1 offset:28672
    buffer_load_dwordx4 a[112:115], v1, s[12:15], s45 offen offset:2048 sc1
    v_mfma_f32_16x16x32_bf16 v[44:47], a[188:191], a[92:95], v[44:47]
    ds_read_b128 a[164:167], v1 offset:29696
    buffer_load_dwordx4 a[116:119], v8, s[12:15], s45 offen offset:2048 sc1
    v_mfma_f32_16x16x32_bf16 v[20:23], a[192:195], a[88:91], v[20:23]
    ds_read_b128 a[168:171], v1 offset:30720
    s_add_u32 s46, s69, 5120
    v_mfma_f32_16x16x32_bf16 v[48:51], a[192:195], a[92:95], v[48:51]
    ds_read_b128 a[172:175], v1 offset:31744
    buffer_load_dwordx4 a[20:23], v1, s[12:15], s46 offen offset:0
    v_mfma_f32_16x16x32_bf16 v[24:27], a[196:199], a[88:91], v[24:27]
    ds_read_b128 a[176:179], v1 offset:32768
    buffer_load_dwordx4 a[24:27], v1, s[12:15], s46 offen offset:1024
    v_mfma_f32_16x16x32_bf16 v[52:55], a[196:199], a[92:95], v[52:55]
    ds_read_b128 a[180:183], v1 offset:33792
    buffer_load_dwordx4 a[28:31], v1, s[12:15], s46 offen offset:2048
    v_mfma_f32_16x16x32_bf16 v[28:31], a[200:203], a[88:91], v[28:31]
    ds_read_b128 a[184:187], v1 offset:34816
    buffer_load_dwordx4 a[32:35], v1, s[12:15], s46 offen offset:3072
    v_mfma_f32_16x16x32_bf16 v[56:59], a[200:203], a[92:95], v[56:59]
    buffer_load_dwordx4 a[36:39], v2, s[12:15], s46 offen
    v_mfma_f32_16x16x32_bf16 v[32:35], a[204:207], a[88:91], v[32:35]
    v_mfma_f32_16x16x32_bf16 v[60:63], a[204:207], a[92:95], v[60:63]
    v_mfma_f32_16x16x32_bf16 v[36:39], a[208:211], a[88:91], v[36:39]
    v_mfma_f32_16x16x32_bf16 v[64:67], a[208:211], a[92:95], v[64:67]
    v_mfma_f32_16x16x32_bf16 v[40:43], a[212:215], a[88:91], v[40:43]
    v_mfma_f32_16x16x32_bf16 v[68:71], a[212:215], a[92:95], v[68:71]
    s_waitcnt vmcnt(14)
    s_waitcnt lgkmcnt(0)
    v_mfma_f32_16x16x32_bf16 v[16:19], a[160:163], a[96:99], v[16:19]
    ds_read_b128 a[188:191], v1 offset:35840
    buffer_load_dwordx4 a[120:123], v1, s[12:15], s45 offen offset:3072 sc1
    v_mfma_f32_16x16x32_bf16 v[44:47], a[160:163], a[100:103], v[44:47]
    ds_read_b128 a[192:195], v1 offset:36864
    buffer_load_dwordx4 a[124:127], v8, s[12:15], s45 offen offset:3072 sc1
    v_mfma_f32_16x16x32_bf16 v[20:23], a[164:167], a[96:99], v[20:23]
    ds_read_b128 a[196:199], v1 offset:37888
    v_mfma_f32_16x16x32_bf16 v[48:51], a[164:167], a[100:103], v[48:51]
    ds_read_b128 a[200:203], v1 offset:38912
    v_mfma_f32_16x16x32_bf16 v[24:27], a[168:171], a[96:99], v[24:27]
    ds_read_b128 a[204:207], v1 offset:39936
    v_mfma_f32_16x16x32_bf16 v[52:55], a[168:171], a[100:103], v[52:55]
    ds_read_b128 a[208:211], v1 offset:40960
    v_mfma_f32_16x16x32_bf16 v[28:31], a[172:175], a[96:99], v[28:31]
    ds_read_b128 a[212:215], v1 offset:41984
    v_mfma_f32_16x16x32_bf16 v[56:59], a[172:175], a[100:103], v[56:59]
    v_mfma_f32_16x16x32_bf16 v[32:35], a[176:179], a[96:99], v[32:35]
    v_mfma_f32_16x16x32_bf16 v[60:63], a[176:179], a[100:103], v[60:63]
    v_mfma_f32_16x16x32_bf16 v[36:39], a[180:183], a[96:99], v[36:39]
    v_mfma_f32_16x16x32_bf16 v[64:67], a[180:183], a[100:103], v[64:67]
    v_mfma_f32_16x16x32_bf16 v[40:43], a[184:187], a[96:99], v[40:43]
    v_mfma_f32_16x16x32_bf16 v[68:71], a[184:187], a[100:103], v[68:71]
    s_waitcnt vmcnt(14)
    s_waitcnt lgkmcnt(0)
    v_mfma_f32_16x16x32_bf16 v[16:19], a[188:191], a[104:107], v[16:19]
    ds_read_b128 a[160:163], v1 offset:43008
    s_add_u32 s45, s44, 16384
    v_mfma_f32_16x16x32_bf16 v[44:47], a[188:191], a[108:111], v[44:47]
    ds_read_b128 a[164:167], v1 offset:44032
    buffer_load_dwordx4 a[128:131], v1, s[12:15], s45 offen offset:0 sc1
    v_mfma_f32_16x16x32_bf16 v[20:23], a[192:195], a[104:107], v[20:23]
    ds_read_b128 a[168:171], v1 offset:45056
    buffer_load_dwordx4 a[132:135], v8, s[12:15], s45 offen offset:0 sc1
    v_mfma_f32_16x16x32_bf16 v[48:51], a[192:195], a[108:111], v[48:51]
    ds_read_b128 a[172:175], v1 offset:46080
    s_add_u32 s46, s69, 10240
    v_mfma_f32_16x16x32_bf16 v[24:27], a[196:199], a[104:107], v[24:27]
    ds_read_b128 a[176:179], v1 offset:47104
    buffer_load_dwordx4 a[40:43], v1, s[12:15], s46 offen offset:0
    v_mfma_f32_16x16x32_bf16 v[52:55], a[196:199], a[108:111], v[52:55]
    ds_read_b128 a[180:183], v1 offset:48128
    buffer_load_dwordx4 a[44:47], v1, s[12:15], s46 offen offset:1024
    v_mfma_f32_16x16x32_bf16 v[28:31], a[200:203], a[104:107], v[28:31]
    ds_read_b128 a[184:187], v1 offset:49152
    buffer_load_dwordx4 a[48:51], v1, s[12:15], s46 offen offset:2048
    v_mfma_f32_16x16x32_bf16 v[56:59], a[200:203], a[108:111], v[56:59]
    buffer_load_dwordx4 a[52:55], v1, s[12:15], s46 offen offset:3072
    v_mfma_f32_16x16x32_bf16 v[32:35], a[204:207], a[104:107], v[32:35]
    buffer_load_dwordx4 a[56:59], v2, s[12:15], s46 offen
    v_mfma_f32_16x16x32_bf16 v[60:63], a[204:207], a[108:111], v[60:63]
    v_mfma_f32_16x16x32_bf16 v[36:39], a[208:211], a[104:107], v[36:39]
    v_mfma_f32_16x16x32_bf16 v[64:67], a[208:211], a[108:111], v[64:67]
    v_mfma_f32_16x16x32_bf16 v[40:43], a[212:215], a[104:107], v[40:43]
    v_mfma_f32_16x16x32_bf16 v[68:71], a[212:215], a[108:111], v[68:71]
    s_waitcnt vmcnt(14)
    s_waitcnt lgkmcnt(0)
    v_mfma_f32_16x16x32_bf16 v[16:19], a[160:163], a[112:115], v[16:19]
    ds_read_b128 a[188:191], v1 offset:50176
    buffer_load_dwordx2 a[136:137], v231, s[12:15], s45 offen offset:1024 sc1
    v_mfma_f32_16x16x32_bf16 v[44:47], a[160:163], a[116:119], v[44:47]
    ds_read_b128 a[192:195], v1 offset:51200
    buffer_load_dwordx2 a[138:139], v231, s[12:15], s45 offen offset:1536 sc1
    v_mfma_f32_16x16x32_bf16 v[20:23], a[164:167], a[112:115], v[20:23]
    ds_read_b128 a[196:199], v1 offset:52224
    buffer_load_dwordx2 a[140:141], v224, s[12:15], s45 offen offset:1024 sc1
    v_mfma_f32_16x16x32_bf16 v[48:51], a[164:167], a[116:119], v[48:51]
    ds_read_b128 a[200:203], v1 offset:53248
    buffer_load_dwordx2 a[142:143], v224, s[12:15], s45 offen offset:1536 sc1
    v_mfma_f32_16x16x32_bf16 v[24:27], a[168:171], a[112:115], v[24:27]
    ds_read_b128 a[204:207], v1 offset:54272
    s_add_u32 s46, s69, 15360
    v_mfma_f32_16x16x32_bf16 v[52:55], a[168:171], a[116:119], v[52:55]
    ds_read_b128 a[208:211], v1 offset:55296
    buffer_load_dwordx4 a[60:63], v1, s[12:15], s46 offen offset:0
    v_mfma_f32_16x16x32_bf16 v[28:31], a[172:175], a[112:115], v[28:31]
    ds_read_b128 a[212:215], v1 offset:56320
    buffer_load_dwordx4 a[64:67], v1, s[12:15], s46 offen offset:1024
    v_mfma_f32_16x16x32_bf16 v[56:59], a[172:175], a[116:119], v[56:59]
    buffer_load_dwordx4 a[68:71], v1, s[12:15], s46 offen offset:2048
    v_mfma_f32_16x16x32_bf16 v[32:35], a[176:179], a[112:115], v[32:35]
    buffer_load_dwordx4 a[72:75], v1, s[12:15], s46 offen offset:3072
    v_mfma_f32_16x16x32_bf16 v[60:63], a[176:179], a[116:119], v[60:63]
    buffer_load_dwordx4 a[76:79], v2, s[12:15], s46 offen
    v_mfma_f32_16x16x32_bf16 v[36:39], a[180:183], a[112:115], v[36:39]
    v_mfma_f32_16x16x32_bf16 v[64:67], a[180:183], a[116:119], v[64:67]
    v_mfma_f32_16x16x32_bf16 v[40:43], a[184:187], a[112:115], v[40:43]
    v_mfma_f32_16x16x32_bf16 v[68:71], a[184:187], a[116:119], v[68:71]
    s_waitcnt vmcnt(16)
    s_waitcnt lgkmcnt(0)
    v_mfma_f32_16x16x32_bf16 v[16:19], a[188:191], a[120:123], v[16:19]
    ds_read_b128 a[160:163], v1 offset:57344
    buffer_load_dwordx4 a[144:147], v1, s[12:15], s45 offen offset:2048 sc1
    v_mfma_f32_16x16x32_bf16 v[44:47], a[188:191], a[124:127], v[44:47]
    ds_read_b128 a[164:167], v1 offset:58368
    buffer_load_dwordx4 a[148:151], v8, s[12:15], s45 offen offset:2048 sc1
    v_mfma_f32_16x16x32_bf16 v[20:23], a[192:195], a[120:123], v[20:23]
    ds_read_b128 a[168:171], v1 offset:59392
    v_mfma_f32_16x16x32_bf16 v[48:51], a[192:195], a[124:127], v[48:51]
    ds_read_b128 a[172:175], v1 offset:60416
    v_mfma_f32_16x16x32_bf16 v[24:27], a[196:199], a[120:123], v[24:27]
    ds_read_b128 a[176:179], v1 offset:61440
    v_mfma_f32_16x16x32_bf16 v[52:55], a[196:199], a[124:127], v[52:55]
    ds_read_b128 a[180:183], v1 offset:62464
    v_mfma_f32_16x16x32_bf16 v[28:31], a[200:203], a[120:123], v[28:31]
    ds_read_b128 a[184:187], v1 offset:63488
    v_mfma_f32_16x16x32_bf16 v[56:59], a[200:203], a[124:127], v[56:59]
    v_mfma_f32_16x16x32_bf16 v[32:35], a[204:207], a[120:123], v[32:35]
    v_mfma_f32_16x16x32_bf16 v[60:63], a[204:207], a[124:127], v[60:63]
    v_mfma_f32_16x16x32_bf16 v[36:39], a[208:211], a[120:123], v[36:39]
    v_mfma_f32_16x16x32_bf16 v[64:67], a[208:211], a[124:127], v[64:67]
    v_mfma_f32_16x16x32_bf16 v[40:43], a[212:215], a[120:123], v[40:43]
    v_mfma_f32_16x16x32_bf16 v[68:71], a[212:215], a[124:127], v[68:71]
    s_waitcnt vmcnt(16)
    s_waitcnt lgkmcnt(0)
    v_mfma_f32_16x16x32_bf16 v[16:19], a[160:163], a[128:131], v[16:19]
    ds_read_b128 a[188:191], v1 offset:64512
    buffer_load_dwordx4 a[152:155], v1, s[12:15], s45 offen offset:3072 sc1
    v_mfma_f32_16x16x32_bf16 v[44:47], a[160:163], a[132:135], v[44:47]
    ds_read_b128 a[192:195], v14 offset:57344
    buffer_load_dwordx4 a[156:159], v8, s[12:15], s45 offen offset:3072 sc1
    v_mfma_f32_16x16x32_bf16 v[20:23], a[164:167], a[128:131], v[20:23]
    ds_read_b128 a[196:199], v14 offset:58368
    s_add_u32 s46, s69, 20480
    v_mfma_f32_16x16x32_bf16 v[48:51], a[164:167], a[132:135], v[48:51]
    ds_read_b128 a[200:203], v14 offset:59392
    buffer_load_dwordx4 a[80:83], v1, s[12:15], s46 offen offset:0
    v_mfma_f32_16x16x32_bf16 v[24:27], a[168:171], a[128:131], v[24:27]
    ds_read_b128 a[204:207], v14 offset:60416
    buffer_load_dwordx4 a[84:87], v1, s[12:15], s46 offen offset:1024
    v_mfma_f32_16x16x32_bf16 v[52:55], a[168:171], a[132:135], v[52:55]
    ds_read_b128 a[208:211], v14 offset:61440
    buffer_load_dwordx4 a[88:91], v1, s[12:15], s46 offen offset:2048
    v_mfma_f32_16x16x32_bf16 v[28:31], a[172:175], a[128:131], v[28:31]
    ds_read_b128 a[212:215], v14 offset:62464
    buffer_load_dwordx4 a[92:95], v1, s[12:15], s46 offen offset:3072
    v_mfma_f32_16x16x32_bf16 v[56:59], a[172:175], a[132:135], v[56:59]
    buffer_load_dwordx4 a[96:99], v2, s[12:15], s46 offen
    v_mfma_f32_16x16x32_bf16 v[32:35], a[176:179], a[128:131], v[32:35]
    v_mfma_f32_16x16x32_bf16 v[60:63], a[176:179], a[132:135], v[60:63]
    v_mfma_f32_16x16x32_bf16 v[36:39], a[180:183], a[128:131], v[36:39]
    v_mfma_f32_16x16x32_bf16 v[64:67], a[180:183], a[132:135], v[64:67]
    v_mfma_f32_16x16x32_bf16 v[40:43], a[184:187], a[128:131], v[40:43]
    v_mfma_f32_16x16x32_bf16 v[68:71], a[184:187], a[132:135], v[68:71]
    s_waitcnt vmcnt(14)
    s_waitcnt lgkmcnt(0)
    v_mfma_f32_16x16x32_bf16 v[16:19], a[188:191], a[136:139], v[16:19]
    ds_read_b128 a[160:163], v14 offset:63488
    s_add_u32 s46, s69, 25600
    v_mfma_f32_16x16x32_bf16 v[44:47], a[188:191], a[140:143], v[44:47]
    ds_read_b128 a[164:167], v14 offset:64512
    buffer_load_dwordx4 a[100:103], v1, s[12:15], s46 offen offset:0
    v_mfma_f32_16x16x32_bf16 v[20:23], a[192:195], a[136:139], v[20:23]
    ds_read_b128 a[168:171], v15 offset:0
    buffer_load_dwordx4 a[104:107], v1, s[12:15], s46 offen offset:1024
    v_mfma_f32_16x16x32_bf16 v[48:51], a[192:195], a[140:143], v[48:51]
    ds_read_b128 a[172:175], v15 offset:1024
    buffer_load_dwordx4 a[108:111], v1, s[12:15], s46 offen offset:2048
    v_mfma_f32_16x16x32_bf16 v[24:27], a[196:199], a[136:139], v[24:27]
    ds_read_b128 a[176:179], v15 offset:2048
    buffer_load_dwordx4 a[112:115], v1, s[12:15], s46 offen offset:3072
    v_mfma_f32_16x16x32_bf16 v[52:55], a[196:199], a[140:143], v[52:55]
    ds_read_b128 a[180:183], v15 offset:3072
    buffer_load_dwordx4 a[116:119], v2, s[12:15], s46 offen
    v_mfma_f32_16x16x32_bf16 v[28:31], a[200:203], a[136:139], v[28:31]
    ds_read_b128 a[184:187], v15 offset:4096
    v_mfma_f32_16x16x32_bf16 v[56:59], a[200:203], a[140:143], v[56:59]
    v_mfma_f32_16x16x32_bf16 v[32:35], a[204:207], a[136:139], v[32:35]
    v_mfma_f32_16x16x32_bf16 v[60:63], a[204:207], a[140:143], v[60:63]
    v_mfma_f32_16x16x32_bf16 v[36:39], a[208:211], a[136:139], v[36:39]
    v_mfma_f32_16x16x32_bf16 v[64:67], a[208:211], a[140:143], v[64:67]
    v_mfma_f32_16x16x32_bf16 v[40:43], a[212:215], a[136:139], v[40:43]
    v_mfma_f32_16x16x32_bf16 v[68:71], a[212:215], a[140:143], v[68:71]
    s_waitcnt vmcnt(12)
    s_waitcnt lgkmcnt(0)
    v_mfma_f32_16x16x32_bf16 v[16:19], a[160:163], a[144:147], v[16:19]
    ds_read_b128 a[188:191], v15 offset:5120
    v_mfma_f32_16x16x32_bf16 v[44:47], a[160:163], a[148:151], v[44:47]
    ds_read_b128 a[192:195], v15 offset:6144
    v_mfma_f32_16x16x32_bf16 v[20:23], a[164:167], a[144:147], v[20:23]
    ds_read_b128 a[196:199], v15 offset:7168
    v_mfma_f32_16x16x32_bf16 v[48:51], a[164:167], a[148:151], v[48:51]
    ds_read_b128 a[200:203], v15 offset:8192
    v_mfma_f32_16x16x32_bf16 v[24:27], a[168:171], a[144:147], v[24:27]
    ds_read_b128 a[204:207], v15 offset:9216
    v_mfma_f32_16x16x32_bf16 v[52:55], a[168:171], a[148:151], v[52:55]
    ds_read_b128 a[208:211], v15 offset:10240
    v_mfma_f32_16x16x32_bf16 v[28:31], a[172:175], a[144:147], v[28:31]
    ds_read_b128 a[212:215], v15 offset:11264
    v_mfma_f32_16x16x32_bf16 v[56:59], a[172:175], a[148:151], v[56:59]
    v_mfma_f32_16x16x32_bf16 v[32:35], a[176:179], a[144:147], v[32:35]
    v_mfma_f32_16x16x32_bf16 v[60:63], a[176:179], a[148:151], v[60:63]
    v_mfma_f32_16x16x32_bf16 v[36:39], a[180:183], a[144:147], v[36:39]
    v_mfma_f32_16x16x32_bf16 v[64:67], a[180:183], a[148:151], v[64:67]
    v_mfma_f32_16x16x32_bf16 v[40:43], a[184:187], a[144:147], v[40:43]
    v_mfma_f32_16x16x32_bf16 v[68:71], a[184:187], a[148:151], v[68:71]
    s_waitcnt vmcnt(10)
    s_waitcnt lgkmcnt(0)
    v_mfma_f32_16x16x32_bf16 v[16:19], a[188:191], a[152:155], v[16:19]
    v_mfma_f32_16x16x32_bf16 v[44:47], a[188:191], a[156:159], v[44:47]
    v_mfma_f32_16x16x32_bf16 v[20:23], a[192:195], a[152:155], v[20:23]
    v_mfma_f32_16x16x32_bf16 v[48:51], a[192:195], a[156:159], v[48:51]
    v_mfma_f32_16x16x32_bf16 v[24:27], a[196:199], a[152:155], v[24:27]
    v_mfma_f32_16x16x32_bf16 v[52:55], a[196:199], a[156:159], v[52:55]
    v_mfma_f32_16x16x32_bf16 v[28:31], a[200:203], a[152:155], v[28:31]
    v_mfma_f32_16x16x32_bf16 v[56:59], a[200:203], a[156:159], v[56:59]
    v_mfma_f32_16x16x32_bf16 v[32:35], a[204:207], a[152:155], v[32:35]
    v_mfma_f32_16x16x32_bf16 v[60:63], a[204:207], a[156:159], v[60:63]
    v_mfma_f32_16x16x32_bf16 v[36:39], a[208:211], a[152:155], v[36:39]
    v_mfma_f32_16x16x32_bf16 v[64:67], a[208:211], a[156:159], v[64:67]
    v_mfma_f32_16x16x32_bf16 v[40:43], a[212:215], a[152:155], v[40:43]
    v_mfma_f32_16x16x32_bf16 v[68:71], a[212:215], a[156:159], v[68:71]
    s_nop 3
    v_pk_fma_f32 v[16:17], v[112:113], v[72:73], v[16:17] op_sel_hi:[1,0,1] neg_lo:[0,1,0] neg_hi:[0,1,0]
    v_pk_fma_f32 v[18:19], v[114:115], v[72:73], v[18:19] op_sel_hi:[1,0,1] neg_lo:[0,1,0] neg_hi:[0,1,0]
    v_pk_fma_f32 v[20:21], v[116:117], v[72:73], v[20:21] op_sel_hi:[1,0,1] neg_lo:[0,1,0] neg_hi:[0,1,0]
    v_pk_fma_f32 v[22:23], v[118:119], v[72:73], v[22:23] op_sel_hi:[1,0,1] neg_lo:[0,1,0] neg_hi:[0,1,0]
    v_pk_fma_f32 v[24:25], v[120:121], v[72:73], v[24:25] op_sel_hi:[1,0,1] neg_lo:[0,1,0] neg_hi:[0,1,0]
    v_pk_fma_f32 v[26:27], v[122:123], v[72:73], v[26:27] op_sel_hi:[1,0,1] neg_lo:[0,1,0] neg_hi:[0,1,0]
    v_pk_fma_f32 v[28:29], v[124:125], v[72:73], v[28:29] op_sel_hi:[1,0,1] neg_lo:[0,1,0] neg_hi:[0,1,0]
    v_pk_fma_f32 v[30:31], v[126:127], v[72:73], v[30:31] op_sel_hi:[1,0,1] neg_lo:[0,1,0] neg_hi:[0,1,0]
    v_pk_fma_f32 v[32:33], v[128:129], v[72:73], v[32:33] op_sel_hi:[1,0,1] neg_lo:[0,1,0] neg_hi:[0,1,0]
    v_pk_fma_f32 v[34:35], v[130:131], v[72:73], v[34:35] op_sel_hi:[1,0,1] neg_lo:[0,1,0] neg_hi:[0,1,0]
    v_pk_fma_f32 v[36:37], v[132:133], v[72:73], v[36:37] op_sel_hi:[1,0,1] neg_lo:[0,1,0] neg_hi:[0,1,0]
    v_pk_fma_f32 v[38:39], v[134:135], v[72:73], v[38:39] op_sel_hi:[1,0,1] neg_lo:[0,1,0] neg_hi:[0,1,0]
    v_pk_fma_f32 v[40:41], v[136:137], v[72:73], v[40:41] op_sel_hi:[1,0,1] neg_lo:[0,1,0] neg_hi:[0,1,0]
    v_pk_fma_f32 v[42:43], v[138:139], v[72:73], v[42:43] op_sel_hi:[1,0,1] neg_lo:[0,1,0] neg_hi:[0,1,0]
    s_add_u32 s46, s69, 30720
    buffer_load_dwordx4 a[120:123], v1, s[12:15], s46 offen offset:0
    v_pk_mul_f32 v[16:17], v[16:17], v[74:75] op_sel_hi:[1,0]
    v_pk_mul_f32 v[18:19], v[18:19], v[74:75] op_sel_hi:[1,0]
    v_pk_mul_f32 v[20:21], v[20:21], v[74:75] op_sel_hi:[1,0]
    v_pk_mul_f32 v[22:23], v[22:23], v[74:75] op_sel_hi:[1,0]
    v_pk_mul_f32 v[24:25], v[24:25], v[74:75] op_sel_hi:[1,0]
    v_pk_mul_f32 v[26:27], v[26:27], v[74:75] op_sel_hi:[1,0]
    v_pk_mul_f32 v[28:29], v[28:29], v[74:75] op_sel_hi:[1,0]
    v_pk_mul_f32 v[30:31], v[30:31], v[74:75] op_sel_hi:[1,0]
    v_pk_mul_f32 v[32:33], v[32:33], v[74:75] op_sel_hi:[1,0]
    v_pk_mul_f32 v[34:35], v[34:35], v[74:75] op_sel_hi:[1,0]
    v_pk_mul_f32 v[36:37], v[36:37], v[74:75] op_sel_hi:[1,0]
    v_pk_mul_f32 v[38:39], v[38:39], v[74:75] op_sel_hi:[1,0]
    v_pk_mul_f32 v[40:41], v[40:41], v[74:75] op_sel_hi:[1,0]
    v_pk_mul_f32 v[42:43], v[42:43], v[74:75] op_sel_hi:[1,0]
    buffer_load_dwordx4 a[124:127], v1, s[12:15], s46 offen offset:1024
    buffer_load_dwordx4 a[128:131], v1, s[12:15], s46 offen offset:2048
    v_pk_mul_f32 v[140:141], v[16:17], v[16:17]
    v_pk_mul_f32 v[142:143], v[18:19], v[18:19]
    v_pk_mul_f32 v[144:145], v[20:21], v[20:21]
    v_pk_mul_f32 v[146:147], v[22:23], v[22:23]
    v_pk_mul_f32 v[148:149], v[24:25], v[24:25]
    v_pk_mul_f32 v[150:151], v[26:27], v[26:27]
    v_pk_mul_f32 v[152:153], v[28:29], v[28:29]
    v_pk_mul_f32 v[154:155], v[30:31], v[30:31]
    v_pk_mul_f32 v[156:157], v[32:33], v[32:33]
    v_pk_mul_f32 v[158:159], v[34:35], v[34:35]
    v_pk_mul_f32 v[160:161], v[36:37], v[36:37]
    v_pk_mul_f32 v[162:163], v[38:39], v[38:39]
    v_pk_mul_f32 v[164:165], v[40:41], v[40:41]
    v_pk_mul_f32 v[166:167], v[42:43], v[42:43]
    buffer_load_dwordx4 a[132:135], v1, s[12:15], s46 offen offset:3072
    buffer_load_dwordx4 a[136:139], v2, s[12:15], s46 offen
    v_pk_fma_f32 v[140:141], v[140:141], v[82:83], v[80:81] op_sel_hi:[1,0,0]
    v_pk_fma_f32 v[142:143], v[142:143], v[82:83], v[80:81] op_sel_hi:[1,0,0]
    v_pk_fma_f32 v[144:145], v[144:145], v[82:83], v[80:81] op_sel_hi:[1,0,0]
    v_pk_fma_f32 v[146:147], v[146:147], v[82:83], v[80:81] op_sel_hi:[1,0,0]
    v_pk_fma_f32 v[148:149], v[148:149], v[82:83], v[80:81] op_sel_hi:[1,0,0]
    v_pk_fma_f32 v[150:151], v[150:151], v[82:83], v[80:81] op_sel_hi:[1,0,0]
    v_pk_fma_f32 v[152:153], v[152:153], v[82:83], v[80:81] op_sel_hi:[1,0,0]
    v_pk_fma_f32 v[154:155], v[154:155], v[82:83], v[80:81] op_sel_hi:[1,0,0]
    v_pk_fma_f32 v[156:157], v[156:157], v[82:83], v[80:81] op_sel_hi:[1,0,0]
    v_pk_fma_f32 v[158:159], v[158:159], v[82:83], v[80:81] op_sel_hi:[1,0,0]
    v_pk_fma_f32 v[160:161], v[160:161], v[82:83], v[80:81] op_sel_hi:[1,0,0]
    v_pk_fma_f32 v[162:163], v[162:163], v[82:83], v[80:81] op_sel_hi:[1,0,0]
    v_pk_fma_f32 v[164:165], v[164:165], v[82:83], v[80:81] op_sel_hi:[1,0,0]
    v_pk_fma_f32 v[166:167], v[166:167], v[82:83], v[80:81] op_sel_hi:[1,0,0]
    s_add_u32 s46, s69, 35840
    buffer_load_dwordx4 a[140:143], v1, s[12:15], s46 offen offset:0
    v_pk_mul_f32 v[140:141], v[140:141], v[16:17]
    v_pk_mul_f32 v[142:143], v[142:143], v[18:19]
    v_pk_mul_f32 v[144:145], v[144:145], v[20:21]
    v_pk_mul_f32 v[146:147], v[146:147], v[22:23]
    v_pk_mul_f32 v[148:149], v[148:149], v[24:25]
    v_pk_mul_f32 v[150:151], v[150:151], v[26:27]
    v_pk_mul_f32 v[152:153], v[152:153], v[28:29]
    v_pk_mul_f32 v[154:155], v[154:155], v[30:31]
    v_pk_mul_f32 v[156:157], v[156:157], v[32:33]
    v_pk_mul_f32 v[158:159], v[158:159], v[34:35]
    v_pk_mul_f32 v[160:161], v[160:161], v[36:37]
    v_pk_mul_f32 v[162:163], v[162:163], v[38:39]
    v_pk_mul_f32 v[164:165], v[164:165], v[40:41]
    v_pk_mul_f32 v[166:167], v[166:167], v[42:43]
    v_exp_f32 v140, v140
    v_exp_f32 v141, v141
    v_exp_f32 v142, v142
    v_exp_f32 v143, v143
    v_exp_f32 v144, v144
    v_exp_f32 v145, v145
    v_exp_f32 v146, v146
    buffer_load_dwordx4 a[144:147], v1, s[12:15], s46 offen offset:1024
    v_exp_f32 v147, v147
    v_exp_f32 v148, v148
    v_exp_f32 v149, v149
    v_exp_f32 v150, v150
    v_exp_f32 v151, v151
    v_exp_f32 v152, v152
    v_exp_f32 v153, v153
    buffer_load_dwordx4 a[148:151], v1, s[12:15], s46 offen offset:2048
    v_exp_f32 v154, v154
    v_exp_f32 v155, v155
    v_exp_f32 v156, v156
    v_exp_f32 v157, v157
    v_exp_f32 v158, v158
    v_exp_f32 v159, v159
    v_exp_f32 v160, v160
    buffer_load_dwordx4 a[152:155], v1, s[12:15], s46 offen offset:3072
    v_exp_f32 v161, v161
    v_exp_f32 v162, v162
    v_exp_f32 v163, v163
    v_exp_f32 v164, v164
    v_exp_f32 v165, v165
    v_exp_f32 v166, v166
    v_exp_f32 v167, v167
    buffer_load_dwordx4 a[156:159], v2, s[12:15], s46 offen
    v_pk_add_f32 v[140:141], v[140:141], 1.0 op_sel_hi:[1,0]
    v_pk_add_f32 v[142:143], v[142:143], 1.0 op_sel_hi:[1,0]
    v_pk_add_f32 v[144:145], v[144:145], 1.0 op_sel_hi:[1,0]
    v_pk_add_f32 v[146:147], v[146:147], 1.0 op_sel_hi:[1,0]
    v_pk_add_f32 v[148:149], v[148:149], 1.0 op_sel_hi:[1,0]
    v_pk_add_f32 v[150:151], v[150:151], 1.0 op_sel_hi:[1,0]
    v_pk_add_f32 v[152:153], v[152:153], 1.0 op_sel_hi:[1,0]
    v_pk_add_f32 v[154:155], v[154:155], 1.0 op_sel_hi:[1,0]
    v_pk_add_f32 v[156:157], v[156:157], 1.0 op_sel_hi:[1,0]
    v_pk_add_f32 v[158:159], v[158:159], 1.0 op_sel_hi:[1,0]
    v_pk_add_f32 v[160:161], v[160:161], 1.0 op_sel_hi:[1,0]
    v_pk_add_f32 v[162:163], v[162:163], 1.0 op_sel_hi:[1,0]
    v_pk_add_f32 v[164:165], v[164:165], 1.0 op_sel_hi:[1,0]
    v_pk_add_f32 v[166:167], v[166:167], 1.0 op_sel_hi:[1,0]
    v_rcp_f32 v140, v140
    v_rcp_f32 v141, v141
    v_rcp_f32 v142, v142
    v_rcp_f32 v143, v143
    v_rcp_f32 v144, v144
    v_rcp_f32 v145, v145
    v_rcp_f32 v146, v146
    s_add_u32 s46, s69, 40960
    v_rcp_f32 v147, v147
    v_rcp_f32 v148, v148
    v_rcp_f32 v149, v149
    v_rcp_f32 v150, v150
    v_rcp_f32 v151, v151
    v_rcp_f32 v152, v152
    v_rcp_f32 v153, v153
    buffer_load_dwordx4 a[160:163], v1, s[12:15], s46 offen offset:0
    v_rcp_f32 v154, v154
    v_rcp_f32 v155, v155
    v_rcp_f32 v156, v156
    v_rcp_f32 v157, v157
    v_rcp_f32 v158, v158
    v_rcp_f32 v159, v159
    v_rcp_f32 v160, v160
    buffer_load_dwordx4 a[164:167], v1, s[12:15], s46 offen offset:1024
    v_rcp_f32 v161, v161
    v_rcp_f32 v162, v162
    v_rcp_f32 v163, v163
    v_rcp_f32 v164, v164
    v_rcp_f32 v165, v165
    v_rcp_f32 v166, v166
    v_rcp_f32 v167, v167
    buffer_load_dwordx4 a[168:171], v1, s[12:15], s46 offen offset:2048
    v_pk_mul_f32 v[16:17], v[16:17], v[140:141]
    v_pk_mul_f32 v[18:19], v[18:19], v[142:143]
    v_pk_mul_f32 v[20:21], v[20:21], v[144:145]
    v_pk_mul_f32 v[22:23], v[22:23], v[146:147]
    v_pk_mul_f32 v[24:25], v[24:25], v[148:149]
    v_pk_mul_f32 v[26:27], v[26:27], v[150:151]
    v_pk_mul_f32 v[28:29], v[28:29], v[152:153]
    v_pk_mul_f32 v[30:31], v[30:31], v[154:155]
    v_pk_mul_f32 v[32:33], v[32:33], v[156:157]
    v_pk_mul_f32 v[34:35], v[34:35], v[158:159]
    v_pk_mul_f32 v[36:37], v[36:37], v[160:161]
    v_pk_mul_f32 v[38:39], v[38:39], v[162:163]
    v_pk_mul_f32 v[40:41], v[40:41], v[164:165]
    v_pk_mul_f32 v[42:43], v[42:43], v[166:167]
    v_cvt_pk_bf16_f32 v170, v16, v17
    v_cvt_pk_bf16_f32 v171, v18, v19
    v_cvt_pk_bf16_f32 v172, v20, v21
    v_cvt_pk_bf16_f32 v173, v22, v23
    v_cvt_pk_bf16_f32 v174, v24, v25
    v_cvt_pk_bf16_f32 v175, v26, v27
    v_cvt_pk_bf16_f32 v176, v28, v29
    v_cvt_pk_bf16_f32 v177, v30, v31
    v_cvt_pk_bf16_f32 v178, v32, v33
    v_cvt_pk_bf16_f32 v179, v34, v35
    v_cvt_pk_bf16_f32 v180, v36, v37
    v_cvt_pk_bf16_f32 v181, v38, v39
    v_cvt_pk_bf16_f32 v182, v40, v41
    v_cvt_pk_bf16_f32 v183, v42, v43
    s_cmp_eq_u32 s36, 15
    s_cbranch_scc1 kb_kernel_t15_22
    s_cmp_eq_u32 s56, 1
    s_cbranch_scc1 kb_kernel_odd_24
    s_add_u32 s45, s54, 11206656
    buffer_store_dwordx4 v[170:173], v1, s[12:15], s45 offen sc1
    s_add_u32 s45, s54, 11207680
    buffer_store_dwordx4 v[174:177], v1, s[12:15], s45 offen sc1
    s_add_u32 s45, s54, 11208704
    buffer_store_dwordx4 v[178:181], v1, s[12:15], s45 offen sc1
    s_add_u32 s45, s54, 11209728
    buffer_store_dwordx2 v[182:183], v231, s[12:15], s45 offen sc1
    s_branch kb_kernel_tse_25
kb_kernel_odd_24:
    s_add_u32 s45, s54, 11207168
    buffer_store_dwordx2 v[170:171], v231, s[12:15], s45 offen sc1
    s_add_u32 s45, s54, 11207680
    buffer_store_dwordx4 v[172:175], v1, s[12:15], s45 offen sc1
    s_add_u32 s45, s54, 11208704
    buffer_store_dwordx4 v[176:179], v1, s[12:15], s45 offen sc1
    s_add_u32 s45, s54, 11209728
    buffer_store_dwordx4 v[180:183], v1, s[12:15], s45 offen sc1
kb_kernel_tse_25:
    s_branch kb_kernel_e15_23
kb_kernel_t15_22:
    s_add_u32 s45, s54, 11209216
    buffer_store_dwordx2 v[178:179], v231, s[12:15], s45 offen sc1
    s_add_u32 s45, s54, 11209728
    buffer_store_dwordx4 v[180:183], v1, s[12:15], s45 offen sc1
kb_kernel_e15_23:
    v_pk_fma_f32 v[44:45], v[112:113], v[76:77], v[44:45] op_sel_hi:[1,0,1] neg_lo:[0,1,0] neg_hi:[0,1,0]
    v_pk_fma_f32 v[46:47], v[114:115], v[76:77], v[46:47] op_sel_hi:[1,0,1] neg_lo:[0,1,0] neg_hi:[0,1,0]
    v_pk_fma_f32 v[48:49], v[116:117], v[76:77], v[48:49] op_sel_hi:[1,0,1] neg_lo:[0,1,0] neg_hi:[0,1,0]
    v_pk_fma_f32 v[50:51], v[118:119], v[76:77], v[50:51] op_sel_hi:[1,0,1] neg_lo:[0,1,0] neg_hi:[0,1,0]
    v_pk_fma_f32 v[52:53], v[120:121], v[76:77], v[52:53] op_sel_hi:[1,0,1] neg_lo:[0,1,0] neg_hi:[0,1,0]
    v_pk_fma_f32 v[54:55], v[122:123], v[76:77], v[54:55] op_sel_hi:[1,0,1] neg_lo:[0,1,0] neg_hi:[0,1,0]
    v_pk_fma_f32 v[56:57], v[124:125], v[76:77], v[56:57] op_sel_hi:[1,0,1] neg_lo:[0,1,0] neg_hi:[0,1,0]
    v_pk_fma_f32 v[58:59], v[126:127], v[76:77], v[58:59] op_sel_hi:[1,0,1] neg_lo:[0,1,0] neg_hi:[0,1,0]
    v_pk_fma_f32 v[60:61], v[128:129], v[76:77], v[60:61] op_sel_hi:[1,0,1] neg_lo:[0,1,0] neg_hi:[0,1,0]
    v_pk_fma_f32 v[62:63], v[130:131], v[76:77], v[62:63] op_sel_hi:[1,0,1] neg_lo:[0,1,0] neg_hi:[0,1,0]
    v_pk_fma_f32 v[64:65], v[132:133], v[76:77], v[64:65] op_sel_hi:[1,0,1] neg_lo:[0,1,0] neg_hi:[0,1,0]
    v_pk_fma_f32 v[66:67], v[134:135], v[76:77], v[66:67] op_sel_hi:[1,0,1] neg_lo:[0,1,0] neg_hi:[0,1,0]
    v_pk_fma_f32 v[68:69], v[136:137], v[76:77], v[68:69] op_sel_hi:[1,0,1] neg_lo:[0,1,0] neg_hi:[0,1,0]
    v_pk_fma_f32 v[70:71], v[138:139], v[76:77], v[70:71] op_sel_hi:[1,0,1] neg_lo:[0,1,0] neg_hi:[0,1,0]
    buffer_load_dwordx4 a[172:175], v1, s[12:15], s46 offen offset:3072
    buffer_load_dwordx4 a[176:179], v2, s[12:15], s46 offen
    v_pk_mul_f32 v[44:45], v[44:45], v[78:79] op_sel_hi:[1,0]
    v_pk_mul_f32 v[46:47], v[46:47], v[78:79] op_sel_hi:[1,0]
    v_pk_mul_f32 v[48:49], v[48:49], v[78:79] op_sel_hi:[1,0]
    v_pk_mul_f32 v[50:51], v[50:51], v[78:79] op_sel_hi:[1,0]
    v_pk_mul_f32 v[52:53], v[52:53], v[78:79] op_sel_hi:[1,0]
    v_pk_mul_f32 v[54:55], v[54:55], v[78:79] op_sel_hi:[1,0]
    v_pk_mul_f32 v[56:57], v[56:57], v[78:79] op_sel_hi:[1,0]
    v_pk_mul_f32 v[58:59], v[58:59], v[78:79] op_sel_hi:[1,0]
    v_pk_mul_f32 v[60:61], v[60:61], v[78:79] op_sel_hi:[1,0]
    v_pk_mul_f32 v[62:63], v[62:63], v[78:79] op_sel_hi:[1,0]
    v_pk_mul_f32 v[64:65], v[64:65], v[78:79] op_sel_hi:[1,0]
    v_pk_mul_f32 v[66:67], v[66:67], v[78:79] op_sel_hi:[1,0]
    v_pk_mul_f32 v[68:69], v[68:69], v[78:79] op_sel_hi:[1,0]
    v_pk_mul_f32 v[70:71], v[70:71], v[78:79] op_sel_hi:[1,0]
    s_add_u32 s46, s69, 46080
    buffer_load_dwordx4 a[180:183], v1, s[12:15], s46 offen offset:0
    v_pk_mul_f32 v[140:141], v[44:45], v[44:45]
    v_pk_mul_f32 v[142:143], v[46:47], v[46:47]
    v_pk_mul_f32 v[144:145], v[48:49], v[48:49]
    v_pk_mul_f32 v[146:147], v[50:51], v[50:51]
    v_pk_mul_f32 v[148:149], v[52:53], v[52:53]
    v_pk_mul_f32 v[150:151], v[54:55], v[54:55]
    v_pk_mul_f32 v[152:153], v[56:57], v[56:57]
    v_pk_mul_f32 v[154:155], v[58:59], v[58:59]
    v_pk_mul_f32 v[156:157], v[60:61], v[60:61]
    v_pk_mul_f32 v[158:159], v[62:63], v[62:63]
    v_pk_mul_f32 v[160:161], v[64:65], v[64:65]
    v_pk_mul_f32 v[162:163], v[66:67], v[66:67]
    v_pk_mul_f32 v[164:165], v[68:69], v[68:69]
    v_pk_mul_f32 v[166:167], v[70:71], v[70:71]
    buffer_load_dwordx4 a[184:187], v1, s[12:15], s46 offen offset:1024
    buffer_load_dwordx4 a[188:191], v1, s[12:15], s46 offen offset:2048
    v_pk_fma_f32 v[140:141], v[140:141], v[82:83], v[80:81] op_sel_hi:[1,0,0]
    v_pk_fma_f32 v[142:143], v[142:143], v[82:83], v[80:81] op_sel_hi:[1,0,0]
    v_pk_fma_f32 v[144:145], v[144:145], v[82:83], v[80:81] op_sel_hi:[1,0,0]
    v_pk_fma_f32 v[146:147], v[146:147], v[82:83], v[80:81] op_sel_hi:[1,0,0]
    v_pk_fma_f32 v[148:149], v[148:149], v[82:83], v[80:81] op_sel_hi:[1,0,0]
    v_pk_fma_f32 v[150:151], v[150:151], v[82:83], v[80:81] op_sel_hi:[1,0,0]
    v_pk_fma_f32 v[152:153], v[152:153], v[82:83], v[80:81] op_sel_hi:[1,0,0]
    v_pk_fma_f32 v[154:155], v[154:155], v[82:83], v[80:81] op_sel_hi:[1,0,0]
    v_pk_fma_f32 v[156:157], v[156:157], v[82:83], v[80:81] op_sel_hi:[1,0,0]
    v_pk_fma_f32 v[158:159], v[158:159], v[82:83], v[80:81] op_sel_hi:[1,0,0]
    v_pk_fma_f32 v[160:161], v[160:161], v[82:83], v[80:81] op_sel_hi:[1,0,0]
    v_pk_fma_f32 v[162:163], v[162:163], v[82:83], v[80:81] op_sel_hi:[1,0,0]
    v_pk_fma_f32 v[164:165], v[164:165], v[82:83], v[80:81] op_sel_hi:[1,0,0]
    v_pk_fma_f32 v[166:167], v[166:167], v[82:83], v[80:81] op_sel_hi:[1,0,0]
    buffer_load_dwordx4 a[192:195], v1, s[12:15], s46 offen offset:3072
    buffer_load_dwordx4 a[196:199], v2, s[12:15], s46 offen
    v_pk_mul_f32 v[140:141], v[140:141], v[44:45]
    v_pk_mul_f32 v[142:143], v[142:143], v[46:47]
    v_pk_mul_f32 v[144:145], v[144:145], v[48:49]
    v_pk_mul_f32 v[146:147], v[146:147], v[50:51]
    v_pk_mul_f32 v[148:149], v[148:149], v[52:53]
    v_pk_mul_f32 v[150:151], v[150:151], v[54:55]
    v_pk_mul_f32 v[152:153], v[152:153], v[56:57]
    v_pk_mul_f32 v[154:155], v[154:155], v[58:59]
    v_pk_mul_f32 v[156:157], v[156:157], v[60:61]
    v_pk_mul_f32 v[158:159], v[158:159], v[62:63]
    v_pk_mul_f32 v[160:161], v[160:161], v[64:65]
    v_pk_mul_f32 v[162:163], v[162:163], v[66:67]
    v_pk_mul_f32 v[164:165], v[164:165], v[68:69]
    v_pk_mul_f32 v[166:167], v[166:167], v[70:71]
    v_exp_f32 v140, v140
    v_exp_f32 v141, v141
    v_exp_f32 v142, v142
    v_exp_f32 v143, v143
    v_exp_f32 v144, v144
    v_exp_f32 v145, v145
    v_exp_f32 v146, v146
    s_add_u32 s46, s69, 51200
    v_exp_f32 v147, v147
    v_exp_f32 v148, v148
    v_exp_f32 v149, v149
    v_exp_f32 v150, v150
    v_exp_f32 v151, v151
    v_exp_f32 v152, v152
    v_exp_f32 v153, v153
    buffer_load_dwordx4 a[200:203], v1, s[12:15], s46 offen offset:0
    v_exp_f32 v154, v154
    v_exp_f32 v155, v155
    v_exp_f32 v156, v156
    v_exp_f32 v157, v157
    v_exp_f32 v158, v158
    v_exp_f32 v159, v159
    v_exp_f32 v160, v160
    buffer_load_dwordx4 a[204:207], v1, s[12:15], s46 offen offset:1024
    v_exp_f32 v161, v161
    v_exp_f32 v162, v162
    v_exp_f32 v163, v163
    v_exp_f32 v164, v164
    v_exp_f32 v165, v165
    v_exp_f32 v166, v166
    v_exp_f32 v167, v167
    buffer_load_dwordx4 a[208:211], v1, s[12:15], s46 offen offset:2048
    v_pk_add_f32 v[140:141], v[140:141], 1.0 op_sel_hi:[1,0]
    v_pk_add_f32 v[142:143], v[142:143], 1.0 op_sel_hi:[1,0]
    v_pk_add_f32 v[144:145], v[144:145], 1.0 op_sel_hi:[1,0]
    v_pk_add_f32 v[146:147], v[146:147], 1.0 op_sel_hi:[1,0]
    v_pk_add_f32 v[148:149], v[148:149], 1.0 op_sel_hi:[1,0]
    v_pk_add_f32 v[150:151], v[150:151], 1.0 op_sel_hi:[1,0]
    v_pk_add_f32 v[152:153], v[152:153], 1.0 op_sel_hi:[1,0]
    v_pk_add_f32 v[154:155], v[154:155], 1.0 op_sel_hi:[1,0]
    v_pk_add_f32 v[156:157], v[156:157], 1.0 op_sel_hi:[1,0]
    v_pk_add_f32 v[158:159], v[158:159], 1.0 op_sel_hi:[1,0]
    v_pk_add_f32 v[160:161], v[160:161], 1.0 op_sel_hi:[1,0]
    v_pk_add_f32 v[162:163], v[162:163], 1.0 op_sel_hi:[1,0]
    v_pk_add_f32 v[164:165], v[164:165], 1.0 op_sel_hi:[1,0]
    v_pk_add_f32 v[166:167], v[166:167], 1.0 op_sel_hi:[1,0]
    v_rcp_f32 v140, v140
    v_rcp_f32 v141, v141
    v_rcp_f32 v142, v142
    v_rcp_f32 v143, v143
    v_rcp_f32 v144, v144
    v_rcp_f32 v145, v145
    v_rcp_f32 v146, v146
    buffer_load_dwordx4 a[212:215], v1, s[12:15], s46 offen offset:3072
    v_rcp_f32 v147, v147
    v_rcp_f32 v148, v148
    v_rcp_f32 v149, v149
    v_rcp_f32 v150, v150
    v_rcp_f32 v151, v151
    v_rcp_f32 v152, v152
    v_rcp_f32 v153, v153
    buffer_load_dwordx4 a[216:219], v2, s[12:15], s46 offen
    v_rcp_f32 v154, v154
    v_rcp_f32 v155, v155
    v_rcp_f32 v156, v156
    v_rcp_f32 v157, v157
    v_rcp_f32 v158, v158
    v_rcp_f32 v159, v159
    v_rcp_f32 v160, v160
    v_rcp_f32 v161, v161
    v_rcp_f32 v162, v162
    v_rcp_f32 v163, v163
    v_rcp_f32 v164, v164
    v_rcp_f32 v165, v165
    v_rcp_f32 v166, v166
    v_rcp_f32 v167, v167
    v_pk_mul_f32 v[44:45], v[44:45], v[140:141]
    v_pk_mul_f32 v[46:47], v[46:47], v[142:143]
    v_pk_mul_f32 v[48:49], v[48:49], v[144:145]
    v_pk_mul_f32 v[50:51], v[50:51], v[146:147]
    v_pk_mul_f32 v[52:53], v[52:53], v[148:149]
    v_pk_mul_f32 v[54:55], v[54:55], v[150:151]
    v_pk_mul_f32 v[56:57], v[56:57], v[152:153]
    v_pk_mul_f32 v[58:59], v[58:59], v[154:155]
    v_pk_mul_f32 v[60:61], v[60:61], v[156:157]
    v_pk_mul_f32 v[62:63], v[62:63], v[158:159]
    v_pk_mul_f32 v[64:65], v[64:65], v[160:161]
    v_pk_mul_f32 v[66:67], v[66:67], v[162:163]
    v_pk_mul_f32 v[68:69], v[68:69], v[164:165]
    v_pk_mul_f32 v[70:71], v[70:71], v[166:167]
    v_cvt_pk_bf16_f32 v184, v44, v45
    v_cvt_pk_bf16_f32 v185, v46, v47
    v_cvt_pk_bf16_f32 v186, v48, v49
    v_cvt_pk_bf16_f32 v187, v50, v51
    v_cvt_pk_bf16_f32 v188, v52, v53
    v_cvt_pk_bf16_f32 v189, v54, v55
    v_cvt_pk_bf16_f32 v190, v56, v57
    v_cvt_pk_bf16_f32 v191, v58, v59
    v_cvt_pk_bf16_f32 v192, v60, v61
    v_cvt_pk_bf16_f32 v193, v62, v63
    v_cvt_pk_bf16_f32 v194, v64, v65
    v_cvt_pk_bf16_f32 v195, v66, v67
    v_cvt_pk_bf16_f32 v196, v68, v69
    v_cvt_pk_bf16_f32 v197, v70, v71
    s_cmp_eq_u32 s36, 15
    s_cbranch_scc1 kb_kernel_t15_26
    s_cmp_eq_u32 s56, 1
    s_cbranch_scc1 kb_kernel_odd_28
    s_add_u32 s45, s55, 11206656
    buffer_store_dwordx4 v[184:187], v1, s[12:15], s45 offen sc1
    s_add_u32 s45, s55, 11207680
    buffer_store_dwordx4 v[188:191], v1, s[12:15], s45 offen sc1
    s_add_u32 s45, s55, 11208704
    buffer_store_dwordx4 v[192:195], v1, s[12:15], s45 offen sc1
    s_add_u32 s45, s55, 11209728
    buffer_store_dwordx2 v[196:197], v231, s[12:15], s45 offen sc1
    s_branch kb_kernel_tse_29
kb_kernel_odd_28:
    s_add_u32 s45, s55, 11207168
    buffer_store_dwordx2 v[184:185], v231, s[12:15], s45 offen sc1
    s_add_u32 s45, s55, 11207680
    buffer_store_dwordx4 v[186:189], v1, s[12:15], s45 offen sc1
    s_add_u32 s45, s55, 11208704
    buffer_store_dwordx4 v[190:193], v1, s[12:15], s45 offen sc1
    s_add_u32 s45, s55, 11209728
    buffer_store_dwordx4 v[194:197], v1, s[12:15], s45 offen sc1
kb_kernel_tse_29:
    s_branch kb_kernel_e15_27
kb_kernel_t15_26:
    s_add_u32 s45, s55, 11209216
    buffer_store_dwordx2 v[192:193], v231, s[12:15], s45 offen sc1
    s_add_u32 s45, s55, 11209728
    buffer_store_dwordx4 v[194:197], v1, s[12:15], s45 offen sc1
kb_kernel_e15_27:
    s_lshl_b32 s47, s35, 7
    s_lshl_b32 s43, s36, 2
    s_add_u32 s47, s47, s43
    s_add_u32 s47, s47, 45056
    s_waitcnt vmcnt(0)
    s_barrier
    s_cmp_eq_u32 s32, 0
    s_cbranch_scc0 kb_kernel_nosig_30
    s_mov_b64 exec, 1
    v_mov_b32 v11, 1
    v_mov_b32 v12, 0
    s_cmp_eq_u32 s30, 1
    s_cbranch_scc1 kb_kernel_stl_31
    buffer_store_dword v11, v12, s[12:15], s47 offen sc1
    s_branch kb_kernel_ste_32
kb_kernel_stl_31:
    buffer_store_dword v11, v12, s[12:15], s47 offen
kb_kernel_ste_32:
    s_mov_b64 exec, -1
kb_kernel_nosig_30:
    s_add_u32 s46, s69, 61440
    s_mul_i32 s40, s32, 14
    s_add_u32 s40, s40, 12
    s_cmp_lt_u32 s40, 54
    s_cselect_b32 s46, s46, 0x40000000
    buffer_load_dwordx4 v[184:187], v1, s[12:15], s46 offen offset:0
    buffer_load_dwordx4 v[188:191], v1, s[12:15], s46 offen offset:1024
    buffer_load_dwordx4 v[192:195], v1, s[12:15], s46 offen offset:2048
    buffer_load_dwordx4 v[196:199], v1, s[12:15], s46 offen offset:3072
    buffer_load_dwordx4 v[200:203], v2, s[12:15], s46 offen
    s_add_u32 s46, s69, 66560
    s_mul_i32 s40, s32, 14
    s_add_u32 s40, s40, 13
    s_cmp_lt_u32 s40, 54
    s_cselect_b32 s46, s46, 0x40000000
    buffer_load_dwordx4 v[204:207], v1, s[12:15], s46 offen offset:0
    buffer_load_dwordx4 v[208:211], v1, s[12:15], s46 offen offset:1024
    buffer_load_dwordx4 v[212:215], v1, s[12:15], s46 offen offset:2048
    buffer_load_dwordx4 v[216:219], v1, s[12:15], s46 offen offset:3072
    buffer_load_dwordx4 v[220:223], v2, s[12:15], s46 offen
    s_add_u32 s40, s32, 0
    s_and_b32 s40, s40, 3
    s_mul_i32 s40, s40, 55296
    v_add_u32 v7, s40, v1
    v_add_u32 v224, s40, v231
    s_add_u32 s40, s32, 1
    s_and_b32 s40, s40, 3
    s_mul_i32 s40, s40, 55296
    v_add_u32 v8, s40, v1
    v_add_u32 v225, s40, v231
    s_add_u32 s40, s32, 2
    s_and_b32 s40, s40, 3
    s_mul_i32 s40, s40, 55296
    v_add_u32 v9, s40, v1
    v_add_u32 v226, s40, v231
    s_add_u32 s40, s32, 3
    s_and_b32 s40, s40, 3
    s_mul_i32 s40, s40, 55296
    v_add_u32 v10, s40, v1
    v_add_u32 v227, s40, v231
    s_mul_i32 s40, s32, 14
    s_mul_i32 s41, s33, 216
    s_add_u32 s41, s41, s40
    s_lshl_b32 s44, s41, 10
    s_add_u32 s44, s44, 11206656
    s_lshr_b32 s40, s33, 1
    s_lshl_b32 s40, s40, 7
    s_add_u32 s40, s40, 45056
    v_and_b32 v11, 15, v3
    v_lshlrev_b32 v11, 2, v11
    v_add_u32 v11, s40, v11
    s_mov_b32 s43, 0
kb_kernel_poll_33:
    buffer_load_dword v13, v11, s[12:15], 0 offen sc1
    s_waitcnt vmcnt(0)
    v_cmp_ne_u32 vcc, 0, v13
    s_add_u32 s43, s43, 1
    s_cmp_eq_u64 vcc, -1
    s_cbranch_scc1 kb_kernel_pdone_34
    s_cmp_lt_u32 s43, 0x40000
    s_cbranch_scc1 kb_kernel_poll_33
kb_kernel_pdone_34:
    buffer_load_dwordx4 v[96:99], v7, s[12:15], s44 offen sc1
    buffer_load_dwordx4 v[100:103], v8, s[12:15], s44 offen sc1
    buffer_load_dwordx4 v[104:107], v9, s[12:15], s44 offen sc1
    buffer_load_dwordx4 v[108:111], v10, s[12:15], s44 offen sc1
    s_add_u32 s44, s44, 1024
    buffer_load_dwordx4 v[112:115], v7, s[12:15], s44 offen sc1
    buffer_load_dwordx4 v[116:119], v8, s[12:15], s44 offen sc1
    buffer_load_dwordx4 v[120:123], v9, s[12:15], s44 offen sc1
    buffer_load_dwordx4 v[124:127], v10, s[12:15], s44 offen sc1
    s_add_u32 s44, s44, 1024
    buffer_load_dwordx4 v[128:131], v7, s[12:15], s44 offen sc1
    buffer_load_dwordx4 v[132:135], v8, s[12:15], s44 offen sc1
    buffer_load_dwordx4 v[136:139], v9, s[12:15], s44 offen sc1
    buffer_load_dwordx4 v[140:143], v10, s[12:15], s44 offen sc1
    s_add_u32 s44, s44, 1024
    s_waitcnt vmcnt(8)
    v_mfma_f32_16x16x32_bf16 v[16:19], a[0:3], v[96:99], 0
    buffer_load_dwordx2 v[144:145], v224, s[12:15], s44 offen sc1
    v_mfma_f32_16x16x32_bf16 v[36:39], a[0:3], v[100:103], 0
    buffer_load_dwordx2 v[146:147], v224, s[12:15], s44 offen offset:512 sc1
    v_mfma_f32_16x16x32_bf16 v[56:59], a[0:3], v[104:107], 0
    buffer_load_dwordx2 v[148:149], v225, s[12:15], s44 offen sc1
    v_mfma_f32_16x16x32_bf16 v[76:79], a[0:3], v[108:111], 0
    buffer_load_dwordx2 v[150:151], v225, s[12:15], s44 offen offset:512 sc1
    v_mfma_f32_16x16x32_bf16 v[20:23], a[4:7], v[96:99], 0
    buffer_load_dwordx2 v[152:153], v226, s[12:15], s44 offen sc1
    v_mfma_f32_16x16x32_bf16 v[40:43], a[4:7], v[100:103], 0
    buffer_load_dwordx2 v[154:155], v226, s[12:15], s44 offen offset:512 sc1
    v_mfma_f32_16x16x32_bf16 v[60:63], a[4:7], v[104:107], 0
    buffer_load_dwordx2 v[156:157], v227, s[12:15], s44 offen sc1
    v_mfma_f32_16x16x32_bf16 v[80:83], a[4:7], v[108:111], 0
    buffer_load_dwordx2 v[158:159], v227, s[12:15], s44 offen offset:512 sc1
    v_mfma_f32_16x16x32_bf16 v[24:27], a[8:11], v[96:99], 0
    s_add_u32 s44, s44, 1024
    v_mfma_f32_16x16x32_bf16 v[44:47], a[8:11], v[100:103], 0
    v_mfma_f32_16x16x32_bf16 v[64:67], a[8:11], v[104:107], 0
    v_mfma_f32_16x16x32_bf16 v[84:87], a[8:11], v[108:111], 0
    v_mfma_f32_16x16x32_bf16 v[28:31], a[12:15], v[96:99], 0
    v_mfma_f32_16x16x32_bf16 v[48:51], a[12:15], v[100:103], 0
    v_mfma_f32_16x16x32_bf16 v[68:71], a[12:15], v[104:107], 0
    v_mfma_f32_16x16x32_bf16 v[88:91], a[12:15], v[108:111], 0
    v_mfma_f32_16x16x32_bf16 v[32:35], a[16:19], v[96:99], 0
    v_mfma_f32_16x16x32_bf16 v[52:55], a[16:19], v[100:103], 0
    v_mfma_f32_16x16x32_bf16 v[72:75], a[16:19], v[104:107], 0
    v_mfma_f32_16x16x32_bf16 v[92:95], a[16:19], v[108:111], 0
    s_waitcnt vmcnt(12)
    v_mfma_f32_16x16x32_bf16 v[16:19], a[20:23], v[112:115], v[16:19]
    buffer_load_dwordx4 v[96:99], v7, s[12:15], s44 offen sc1
    v_mfma_f32_16x16x32_bf16 v[36:39], a[20:23], v[116:119], v[36:39]
    buffer_load_dwordx4 v[100:103], v8, s[12:15], s44 offen sc1
    v_mfma_f32_16x16x32_bf16 v[56:59], a[20:23], v[120:123], v[56:59]
    buffer_load_dwordx4 v[104:107], v9, s[12:15], s44 offen sc1
    v_mfma_f32_16x16x32_bf16 v[76:79], a[20:23], v[124:127], v[76:79]
    buffer_load_dwordx4 v[108:111], v10, s[12:15], s44 offen sc1
    v_mfma_f32_16x16x32_bf16 v[20:23], a[24:27], v[112:115], v[20:23]
    s_add_u32 s44, s44, 1024
    v_mfma_f32_16x16x32_bf16 v[40:43], a[24:27], v[116:119], v[40:43]
    v_mfma_f32_16x16x32_bf16 v[60:63], a[24:27], v[120:123], v[60:63]
    v_mfma_f32_16x16x32_bf16 v[80:83], a[24:27], v[124:127], v[80:83]
    v_mfma_f32_16x16x32_bf16 v[24:27], a[28:31], v[112:115], v[24:27]
    v_mfma_f32_16x16x32_bf16 v[44:47], a[28:31], v[116:119], v[44:47]
    v_mfma_f32_16x16x32_bf16 v[64:67], a[28:31], v[120:123], v[64:67]
    v_mfma_f32_16x16x32_bf16 v[84:87], a[28:31], v[124:127], v[84:87]
    v_mfma_f32_16x16x32_bf16 v[28:31], a[32:35], v[112:115], v[28:31]
    v_mfma_f32_16x16x32_bf16 v[48:51], a[32:35], v[116:119], v[48:51]
    v_mfma_f32_16x16x32_bf16 v[68:71], a[32:35], v[120:123], v[68:71]
    v_mfma_f32_16x16x32_bf16 v[88:91], a[32:35], v[124:127], v[88:91]
    v_mfma_f32_16x16x32_bf16 v[32:35], a[36:39], v[112:115], v[32:35]
    v_mfma_f32_16x16x32_bf16 v[52:55], a[36:39], v[116:119], v[52:55]
    v_mfma_f32_16x16x32_bf16 v[72:75], a[36:39], v[120:123], v[72:75]
    v_mfma_f32_16x16x32_bf16 v[92:95], a[36:39], v[124:127], v[92:95]
    s_waitcnt vmcnt(12)
    v_mfma_f32_16x16x32_bf16 v[16:19], a[40:43], v[128:131], v[16:19]
    buffer_load_dwordx4 v[112:115], v7, s[12:15], s44 offen sc1
    v_mfma_f32_16x16x32_bf16 v[36:39], a[40:43], v[132:135], v[36:39]
    buffer_load_dwordx4 v[116:119], v8, s[12:15], s44 offen sc1
    v_mfma_f32_16x16x32_bf16 v[56:59], a[40:43], v[136:139], v[56:59]
    buffer_load_dwordx4 v[120:123], v9, s[12:15], s44 offen sc1
    v_mfma_f32_16x16x32_bf16 v[76:79], a[40:43], v[140:143], v[76:79]
    buffer_load_dwordx4 v[124:127], v10, s[12:15], s44 offen sc1
    v_mfma_f32_16x16x32_bf16 v[20:23], a[44:47], v[128:131], v[20:23]
    s_add_u32 s44, s44, 1024
    v_mfma_f32_16x16x32_bf16 v[40:43], a[44:47], v[132:135], v[40:43]
    v_mfma_f32_16x16x32_bf16 v[60:63], a[44:47], v[136:139], v[60:63]
    v_mfma_f32_16x16x32_bf16 v[80:83], a[44:47], v[140:143], v[80:83]
    v_mfma_f32_16x16x32_bf16 v[24:27], a[48:51], v[128:131], v[24:27]
    v_mfma_f32_16x16x32_bf16 v[44:47], a[48:51], v[132:135], v[44:47]
    v_mfma_f32_16x16x32_bf16 v[64:67], a[48:51], v[136:139], v[64:67]
    v_mfma_f32_16x16x32_bf16 v[84:87], a[48:51], v[140:143], v[84:87]
    v_mfma_f32_16x16x32_bf16 v[28:31], a[52:55], v[128:131], v[28:31]
    v_mfma_f32_16x16x32_bf16 v[48:51], a[52:55], v[132:135], v[48:51]
    v_mfma_f32_16x16x32_bf16 v[68:71], a[52:55], v[136:139], v[68:71]
    v_mfma_f32_16x16x32_bf16 v[88:91], a[52:55], v[140:143], v[88:91]
    v_mfma_f32_16x16x32_bf16 v[32:35], a[56:59], v[128:131], v[32:35]
    v_mfma_f32_16x16x32_bf16 v[52:55], a[56:59], v[132:135], v[52:55]
    v_mfma_f32_16x16x32_bf16 v[72:75], a[56:59], v[136:139], v[72:75]
    v_mfma_f32_16x16x32_bf16 v[92:95], a[56:59], v[140:143], v[92:95]
    s_waitcnt vmcnt(8)
    v_mfma_f32_16x16x32_bf16 v[16:19], a[60:63], v[144:147], v[16:19]
    buffer_load_dwordx4 v[128:131], v7, s[12:15], s44 offen sc1
    v_mfma_f32_16x16x32_bf16 v[36:39], a[60:63], v[148:151], v[36:39]
    buffer_load_dwordx4 v[132:135], v8, s[12:15], s44 offen sc1
    v_mfma_f32_16x16x32_bf16 v[56:59], a[60:63], v[152:155], v[56:59]
    buffer_load_dwordx4 v[136:139], v9, s[12:15], s44 offen sc1
    v_mfma_f32_16x16x32_bf16 v[76:79], a[60:63], v[156:159], v[76:79]
    buffer_load_dwordx4 v[140:143], v10, s[12:15], s44 offen sc1
    v_mfma_f32_16x16x32_bf16 v[20:23], a[64:67], v[144:147], v[20:23]
    s_add_u32 s44, s44, 1024
    v_mfma_f32_16x16x32_bf16 v[40:43], a[64:67], v[148:151], v[40:43]
    v_mfma_f32_16x16x32_bf16 v[60:63], a[64:67], v[152:155], v[60:63]
    v_mfma_f32_16x16x32_bf16 v[80:83], a[64:67], v[156:159], v[80:83]
    v_mfma_f32_16x16x32_bf16 v[24:27], a[68:71], v[144:147], v[24:27]
    v_mfma_f32_16x16x32_bf16 v[44:47], a[68:71], v[148:151], v[44:47]
    v_mfma_f32_16x16x32_bf16 v[64:67], a[68:71], v[152:155], v[64:67]
    v_mfma_f32_16x16x32_bf16 v[84:87], a[68:71], v[156:159], v[84:87]
    v_mfma_f32_16x16x32_bf16 v[28:31], a[72:75], v[144:147], v[28:31]
    v_mfma_f32_16x16x32_bf16 v[48:51], a[72:75], v[148:151], v[48:51]
    v_mfma_f32_16x16x32_bf16 v[68:71], a[72:75], v[152:155], v[68:71]
    v_mfma_f32_16x16x32_bf16 v[88:91], a[72:75], v[156:159], v[88:91]
    v_mfma_f32_16x16x32_bf16 v[32:35], a[76:79], v[144:147], v[32:35]
    v_mfma_f32_16x16x32_bf16 v[52:55], a[76:79], v[148:151], v[52:55]
    v_mfma_f32_16x16x32_bf16 v[72:75], a[76:79], v[152:155], v[72:75]
    v_mfma_f32_16x16x32_bf16 v[92:95], a[76:79], v[156:159], v[92:95]
    s_waitcnt vmcnt(8)
    v_mfma_f32_16x16x32_bf16 v[16:19], a[80:83], v[96:99], v[16:19]
    buffer_load_dwordx4 v[144:147], v7, s[12:15], s44 offen sc1
    v_mfma_f32_16x16x32_bf16 v[36:39], a[80:83], v[100:103], v[36:39]
    buffer_load_dwordx4 v[148:151], v8, s[12:15], s44 offen sc1
    v_mfma_f32_16x16x32_bf16 v[56:59], a[80:83], v[104:107], v[56:59]
    buffer_load_dwordx4 v[152:155], v9, s[12:15], s44 offen sc1
    v_mfma_f32_16x16x32_bf16 v[76:79], a[80:83], v[108:111], v[76:79]
    buffer_load_dwordx4 v[156:159], v10, s[12:15], s44 offen sc1
    v_mfma_f32_16x16x32_bf16 v[20:23], a[84:87], v[96:99], v[20:23]
    s_add_u32 s44, s44, 1024
    v_mfma_f32_16x16x32_bf16 v[40:43], a[84:87], v[100:103], v[40:43]
    v_mfma_f32_16x16x32_bf16 v[60:63], a[84:87], v[104:107], v[60:63]
    v_mfma_f32_16x16x32_bf16 v[80:83], a[84:87], v[108:111], v[80:83]
    v_mfma_f32_16x16x32_bf16 v[24:27], a[88:91], v[96:99], v[24:27]
    v_mfma_f32_16x16x32_bf16 v[44:47], a[88:91], v[100:103], v[44:47]
    v_mfma_f32_16x16x32_bf16 v[64:67], a[88:91], v[104:107], v[64:67]
    v_mfma_f32_16x16x32_bf16 v[84:87], a[88:91], v[108:111], v[84:87]
    v_mfma_f32_16x16x32_bf16 v[28:31], a[92:95], v[96:99], v[28:31]
    v_mfma_f32_16x16x32_bf16 v[48:51], a[92:95], v[100:103], v[48:51]
    v_mfma_f32_16x16x32_bf16 v[68:71], a[92:95], v[104:107], v[68:71]
    v_mfma_f32_16x16x32_bf16 v[88:91], a[92:95], v[108:111], v[88:91]
    v_mfma_f32_16x16x32_bf16 v[32:35], a[96:99], v[96:99], v[32:35]
    v_mfma_f32_16x16x32_bf16 v[52:55], a[96:99], v[100:103], v[52:55]
    v_mfma_f32_16x16x32_bf16 v[72:75], a[96:99], v[104:107], v[72:75]
    v_mfma_f32_16x16x32_bf16 v[92:95], a[96:99], v[108:111], v[92:95]
    s_waitcnt vmcnt(8)
    v_mfma_f32_16x16x32_bf16 v[16:19], a[100:103], v[112:115], v[16:19]
    buffer_load_dwordx4 v[96:99], v7, s[12:15], s44 offen sc1
    v_mfma_f32_16x16x32_bf16 v[36:39], a[100:103], v[116:119], v[36:39]
    buffer_load_dwordx4 v[100:103], v8, s[12:15], s44 offen sc1
    v_mfma_f32_16x16x32_bf16 v[56:59], a[100:103], v[120:123], v[56:59]
    buffer_load_dwordx4 v[104:107], v9, s[12:15], s44 offen sc1
    v_mfma_f32_16x16x32_bf16 v[76:79], a[100:103], v[124:127], v[76:79]
    buffer_load_dwordx4 v[108:111], v10, s[12:15], s44 offen sc1
    v_mfma_f32_16x16x32_bf16 v[20:23], a[104:107], v[112:115], v[20:23]
    s_add_u32 s44, s44, 1024
    v_mfma_f32_16x16x32_bf16 v[40:43], a[104:107], v[116:119], v[40:43]
    v_mfma_f32_16x16x32_bf16 v[60:63], a[104:107], v[120:123], v[60:63]
    v_mfma_f32_16x16x32_bf16 v[80:83], a[104:107], v[124:127], v[80:83]
    v_mfma_f32_16x16x32_bf16 v[24:27], a[108:111], v[112:115], v[24:27]
    v_mfma_f32_16x16x32_bf16 v[44:47], a[108:111], v[116:119], v[44:47]
    v_mfma_f32_16x16x32_bf16 v[64:67], a[108:111], v[120:123], v[64:67]
    v_mfma_f32_16x16x32_bf16 v[84:87], a[108:111], v[124:127], v[84:87]
    v_mfma_f32_16x16x32_bf16 v[28:31], a[112:115], v[112:115], v[28:31]
    v_mfma_f32_16x16x32_bf16 v[48:51], a[112:115], v[116:119], v[48:51]
    v_mfma_f32_16x16x32_bf16 v[68:71], a[112:115], v[120:123], v[68:71]
    v_mfma_f32_16x16x32_bf16 v[88:91], a[112:115], v[124:127], v[88:91]
    v_mfma_f32_16x16x32_bf16 v[32:35], a[116:119], v[112:115], v[32:35]
    v_mfma_f32_16x16x32_bf16 v[52:55], a[116:119], v[116:119], v[52:55]
    v_mfma_f32_16x16x32_bf16 v[72:75], a[116:119], v[120:123], v[72:75]
    v_mfma_f32_16x16x32_bf16 v[92:95], a[116:119], v[124:127], v[92:95]
    s_waitcnt vmcnt(8)
    v_mfma_f32_16x16x32_bf16 v[16:19], a[120:123], v[128:131], v[16:19]
    buffer_load_dwordx4 v[112:115], v7, s[12:15], s44 offen sc1
    v_mfma_f32_16x16x32_bf16 v[36:39], a[120:123], v[132:135], v[36:39]
    buffer_load_dwordx4 v[116:119], v8, s[12:15], s44 offen sc1
    v_mfma_f32_16x16x32_bf16 v[56:59], a[120:123], v[136:139], v[56:59]
    buffer_load_dwordx4 v[120:123], v9, s[12:15], s44 offen sc1
    v_mfma_f32_16x16x32_bf16 v[76:79], a[120:123], v[140:143], v[76:79]
    buffer_load_dwordx4 v[124:127], v10, s[12:15], s44 offen sc1
    v_mfma_f32_16x16x32_bf16 v[20:23], a[124:127], v[128:131], v[20:23]
    s_add_u32 s44, s44, 1024
    v_mfma_f32_16x16x32_bf16 v[40:43], a[124:127], v[132:135], v[40:43]
    v_mfma_f32_16x16x32_bf16 v[60:63], a[124:127], v[136:139], v[60:63]
    v_mfma_f32_16x16x32_bf16 v[80:83], a[124:127], v[140:143], v[80:83]
    v_mfma_f32_16x16x32_bf16 v[24:27], a[128:131], v[128:131], v[24:27]
    v_mfma_f32_16x16x32_bf16 v[44:47], a[128:131], v[132:135], v[44:47]
    v_mfma_f32_16x16x32_bf16 v[64:67], a[128:131], v[136:139], v[64:67]
    v_mfma_f32_16x16x32_bf16 v[84:87], a[128:131], v[140:143], v[84:87]
    v_mfma_f32_16x16x32_bf16 v[28:31], a[132:135], v[128:131], v[28:31]
    v_mfma_f32_16x16x32_bf16 v[48:51], a[132:135], v[132:135], v[48:51]
    v_mfma_f32_16x16x32_bf16 v[68:71], a[132:135], v[136:139], v[68:71]
    v_mfma_f32_16x16x32_bf16 v[88:91], a[132:135], v[140:143], v[88:91]
    v_mfma_f32_16x16x32_bf16 v[32:35], a[136:139], v[128:131], v[32:35]
    v_mfma_f32_16x16x32_bf16 v[52:55], a[136:139], v[132:135], v[52:55]
    v_mfma_f32_16x16x32_bf16 v[72:75], a[136:139], v[136:139], v[72:75]
    v_mfma_f32_16x16x32_bf16 v[92:95], a[136:139], v[140:143], v[92:95]
    s_waitcnt vmcnt(8)
    v_mfma_f32_16x16x32_bf16 v[16:19], a[140:143], v[144:147], v[16:19]
    buffer_load_dwordx2 v[128:129], v224, s[12:15], s44 offen sc1
    v_mfma_f32_16x16x32_bf16 v[36:39], a[140:143], v[148:151], v[36:39]
    buffer_load_dwordx2 v[130:131], v224, s[12:15], s44 offen offset:512 sc1
    v_mfma_f32_16x16x32_bf16 v[56:59], a[140:143], v[152:155], v[56:59]
    buffer_load_dwordx2 v[132:133], v225, s[12:15], s44 offen sc1
    v_mfma_f32_16x16x32_bf16 v[76:79], a[140:143], v[156:159], v[76:79]
    buffer_load_dwordx2 v[134:135], v225, s[12:15], s44 offen offset:512 sc1
    v_mfma_f32_16x16x32_bf16 v[20:23], a[144:147], v[144:147], v[20:23]
    buffer_load_dwordx2 v[136:137], v226, s[12:15], s44 offen sc1
    v_mfma_f32_16x16x32_bf16 v[40:43], a[144:147], v[148:151], v[40:43]
    buffer_load_dwordx2 v[138:139], v226, s[12:15], s44 offen offset:512 sc1
    v_mfma_f32_16x16x32_bf16 v[60:63], a[144:147], v[152:155], v[60:63]
    buffer_load_dwordx2 v[140:141], v227, s[12:15], s44 offen sc1
    v_mfma_f32_16x16x32_bf16 v[80:83], a[144:147], v[156:159], v[80:83]
    buffer_load_dwordx2 v[142:143], v227, s[12:15], s44 offen offset:512 sc1
    v_mfma_f32_16x16x32_bf16 v[24:27], a[148:151], v[144:147], v[24:27]
    s_add_u32 s44, s44, 1024
    v_mfma_f32_16x16x32_bf16 v[44:47], a[148:151], v[148:151], v[44:47]
    v_mfma_f32_16x16x32_bf16 v[64:67], a[148:151], v[152:155], v[64:67]
    v_mfma_f32_16x16x32_bf16 v[84:87], a[148:151], v[156:159], v[84:87]
    v_mfma_f32_16x16x32_bf16 v[28:31], a[152:155], v[144:147], v[28:31]
    v_mfma_f32_16x16x32_bf16 v[48:51], a[152:155], v[148:151], v[48:51]
    v_mfma_f32_16x16x32_bf16 v[68:71], a[152:155], v[152:155], v[68:71]
    v_mfma_f32_16x16x32_bf16 v[88:91], a[152:155], v[156:159], v[88:91]
    v_mfma_f32_16x16x32_bf16 v[32:35], a[156:159], v[144:147], v[32:35]
    v_mfma_f32_16x16x32_bf16 v[52:55], a[156:159], v[148:151], v[52:55]
    v_mfma_f32_16x16x32_bf16 v[72:75], a[156:159], v[152:155], v[72:75]
    v_mfma_f32_16x16x32_bf16 v[92:95], a[156:159], v[156:159], v[92:95]
    s_waitcnt vmcnt(12)
    v_mfma_f32_16x16x32_bf16 v[16:19], a[160:163], v[96:99], v[16:19]
    buffer_load_dwordx4 v[144:147], v7, s[12:15], s44 offen sc1
    v_mfma_f32_16x16x32_bf16 v[36:39], a[160:163], v[100:103], v[36:39]
    buffer_load_dwordx4 v[148:151], v8, s[12:15], s44 offen sc1
    v_mfma_f32_16x16x32_bf16 v[56:59], a[160:163], v[104:107], v[56:59]
    buffer_load_dwordx4 v[152:155], v9, s[12:15], s44 offen sc1
    v_mfma_f32_16x16x32_bf16 v[76:79], a[160:163], v[108:111], v[76:79]
    buffer_load_dwordx4 v[156:159], v10, s[12:15], s44 offen sc1
    v_mfma_f32_16x16x32_bf16 v[20:23], a[164:167], v[96:99], v[20:23]
    s_add_u32 s44, s44, 1024
    v_mfma_f32_16x16x32_bf16 v[40:43], a[164:167], v[100:103], v[40:43]
    v_mfma_f32_16x16x32_bf16 v[60:63], a[164:167], v[104:107], v[60:63]
    v_mfma_f32_16x16x32_bf16 v[80:83], a[164:167], v[108:111], v[80:83]
    v_mfma_f32_16x16x32_bf16 v[24:27], a[168:171], v[96:99], v[24:27]
    v_mfma_f32_16x16x32_bf16 v[44:47], a[168:171], v[100:103], v[44:47]
    v_mfma_f32_16x16x32_bf16 v[64:67], a[168:171], v[104:107], v[64:67]
    v_mfma_f32_16x16x32_bf16 v[84:87], a[168:171], v[108:111], v[84:87]
    v_mfma_f32_16x16x32_bf16 v[28:31], a[172:175], v[96:99], v[28:31]
    v_mfma_f32_16x16x32_bf16 v[48:51], a[172:175], v[100:103], v[48:51]
    v_mfma_f32_16x16x32_bf16 v[68:71], a[172:175], v[104:107], v[68:71]
    v_mfma_f32_16x16x32_bf16 v[88:91], a[172:175], v[108:111], v[88:91]
    v_mfma_f32_16x16x32_bf16 v[32:35], a[176:179], v[96:99], v[32:35]
    v_mfma_f32_16x16x32_bf16 v[52:55], a[176:179], v[100:103], v[52:55]
    v_mfma_f32_16x16x32_bf16 v[72:75], a[176:179], v[104:107], v[72:75]
    v_mfma_f32_16x16x32_bf16 v[92:95], a[176:179], v[108:111], v[92:95]
    s_waitcnt vmcnt(12)
    v_mfma_f32_16x16x32_bf16 v[16:19], a[180:183], v[112:115], v[16:19]
    s_mul_i32 s40, s32, 14
    s_add_u32 s40, s40, 12
    s_cmp_lt_u32 s40, 54
    s_cselect_b32 s47, s44, 0x40000000
    v_mfma_f32_16x16x32_bf16 v[36:39], a[180:183], v[116:119], v[36:39]
    buffer_load_dwordx4 v[96:99], v7, s[12:15], s47 offen sc1
    v_mfma_f32_16x16x32_bf16 v[56:59], a[180:183], v[120:123], v[56:59]
    buffer_load_dwordx4 v[100:103], v8, s[12:15], s47 offen sc1
    v_mfma_f32_16x16x32_bf16 v[76:79], a[180:183], v[124:127], v[76:79]
    buffer_load_dwordx4 v[104:107], v9, s[12:15], s47 offen sc1
    v_mfma_f32_16x16x32_bf16 v[20:23], a[184:187], v[112:115], v[20:23]
    buffer_load_dwordx4 v[108:111], v10, s[12:15], s47 offen sc1
    v_mfma_f32_16x16x32_bf16 v[40:43], a[184:187], v[116:119], v[40:43]
    s_add_u32 s44, s44, 1024
    v_mfma_f32_16x16x32_bf16 v[60:63], a[184:187], v[120:123], v[60:63]
    v_mfma_f32_16x16x32_bf16 v[80:83], a[184:187], v[124:127], v[80:83]
    v_mfma_f32_16x16x32_bf16 v[24:27], a[188:191], v[112:115], v[24:27]
    v_mfma_f32_16x16x32_bf16 v[44:47], a[188:191], v[116:119], v[44:47]
    v_mfma_f32_16x16x32_bf16 v[64:67], a[188:191], v[120:123], v[64:67]
    v_mfma_f32_16x16x32_bf16 v[84:87], a[188:191], v[124:127], v[84:87]
    v_mfma_f32_16x16x32_bf16 v[28:31], a[192:195], v[112:115], v[28:31]
    v_mfma_f32_16x16x32_bf16 v[48:51], a[192:195], v[116:119], v[48:51]
    v_mfma_f32_16x16x32_bf16 v[68:71], a[192:195], v[120:123], v[68:71]
    v_mfma_f32_16x16x32_bf16 v[88:91], a[192:195], v[124:127], v[88:91]
    v_mfma_f32_16x16x32_bf16 v[32:35], a[196:199], v[112:115], v[32:35]
    v_mfma_f32_16x16x32_bf16 v[52:55], a[196:199], v[116:119], v[52:55]
    v_mfma_f32_16x16x32_bf16 v[72:75], a[196:199], v[120:123], v[72:75]
    v_mfma_f32_16x16x32_bf16 v[92:95], a[196:199], v[124:127], v[92:95]
    s_waitcnt vmcnt(8)
    v_mfma_f32_16x16x32_bf16 v[16:19], a[200:203], v[128:131], v[16:19]
    s_mul_i32 s40, s32, 14
    s_add_u32 s40, s40, 13
    s_cmp_lt_u32 s40, 54
    s_cselect_b32 s47, s44, 0x40000000
    v_mfma_f32_16x16x32_bf16 v[36:39], a[200:203], v[132:135], v[36:39]
    buffer_load_dwordx4 v[112:115], v7, s[12:15], s47 offen sc1
    v_mfma_f32_16x16x32_bf16 v[56:59], a[200:203], v[136:139], v[56:59]
    buffer_load_dwordx4 v[116:119], v8, s[12:15], s47 offen sc1
    v_mfma_f32_16x16x32_bf16 v[76:79], a[200:203], v[140:143], v[76:79]
    buffer_load_dwordx4 v[120:123], v9, s[12:15], s47 offen sc1
    v_mfma_f32_16x16x32_bf16 v[20:23], a[204:207], v[128:131], v[20:23]
    buffer_load_dwordx4 v[124:127], v10, s[12:15], s47 offen sc1
    v_mfma_f32_16x16x32_bf16 v[40:43], a[204:207], v[132:135], v[40:43]
    v_mfma_f32_16x16x32_bf16 v[60:63], a[204:207], v[136:139], v[60:63]
    v_mfma_f32_16x16x32_bf16 v[80:83], a[204:207], v[140:143], v[80:83]
    v_mfma_f32_16x16x32_bf16 v[24:27], a[208:211], v[128:131], v[24:27]
    v_mfma_f32_16x16x32_bf16 v[44:47], a[208:211], v[132:135], v[44:47]
    v_mfma_f32_16x16x32_bf16 v[64:67], a[208:211], v[136:139], v[64:67]
    v_mfma_f32_16x16x32_bf16 v[84:87], a[208:211], v[140:143], v[84:87]
    v_mfma_f32_16x16x32_bf16 v[28:31], a[212:215], v[128:131], v[28:31]
    v_mfma_f32_16x16x32_bf16 v[48:51], a[212:215], v[132:135], v[48:51]
    v_mfma_f32_16x16x32_bf16 v[68:71], a[212:215], v[136:139], v[68:71]
    v_mfma_f32_16x16x32_bf16 v[88:91], a[212:215], v[140:143], v[88:91]
    v_mfma_f32_16x16x32_bf16 v[32:35], a[216:219], v[128:131], v[32:35]
    v_mfma_f32_16x16x32_bf16 v[52:55], a[216:219], v[132:135], v[52:55]
    v_mfma_f32_16x16x32_bf16 v[72:75], a[216:219], v[136:139], v[72:75]
    v_mfma_f32_16x16x32_bf16 v[92:95], a[216:219], v[140:143], v[92:95]
    s_waitcnt vmcnt(8)
    v_mfma_f32_16x16x32_bf16 v[16:19], a[220:223], v[144:147], v[16:19]
    v_mfma_f32_16x16x32_bf16 v[36:39], a[220:223], v[148:151], v[36:39]
    v_mfma_f32_16x16x32_bf16 v[56:59], a[220:223], v[152:155], v[56:59]
    v_mfma_f32_16x16x32_bf16 v[76:79], a[220:223], v[156:159], v[76:79]
    v_mfma_f32_16x16x32_bf16 v[20:23], a[224:227], v[144:147], v[20:23]
    v_mfma_f32_16x16x32_bf16 v[40:43], a[224:227], v[148:151], v[40:43]
    v_mfma_f32_16x16x32_bf16 v[60:63], a[224:227], v[152:155], v[60:63]
    v_mfma_f32_16x16x32_bf16 v[80:83], a[224:227], v[156:159], v[80:83]
    v_mfma_f32_16x16x32_bf16 v[24:27], a[228:231], v[144:147], v[24:27]
    v_mfma_f32_16x16x32_bf16 v[44:47], a[228:231], v[148:151], v[44:47]
    v_mfma_f32_16x16x32_bf16 v[64:67], a[228:231], v[152:155], v[64:67]
    v_mfma_f32_16x16x32_bf16 v[84:87], a[228:231], v[156:159], v[84:87]
    v_mfma_f32_16x16x32_bf16 v[28:31], a[232:235], v[144:147], v[28:31]
    v_mfma_f32_16x16x32_bf16 v[48:51], a[232:235], v[148:151], v[48:51]
    v_mfma_f32_16x16x32_bf16 v[68:71], a[232:235], v[152:155], v[68:71]
    v_mfma_f32_16x16x32_bf16 v[88:91], a[232:235], v[156:159], v[88:91]
    v_mfma_f32_16x16x32_bf16 v[32:35], a[236:239], v[144:147], v[32:35]
    v_mfma_f32_16x16x32_bf16 v[52:55], a[236:239], v[148:151], v[52:55]
    v_mfma_f32_16x16x32_bf16 v[72:75], a[236:239], v[152:155], v[72:75]
    v_mfma_f32_16x16x32_bf16 v[92:95], a[236:239], v[156:159], v[92:95]
    s_waitcnt vmcnt(4)
    v_mfma_f32_16x16x32_bf16 v[16:19], v[184:187], v[96:99], v[16:19]
    v_mfma_f32_16x16x32_bf16 v[36:39], v[184:187], v[100:103], v[36:39]
    v_mfma_f32_16x16x32_bf16 v[56:59], v[184:187], v[104:107], v[56:59]
    v_mfma_f32_16x16x32_bf16 v[76:79], v[184:187], v[108:111], v[76:79]
    v_mfma_f32_16x16x32_bf16 v[20:23], v[188:191], v[96:99], v[20:23]
    v_mfma_f32_16x16x32_bf16 v[40:43], v[188:191], v[100:103], v[40:43]
    v_mfma_f32_16x16x32_bf16 v[60:63], v[188:191], v[104:107], v[60:63]
    v_mfma_f32_16x16x32_bf16 v[80:83], v[188:191], v[108:111], v[80:83]
    v_mfma_f32_16x16x32_bf16 v[24:27], v[192:195], v[96:99], v[24:27]
    v_mfma_f32_16x16x32_bf16 v[44:47], v[192:195], v[100:103], v[44:47]
    v_mfma_f32_16x16x32_bf16 v[64:67], v[192:195], v[104:107], v[64:67]
    v_mfma_f32_16x16x32_bf16 v[84:87], v[192:195], v[108:111], v[84:87]
    v_mfma_f32_16x16x32_bf16 v[28:31], v[196:199], v[96:99], v[28:31]
    v_mfma_f32_16x16x32_bf16 v[48:51], v[196:199], v[100:103], v[48:51]
    v_mfma_f32_16x16x32_bf16 v[68:71], v[196:199], v[104:107], v[68:71]
    v_mfma_f32_16x16x32_bf16 v[88:91], v[196:199], v[108:111], v[88:91]
    v_mfma_f32_16x16x32_bf16 v[32:35], v[200:203], v[96:99], v[32:35]
    v_mfma_f32_16x16x32_bf16 v[52:55], v[200:203], v[100:103], v[52:55]
    v_mfma_f32_16x16x32_bf16 v[72:75], v[200:203], v[104:107], v[72:75]
    v_mfma_f32_16x16x32_bf16 v[92:95], v[200:203], v[108:111], v[92:95]
    s_waitcnt vmcnt(0)
    s_add_u32 s40, s32, 1
    s_and_b32 s40, s40, 3
    s_mul_i32 s40, s40, 15360
    s_add_u32 s40, s40, 98304
    v_add_u32 v12, s40, v1
    s_add_u32 s40, s32, 2
    s_and_b32 s40, s40, 3
    s_mul_i32 s40, s40, 15360
    s_add_u32 s40, s40, 103424
    v_add_u32 v13, s40, v1
    s_add_u32 s40, s32, 3
    s_and_b32 s40, s40, 3
    s_mul_i32 s40, s40, 15360
    s_add_u32 s40, s40, 108544
    v_add_u32 v14, s40, v1
    s_mul_i32 s40, s32, 15360
    s_add_u32 s40, s40, 98304
    v_add_u32 v11, s40, v1
    v_mfma_f32_16x16x32_bf16 v[36:39], v[204:207], v[116:119], v[36:39]
    v_mfma_f32_16x16x32_bf16 v[40:43], v[208:211], v[116:119], v[40:43]
    v_mfma_f32_16x16x32_bf16 v[44:47], v[212:215], v[116:119], v[44:47]
    v_mfma_f32_16x16x32_bf16 v[48:51], v[216:219], v[116:119], v[48:51]
    v_mfma_f32_16x16x32_bf16 v[52:55], v[220:223], v[116:119], v[52:55]
    v_mfma_f32_16x16x32_bf16 v[56:59], v[204:207], v[120:123], v[56:59]
    v_mfma_f32_16x16x32_bf16 v[60:63], v[208:211], v[120:123], v[60:63]
    v_mfma_f32_16x16x32_bf16 v[64:67], v[212:215], v[120:123], v[64:67]
    v_mfma_f32_16x16x32_bf16 v[68:71], v[216:219], v[120:123], v[68:71]
    ds_write_b128 v12, v[36:39] offset:0
    v_mfma_f32_16x16x32_bf16 v[72:75], v[220:223], v[120:123], v[72:75]
    ds_write_b128 v12, v[40:43] offset:1024
    v_mfma_f32_16x16x32_bf16 v[76:79], v[204:207], v[124:127], v[76:79]
    ds_write_b128 v12, v[44:47] offset:2048
    v_mfma_f32_16x16x32_bf16 v[80:83], v[208:211], v[124:127], v[80:83]
    ds_write_b128 v12, v[48:51] offset:3072
    v_mfma_f32_16x16x32_bf16 v[84:87], v[212:215], v[124:127], v[84:87]
    ds_write_b128 v12, v[52:55] offset:4096
    v_mfma_f32_16x16x32_bf16 v[88:91], v[216:219], v[124:127], v[88:91]
    ds_write_b128 v13, v[56:59] offset:0
    v_mfma_f32_16x16x32_bf16 v[92:95], v[220:223], v[124:127], v[92:95]
    ds_write_b128 v13, v[60:63] offset:1024
    v_mfma_f32_16x16x32_bf16 v[16:19], v[204:207], v[112:115], v[16:19]
    ds_write_b128 v13, v[64:67] offset:2048
    v_mfma_f32_16x16x32_bf16 v[20:23], v[208:211], v[112:115], v[20:23]
    ds_write_b128 v13, v[68:71] offset:3072
    v_mfma_f32_16x16x32_bf16 v[24:27], v[212:215], v[112:115], v[24:27]
    ds_write_b128 v13, v[72:75] offset:4096
    v_mfma_f32_16x16x32_bf16 v[28:31], v[216:219], v[112:115], v[28:31]
    ds_write_b128 v14, v[76:79] offset:0
    v_mfma_f32_16x16x32_bf16 v[32:35], v[220:223], v[112:115], v[32:35]
    ds_write_b128 v14, v[80:83] offset:1024
    s_nop 3
    ds_write_b128 v14, v[84:87] offset:2048
    ds_write_b128 v14, v[88:91] offset:3072
    ds_write_b128 v14, v[92:95] offset:4096
    s_waitcnt lgkmcnt(0)
    s_barrier
    ds_read_b128 v[36:39], v11 offset:0
    ds_read_b128 v[40:43], v11 offset:1024
    ds_read_b128 v[44:47], v11 offset:2048
    ds_read_b128 v[48:51], v11 offset:3072
    ds_read_b128 v[52:55], v11 offset:4096
    ds_read_b128 v[56:59], v11 offset:5120
    ds_read_b128 v[60:63], v11 offset:6144
    ds_read_b128 v[64:67], v11 offset:7168
    ds_read_b128 v[68:71], v11 offset:8192
    ds_read_b128 v[72:75], v11 offset:9216
    ds_read_b128 v[76:79], v11 offset:10240
    ds_read_b128 v[80:83], v11 offset:11264
    ds_read_b128 v[84:87], v11 offset:12288
    ds_read_b128 v[88:91], v11 offset:13312
    ds_read_b128 v[92:95], v11 offset:14336
    v_lshlrev_b32 v12, 4, v4
    v_add_u32 v12, 161280, v12
    ds_read_b128 v[96:99], v12 offset:0
    ds_read_b128 v[100:103], v12 offset:64
    ds_read_b128 v[104:107], v12 offset:128
    ds_read_b128 v[108:111], v12 offset:192
    ds_read_b128 v[112:115], v12 offset:256
    v_lshlrev_b32 v116, 16, v242
    v_and_b32 v117, 0xffff0000, v242
    v_lshlrev_b32 v118, 16, v243
    v_and_b32 v119, 0xffff0000, v243
    v_lshlrev_b32 v120, 16, v244
    v_and_b32 v121, 0xffff0000, v244
    v_lshlrev_b32 v122, 16, v245
    v_and_b32 v123, 0xffff0000, v245
    v_lshlrev_b32 v124, 16, v246
    v_and_b32 v125, 0xffff0000, v246
    v_lshlrev_b32 v126, 16, v247
    v_and_b32 v127, 0xffff0000, v247
    v_lshlrev_b32 v128, 16, v248
    v_and_b32 v129, 0xffff0000, v248
    v_lshlrev_b32 v130, 16, v249
    v_and_b32 v131, 0xffff0000, v249
    v_lshlrev_b32 v132, 16, v250
    v_and_b32 v133, 0xffff0000, v250
    v_lshlrev_b32 v134, 16, v251
    v_and_b32 v135, 0xffff0000, v251
    v_lshlrev_b32 v136, 16, v232
    v_and_b32 v137, 0xffff0000, v232
    v_lshlrev_b32 v138, 16, v233
    v_and_b32 v139, 0xffff0000, v233
    v_lshlrev_b32 v140, 16, v234
    v_and_b32 v141, 0xffff0000, v234
    v_lshlrev_b32 v142, 16, v235
    v_and_b32 v143, 0xffff0000, v235
    v_lshlrev_b32 v144, 16, v236
    v_and_b32 v145, 0xffff0000, v236
    v_lshlrev_b32 v146, 16, v237
    v_and_b32 v147, 0xffff0000, v237
    v_lshlrev_b32 v148, 16, v238
    v_and_b32 v149, 0xffff0000, v238
    v_lshlrev_b32 v150, 16, v239
    v_and_b32 v151, 0xffff0000, v239
    v_lshlrev_b32 v152, 16, v240
    v_and_b32 v153, 0xffff0000, v240
    v_lshlrev_b32 v154, 16, v241
    v_and_b32 v155, 0xffff0000, v241
    s_waitcnt lgkmcnt(15)
    v_pk_add_f32 v[16:17], v[16:17], v[36:37]
    v_pk_add_f32 v[18:19], v[18:19], v[38:39]
    v_pk_add_f32 v[20:21], v[20:21], v[40:41]
    v_pk_add_f32 v[22:23], v[22:23], v[42:43]
    v_pk_add_f32 v[24:25], v[24:25], v[44:45]
    v_pk_add_f32 v[26:27], v[26:27], v[46:47]
    v_pk_add_f32 v[28:29], v[28:29], v[48:49]
    v_pk_add_f32 v[30:31], v[30:31], v[50:51]
    v_pk_add_f32 v[32:33], v[32:33], v[52:53]
    v_pk_add_f32 v[34:35], v[34:35], v[54:55]
    s_waitcnt lgkmcnt(10)
    v_pk_add_f32 v[16:17], v[16:17], v[56:57]
    v_pk_add_f32 v[18:19], v[18:19], v[58:59]
    v_pk_add_f32 v[20:21], v[20:21], v[60:61]
    v_pk_add_f32 v[22:23], v[22:23], v[62:63]
    v_pk_add_f32 v[24:25], v[24:25], v[64:65]
    v_pk_add_f32 v[26:27], v[26:27], v[66:67]
    v_pk_add_f32 v[28:29], v[28:29], v[68:69]
    v_pk_add_f32 v[30:31], v[30:31], v[70:71]
    v_pk_add_f32 v[32:33], v[32:33], v[72:73]
    v_pk_add_f32 v[34:35], v[34:35], v[74:75]
    s_waitcnt lgkmcnt(5)
    v_pk_add_f32 v[16:17], v[16:17], v[76:77]
    v_pk_add_f32 v[18:19], v[18:19], v[78:79]
    v_pk_add_f32 v[20:21], v[20:21], v[80:81]
    v_pk_add_f32 v[22:23], v[22:23], v[82:83]
    v_pk_add_f32 v[24:25], v[24:25], v[84:85]
    v_pk_add_f32 v[26:27], v[26:27], v[86:87]
    v_pk_add_f32 v[28:29], v[28:29], v[88:89]
    v_pk_add_f32 v[30:31], v[30:31], v[90:91]
    v_pk_add_f32 v[32:33], v[32:33], v[92:93]
    v_pk_add_f32 v[34:35], v[34:35], v[94:95]
    v_pk_add_f32 v[116:117], v[116:117], v[16:17]
    v_pk_add_f32 v[118:119], v[118:119], v[18:19]
    v_pk_add_f32 v[120:121], v[120:121], v[20:21]
    v_pk_add_f32 v[122:123], v[122:123], v[22:23]
    v_pk_add_f32 v[124:125], v[124:125], v[24:25]
    v_pk_add_f32 v[126:127], v[126:127], v[26:27]
    v_pk_add_f32 v[128:129], v[128:129], v[28:29]
    v_pk_add_f32 v[130:131], v[130:131], v[30:31]
    v_pk_add_f32 v[132:133], v[132:133], v[32:33]
    v_pk_add_f32 v[134:135], v[134:135], v[34:35]
    s_waitcnt lgkmcnt(0)
    v_pk_fma_f32 v[116:117], v[116:117], v[96:97], v[136:137]
    v_pk_fma_f32 v[118:119], v[118:119], v[98:99], v[138:139]
    v_pk_fma_f32 v[120:121], v[120:121], v[100:101], v[140:141]
    v_pk_fma_f32 v[122:123], v[122:123], v[102:103], v[142:143]
    v_pk_fma_f32 v[124:125], v[124:125], v[104:105], v[144:145]
    v_pk_fma_f32 v[126:127], v[126:127], v[106:107], v[146:147]
    v_pk_fma_f32 v[128:129], v[128:129], v[108:109], v[148:149]
    v_pk_fma_f32 v[130:131], v[130:131], v[110:111], v[150:151]
    v_pk_fma_f32 v[132:133], v[132:133], v[112:113], v[152:153]
    v_pk_fma_f32 v[134:135], v[134:135], v[114:115], v[154:155]
    v_cvt_pk_bf16_f32 v36, v116, v117
    v_cvt_pk_bf16_f32 v37, v118, v119
    v_cvt_pk_bf16_f32 v38, v120, v121
    v_cvt_pk_bf16_f32 v39, v122, v123
    v_cvt_pk_bf16_f32 v40, v124, v125
    v_cvt_pk_bf16_f32 v41, v126, v127
    v_cvt_pk_bf16_f32 v42, v128, v129
    v_cvt_pk_bf16_f32 v43, v130, v131
    v_cvt_pk_bf16_f32 v44, v132, v133
    v_cvt_pk_bf16_f32 v45, v134, v135
    buffer_store_dwordx2 v[36:37], v6, s[24:27], 0 offen offset:0
    buffer_store_dwordx2 v[38:39], v6, s[24:27], 0 offen offset:32
    buffer_store_dwordx2 v[40:41], v6, s[24:27], 0 offen offset:64
    buffer_store_dwordx2 v[42:43], v6, s[24:27], 0 offen offset:96
    buffer_store_dwordx2 v[44:45], v6, s[24:27], 0 offen offset:128
kb_end:
    s_endpgm
code_end:
.section .rodata,"a"
.p2align 6
.amdhsa_kernel k0_kernel
  .amdhsa_next_free_vgpr 160
  .amdhsa_next_free_sgpr 48
  .amdhsa_accum_offset 160
  .amdhsa_group_segment_fixed_size 0
  .amdhsa_kernarg_size 120
  .amdhsa_user_sgpr_count 2
  .amdhsa_user_sgpr_kernarg_segment_ptr 1
  .amdhsa_system_sgpr_workgroup_id_x 1
  .amdhsa_float_denorm_mode_32 3
.end_amdhsa_kernel
.p2align 6
.amdhsa_kernel ka_kernel
  .amdhsa_next_free_vgpr 508
  .amdhsa_next_free_sgpr 84
  .amdhsa_accum_offset 256
  .amdhsa_group_segment_fixed_size 0
  .amdhsa_kernarg_size 120
  .amdhsa_user_sgpr_count 2
  .amdhsa_user_sgpr_kernarg_segment_ptr 1
  .amdhsa_system_sgpr_workgroup_id_x 1
  .amdhsa_float_denorm_mode_32 3
.end_amdhsa_kernel
.p2align 6
.amdhsa_kernel kb_kernel
  .amdhsa_next_free_vgpr 496
  .amdhsa_next_free_sgpr 70
  .amdhsa_accum_offset 256
  .amdhsa_group_segment_fixed_size 0
  .amdhsa_kernarg_size 120
  .amdhsa_user_sgpr_count 2
  .amdhsa_user_sgpr_kernarg_segment_ptr 1
  .amdhsa_system_sgpr_workgroup_id_x 1
  .amdhsa_float_denorm_mode_32 3
.end_amdhsa_kernel
.p2align 6
```
